```python
import torch

def _softmax(x, axis=-1):
    return torch.softmax(x, dim=axis)
def _gelu(x):
    return torch.nn.functional.gelu(x, approximate="tanh")
def _silu(x):
    return torch.nn.functional.silu(x)
def _sigmoid(x):
    return torch.sigmoid(x)
def _layernorm(x, axis=-1, eps=1e-5):
    m = x.mean(dim=axis, keepdim=True)
    v = x.var(dim=axis, keepdim=True, unbiased=False)
    return (x - m) / torch.sqrt(v + eps)
def _scatter_add(tgt, idx, src, axis=0):
    return tgt.clone().index_add_(axis, idx, src)
def _segment_sum(src, seg, n):
    out = torch.zeros((n,) + src.shape[1:], dtype=src.dtype)
    return out.index_add_(0, seg, src)
def _pad(x, pw):
    flat = tuple(v for pair in reversed(pw) for v in pair)
    return torch.nn.functional.pad(x, flat)

kernel_name = 'concat_heads__grouped_kv_mqa__compressed_kv_cla__prompt'

def setup_inputs():

    _w = (lambda a: (lambda t: t.to(torch.bfloat16) if t.is_floating_point() else t)(torch.as_tensor(a)))
    def _A_setup():
        B, S, D, H = 1, 2048, 576, 32
        Dh = D // H
        return {
            "x": _w((lambda *s: torch.randn(*s, dtype=torch.bfloat16) * 0.05)(B, S, D)),
            "wq": _w((lambda *s: torch.randn(*s, dtype=torch.bfloat16) * 0.8)(D, H * Dh)),
            "wk": _w((lambda *s: torch.randn(*s, dtype=torch.bfloat16) * 0.8)(D, Dh)),
            "wv": _w((lambda *s: torch.randn(*s, dtype=torch.bfloat16) * 0.05)(D, Dh)),
            "wo": _w((lambda *s: torch.randn(*s, dtype=torch.bfloat16) * 0.05)(H * Dh, D)),
        }
    _A_in = _A_setup()

    def _B_setup():
        B, H, Sq, Sk, D, M = 1, 32, 2048, 2048, 128, 576
        Dc = 4 * D
        return {
            "x": _w((lambda *s: torch.randn(*s, dtype=torch.bfloat16) * 3.2)(B, Sq, M)),
            "c_kv": _w((lambda *s: torch.randn(*s, dtype=torch.bfloat16) * 0.1)(B, Sk, Dc)),
            "w_q": _w((lambda *s: torch.randn(*s, dtype=torch.bfloat16) * 6.4)(M, H, D) * (M ** -0.5)),
            "w_uk": _w((lambda *s: torch.randn(*s, dtype=torch.bfloat16) * 6.4)(Dc, H, D) * (Dc ** -0.5)),
            "w_uv": _w((lambda *s: torch.randn(*s, dtype=torch.bfloat16) * 0.1)(Dc, H, D) * (Dc ** -0.5)),
            "w_o": _w((lambda *s: torch.randn(*s, dtype=torch.bfloat16) * 0.1)(H, D, M) * ((H * D) ** -0.5)),
        }
    _B_in = _B_setup()

    return {
        "A_x": _A_in["x"],
        "A_wq": _A_in["wq"],
        "A_wk": _A_in["wk"],
        "A_wv": _A_in["wv"],
        "A_wo": _A_in["wo"],
        "B_x": _B_in["x"],
        "B_c_kv": _B_in["c_kv"],
        "B_w_q": _B_in["w_q"],
        "B_w_uk": _B_in["w_uk"],
        "B_w_uv": _B_in["w_uv"],
        "B_w_o": _B_in["w_o"],
    }

def reference(A_x, A_wq, A_wk, A_wv, A_wo, B_x, B_c_kv, B_w_q, B_w_uk, B_w_uv, B_w_o):
    def _A_ref(x, wq, wk, wv, wo):
        B, S, D = x.shape
        H = 32
        Dh = D // H
        q = (lambda x, *d: x.permute(*d))((x @ wq).reshape(B, S, H, Dh), 0, 2, 1, 3)
        k = x @ wk
        v = x @ wv
        scores = torch.einsum("bhqd,bkd->bhqk", q, k) * (Dh ** -0.5)
        p = _softmax(scores, axis=-1)
        o = torch.einsum("bhqk,bkd->bhqd", p, v)
        return (lambda x, *d: x.permute(*d))(o, 0, 2, 1, 3).reshape(B, S, H * Dh) @ wo

    def _B_ref(x, c_kv, w_q, w_uk, w_uv, w_o):
        B, Sq, M = x.shape[0], x.shape[1], x.shape[2]
        Sk = c_kv.shape[1]
        H, D = w_q.shape[1], w_q.shape[2]
        q = torch.einsum("bqm,mhd->bhqd", x, w_q)
        k = torch.einsum("bkc,chd->bhkd", c_kv, w_uk)
        v = torch.einsum("bkc,chd->bhkd", c_kv, w_uv)
        scores = torch.einsum("bhqd,bhkd->bhqk", q, k) * (D ** -0.5)
        off = Sk - Sq
        qi = torch.arange(Sq)[:, None]
        kj = torch.arange(Sk)[None, :]
        cmask = kj <= (qi + off)
        scores = torch.where(cmask[None, None], scores, -1e9)
        p = _softmax(scores, axis=-1)
        ctx = torch.einsum("bhqk,bhkd->bhqd", p, v)
        return torch.einsum("bhqd,hdm->bqm", ctx, w_o)

    a = _A_ref(A_x, A_wq, A_wk, A_wv, A_wo)
    b = _B_ref(B_x, B_c_kv, B_w_q, B_w_uk, B_w_uv, B_w_o)
    return torch.concatenate([a, b], axis=-1)
```

```asm
; @launch grid=(256,1,1) block=(512,1,1) lds=163840
.amdgcn_target "amdgcn-amd-amdhsa--gfx950"
.text
.globl concat_heads__grouped_kv_mqa__compressed_kv_cla__prompt_kernel
.p2align 8
.type concat_heads__grouped_kv_mqa__compressed_kv_cla__prompt_kernel,@function
concat_heads__grouped_kv_mqa__compressed_kv_cla__prompt_kernel:
    s_cmp_ge_u32 s2, 256
    s_cbranch_scc1 DONE_1
    s_load_dwordx16 s[16:31], s[0:1], 0
    s_load_dwordx8 s[32:39], s[0:1], 64
    s_load_dwordx4 s[40:43], s[0:1], 96
    v_lshrrev_b32 v2, 6, v0
    v_and_b32 v1, 63, v0
    s_nop 0
    v_readfirstlane_b32 s64, v2
    s_waitcnt lgkmcnt(0)
    s_mov_b32 s4, s40
    s_and_b32 s5, s41, 0xffff
    s_mov_b32 s6, 256
    s_mov_b32 s7, 0x00020000
    s_memrealtime s[14:15]
    s_waitcnt lgkmcnt(0)
    s_cmp_lg_u32 s64, 4
    s_cbranch_scc1 SY_2
    s_not_b64 s[12:13], s[14:15]
    v_mov_b32 v2, s12
    v_mov_b32 v3, s13
    v_mov_b32 v4, 248
    s_mov_b64 exec, 1
    buffer_atomic_umax_x2 v[2:3], v4, s[4:7], 0 offen
    s_mov_b64 exec, -1
SY_2:
    s_add_u32 s14, s14, 250
    s_addc_u32 s15, s15, 0
L_P0:
    s_getpc_b64 s[12:13]
CWH_3:
    s_add_u32 s12, s12, L_P0X-CWH_3
    s_addc_u32 s13, s13, 0
    s_mul_i32 s8, s64, 64
    v_min_u32 v250, 63, v1
    v_add_u32 v250, s8, v250
    v_lshlrev_b32 v250, 7, v250
    v_min_u32 v250, L_P2-L_P0X-4, v250
    global_load_dword v251, v250, s[12:13]
L_P0X:
    v_mov_b32 v108, -1
    v_mov_b32 v109, -1
    s_cmp_ge_u32 s2, 144
    s_cbranch_scc1 F_OLD_6
    s_mov_b32 s44, s28
    s_and_b32 s45, s29, 0xffff
    s_mov_b32 s46, 2097152
    s_mov_b32 s47, 0x00020000
    s_mov_b32 s48, s32
    s_and_b32 s49, s33, 0xffff
    s_mov_b32 s50, 4194304
    s_mov_b32 s51, 0x00020000
    s_mov_b32 s52, s34
    s_and_b32 s53, s35, 0xffff
    s_mov_b32 s54, 4194304
    s_mov_b32 s55, 0x00020000
    s_mov_b32 s56, s42
    s_and_b32 s57, s43, 0xffff
    s_mov_b32 s58, 268435456
    s_mov_b32 s59, 0x00020000
    s_and_b32 s66, s2, 31
    s_lshr_b32 s67, s2, 5
    v_lshrrev_b32 v11, 3, v1
    s_lshl_b32 s69, s67, 8
    s_lshl_b32 s70, s64, 5
    s_add_u32 s69, s69, s70
    v_add_u32 v11, s69, v11
    v_lshlrev_b32 v11, 10, v11
    v_lshrrev_b32 v12, 4, v1
    v_and_b32 v13, 7, v1
    v_xor_b32 v14, v13, v12
    v_lshl_add_u32 v2, v14, 4, v11
    v_xor_b32 v14, 4, v14
    v_lshl_add_u32 v3, v14, 4, v11
    v_add_u32 v3, 8192, v3
    v_and_b32 v13, 15, v1
    v_lshlrev_b32 v14, 2, v12
    v_xor_b32 v13, v13, v14
    v_lshlrev_b32 v13, 4, v13
    v_lshl_add_u32 v4, v12, 13, v13
    s_lshl_b32 s69, s66, 8
    v_add_u32 v4, s69, v4
    v_and_b32 v11, 31, v1
    s_and_b32 s69, s64, 1
    s_lshl_b32 s69, s69, 7
    v_add_u32 v12, s69, v11
    v_lshlrev_b32 v12, 7, v12
    v_bfe_u32 v13, v1, 1, 3
    v_lshrrev_b32 v14, 5, v1
    v_add_u32 v15, 0, v14
    v_xor_b32 v15, v15, v13
    v_lshl_add_u32 v5, v15, 4, v12
    v_add_u32 v15, 2, v14
    v_xor_b32 v15, v15, v13
    v_lshl_add_u32 v6, v15, 4, v12
    v_add_u32 v15, 4, v14
    v_xor_b32 v15, v15, v13
    v_lshl_add_u32 v7, v15, 4, v12
    v_add_u32 v15, 6, v14
    v_xor_b32 v15, v15, v13
    v_lshl_add_u32 v8, v15, 4, v12
    v_bfe_u32 v11, v1, 2, 2
    v_lshrrev_b32 v12, 5, v1
    v_lshl_add_u32 v12, v12, 3, v11
    v_lshlrev_b32 v12, 8, v12
    v_bfe_u32 v13, v1, 4, 1
    v_bfe_u32 v14, v1, 1, 1
    v_lshl_add_u32 v13, v13, 1, v14
    v_lshl_add_u32 v12, v13, 4, v12
    v_and_b32 v13, 1, v1
    v_lshl_add_u32 v12, v13, 3, v12
    s_lshr_b32 s69, s64, 2
    s_lshl_b32 s69, s69, 14
    s_add_u32 s69, s69, 32768
    v_add_u32 v12, s69, v12
    s_and_b32 s69, s64, 2
    s_add_u32 s70, s69, 0
    v_xor_b32 v13, s70, v11
    v_lshl_add_u32 v9, v13, 6, v12
    s_add_u32 s70, s69, 1
    v_xor_b32 v13, s70, v11
    v_lshl_add_u32 v10, v13, 6, v12
    s_lshl_b32 s75, s64, 12
    s_lshl_b32 s76, s64, 11
    s_add_u32 s76, s76, 32768
    s_lshl_b32 s74, s64, 16
    s_mov_b32 s73, 0
    s_mov_b32 s60, s16
    s_and_b32 s61, s17, 0xffff
    s_mov_b32 s62, 2359296
    s_mov_b32 s63, 0x00020000
    s_mov_b32 s84, s18
    s_and_b32 s85, s19, 0xffff
    s_mov_b32 s86, 663552
    s_mov_b32 s87, 0x00020000
    s_lshr_b32 s79, s2, 3
    s_and_b32 s78, s2, 7
    s_lshl_b32 s78, s78, 1
    s_cmp_ge_u32 s79, 9
    s_cselect_b32 s80, 1, 0
    s_add_u32 s78, s78, s80
    s_mul_i32 s80, s80, 9
    s_sub_u32 s79, s79, s80
    v_lshrrev_b32 v96, 3, v1
    s_lshl_b32 s80, s78, 7
    s_lshl_b32 s81, s64, 4
    s_add_u32 s80, s80, s81
    v_add_u32 v96, s80, v96
    v_mul_u32_u24 v96, 1152, v96
    v_lshrrev_b32 v97, 4, v1
    v_and_b32 v98, 7, v1
    v_xor_b32 v99, v98, v97
    v_lshl_add_u32 v80, v99, 4, v96
    v_xor_b32 v99, 4, v99
    v_lshl_add_u32 v81, v99, 4, v96
    v_add_u32 v81, 9216, v81
    v_lshrrev_b32 v96, 3, v1
    s_lshl_b32 s80, s64, 3
    v_add_u32 v96, s80, v96
    v_mul_u32_u24 v96, 1152, v96
    v_bfe_u32 v97, v1, 4, 1
    v_lshlrev_b32 v97, 2, v97
    v_xor_b32 v97, v97, v98
    v_lshl_add_u32 v82, v97, 4, v96
    s_lshl_b32 s80, s79, 7
    v_add_u32 v82, s80, v82
    v_and_b32 v96, 31, v1
    s_and_b32 s80, s64, 3
    s_lshl_b32 s80, s80, 5
    v_add_u32 v97, s80, v96
    v_lshlrev_b32 v97, 7, v97
    v_add_u32 v97, 65536, v97
    v_bfe_u32 v98, v1, 1, 3
    v_lshrrev_b32 v99, 5, v1
    v_add_u32 v100, 0, v99
    v_xor_b32 v100, v100, v98
    v_lshl_add_u32 v84, v100, 4, v97
    v_add_u32 v88, 49152, v84
    v_add_u32 v100, 2, v99
    v_xor_b32 v100, v100, v98
    v_lshl_add_u32 v85, v100, 4, v97
    v_add_u32 v89, 49152, v85
    v_add_u32 v100, 4, v99
    v_xor_b32 v100, v100, v98
    v_lshl_add_u32 v86, v100, 4, v97
    v_add_u32 v90, 49152, v86
    v_add_u32 v100, 6, v99
    v_xor_b32 v100, v100, v98
    v_lshl_add_u32 v87, v100, 4, v97
    v_add_u32 v91, 49152, v87
    v_bfe_u32 v96, v1, 2, 2
    v_lshrrev_b32 v97, 5, v1
    v_lshl_add_u32 v97, v97, 3, v96
    v_lshlrev_b32 v97, 7, v97
    v_bfe_u32 v98, v1, 4, 1
    v_bfe_u32 v99, v1, 1, 1
    v_lshl_add_u32 v98, v98, 1, v99
    s_lshr_b32 s80, s64, 2
    s_lshl_b32 s80, s80, 2
    v_add_u32 v98, s80, v98
    v_bfe_u32 v99, v1, 3, 1
    v_lshlrev_b32 v99, 2, v99
    v_xor_b32 v98, v98, v99
    v_lshl_add_u32 v97, v98, 4, v97
    v_and_b32 v98, 1, v1
    v_lshl_add_u32 v83, v98, 3, v97
    v_add_u32 v83, 81920, v83
    v_add_u32 v92, 49152, v83
    s_lshl_b32 s82, s64, 11
    s_add_u32 s82, s82, 65536
    s_lshl_b32 s83, s64, 10
    s_add_u32 s83, s83, 81920
    s_mov_b32 s80, 0
    s_add_u32 m0, s82, 0
    s_nop 0
    buffer_load_dwordx4 v80, s[60:63], s80 offen lds
    s_add_u32 m0, s82, 1024
    s_nop 0
    buffer_load_dwordx4 v81, s[60:63], s80 offen lds
    s_add_u32 m0, s83, 0
    s_mov_b32 s80, 0
    buffer_load_dwordx4 v82, s[84:87], s80 offen lds
    s_mov_b32 s80, 128
    s_add_u32 m0, s82, 24576
    s_nop 0
    buffer_load_dwordx4 v80, s[60:63], s80 offen lds
    s_add_u32 m0, s82, 25600
    s_nop 0
    buffer_load_dwordx4 v81, s[60:63], s80 offen lds
    s_add_u32 m0, s83, 24576
    s_mov_b32 s80, 73728
    buffer_load_dwordx4 v82, s[84:87], s80 offen lds
    s_mov_b32 s80, 256
    s_add_u32 m0, s82, 49152
    s_nop 0
    buffer_load_dwordx4 v80, s[60:63], s80 offen lds
    s_add_u32 m0, s82, 50176
    s_nop 0
    buffer_load_dwordx4 v81, s[60:63], s80 offen lds
    s_add_u32 m0, s83, 49152
    s_mov_b32 s80, 147456
    buffer_load_dwordx4 v82, s[84:87], s80 offen lds
    s_mov_b32 s80, 384
    s_add_u32 m0, s82, 73728
    s_nop 0
    buffer_load_dwordx4 v80, s[60:63], s80 offen lds
    s_add_u32 m0, s82, 74752
    s_nop 0
    buffer_load_dwordx4 v81, s[60:63], s80 offen lds
    s_add_u32 m0, s83, 73728
    s_mov_b32 s80, 221184
    buffer_load_dwordx4 v82, s[84:87], s80 offen lds
    s_add_u32 m0, s75, 0
    s_nop 0
    buffer_load_dwordx4 v2, s[44:47], s73 offen lds
    s_add_u32 m0, s75, 1024
    s_nop 0
    buffer_load_dwordx4 v3, s[44:47], s73 offen lds
    s_add_u32 m0, s75, 2048
    s_add_u32 s69, s73, 16384
    buffer_load_dwordx4 v2, s[44:47], s69 offen lds
    s_add_u32 m0, s75, 3072
    s_add_u32 s69, s73, 16384
    buffer_load_dwordx4 v3, s[44:47], s69 offen lds
    s_add_u32 s69, s74, 0
    s_add_u32 m0, s76, 0
    s_nop 0
    buffer_load_dwordx4 v4, s[48:51], s69 offen lds
    s_add_u32 m0, s76, 16384
    s_nop 0
    buffer_load_dwordx4 v4, s[52:55], s69 offen lds
    s_add_u32 s69, s74, 32768
    s_add_u32 m0, s76, 1024
    s_nop 0
    buffer_load_dwordx4 v4, s[48:51], s69 offen lds
    s_add_u32 m0, s76, 17408
    s_nop 0
    buffer_load_dwordx4 v4, s[52:55], s69 offen lds
    s_add_u32 s73, s73, 128
    s_add_u32 s74, s74, 524288
    s_waitcnt vmcnt(17)
    s_barrier
    ds_read_b128 v[112:115], v84 offset:0
    ds_read_b64_tr_b16 v[116:117], v83 offset:0
    ds_read_b64_tr_b16 v[118:119], v83 offset:512
    ds_read_b128 v[120:123], v85 offset:0
    ds_read_b64_tr_b16 v[124:125], v83 offset:2048
    ds_read_b64_tr_b16 v[126:127], v83 offset:2560
    ds_read_b128 v[128:131], v86 offset:0
    ds_read_b64_tr_b16 v[132:133], v83 offset:4096
    ds_read_b64_tr_b16 v[134:135], v83 offset:4608
    ds_read_b128 v[136:139], v87 offset:0
    ds_read_b64_tr_b16 v[140:141], v83 offset:6144
    ds_read_b64_tr_b16 v[142:143], v83 offset:6656
    s_waitcnt lgkmcnt(9)
    v_mfma_f32_32x32x16_bf16 v[48:63], v[116:119], v[112:115], 0
    s_waitcnt lgkmcnt(6)
    v_mfma_f32_32x32x16_bf16 v[48:63], v[124:127], v[120:123], v[48:63]
    s_waitcnt lgkmcnt(3)
    v_mfma_f32_32x32x16_bf16 v[48:63], v[132:135], v[128:131], v[48:63]
    s_waitcnt lgkmcnt(0)
    v_mfma_f32_32x32x16_bf16 v[48:63], v[140:143], v[136:139], v[48:63]
    s_waitcnt vmcnt(14)
    s_barrier
    ds_read_b128 v[112:115], v84 offset:24576
    ds_read_b64_tr_b16 v[116:117], v83 offset:24576
    ds_read_b64_tr_b16 v[118:119], v83 offset:25088
    ds_read_b128 v[120:123], v85 offset:24576
    ds_read_b64_tr_b16 v[124:125], v83 offset:26624
    ds_read_b64_tr_b16 v[126:127], v83 offset:27136
    ds_read_b128 v[128:131], v86 offset:24576
    ds_read_b64_tr_b16 v[132:133], v83 offset:28672
    ds_read_b64_tr_b16 v[134:135], v83 offset:29184
    ds_read_b128 v[136:139], v87 offset:24576
    ds_read_b64_tr_b16 v[140:141], v83 offset:30720
    ds_read_b64_tr_b16 v[142:143], v83 offset:31232
    s_mov_b32 s80, 512
    s_add_u32 m0, s82, 0
    s_nop 0
    buffer_load_dwordx4 v80, s[60:63], s80 offen lds
    s_add_u32 m0, s82, 1024
    s_nop 0
    buffer_load_dwordx4 v81, s[60:63], s80 offen lds
    s_add_u32 m0, s83, 0
    s_mov_b32 s80, 294912
    buffer_load_dwordx4 v82, s[84:87], s80 offen lds
    s_waitcnt lgkmcnt(9)
    v_mfma_f32_32x32x16_bf16 v[48:63], v[116:119], v[112:115], v[48:63]
    s_waitcnt lgkmcnt(6)
    v_mfma_f32_32x32x16_bf16 v[48:63], v[124:127], v[120:123], v[48:63]
    s_waitcnt lgkmcnt(3)
    v_mfma_f32_32x32x16_bf16 v[48:63], v[132:135], v[128:131], v[48:63]
    s_waitcnt lgkmcnt(0)
    v_mfma_f32_32x32x16_bf16 v[48:63], v[140:143], v[136:139], v[48:63]
    s_waitcnt vmcnt(14)
    s_barrier
    ds_read_b128 v[112:115], v88 offset:0
    ds_read_b64_tr_b16 v[116:117], v92 offset:0
    ds_read_b64_tr_b16 v[118:119], v92 offset:512
    ds_read_b128 v[120:123], v89 offset:0
    ds_read_b64_tr_b16 v[124:125], v92 offset:2048
    ds_read_b64_tr_b16 v[126:127], v92 offset:2560
    ds_read_b128 v[128:131], v90 offset:0
    ds_read_b64_tr_b16 v[132:133], v92 offset:4096
    ds_read_b64_tr_b16 v[134:135], v92 offset:4608
    ds_read_b128 v[136:139], v91 offset:0
    ds_read_b64_tr_b16 v[140:141], v92 offset:6144
    ds_read_b64_tr_b16 v[142:143], v92 offset:6656
    s_mov_b32 s80, 640
    s_add_u32 m0, s82, 24576
    s_nop 0
    buffer_load_dwordx4 v80, s[60:63], s80 offen lds
    s_add_u32 m0, s82, 25600
    s_nop 0
    buffer_load_dwordx4 v81, s[60:63], s80 offen lds
    s_add_u32 m0, s83, 24576
    s_mov_b32 s80, 368640
    buffer_load_dwordx4 v82, s[84:87], s80 offen lds
    s_waitcnt lgkmcnt(9)
    v_mfma_f32_32x32x16_bf16 v[48:63], v[116:119], v[112:115], v[48:63]
    s_waitcnt lgkmcnt(6)
    v_mfma_f32_32x32x16_bf16 v[48:63], v[124:127], v[120:123], v[48:63]
    s_waitcnt lgkmcnt(3)
    v_mfma_f32_32x32x16_bf16 v[48:63], v[132:135], v[128:131], v[48:63]
    s_waitcnt lgkmcnt(0)
    v_mfma_f32_32x32x16_bf16 v[48:63], v[140:143], v[136:139], v[48:63]
    s_waitcnt vmcnt(14)
    s_barrier
    ds_read_b128 v[112:115], v88 offset:24576
    ds_read_b64_tr_b16 v[116:117], v92 offset:24576
    ds_read_b64_tr_b16 v[118:119], v92 offset:25088
    ds_read_b128 v[120:123], v89 offset:24576
    ds_read_b64_tr_b16 v[124:125], v92 offset:26624
    ds_read_b64_tr_b16 v[126:127], v92 offset:27136
    ds_read_b128 v[128:131], v90 offset:24576
    ds_read_b64_tr_b16 v[132:133], v92 offset:28672
    ds_read_b64_tr_b16 v[134:135], v92 offset:29184
    ds_read_b128 v[136:139], v91 offset:24576
    ds_read_b64_tr_b16 v[140:141], v92 offset:30720
    ds_read_b64_tr_b16 v[142:143], v92 offset:31232
    s_mov_b32 s80, 768
    s_add_u32 m0, s82, 49152
    s_nop 0
    buffer_load_dwordx4 v80, s[60:63], s80 offen lds
    s_add_u32 m0, s82, 50176
    s_nop 0
    buffer_load_dwordx4 v81, s[60:63], s80 offen lds
    s_add_u32 m0, s83, 49152
    s_mov_b32 s80, 442368
    buffer_load_dwordx4 v82, s[84:87], s80 offen lds
    s_waitcnt lgkmcnt(9)
    v_mfma_f32_32x32x16_bf16 v[48:63], v[116:119], v[112:115], v[48:63]
    s_waitcnt lgkmcnt(6)
    v_mfma_f32_32x32x16_bf16 v[48:63], v[124:127], v[120:123], v[48:63]
    s_waitcnt lgkmcnt(3)
    v_mfma_f32_32x32x16_bf16 v[48:63], v[132:135], v[128:131], v[48:63]
    s_waitcnt lgkmcnt(0)
    v_mfma_f32_32x32x16_bf16 v[48:63], v[140:143], v[136:139], v[48:63]
    s_waitcnt vmcnt(6)
    s_barrier
    ds_read_b128 v[112:115], v84 offset:0
    ds_read_b64_tr_b16 v[116:117], v83 offset:0
    ds_read_b64_tr_b16 v[118:119], v83 offset:512
    ds_read_b128 v[120:123], v85 offset:0
    ds_read_b64_tr_b16 v[124:125], v83 offset:2048
    ds_read_b64_tr_b16 v[126:127], v83 offset:2560
    ds_read_b128 v[128:131], v86 offset:0
    ds_read_b64_tr_b16 v[132:133], v83 offset:4096
    ds_read_b64_tr_b16 v[134:135], v83 offset:4608
    ds_read_b128 v[136:139], v87 offset:0
    ds_read_b64_tr_b16 v[140:141], v83 offset:6144
    ds_read_b64_tr_b16 v[142:143], v83 offset:6656
    s_mov_b32 s80, 896
    s_add_u32 m0, s82, 73728
    s_nop 0
    buffer_load_dwordx4 v80, s[60:63], s80 offen lds
    s_add_u32 m0, s82, 74752
    s_nop 0
    buffer_load_dwordx4 v81, s[60:63], s80 offen lds
    s_add_u32 m0, s83, 73728
    s_mov_b32 s80, 516096
    buffer_load_dwordx4 v82, s[84:87], s80 offen lds
    s_waitcnt lgkmcnt(9)
    v_mfma_f32_32x32x16_bf16 v[48:63], v[116:119], v[112:115], v[48:63]
    s_waitcnt lgkmcnt(6)
    v_mfma_f32_32x32x16_bf16 v[48:63], v[124:127], v[120:123], v[48:63]
    s_waitcnt lgkmcnt(3)
    v_mfma_f32_32x32x16_bf16 v[48:63], v[132:135], v[128:131], v[48:63]
    s_waitcnt lgkmcnt(0)
    v_mfma_f32_32x32x16_bf16 v[48:63], v[140:143], v[136:139], v[48:63]
    s_waitcnt vmcnt(6)
    s_barrier
    ds_read_b128 v[112:115], v84 offset:24576
    ds_read_b64_tr_b16 v[116:117], v83 offset:24576
    ds_read_b64_tr_b16 v[118:119], v83 offset:25088
    ds_read_b128 v[120:123], v85 offset:24576
    ds_read_b64_tr_b16 v[124:125], v83 offset:26624
    ds_read_b64_tr_b16 v[126:127], v83 offset:27136
    ds_read_b128 v[128:131], v86 offset:24576
    ds_read_b64_tr_b16 v[132:133], v83 offset:28672
    ds_read_b64_tr_b16 v[134:135], v83 offset:29184
    ds_read_b128 v[136:139], v87 offset:24576
    ds_read_b64_tr_b16 v[140:141], v83 offset:30720
    ds_read_b64_tr_b16 v[142:143], v83 offset:31232
    s_mov_b32 s80, 1024
    s_add_u32 m0, s82, 0
    s_nop 0
    buffer_load_dwordx4 v80, s[60:63], s80 offen lds
    s_add_u32 m0, s82, 1024
    s_nop 0
    buffer_load_dwordx4 v81, s[60:63], s80 offen lds
    s_add_u32 m0, s83, 0
    s_mov_b32 s80, 589824
    buffer_load_dwordx4 v82, s[84:87], s80 offen lds
    s_waitcnt lgkmcnt(9)
    v_mfma_f32_32x32x16_bf16 v[48:63], v[116:119], v[112:115], v[48:63]
    s_waitcnt lgkmcnt(6)
    v_mfma_f32_32x32x16_bf16 v[48:63], v[124:127], v[120:123], v[48:63]
    s_waitcnt lgkmcnt(3)
    v_mfma_f32_32x32x16_bf16 v[48:63], v[132:135], v[128:131], v[48:63]
    s_waitcnt lgkmcnt(0)
    v_mfma_f32_32x32x16_bf16 v[48:63], v[140:143], v[136:139], v[48:63]
    s_waitcnt vmcnt(6)
    s_barrier
    ds_read_b128 v[112:115], v88 offset:0
    ds_read_b64_tr_b16 v[116:117], v92 offset:0
    ds_read_b64_tr_b16 v[118:119], v92 offset:512
    ds_read_b128 v[120:123], v89 offset:0
    ds_read_b64_tr_b16 v[124:125], v92 offset:2048
    ds_read_b64_tr_b16 v[126:127], v92 offset:2560
    ds_read_b128 v[128:131], v90 offset:0
    ds_read_b64_tr_b16 v[132:133], v92 offset:4096
    ds_read_b64_tr_b16 v[134:135], v92 offset:4608
    ds_read_b128 v[136:139], v91 offset:0
    ds_read_b64_tr_b16 v[140:141], v92 offset:6144
    ds_read_b64_tr_b16 v[142:143], v92 offset:6656
    s_waitcnt lgkmcnt(9)
    v_mfma_f32_32x32x16_bf16 v[48:63], v[116:119], v[112:115], v[48:63]
    s_waitcnt lgkmcnt(6)
    v_mfma_f32_32x32x16_bf16 v[48:63], v[124:127], v[120:123], v[48:63]
    s_waitcnt lgkmcnt(3)
    v_mfma_f32_32x32x16_bf16 v[48:63], v[132:135], v[128:131], v[48:63]
    s_waitcnt lgkmcnt(0)
    v_mfma_f32_32x32x16_bf16 v[48:63], v[140:143], v[136:139], v[48:63]
    s_waitcnt vmcnt(3)
    s_barrier
    ds_read_b128 v[112:115], v88 offset:24576
    ds_read_b64_tr_b16 v[116:117], v92 offset:24576
    ds_read_b64_tr_b16 v[118:119], v92 offset:25088
    ds_read_b128 v[120:123], v89 offset:24576
    ds_read_b64_tr_b16 v[124:125], v92 offset:26624
    ds_read_b64_tr_b16 v[126:127], v92 offset:27136
    ds_read_b128 v[128:131], v90 offset:24576
    ds_read_b64_tr_b16 v[132:133], v92 offset:28672
    ds_read_b64_tr_b16 v[134:135], v92 offset:29184
    ds_read_b128 v[136:139], v91 offset:24576
    ds_read_b64_tr_b16 v[140:141], v92 offset:30720
    ds_read_b64_tr_b16 v[142:143], v92 offset:31232
    s_waitcnt lgkmcnt(9)
    v_mfma_f32_32x32x16_bf16 v[48:63], v[116:119], v[112:115], v[48:63]
    s_waitcnt lgkmcnt(6)
    v_mfma_f32_32x32x16_bf16 v[48:63], v[124:127], v[120:123], v[48:63]
    s_waitcnt lgkmcnt(3)
    v_mfma_f32_32x32x16_bf16 v[48:63], v[132:135], v[128:131], v[48:63]
    s_waitcnt lgkmcnt(0)
    v_mfma_f32_32x32x16_bf16 v[48:63], v[140:143], v[136:139], v[48:63]
    s_waitcnt vmcnt(0)
    s_barrier
    ds_read_b128 v[112:115], v84 offset:0
    ds_read_b64_tr_b16 v[116:117], v83 offset:0
    ds_read_b64_tr_b16 v[118:119], v83 offset:512
    ds_read_b128 v[120:123], v85 offset:0
    ds_read_b64_tr_b16 v[124:125], v83 offset:2048
    ds_read_b64_tr_b16 v[126:127], v83 offset:2560
    ds_read_b128 v[128:131], v86 offset:0
    ds_read_b64_tr_b16 v[132:133], v83 offset:4096
    ds_read_b64_tr_b16 v[134:135], v83 offset:4608
    ds_read_b128 v[136:139], v87 offset:0
    ds_read_b64_tr_b16 v[140:141], v83 offset:6144
    ds_read_b64_tr_b16 v[142:143], v83 offset:6656
    s_waitcnt lgkmcnt(9)
    v_mfma_f32_32x32x16_bf16 v[48:63], v[116:119], v[112:115], v[48:63]
    s_waitcnt lgkmcnt(6)
    v_mfma_f32_32x32x16_bf16 v[48:63], v[124:127], v[120:123], v[48:63]
    s_waitcnt lgkmcnt(3)
    v_mfma_f32_32x32x16_bf16 v[48:63], v[132:135], v[128:131], v[48:63]
    s_waitcnt lgkmcnt(0)
    v_mfma_f32_32x32x16_bf16 v[48:63], v[140:143], v[136:139], v[48:63]
    s_barrier
    s_add_u32 m0, s75, 65536
    s_nop 0
    buffer_load_dwordx4 v2, s[44:47], s73 offen lds
    s_add_u32 m0, s75, 66560
    s_nop 0
    buffer_load_dwordx4 v3, s[44:47], s73 offen lds
    s_add_u32 m0, s75, 67584
    s_add_u32 s69, s73, 16384
    buffer_load_dwordx4 v2, s[44:47], s69 offen lds
    s_add_u32 m0, s75, 68608
    s_add_u32 s69, s73, 16384
    buffer_load_dwordx4 v3, s[44:47], s69 offen lds
    s_add_u32 s69, s74, 0
    s_add_u32 m0, s76, 65536
    s_nop 0
    buffer_load_dwordx4 v4, s[48:51], s69 offen lds
    s_add_u32 m0, s76, 81920
    s_nop 0
    buffer_load_dwordx4 v4, s[52:55], s69 offen lds
    s_add_u32 s69, s74, 32768
    s_add_u32 m0, s76, 66560
    s_nop 0
    buffer_load_dwordx4 v4, s[48:51], s69 offen lds
    s_add_u32 m0, s76, 82944
    s_nop 0
    buffer_load_dwordx4 v4, s[52:55], s69 offen lds
    s_add_u32 s73, s73, 128
    s_add_u32 s74, s74, 524288
    s_nop 7
    s_mov_b32 s80, 0x3eae1a93
    v_mul_f32 v48, s80, v48
    v_mul_f32 v49, s80, v49
    v_mul_f32 v50, s80, v50
    v_mul_f32 v51, s80, v51
    v_mul_f32 v52, s80, v52
    v_mul_f32 v53, s80, v53
    v_mul_f32 v54, s80, v54
    v_mul_f32 v55, s80, v55
    v_mul_f32 v56, s80, v56
    v_mul_f32 v57, s80, v57
    v_mul_f32 v58, s80, v58
    v_mul_f32 v59, s80, v59
    v_mul_f32 v60, s80, v60
    v_mul_f32 v61, s80, v61
    v_mul_f32 v62, s80, v62
    v_mul_f32 v63, s80, v63
    v_cvt_pk_bf16_f32 v112, v48, v49
    v_cvt_pk_bf16_f32 v113, v50, v51
    v_cvt_pk_bf16_f32 v114, v52, v53
    v_cvt_pk_bf16_f32 v115, v54, v55
    v_cvt_pk_bf16_f32 v116, v56, v57
    v_cvt_pk_bf16_f32 v117, v58, v59
    v_cvt_pk_bf16_f32 v118, v60, v61
    v_cvt_pk_bf16_f32 v119, v62, v63
    s_nop 1
    v_permlane32_swap_b32 v112, v114
    v_permlane32_swap_b32 v113, v115
    v_permlane32_swap_b32 v116, v118
    v_permlane32_swap_b32 v117, v119
    v_and_b32 v96, 31, v1
    s_lshl_b32 s80, s78, 7
    s_and_b32 s81, s64, 3
    s_lshl_b32 s81, s81, 5
    s_add_u32 s80, s80, s81
    v_add_u32 v96, s80, v96
    v_mul_u32_u24 v96, 1152, v96
    v_lshrrev_b32 v97, 5, v1
    v_lshl_add_u32 v96, v97, 4, v96
    s_lshl_b32 s80, s79, 7
    s_lshr_b32 s81, s64, 2
    s_lshl_b32 s81, s81, 6
    s_add_u32 s80, s80, s81
    s_add_u32 s80, s80, 50331648
    buffer_store_dwordx4 v[112:115], v96, s[56:59], s80 offen offset:0 sc1
    buffer_store_dwordx4 v[116:119], v96, s[56:59], s80 offen offset:32 sc1
    s_branch F_AP_5
F_OLD_6:
    s_cmp_ge_u32 s2, 160
    s_cbranch_scc1 F_NOAP_4
    s_mov_b32 s44, s16
    s_and_b32 s45, s17, 0xffff
    s_mov_b32 s46, 2359296
    s_mov_b32 s47, 0x00020000
    s_mov_b32 s48, s18
    s_and_b32 s49, s19, 0xffff
    s_mov_b32 s50, 663552
    s_mov_b32 s51, 0x00020000
    s_mov_b32 s52, s20
    s_and_b32 s53, s21, 0xffff
    s_mov_b32 s54, 20736
    s_mov_b32 s55, 0x00020000
    s_mov_b32 s60, s22
    s_and_b32 s61, s23, 0xffff
    s_mov_b32 s62, 20736
    s_mov_b32 s63, 0x00020000
    s_mov_b32 s56, s42
    s_and_b32 s57, s43, 0xffff
    s_mov_b32 s58, 268435456
    s_mov_b32 s59, 0x00020000
    s_and_b32 s78, s2, 7
    s_lshl_b32 s78, s78, 1
    s_sub_u32 s80, s2, 144
    s_lshr_b32 s80, s80, 3
    s_add_u32 s78, s78, s80
    s_mov_b32 s79, 9
    v_lshrrev_b32 v11, 3, v1
    s_lshl_b32 s80, s78, 7
    s_lshl_b32 s81, s64, 4
    s_add_u32 s80, s80, s81
    v_add_u32 v11, s80, v11
    s_movk_i32 s80, 1152
    v_mul_lo_u32 v11, v11, s80
    v_lshrrev_b32 v12, 4, v1
    v_and_b32 v13, 7, v1
    v_xor_b32 v14, v13, v12
    v_lshl_add_u32 v2, v14, 4, v11
    v_xor_b32 v14, 4, v14
    v_lshl_add_u32 v3, v14, 4, v11
    v_add_u32 v3, 9216, v3
    v_lshrrev_b32 v11, 3, v1
    v_mul_lo_u32 v11, v11, s80
    v_bfe_u32 v12, v1, 4, 1
    v_lshlrev_b32 v12, 2, v12
    v_xor_b32 v12, v12, v13
    v_lshl_add_u32 v4, v12, 4, v11
    s_lshl_b32 s80, s79, 7
    v_add_u32 v4, s80, v4
    v_and_b32 v11, 31, v1
    s_and_b32 s80, s64, 3
    s_lshl_b32 s80, s80, 5
    v_add_u32 v12, s80, v11
    v_lshlrev_b32 v12, 7, v12
    v_add_u32 v12, 73728, v12
    v_bfe_u32 v13, v1, 1, 3
    v_lshrrev_b32 v14, 5, v1
    v_add_u32 v15, 0, v14
    v_xor_b32 v15, v15, v13
    v_lshl_add_u32 v5, v15, 4, v12
    v_add_u32 v15, 2, v14
    v_xor_b32 v15, v15, v13
    v_lshl_add_u32 v6, v15, 4, v12
    v_add_u32 v15, 4, v14
    v_xor_b32 v15, v15, v13
    v_lshl_add_u32 v7, v15, 4, v12
    v_add_u32 v15, 6, v14
    v_xor_b32 v15, v15, v13
    v_lshl_add_u32 v8, v15, 4, v12
    v_bfe_u32 v11, v1, 2, 2
    v_lshrrev_b32 v12, 5, v1
    v_lshl_add_u32 v12, v12, 3, v11
    v_lshlrev_b32 v12, 7, v12
    v_bfe_u32 v13, v1, 4, 1
    v_bfe_u32 v14, v1, 1, 1
    v_lshl_add_u32 v13, v13, 1, v14
    s_lshr_b32 s80, s64, 2
    s_lshl_b32 s80, s80, 2
    v_add_u32 v13, s80, v13
    v_bfe_u32 v14, v1, 3, 1
    v_lshlrev_b32 v14, 2, v14
    v_xor_b32 v13, v13, v14
    v_lshl_add_u32 v12, v13, 4, v12
    v_and_b32 v13, 1, v1
    v_lshl_add_u32 v9, v13, 3, v12
    v_add_u32 v10, 0x10000, v9
    s_lshl_b32 s83, s64, 11
    s_add_u32 s83, s83, 73728
    s_mov_b32 s82, 0
    s_cmp_eq_u32 s79, 9
    s_cbranch_scc1 AP_KV_7
    s_mul_i32 s81, s64, 9216
    s_lshl_b32 s80, s64, 10
    s_add_u32 m0, s80, 0
    s_add_u32 s80, s81, 0
    buffer_load_dwordx4 v4, s[48:51], s80 offen lds
    s_lshl_b32 s80, s64, 10
    s_add_u32 m0, s80, 8192
    s_add_u32 s80, s81, 73728
    buffer_load_dwordx4 v4, s[48:51], s80 offen lds
    s_lshl_b32 s80, s64, 10
    s_add_u32 m0, s80, 16384
    s_add_u32 s80, s81, 147456
    buffer_load_dwordx4 v4, s[48:51], s80 offen lds
    s_lshl_b32 s80, s64, 10
    s_add_u32 m0, s80, 24576
    s_add_u32 s80, s81, 221184
    buffer_load_dwordx4 v4, s[48:51], s80 offen lds
    s_lshl_b32 s80, s64, 10
    s_add_u32 m0, s80, 32768
    s_add_u32 s80, s81, 294912
    buffer_load_dwordx4 v4, s[48:51], s80 offen lds
    s_lshl_b32 s80, s64, 10
    s_add_u32 m0, s80, 40960
    s_add_u32 s80, s81, 368640
    buffer_load_dwordx4 v4, s[48:51], s80 offen lds
    s_lshl_b32 s80, s64, 10
    s_add_u32 m0, s80, 49152
    s_add_u32 s80, s81, 442368
    buffer_load_dwordx4 v4, s[48:51], s80 offen lds
    s_lshl_b32 s80, s64, 10
    s_add_u32 m0, s80, 57344
    s_add_u32 s80, s81, 516096
    buffer_load_dwordx4 v4, s[48:51], s80 offen lds
    s_lshl_b32 s80, s64, 10
    s_add_u32 m0, s80, 65536
    s_add_u32 s80, s81, 589824
    buffer_load_dwordx4 v4, s[48:51], s80 offen lds
    s_branch AP_W_8
AP_KV_7:
    v_add_u32 v11, 0, v0
    v_lshlrev_b32 v11, 2, v11
    buffer_load_dword v64, v11, s[52:55], 0 offen
    buffer_load_dword v80, v11, s[60:63], 0 offen
    v_add_u32 v11, 512, v0
    v_lshlrev_b32 v11, 2, v11
    buffer_load_dword v65, v11, s[52:55], 0 offen
    buffer_load_dword v81, v11, s[60:63], 0 offen
    v_add_u32 v11, 1024, v0
    v_lshlrev_b32 v11, 2, v11
    buffer_load_dword v66, v11, s[52:55], 0 offen
    buffer_load_dword v82, v11, s[60:63], 0 offen
    v_add_u32 v11, 1536, v0
    v_lshlrev_b32 v11, 2, v11
    buffer_load_dword v67, v11, s[52:55], 0 offen
    buffer_load_dword v83, v11, s[60:63], 0 offen
    v_add_u32 v11, 2048, v0
    v_lshlrev_b32 v11, 2, v11
    buffer_load_dword v68, v11, s[52:55], 0 offen
    buffer_load_dword v84, v11, s[60:63], 0 offen
    v_add_u32 v11, 2560, v0
    v_lshlrev_b32 v11, 2, v11
    buffer_load_dword v69, v11, s[52:55], 0 offen
    buffer_load_dword v85, v11, s[60:63], 0 offen
    v_add_u32 v11, 3072, v0
    v_lshlrev_b32 v11, 2, v11
    buffer_load_dword v70, v11, s[52:55], 0 offen
    buffer_load_dword v86, v11, s[60:63], 0 offen
    v_add_u32 v11, 3584, v0
    v_lshlrev_b32 v11, 2, v11
    buffer_load_dword v71, v11, s[52:55], 0 offen
    buffer_load_dword v87, v11, s[60:63], 0 offen
    v_add_u32 v11, 4096, v0
    v_lshlrev_b32 v11, 2, v11
    buffer_load_dword v72, v11, s[52:55], 0 offen
    buffer_load_dword v88, v11, s[60:63], 0 offen
    v_add_u32 v11, 4608, v0
    v_lshlrev_b32 v11, 2, v11
    buffer_load_dword v73, v11, s[52:55], 0 offen
    buffer_load_dword v89, v11, s[60:63], 0 offen
    v_add_u32 v11, 5120, v0
    v_lshlrev_b32 v11, 2, v11
    buffer_load_dword v74, v11, s[52:55], 0 offen
    buffer_load_dword v90, v11, s[60:63], 0 offen
    v_mov_b32 v112, 0
    v_mov_b32 v113, 0
    v_mov_b32 v114, 0
    v_mov_b32 v115, 0
    v_lshlrev_b32 v11, 4, v0
    ds_write_b128 v11, v[112:115] offset:0
    ds_write_b128 v11, v[112:115] offset:8192
    ds_write_b128 v11, v[112:115] offset:16384
    ds_write_b128 v11, v[112:115] offset:24576
    ds_write_b128 v11, v[112:115] offset:32768
    ds_write_b128 v11, v[112:115] offset:40960
    ds_write_b128 v11, v[112:115] offset:49152
    ds_write_b128 v11, v[112:115] offset:57344
    v_add_u32 v11, 0x10000, v11
    ds_write_b128 v11, v[112:115]
    s_waitcnt lgkmcnt(0)
    s_barrier
    s_movk_i32 s80, 7282
    s_movk_i32 s81, 5184
    v_add_u32 v11, 0, v0
    v_mul_lo_u32 v12, v11, s80
    v_lshrrev_b32 v12, 16, v12
    v_mul_u32_u24 v13, 9, v12
    v_sub_u32 v13, v11, v13
    v_bfe_u32 v14, v12, 1, 1
    v_lshlrev_b32 v14, 2, v14
    v_lshrrev_b32 v15, 2, v13
    v_xor_b32 v14, v14, v15
    v_lshlrev_b32 v14, 4, v14
    v_lshl_add_u32 v14, v12, 7, v14
    v_and_b32 v13, 3, v13
    v_lshl_add_u32 v14, v13, 2, v14
    v_xor_b32 v15, 64, v14
    s_waitcnt vmcnt(0)
    ds_write_b32 v14, v64
    ds_write_b32 v15, v80
    v_add_u32 v11, 512, v0
    v_mul_lo_u32 v12, v11, s80
    v_lshrrev_b32 v12, 16, v12
    v_mul_u32_u24 v13, 9, v12
    v_sub_u32 v13, v11, v13
    v_bfe_u32 v14, v12, 1, 1
    v_lshlrev_b32 v14, 2, v14
    v_lshrrev_b32 v15, 2, v13
    v_xor_b32 v14, v14, v15
    v_lshlrev_b32 v14, 4, v14
    v_lshl_add_u32 v14, v12, 7, v14
    v_and_b32 v13, 3, v13
    v_lshl_add_u32 v14, v13, 2, v14
    v_xor_b32 v15, 64, v14
    ds_write_b32 v14, v65
    ds_write_b32 v15, v81
    v_add_u32 v11, 1024, v0
    v_mul_lo_u32 v12, v11, s80
    v_lshrrev_b32 v12, 16, v12
    v_mul_u32_u24 v13, 9, v12
    v_sub_u32 v13, v11, v13
    v_bfe_u32 v14, v12, 1, 1
    v_lshlrev_b32 v14, 2, v14
    v_lshrrev_b32 v15, 2, v13
    v_xor_b32 v14, v14, v15
    v_lshlrev_b32 v14, 4, v14
    v_lshl_add_u32 v14, v12, 7, v14
    v_and_b32 v13, 3, v13
    v_lshl_add_u32 v14, v13, 2, v14
    v_xor_b32 v15, 64, v14
    ds_write_b32 v14, v66
    ds_write_b32 v15, v82
    v_add_u32 v11, 1536, v0
    v_mul_lo_u32 v12, v11, s80
    v_lshrrev_b32 v12, 16, v12
    v_mul_u32_u24 v13, 9, v12
    v_sub_u32 v13, v11, v13
    v_bfe_u32 v14, v12, 1, 1
    v_lshlrev_b32 v14, 2, v14
    v_lshrrev_b32 v15, 2, v13
    v_xor_b32 v14, v14, v15
    v_lshlrev_b32 v14, 4, v14
    v_lshl_add_u32 v14, v12, 7, v14
    v_and_b32 v13, 3, v13
    v_lshl_add_u32 v14, v13, 2, v14
    v_xor_b32 v15, 64, v14
    ds_write_b32 v14, v67
    ds_write_b32 v15, v83
    v_add_u32 v11, 2048, v0
    v_mul_lo_u32 v12, v11, s80
    v_lshrrev_b32 v12, 16, v12
    v_mul_u32_u24 v13, 9, v12
    v_sub_u32 v13, v11, v13
    v_bfe_u32 v14, v12, 1, 1
    v_lshlrev_b32 v14, 2, v14
    v_lshrrev_b32 v15, 2, v13
    v_xor_b32 v14, v14, v15
    v_lshlrev_b32 v14, 4, v14
    v_lshl_add_u32 v14, v12, 7, v14
    v_and_b32 v13, 3, v13
    v_lshl_add_u32 v14, v13, 2, v14
    v_xor_b32 v15, 64, v14
    ds_write_b32 v14, v68
    ds_write_b32 v15, v84
    v_add_u32 v11, 2560, v0
    v_mul_lo_u32 v12, v11, s80
    v_lshrrev_b32 v12, 16, v12
    v_mul_u32_u24 v13, 9, v12
    v_sub_u32 v13, v11, v13
    v_bfe_u32 v14, v12, 1, 1
    v_lshlrev_b32 v14, 2, v14
    v_lshrrev_b32 v15, 2, v13
    v_xor_b32 v14, v14, v15
    v_lshlrev_b32 v14, 4, v14
    v_lshl_add_u32 v14, v12, 7, v14
    v_and_b32 v13, 3, v13
    v_lshl_add_u32 v14, v13, 2, v14
    v_xor_b32 v15, 64, v14
    ds_write_b32 v14, v69
    ds_write_b32 v15, v85
    v_add_u32 v11, 3072, v0
    v_mul_lo_u32 v12, v11, s80
    v_lshrrev_b32 v12, 16, v12
    v_mul_u32_u24 v13, 9, v12
    v_sub_u32 v13, v11, v13
    v_bfe_u32 v14, v12, 1, 1
    v_lshlrev_b32 v14, 2, v14
    v_lshrrev_b32 v15, 2, v13
    v_xor_b32 v14, v14, v15
    v_lshlrev_b32 v14, 4, v14
    v_lshl_add_u32 v14, v12, 7, v14
    v_and_b32 v13, 3, v13
    v_lshl_add_u32 v14, v13, 2, v14
    v_xor_b32 v15, 64, v14
    ds_write_b32 v14, v70
    ds_write_b32 v15, v86
    v_add_u32 v11, 3584, v0
    v_mul_lo_u32 v12, v11, s80
    v_lshrrev_b32 v12, 16, v12
    v_mul_u32_u24 v13, 9, v12
    v_sub_u32 v13, v11, v13
    v_bfe_u32 v14, v12, 1, 1
    v_lshlrev_b32 v14, 2, v14
    v_lshrrev_b32 v15, 2, v13
    v_xor_b32 v14, v14, v15
    v_lshlrev_b32 v14, 4, v14
    v_lshl_add_u32 v14, v12, 7, v14
    v_and_b32 v13, 3, v13
    v_lshl_add_u32 v14, v13, 2, v14
    v_xor_b32 v15, 64, v14
    ds_write_b32 v14, v71
    ds_write_b32 v15, v87
    v_add_u32 v11, 4096, v0
    v_mul_lo_u32 v12, v11, s80
    v_lshrrev_b32 v12, 16, v12
    v_mul_u32_u24 v13, 9, v12
    v_sub_u32 v13, v11, v13
    v_bfe_u32 v14, v12, 1, 1
    v_lshlrev_b32 v14, 2, v14
    v_lshrrev_b32 v15, 2, v13
    v_xor_b32 v14, v14, v15
    v_lshlrev_b32 v14, 4, v14
    v_lshl_add_u32 v14, v12, 7, v14
    v_and_b32 v13, 3, v13
    v_lshl_add_u32 v14, v13, 2, v14
    v_xor_b32 v15, 64, v14
    ds_write_b32 v14, v72
    ds_write_b32 v15, v88
    v_add_u32 v11, 4608, v0
    v_mul_lo_u32 v12, v11, s80
    v_lshrrev_b32 v12, 16, v12
    v_mul_u32_u24 v13, 9, v12
    v_sub_u32 v13, v11, v13
    v_bfe_u32 v14, v12, 1, 1
    v_lshlrev_b32 v14, 2, v14
    v_lshrrev_b32 v15, 2, v13
    v_xor_b32 v14, v14, v15
    v_lshlrev_b32 v14, 4, v14
    v_lshl_add_u32 v14, v12, 7, v14
    v_and_b32 v13, 3, v13
    v_lshl_add_u32 v14, v13, 2, v14
    v_xor_b32 v15, 64, v14
    ds_write_b32 v14, v73
    ds_write_b32 v15, v89
    v_add_u32 v11, 5120, v0
    v_mul_lo_u32 v12, v11, s80
    v_lshrrev_b32 v12, 16, v12
    v_mul_u32_u24 v13, 9, v12
    v_sub_u32 v13, v11, v13
    v_bfe_u32 v14, v12, 1, 1
    v_lshlrev_b32 v14, 2, v14
    v_lshrrev_b32 v15, 2, v13
    v_xor_b32 v14, v14, v15
    v_lshlrev_b32 v14, 4, v14
    v_lshl_add_u32 v14, v12, 7, v14
    v_and_b32 v13, 3, v13
    v_lshl_add_u32 v14, v13, 2, v14
    v_xor_b32 v15, 64, v14
    v_cmp_gt_u32 vcc, s81, v11
    s_and_saveexec_b64 s[84:85], vcc
    ds_write_b32 v14, v74
    ds_write_b32 v15, v90
    s_mov_b64 exec, s[84:85]
    s_waitcnt lgkmcnt(0)
AP_W_8:
    s_add_u32 m0, s83, 0
    s_nop 0
    buffer_load_dwordx4 v2, s[44:47], s82 offen lds
    s_add_u32 m0, s83, 1024
    s_nop 0
    buffer_load_dwordx4 v3, s[44:47], s82 offen lds
    s_add_u32 s82, s82, 128
    s_add_u32 m0, s83, 16384
    s_nop 0
    buffer_load_dwordx4 v2, s[44:47], s82 offen lds
    s_add_u32 m0, s83, 17408
    s_nop 0
    buffer_load_dwordx4 v3, s[44:47], s82 offen lds
    s_add_u32 s82, s82, 128
    s_add_u32 m0, s83, 32768
    s_nop 0
    buffer_load_dwordx4 v2, s[44:47], s82 offen lds
    s_add_u32 m0, s83, 33792
    s_nop 0
    buffer_load_dwordx4 v3, s[44:47], s82 offen lds
    s_add_u32 s82, s82, 128
    s_add_u32 m0, s83, 49152
    s_nop 0
    buffer_load_dwordx4 v2, s[44:47], s82 offen lds
    s_add_u32 m0, s83, 50176
    s_nop 0
    buffer_load_dwordx4 v3, s[44:47], s82 offen lds
    s_add_u32 s82, s82, 128
    s_add_u32 m0, s83, 65536
    s_nop 0
    buffer_load_dwordx4 v2, s[44:47], s82 offen lds
    s_add_u32 m0, s83, 66560
    s_nop 0
    buffer_load_dwordx4 v3, s[44:47], s82 offen lds
    s_add_u32 s82, s82, 128
    s_cmp_eq_u32 s79, 9
    s_cselect_b32 s81, s64, 0
    s_cmp_ge_u32 s81, 4
    s_cbranch_scc1 AP_V_9
    s_waitcnt vmcnt(8)
    s_barrier
    ds_read_b128 v[112:115], v5 offset:0
    ds_read_b64_tr_b16 v[116:117], v9 offset:0
    ds_read_b64_tr_b16 v[118:119], v9 offset:512
    ds_read_b128 v[120:123], v6 offset:0
    ds_read_b64_tr_b16 v[124:125], v9 offset:2048
    ds_read_b64_tr_b16 v[126:127], v9 offset:2560
    ds_read_b128 v[128:131], v7 offset:0
    ds_read_b64_tr_b16 v[132:133], v9 offset:4096
    ds_read_b64_tr_b16 v[134:135], v9 offset:4608
    ds_read_b128 v[136:139], v8 offset:0
    ds_read_b64_tr_b16 v[140:141], v9 offset:6144
    ds_read_b64_tr_b16 v[142:143], v9 offset:6656
    s_waitcnt lgkmcnt(9)
    v_mfma_f32_32x32x16_bf16 v[48:63], v[116:119], v[112:115], 0
    s_waitcnt lgkmcnt(6)
    v_mfma_f32_32x32x16_bf16 v[48:63], v[124:127], v[120:123], v[48:63]
    s_waitcnt lgkmcnt(3)
    v_mfma_f32_32x32x16_bf16 v[48:63], v[132:135], v[128:131], v[48:63]
    s_waitcnt lgkmcnt(0)
    v_mfma_f32_32x32x16_bf16 v[48:63], v[140:143], v[136:139], v[48:63]
    s_waitcnt vmcnt(6)
    s_barrier
    ds_read_b128 v[112:115], v5 offset:16384
    ds_read_b64_tr_b16 v[116:117], v9 offset:8192
    ds_read_b64_tr_b16 v[118:119], v9 offset:8704
    ds_read_b128 v[120:123], v6 offset:16384
    ds_read_b64_tr_b16 v[124:125], v9 offset:10240
    ds_read_b64_tr_b16 v[126:127], v9 offset:10752
    ds_read_b128 v[128:131], v7 offset:16384
    ds_read_b64_tr_b16 v[132:133], v9 offset:12288
    ds_read_b64_tr_b16 v[134:135], v9 offset:12800
    ds_read_b128 v[136:139], v8 offset:16384
    ds_read_b64_tr_b16 v[140:141], v9 offset:14336
    ds_read_b64_tr_b16 v[142:143], v9 offset:14848
    s_add_u32 m0, s83, 0
    s_nop 0
    buffer_load_dwordx4 v2, s[44:47], s82 offen lds
    s_add_u32 m0, s83, 1024
    s_nop 0
    buffer_load_dwordx4 v3, s[44:47], s82 offen lds
    s_add_u32 s82, s82, 128
    s_waitcnt lgkmcnt(9)
    v_mfma_f32_32x32x16_bf16 v[48:63], v[116:119], v[112:115], v[48:63]
    s_waitcnt lgkmcnt(6)
    v_mfma_f32_32x32x16_bf16 v[48:63], v[124:127], v[120:123], v[48:63]
    s_waitcnt lgkmcnt(3)
    v_mfma_f32_32x32x16_bf16 v[48:63], v[132:135], v[128:131], v[48:63]
    s_waitcnt lgkmcnt(0)
    v_mfma_f32_32x32x16_bf16 v[48:63], v[140:143], v[136:139], v[48:63]
    s_waitcnt vmcnt(6)
    s_barrier
    ds_read_b128 v[112:115], v5 offset:32768
    ds_read_b64_tr_b16 v[116:117], v9 offset:16384
    ds_read_b64_tr_b16 v[118:119], v9 offset:16896
    ds_read_b128 v[120:123], v6 offset:32768
    ds_read_b64_tr_b16 v[124:125], v9 offset:18432
    ds_read_b64_tr_b16 v[126:127], v9 offset:18944
    ds_read_b128 v[128:131], v7 offset:32768
    ds_read_b64_tr_b16 v[132:133], v9 offset:20480
    ds_read_b64_tr_b16 v[134:135], v9 offset:20992
    ds_read_b128 v[136:139], v8 offset:32768
    ds_read_b64_tr_b16 v[140:141], v9 offset:22528
    ds_read_b64_tr_b16 v[142:143], v9 offset:23040
    s_add_u32 m0, s83, 16384
    s_nop 0
    buffer_load_dwordx4 v2, s[44:47], s82 offen lds
    s_add_u32 m0, s83, 17408
    s_nop 0
    buffer_load_dwordx4 v3, s[44:47], s82 offen lds
    s_add_u32 s82, s82, 128
    s_waitcnt lgkmcnt(9)
    v_mfma_f32_32x32x16_bf16 v[48:63], v[116:119], v[112:115], v[48:63]
    s_waitcnt lgkmcnt(6)
    v_mfma_f32_32x32x16_bf16 v[48:63], v[124:127], v[120:123], v[48:63]
    s_waitcnt lgkmcnt(3)
    v_mfma_f32_32x32x16_bf16 v[48:63], v[132:135], v[128:131], v[48:63]
    s_waitcnt lgkmcnt(0)
    v_mfma_f32_32x32x16_bf16 v[48:63], v[140:143], v[136:139], v[48:63]
    s_waitcnt vmcnt(6)
    s_barrier
    ds_read_b128 v[112:115], v5 offset:49152
    ds_read_b64_tr_b16 v[116:117], v9 offset:24576
    ds_read_b64_tr_b16 v[118:119], v9 offset:25088
    ds_read_b128 v[120:123], v6 offset:49152
    ds_read_b64_tr_b16 v[124:125], v9 offset:26624
    ds_read_b64_tr_b16 v[126:127], v9 offset:27136
    ds_read_b128 v[128:131], v7 offset:49152
    ds_read_b64_tr_b16 v[132:133], v9 offset:28672
    ds_read_b64_tr_b16 v[134:135], v9 offset:29184
    ds_read_b128 v[136:139], v8 offset:49152
    ds_read_b64_tr_b16 v[140:141], v9 offset:30720
    ds_read_b64_tr_b16 v[142:143], v9 offset:31232
    s_add_u32 m0, s83, 32768
    s_nop 0
    buffer_load_dwordx4 v2, s[44:47], s82 offen lds
    s_add_u32 m0, s83, 33792
    s_nop 0
    buffer_load_dwordx4 v3, s[44:47], s82 offen lds
    s_add_u32 s82, s82, 128
    s_waitcnt lgkmcnt(9)
    v_mfma_f32_32x32x16_bf16 v[48:63], v[116:119], v[112:115], v[48:63]
    s_waitcnt lgkmcnt(6)
    v_mfma_f32_32x32x16_bf16 v[48:63], v[124:127], v[120:123], v[48:63]
    s_waitcnt lgkmcnt(3)
    v_mfma_f32_32x32x16_bf16 v[48:63], v[132:135], v[128:131], v[48:63]
    s_waitcnt lgkmcnt(0)
    v_mfma_f32_32x32x16_bf16 v[48:63], v[140:143], v[136:139], v[48:63]
    s_waitcnt vmcnt(6)
    s_barrier
    v_add_u32 v11, 0x10000, v5
    ds_read_b128 v[112:115], v11
    ds_read_b64_tr_b16 v[116:117], v9 offset:32768
    ds_read_b64_tr_b16 v[118:119], v9 offset:33280
    v_add_u32 v12, 0x10000, v6
    ds_read_b128 v[120:123], v12
    ds_read_b64_tr_b16 v[124:125], v9 offset:34816
    ds_read_b64_tr_b16 v[126:127], v9 offset:35328
    v_add_u32 v13, 0x10000, v7
    ds_read_b128 v[128:131], v13
    ds_read_b64_tr_b16 v[132:133], v9 offset:36864
    ds_read_b64_tr_b16 v[134:135], v9 offset:37376
    v_add_u32 v14, 0x10000, v8
    ds_read_b128 v[136:139], v14
    ds_read_b64_tr_b16 v[140:141], v9 offset:38912
    ds_read_b64_tr_b16 v[142:143], v9 offset:39424
    s_add_u32 m0, s83, 49152
    s_nop 0
    buffer_load_dwordx4 v2, s[44:47], s82 offen lds
    s_add_u32 m0, s83, 50176
    s_nop 0
    buffer_load_dwordx4 v3, s[44:47], s82 offen lds
    s_add_u32 s82, s82, 128
    s_waitcnt lgkmcnt(9)
    v_mfma_f32_32x32x16_bf16 v[48:63], v[116:119], v[112:115], v[48:63]
    s_waitcnt lgkmcnt(6)
    v_mfma_f32_32x32x16_bf16 v[48:63], v[124:127], v[120:123], v[48:63]
    s_waitcnt lgkmcnt(3)
    v_mfma_f32_32x32x16_bf16 v[48:63], v[132:135], v[128:131], v[48:63]
    s_waitcnt lgkmcnt(0)
    v_mfma_f32_32x32x16_bf16 v[48:63], v[140:143], v[136:139], v[48:63]
    s_waitcnt vmcnt(6)
    s_barrier
    ds_read_b128 v[112:115], v5 offset:0
    ds_read_b64_tr_b16 v[116:117], v9 offset:40960
    ds_read_b64_tr_b16 v[118:119], v9 offset:41472
    ds_read_b128 v[120:123], v6 offset:0
    ds_read_b64_tr_b16 v[124:125], v9 offset:43008
    ds_read_b64_tr_b16 v[126:127], v9 offset:43520
    ds_read_b128 v[128:131], v7 offset:0
    ds_read_b64_tr_b16 v[132:133], v9 offset:45056
    ds_read_b64_tr_b16 v[134:135], v9 offset:45568
    ds_read_b128 v[136:139], v8 offset:0
    ds_read_b64_tr_b16 v[140:141], v9 offset:47104
    ds_read_b64_tr_b16 v[142:143], v9 offset:47616
    s_waitcnt lgkmcnt(9)
    v_mfma_f32_32x32x16_bf16 v[48:63], v[116:119], v[112:115], v[48:63]
    s_waitcnt lgkmcnt(6)
    v_mfma_f32_32x32x16_bf16 v[48:63], v[124:127], v[120:123], v[48:63]
    s_waitcnt lgkmcnt(3)
    v_mfma_f32_32x32x16_bf16 v[48:63], v[132:135], v[128:131], v[48:63]
    s_waitcnt lgkmcnt(0)
    v_mfma_f32_32x32x16_bf16 v[48:63], v[140:143], v[136:139], v[48:63]
    s_waitcnt vmcnt(4)
    s_barrier
    ds_read_b128 v[112:115], v5 offset:16384
    ds_read_b64_tr_b16 v[116:117], v9 offset:49152
    ds_read_b64_tr_b16 v[118:119], v9 offset:49664
    ds_read_b128 v[120:123], v6 offset:16384
    ds_read_b64_tr_b16 v[124:125], v9 offset:51200
    ds_read_b64_tr_b16 v[126:127], v9 offset:51712
    ds_read_b128 v[128:131], v7 offset:16384
    ds_read_b64_tr_b16 v[132:133], v9 offset:53248
    ds_read_b64_tr_b16 v[134:135], v9 offset:53760
    ds_read_b128 v[136:139], v8 offset:16384
    ds_read_b64_tr_b16 v[140:141], v9 offset:55296
    ds_read_b64_tr_b16 v[142:143], v9 offset:55808
    s_waitcnt lgkmcnt(9)
    v_mfma_f32_32x32x16_bf16 v[48:63], v[116:119], v[112:115], v[48:63]
    s_waitcnt lgkmcnt(6)
    v_mfma_f32_32x32x16_bf16 v[48:63], v[124:127], v[120:123], v[48:63]
    s_waitcnt lgkmcnt(3)
    v_mfma_f32_32x32x16_bf16 v[48:63], v[132:135], v[128:131], v[48:63]
    s_waitcnt lgkmcnt(0)
    v_mfma_f32_32x32x16_bf16 v[48:63], v[140:143], v[136:139], v[48:63]
    s_waitcnt vmcnt(2)
    s_barrier
    ds_read_b128 v[112:115], v5 offset:32768
    ds_read_b64_tr_b16 v[116:117], v9 offset:57344
    ds_read_b64_tr_b16 v[118:119], v9 offset:57856
    ds_read_b128 v[120:123], v6 offset:32768
    ds_read_b64_tr_b16 v[124:125], v9 offset:59392
    ds_read_b64_tr_b16 v[126:127], v9 offset:59904
    ds_read_b128 v[128:131], v7 offset:32768
    ds_read_b64_tr_b16 v[132:133], v9 offset:61440
    ds_read_b64_tr_b16 v[134:135], v9 offset:61952
    ds_read_b128 v[136:139], v8 offset:32768
    ds_read_b64_tr_b16 v[140:141], v9 offset:63488
    ds_read_b64_tr_b16 v[142:143], v9 offset:64000
    s_waitcnt lgkmcnt(9)
    v_mfma_f32_32x32x16_bf16 v[48:63], v[116:119], v[112:115], v[48:63]
    s_waitcnt lgkmcnt(6)
    v_mfma_f32_32x32x16_bf16 v[48:63], v[124:127], v[120:123], v[48:63]
    s_waitcnt lgkmcnt(3)
    v_mfma_f32_32x32x16_bf16 v[48:63], v[132:135], v[128:131], v[48:63]
    s_waitcnt lgkmcnt(0)
    v_mfma_f32_32x32x16_bf16 v[48:63], v[140:143], v[136:139], v[48:63]
    s_waitcnt vmcnt(0)
    s_barrier
    ds_read_b128 v[112:115], v5 offset:49152
    ds_read_b64_tr_b16 v[116:117], v10 offset:0
    ds_read_b64_tr_b16 v[118:119], v10 offset:512
    ds_read_b128 v[120:123], v6 offset:49152
    ds_read_b64_tr_b16 v[124:125], v10 offset:2048
    ds_read_b64_tr_b16 v[126:127], v10 offset:2560
    ds_read_b128 v[128:131], v7 offset:49152
    ds_read_b64_tr_b16 v[132:133], v10 offset:4096
    ds_read_b64_tr_b16 v[134:135], v10 offset:4608
    ds_read_b128 v[136:139], v8 offset:49152
    ds_read_b64_tr_b16 v[140:141], v10 offset:6144
    ds_read_b64_tr_b16 v[142:143], v10 offset:6656
    s_waitcnt lgkmcnt(9)
    v_mfma_f32_32x32x16_bf16 v[48:63], v[116:119], v[112:115], v[48:63]
    s_waitcnt lgkmcnt(6)
    v_mfma_f32_32x32x16_bf16 v[48:63], v[124:127], v[120:123], v[48:63]
    s_waitcnt lgkmcnt(3)
    v_mfma_f32_32x32x16_bf16 v[48:63], v[132:135], v[128:131], v[48:63]
    s_waitcnt lgkmcnt(0)
    v_mfma_f32_32x32x16_bf16 v[48:63], v[140:143], v[136:139], v[48:63]
    s_branch AP_E_10
AP_V_9:
    s_waitcnt vmcnt(8)
    s_barrier
    ds_read_b128 v[112:115], v5 offset:0
    ds_read_b64_tr_b16 v[116:117], v9 offset:0
    ds_read_b64_tr_b16 v[118:119], v9 offset:512
    ds_read_b128 v[120:123], v6 offset:0
    ds_read_b64_tr_b16 v[124:125], v9 offset:2048
    ds_read_b64_tr_b16 v[126:127], v9 offset:2560
    ds_read_b128 v[128:131], v7 offset:0
    ds_read_b64_tr_b16 v[132:133], v9 offset:4096
    ds_read_b64_tr_b16 v[134:135], v9 offset:4608
    ds_read_b128 v[136:139], v8 offset:0
    ds_read_b64_tr_b16 v[140:141], v9 offset:6144
    ds_read_b64_tr_b16 v[142:143], v9 offset:6656
    s_waitcnt lgkmcnt(9)
    v_mfma_f32_32x32x16_bf16 v[48:63], v[112:115], v[116:119], 0
    s_waitcnt lgkmcnt(6)
    v_mfma_f32_32x32x16_bf16 v[48:63], v[120:123], v[124:127], v[48:63]
    s_waitcnt lgkmcnt(3)
    v_mfma_f32_32x32x16_bf16 v[48:63], v[128:131], v[132:135], v[48:63]
    s_waitcnt lgkmcnt(0)
    v_mfma_f32_32x32x16_bf16 v[48:63], v[136:139], v[140:143], v[48:63]
    s_waitcnt vmcnt(6)
    s_barrier
    ds_read_b128 v[112:115], v5 offset:16384
    ds_read_b64_tr_b16 v[116:117], v9 offset:8192
    ds_read_b64_tr_b16 v[118:119], v9 offset:8704
    ds_read_b128 v[120:123], v6 offset:16384
    ds_read_b64_tr_b16 v[124:125], v9 offset:10240
    ds_read_b64_tr_b16 v[126:127], v9 offset:10752
    ds_read_b128 v[128:131], v7 offset:16384
    ds_read_b64_tr_b16 v[132:133], v9 offset:12288
    ds_read_b64_tr_b16 v[134:135], v9 offset:12800
    ds_read_b128 v[136:139], v8 offset:16384
    ds_read_b64_tr_b16 v[140:141], v9 offset:14336
    ds_read_b64_tr_b16 v[142:143], v9 offset:14848
    s_add_u32 m0, s83, 0
    s_nop 0
    buffer_load_dwordx4 v2, s[44:47], s82 offen lds
    s_add_u32 m0, s83, 1024
    s_nop 0
    buffer_load_dwordx4 v3, s[44:47], s82 offen lds
    s_add_u32 s82, s82, 128
    s_waitcnt lgkmcnt(9)
    v_mfma_f32_32x32x16_bf16 v[48:63], v[112:115], v[116:119], v[48:63]
    s_waitcnt lgkmcnt(6)
    v_mfma_f32_32x32x16_bf16 v[48:63], v[120:123], v[124:127], v[48:63]
    s_waitcnt lgkmcnt(3)
    v_mfma_f32_32x32x16_bf16 v[48:63], v[128:131], v[132:135], v[48:63]
    s_waitcnt lgkmcnt(0)
    v_mfma_f32_32x32x16_bf16 v[48:63], v[136:139], v[140:143], v[48:63]
    s_waitcnt vmcnt(6)
    s_barrier
    ds_read_b128 v[112:115], v5 offset:32768
    ds_read_b64_tr_b16 v[116:117], v9 offset:16384
    ds_read_b64_tr_b16 v[118:119], v9 offset:16896
    ds_read_b128 v[120:123], v6 offset:32768
    ds_read_b64_tr_b16 v[124:125], v9 offset:18432
    ds_read_b64_tr_b16 v[126:127], v9 offset:18944
    ds_read_b128 v[128:131], v7 offset:32768
    ds_read_b64_tr_b16 v[132:133], v9 offset:20480
    ds_read_b64_tr_b16 v[134:135], v9 offset:20992
    ds_read_b128 v[136:139], v8 offset:32768
    ds_read_b64_tr_b16 v[140:141], v9 offset:22528
    ds_read_b64_tr_b16 v[142:143], v9 offset:23040
    s_add_u32 m0, s83, 16384
    s_nop 0
    buffer_load_dwordx4 v2, s[44:47], s82 offen lds
    s_add_u32 m0, s83, 17408
    s_nop 0
    buffer_load_dwordx4 v3, s[44:47], s82 offen lds
    s_add_u32 s82, s82, 128
    s_waitcnt lgkmcnt(9)
    v_mfma_f32_32x32x16_bf16 v[48:63], v[112:115], v[116:119], v[48:63]
    s_waitcnt lgkmcnt(6)
    v_mfma_f32_32x32x16_bf16 v[48:63], v[120:123], v[124:127], v[48:63]
    s_waitcnt lgkmcnt(3)
    v_mfma_f32_32x32x16_bf16 v[48:63], v[128:131], v[132:135], v[48:63]
    s_waitcnt lgkmcnt(0)
    v_mfma_f32_32x32x16_bf16 v[48:63], v[136:139], v[140:143], v[48:63]
    s_waitcnt vmcnt(6)
    s_barrier
    ds_read_b128 v[112:115], v5 offset:49152
    ds_read_b64_tr_b16 v[116:117], v9 offset:24576
    ds_read_b64_tr_b16 v[118:119], v9 offset:25088
    ds_read_b128 v[120:123], v6 offset:49152
    ds_read_b64_tr_b16 v[124:125], v9 offset:26624
    ds_read_b64_tr_b16 v[126:127], v9 offset:27136
    ds_read_b128 v[128:131], v7 offset:49152
    ds_read_b64_tr_b16 v[132:133], v9 offset:28672
    ds_read_b64_tr_b16 v[134:135], v9 offset:29184
    ds_read_b128 v[136:139], v8 offset:49152
    ds_read_b64_tr_b16 v[140:141], v9 offset:30720
    ds_read_b64_tr_b16 v[142:143], v9 offset:31232
    s_add_u32 m0, s83, 32768
    s_nop 0
    buffer_load_dwordx4 v2, s[44:47], s82 offen lds
    s_add_u32 m0, s83, 33792
    s_nop 0
    buffer_load_dwordx4 v3, s[44:47], s82 offen lds
    s_add_u32 s82, s82, 128
    s_waitcnt lgkmcnt(9)
    v_mfma_f32_32x32x16_bf16 v[48:63], v[112:115], v[116:119], v[48:63]
    s_waitcnt lgkmcnt(6)
    v_mfma_f32_32x32x16_bf16 v[48:63], v[120:123], v[124:127], v[48:63]
    s_waitcnt lgkmcnt(3)
    v_mfma_f32_32x32x16_bf16 v[48:63], v[128:131], v[132:135], v[48:63]
    s_waitcnt lgkmcnt(0)
    v_mfma_f32_32x32x16_bf16 v[48:63], v[136:139], v[140:143], v[48:63]
    s_waitcnt vmcnt(6)
    s_barrier
    v_add_u32 v11, 0x10000, v5
    ds_read_b128 v[112:115], v11
    ds_read_b64_tr_b16 v[116:117], v9 offset:32768
    ds_read_b64_tr_b16 v[118:119], v9 offset:33280
    v_add_u32 v12, 0x10000, v6
    ds_read_b128 v[120:123], v12
    ds_read_b64_tr_b16 v[124:125], v9 offset:34816
    ds_read_b64_tr_b16 v[126:127], v9 offset:35328
    v_add_u32 v13, 0x10000, v7
    ds_read_b128 v[128:131], v13
    ds_read_b64_tr_b16 v[132:133], v9 offset:36864
    ds_read_b64_tr_b16 v[134:135], v9 offset:37376
    v_add_u32 v14, 0x10000, v8
    ds_read_b128 v[136:139], v14
    ds_read_b64_tr_b16 v[140:141], v9 offset:38912
    ds_read_b64_tr_b16 v[142:143], v9 offset:39424
    s_add_u32 m0, s83, 49152
    s_nop 0
    buffer_load_dwordx4 v2, s[44:47], s82 offen lds
    s_add_u32 m0, s83, 50176
    s_nop 0
    buffer_load_dwordx4 v3, s[44:47], s82 offen lds
    s_add_u32 s82, s82, 128
    s_waitcnt lgkmcnt(9)
    v_mfma_f32_32x32x16_bf16 v[48:63], v[112:115], v[116:119], v[48:63]
    s_waitcnt lgkmcnt(6)
    v_mfma_f32_32x32x16_bf16 v[48:63], v[120:123], v[124:127], v[48:63]
    s_waitcnt lgkmcnt(3)
    v_mfma_f32_32x32x16_bf16 v[48:63], v[128:131], v[132:135], v[48:63]
    s_waitcnt lgkmcnt(0)
    v_mfma_f32_32x32x16_bf16 v[48:63], v[136:139], v[140:143], v[48:63]
    s_waitcnt vmcnt(6)
    s_barrier
    ds_read_b128 v[112:115], v5 offset:0
    ds_read_b64_tr_b16 v[116:117], v9 offset:40960
    ds_read_b64_tr_b16 v[118:119], v9 offset:41472
    ds_read_b128 v[120:123], v6 offset:0
    ds_read_b64_tr_b16 v[124:125], v9 offset:43008
    ds_read_b64_tr_b16 v[126:127], v9 offset:43520
    ds_read_b128 v[128:131], v7 offset:0
    ds_read_b64_tr_b16 v[132:133], v9 offset:45056
    ds_read_b64_tr_b16 v[134:135], v9 offset:45568
    ds_read_b128 v[136:139], v8 offset:0
    ds_read_b64_tr_b16 v[140:141], v9 offset:47104
    ds_read_b64_tr_b16 v[142:143], v9 offset:47616
    s_waitcnt lgkmcnt(9)
    v_mfma_f32_32x32x16_bf16 v[48:63], v[112:115], v[116:119], v[48:63]
    s_waitcnt lgkmcnt(6)
    v_mfma_f32_32x32x16_bf16 v[48:63], v[120:123], v[124:127], v[48:63]
    s_waitcnt lgkmcnt(3)
    v_mfma_f32_32x32x16_bf16 v[48:63], v[128:131], v[132:135], v[48:63]
    s_waitcnt lgkmcnt(0)
    v_mfma_f32_32x32x16_bf16 v[48:63], v[136:139], v[140:143], v[48:63]
    s_waitcnt vmcnt(4)
    s_barrier
    ds_read_b128 v[112:115], v5 offset:16384
    ds_read_b64_tr_b16 v[116:117], v9 offset:49152
    ds_read_b64_tr_b16 v[118:119], v9 offset:49664
    ds_read_b128 v[120:123], v6 offset:16384
    ds_read_b64_tr_b16 v[124:125], v9 offset:51200
    ds_read_b64_tr_b16 v[126:127], v9 offset:51712
    ds_read_b128 v[128:131], v7 offset:16384
    ds_read_b64_tr_b16 v[132:133], v9 offset:53248
    ds_read_b64_tr_b16 v[134:135], v9 offset:53760
    ds_read_b128 v[136:139], v8 offset:16384
    ds_read_b64_tr_b16 v[140:141], v9 offset:55296
    ds_read_b64_tr_b16 v[142:143], v9 offset:55808
    s_waitcnt lgkmcnt(9)
    v_mfma_f32_32x32x16_bf16 v[48:63], v[112:115], v[116:119], v[48:63]
    s_waitcnt lgkmcnt(6)
    v_mfma_f32_32x32x16_bf16 v[48:63], v[120:123], v[124:127], v[48:63]
    s_waitcnt lgkmcnt(3)
    v_mfma_f32_32x32x16_bf16 v[48:63], v[128:131], v[132:135], v[48:63]
    s_waitcnt lgkmcnt(0)
    v_mfma_f32_32x32x16_bf16 v[48:63], v[136:139], v[140:143], v[48:63]
    s_waitcnt vmcnt(2)
    s_barrier
    ds_read_b128 v[112:115], v5 offset:32768
    ds_read_b64_tr_b16 v[116:117], v9 offset:57344
    ds_read_b64_tr_b16 v[118:119], v9 offset:57856
    ds_read_b128 v[120:123], v6 offset:32768
    ds_read_b64_tr_b16 v[124:125], v9 offset:59392
    ds_read_b64_tr_b16 v[126:127], v9 offset:59904
    ds_read_b128 v[128:131], v7 offset:32768
    ds_read_b64_tr_b16 v[132:133], v9 offset:61440
    ds_read_b64_tr_b16 v[134:135], v9 offset:61952
    ds_read_b128 v[136:139], v8 offset:32768
    ds_read_b64_tr_b16 v[140:141], v9 offset:63488
    ds_read_b64_tr_b16 v[142:143], v9 offset:64000
    s_waitcnt lgkmcnt(9)
    v_mfma_f32_32x32x16_bf16 v[48:63], v[112:115], v[116:119], v[48:63]
    s_waitcnt lgkmcnt(6)
    v_mfma_f32_32x32x16_bf16 v[48:63], v[120:123], v[124:127], v[48:63]
    s_waitcnt lgkmcnt(3)
    v_mfma_f32_32x32x16_bf16 v[48:63], v[128:131], v[132:135], v[48:63]
    s_waitcnt lgkmcnt(0)
    v_mfma_f32_32x32x16_bf16 v[48:63], v[136:139], v[140:143], v[48:63]
    s_waitcnt vmcnt(0)
    s_barrier
    ds_read_b128 v[112:115], v5 offset:49152
    ds_read_b64_tr_b16 v[116:117], v10 offset:0
    ds_read_b64_tr_b16 v[118:119], v10 offset:512
    ds_read_b128 v[120:123], v6 offset:49152
    ds_read_b64_tr_b16 v[124:125], v10 offset:2048
    ds_read_b64_tr_b16 v[126:127], v10 offset:2560
    ds_read_b128 v[128:131], v7 offset:49152
    ds_read_b64_tr_b16 v[132:133], v10 offset:4096
    ds_read_b64_tr_b16 v[134:135], v10 offset:4608
    ds_read_b128 v[136:139], v8 offset:49152
    ds_read_b64_tr_b16 v[140:141], v10 offset:6144
    ds_read_b64_tr_b16 v[142:143], v10 offset:6656
    s_waitcnt lgkmcnt(9)
    v_mfma_f32_32x32x16_bf16 v[48:63], v[112:115], v[116:119], v[48:63]
    s_waitcnt lgkmcnt(6)
    v_mfma_f32_32x32x16_bf16 v[48:63], v[120:123], v[124:127], v[48:63]
    s_waitcnt lgkmcnt(3)
    v_mfma_f32_32x32x16_bf16 v[48:63], v[128:131], v[132:135], v[48:63]
    s_waitcnt lgkmcnt(0)
    v_mfma_f32_32x32x16_bf16 v[48:63], v[136:139], v[140:143], v[48:63]
AP_E_10:
    s_barrier
    s_mov_b32 s44, s28
    s_and_b32 s45, s29, 0xffff
    s_mov_b32 s46, 2097152
    s_mov_b32 s47, 0x00020000
    s_mov_b32 s48, s32
    s_and_b32 s49, s33, 0xffff
    s_mov_b32 s50, 4194304
    s_mov_b32 s51, 0x00020000
    s_mov_b32 s52, s34
    s_and_b32 s53, s35, 0xffff
    s_mov_b32 s54, 4194304
    s_mov_b32 s55, 0x00020000
    s_mov_b32 s56, s42
    s_and_b32 s57, s43, 0xffff
    s_mov_b32 s58, 268435456
    s_mov_b32 s59, 0x00020000
    s_and_b32 s66, s2, 31
    s_lshr_b32 s67, s2, 5
    v_lshrrev_b32 v11, 3, v1
    s_lshl_b32 s69, s67, 8
    s_lshl_b32 s70, s64, 5
    s_add_u32 s69, s69, s70
    v_add_u32 v11, s69, v11
    v_lshlrev_b32 v11, 10, v11
    v_lshrrev_b32 v12, 4, v1
    v_and_b32 v13, 7, v1
    v_xor_b32 v14, v13, v12
    v_lshl_add_u32 v2, v14, 4, v11
    v_xor_b32 v14, 4, v14
    v_lshl_add_u32 v3, v14, 4, v11
    v_add_u32 v3, 8192, v3
    v_and_b32 v13, 15, v1
    v_lshlrev_b32 v14, 2, v12
    v_xor_b32 v13, v13, v14
    v_lshlrev_b32 v13, 4, v13
    v_lshl_add_u32 v4, v12, 13, v13
    s_lshl_b32 s69, s66, 8
    v_add_u32 v4, s69, v4
    v_and_b32 v11, 31, v1
    s_and_b32 s69, s64, 1
    s_lshl_b32 s69, s69, 7
    v_add_u32 v12, s69, v11
    v_lshlrev_b32 v12, 7, v12
    v_bfe_u32 v13, v1, 1, 3
    v_lshrrev_b32 v14, 5, v1
    v_add_u32 v15, 0, v14
    v_xor_b32 v15, v15, v13
    v_lshl_add_u32 v5, v15, 4, v12
    v_add_u32 v15, 2, v14
    v_xor_b32 v15, v15, v13
    v_lshl_add_u32 v6, v15, 4, v12
    v_add_u32 v15, 4, v14
    v_xor_b32 v15, v15, v13
    v_lshl_add_u32 v7, v15, 4, v12
    v_add_u32 v15, 6, v14
    v_xor_b32 v15, v15, v13
    v_lshl_add_u32 v8, v15, 4, v12
    v_bfe_u32 v11, v1, 2, 2
    v_lshrrev_b32 v12, 5, v1
    v_lshl_add_u32 v12, v12, 3, v11
    v_lshlrev_b32 v12, 8, v12
    v_bfe_u32 v13, v1, 4, 1
    v_bfe_u32 v14, v1, 1, 1
    v_lshl_add_u32 v13, v13, 1, v14
    v_lshl_add_u32 v12, v13, 4, v12
    v_and_b32 v13, 1, v1
    v_lshl_add_u32 v12, v13, 3, v12
    s_lshr_b32 s69, s64, 2
    s_lshl_b32 s69, s69, 14
    s_add_u32 s69, s69, 32768
    v_add_u32 v12, s69, v12
    s_and_b32 s69, s64, 2
    s_add_u32 s70, s69, 0
    v_xor_b32 v13, s70, v11
    v_lshl_add_u32 v9, v13, 6, v12
    s_add_u32 s70, s69, 1
    v_xor_b32 v13, s70, v11
    v_lshl_add_u32 v10, v13, 6, v12
    s_lshl_b32 s75, s64, 12
    s_lshl_b32 s76, s64, 11
    s_add_u32 s76, s76, 32768
    s_lshl_b32 s74, s64, 16
    s_mov_b32 s73, 0
    s_add_u32 m0, s75, 0
    s_nop 0
    buffer_load_dwordx4 v2, s[44:47], s73 offen lds
    s_add_u32 m0, s75, 1024
    s_nop 0
    buffer_load_dwordx4 v3, s[44:47], s73 offen lds
    s_add_u32 m0, s75, 2048
    s_add_u32 s69, s73, 16384
    buffer_load_dwordx4 v2, s[44:47], s69 offen lds
    s_add_u32 m0, s75, 3072
    s_add_u32 s69, s73, 16384
    buffer_load_dwordx4 v3, s[44:47], s69 offen lds
    s_add_u32 s69, s74, 0
    s_add_u32 m0, s76, 0
    s_nop 0
    buffer_load_dwordx4 v4, s[48:51], s69 offen lds
    s_add_u32 m0, s76, 16384
    s_nop 0
    buffer_load_dwordx4 v4, s[52:55], s69 offen lds
    s_add_u32 s69, s74, 32768
    s_add_u32 m0, s76, 1024
    s_nop 0
    buffer_load_dwordx4 v4, s[48:51], s69 offen lds
    s_add_u32 m0, s76, 17408
    s_nop 0
    buffer_load_dwordx4 v4, s[52:55], s69 offen lds
    s_add_u32 s73, s73, 128
    s_add_u32 s74, s74, 524288
    s_add_u32 m0, s75, 65536
    s_nop 0
    buffer_load_dwordx4 v2, s[44:47], s73 offen lds
    s_add_u32 m0, s75, 66560
    s_nop 0
    buffer_load_dwordx4 v3, s[44:47], s73 offen lds
    s_add_u32 m0, s75, 67584
    s_add_u32 s69, s73, 16384
    buffer_load_dwordx4 v2, s[44:47], s69 offen lds
    s_add_u32 m0, s75, 68608
    s_add_u32 s69, s73, 16384
    buffer_load_dwordx4 v3, s[44:47], s69 offen lds
    s_add_u32 s69, s74, 0
    s_add_u32 m0, s76, 65536
    s_nop 0
    buffer_load_dwordx4 v4, s[48:51], s69 offen lds
    s_add_u32 m0, s76, 81920
    s_nop 0
    buffer_load_dwordx4 v4, s[52:55], s69 offen lds
    s_add_u32 s69, s74, 32768
    s_add_u32 m0, s76, 66560
    s_nop 0
    buffer_load_dwordx4 v4, s[48:51], s69 offen lds
    s_add_u32 m0, s76, 82944
    s_nop 0
    buffer_load_dwordx4 v4, s[52:55], s69 offen lds
    s_add_u32 s73, s73, 128
    s_add_u32 s74, s74, 524288
    s_nop 15
    s_cmp_lg_u32 s79, 9
    s_cbranch_scc1 AP_Q_11
    v_cvt_pk_bf16_f32 v112, v48, v49
    v_cvt_pk_bf16_f32 v113, v50, v51
    v_cvt_pk_bf16_f32 v114, v52, v53
    v_cvt_pk_bf16_f32 v115, v54, v55
    v_cvt_pk_bf16_f32 v116, v56, v57
    v_cvt_pk_bf16_f32 v117, v58, v59
    v_cvt_pk_bf16_f32 v118, v60, v61
    v_cvt_pk_bf16_f32 v119, v62, v63
    s_cmp_ge_u32 s64, 4
    s_cbranch_scc1 AP_K_14
    v_mov_b32 v96, 0
    v_lshlrev_b32 v97, 16, v112
    v_and_b32 v98, 0xffff0000, v112
    v_fmac_f32 v96, v97, v97
    v_fmac_f32 v96, v98, v98
    v_lshlrev_b32 v97, 16, v113
    v_and_b32 v98, 0xffff0000, v113
    v_fmac_f32 v96, v97, v97
    v_fmac_f32 v96, v98, v98
    v_lshlrev_b32 v97, 16, v114
    v_and_b32 v98, 0xffff0000, v114
    v_fmac_f32 v96, v97, v97
    v_fmac_f32 v96, v98, v98
    v_lshlrev_b32 v97, 16, v115
    v_and_b32 v98, 0xffff0000, v115
    v_fmac_f32 v96, v97, v97
    v_fmac_f32 v96, v98, v98
    v_lshlrev_b32 v97, 16, v116
    v_and_b32 v98, 0xffff0000, v116
    v_fmac_f32 v96, v97, v97
    v_fmac_f32 v96, v98, v98
    v_lshlrev_b32 v97, 16, v117
    v_and_b32 v98, 0xffff0000, v117
    v_fmac_f32 v96, v97, v97
    v_fmac_f32 v96, v98, v98
    v_lshlrev_b32 v97, 16, v118
    v_and_b32 v98, 0xffff0000, v118
    v_fmac_f32 v96, v97, v97
    v_fmac_f32 v96, v98, v98
    v_lshlrev_b32 v97, 16, v119
    v_and_b32 v98, 0xffff0000, v119
    v_fmac_f32 v96, v97, v97
    v_fmac_f32 v96, v98, v98
    v_mov_b32 v97, v96
    s_nop 1
    v_permlane32_swap_b32 v96, v97
    s_nop 1
    v_add_f32 v96, v96, v97
    v_and_b32 v96, 0x7fffffff, v96
    ds_swizzle_b32 v97, v96 offset:0x41f
    s_waitcnt lgkmcnt(0)
    v_max_u32 v96, v96, v97
    ds_swizzle_b32 v97, v96 offset:0x81f
    s_waitcnt lgkmcnt(0)
    v_max_u32 v96, v96, v97
    ds_swizzle_b32 v97, v96 offset:0x101f
    s_waitcnt lgkmcnt(0)
    v_max_u32 v96, v96, v97
    ds_swizzle_b32 v97, v96 offset:0x201f
    s_waitcnt lgkmcnt(0)
    v_max_u32 v96, v96, v97
    ds_swizzle_b32 v97, v96 offset:0x401f
    s_waitcnt lgkmcnt(0)
    v_max_u32 v96, v96, v97
    s_lshl_b32 s80, s78, 2
    s_add_u32 s80, s80, s64
    s_lshl_b32 s80, s80, 2
    s_add_u32 s80, s80, 62922752
    v_mov_b32 v97, 0
    s_mov_b64 exec, 1
    buffer_store_dword v96, v97, s[56:59], s80 offen sc1
    s_mov_b64 exec, -1
    s_lshl_b32 s80, s78, 2
    s_add_u32 s80, s80, s64
    s_mul_i32 s80, s80, 2368
    s_add_u32 s80, s80, 54525952
    v_lshlrev_b32 v96, 4, v1
    buffer_store_dwordx4 v[112:115], v96, s[56:59], s80 offen sc1
    v_lshlrev_b32 v96, 2, v1
    s_mov_b64 exec, 0xffffffff
    buffer_store_dword v116, v96, s[56:59], s80 offen offset:1024 sc1
    s_mov_b64 exec, -1
    s_branch AP_D_12
AP_K_14:
    v_and_b32 v96, 31, v1
    v_cmp_eq_u32 vcc, 18, v96
    v_mov_b32 v97, 0x3f803f80
    s_nop 0
    v_cndmask_b32 v112, v112, v97, vcc
    v_cndmask_b32 v113, v113, v97, vcc
    v_cndmask_b32 v114, v114, v97, vcc
    v_cndmask_b32 v115, v115, v97, vcc
    v_cndmask_b32 v116, v116, v97, vcc
    v_cndmask_b32 v117, v117, v97, vcc
    v_cndmask_b32 v118, v118, v97, vcc
    v_cndmask_b32 v119, v119, v97, vcc
    s_lshl_b32 s80, s78, 2
    s_and_b32 s83, s64, 3
    s_add_u32 s80, s80, s83
    s_mul_i32 s80, s80, 2368
    s_add_u32 s80, s80, 54525952
    v_cmp_gt_u32 vcc, 19, v96
    v_lshrrev_b32 v97, 5, v1
    v_mul_u32_u24 v97, 304, v97
    v_lshl_add_u32 v96, v96, 4, v97
    s_and_saveexec_b64 s[84:85], vcc
    buffer_store_dwordx4 v[112:115], v96, s[56:59], s80 offen offset:1152 sc1
    buffer_store_dwordx4 v[116:119], v96, s[56:59], s80 offen offset:1760 sc1
    s_mov_b64 exec, s[84:85]
    s_branch AP_D_12
AP_Q_11:
    s_mov_b32 s80, 0x3eae1a93
    v_mul_f32 v48, s80, v48
    v_mul_f32 v49, s80, v49
    v_mul_f32 v50, s80, v50
    v_mul_f32 v51, s80, v51
    v_mul_f32 v52, s80, v52
    v_mul_f32 v53, s80, v53
    v_mul_f32 v54, s80, v54
    v_mul_f32 v55, s80, v55
    v_mul_f32 v56, s80, v56
    v_mul_f32 v57, s80, v57
    v_mul_f32 v58, s80, v58
    v_mul_f32 v59, s80, v59
    v_mul_f32 v60, s80, v60
    v_mul_f32 v61, s80, v61
    v_mul_f32 v62, s80, v62
    v_mul_f32 v63, s80, v63
    v_cvt_pk_bf16_f32 v112, v48, v49
    v_cvt_pk_bf16_f32 v113, v50, v51
    v_cvt_pk_bf16_f32 v114, v52, v53
    v_cvt_pk_bf16_f32 v115, v54, v55
    v_cvt_pk_bf16_f32 v116, v56, v57
    v_cvt_pk_bf16_f32 v117, v58, v59
    v_cvt_pk_bf16_f32 v118, v60, v61
    v_cvt_pk_bf16_f32 v119, v62, v63
    v_and_b32 v96, 31, v1
    s_lshl_b32 s80, s78, 7
    s_and_b32 s81, s64, 3
    s_lshl_b32 s81, s81, 5
    s_add_u32 s80, s80, s81
    v_add_u32 v96, s80, v96
    s_movk_i32 s80, 1152
    v_mul_lo_u32 v96, v96, s80
    v_lshrrev_b32 v97, 5, v1
    v_lshl_add_u32 v96, v97, 3, v96
    s_lshl_b32 s80, s79, 7
    s_lshr_b32 s81, s64, 2
    s_lshl_b32 s81, s81, 6
    s_add_u32 s80, s80, s81
    s_add_u32 s80, s80, 50331648
    buffer_store_dwordx2 v[112:113], v96, s[56:59], s80 offen offset:0 sc1
    buffer_store_dwordx2 v[114:115], v96, s[56:59], s80 offen offset:16 sc1
    buffer_store_dwordx2 v[116:117], v96, s[56:59], s80 offen offset:32 sc1
    buffer_store_dwordx2 v[118:119], v96, s[56:59], s80 offen offset:48 sc1
AP_D_12:
    s_waitcnt vmcnt(10)
    s_branch F_AP_5
F_NOAP_4:
    s_mov_b32 s44, s28
    s_and_b32 s45, s29, 0xffff
    s_mov_b32 s46, 2097152
    s_mov_b32 s47, 0x00020000
    s_mov_b32 s48, s32
    s_and_b32 s49, s33, 0xffff
    s_mov_b32 s50, 4194304
    s_mov_b32 s51, 0x00020000
    s_mov_b32 s52, s34
    s_and_b32 s53, s35, 0xffff
    s_mov_b32 s54, 4194304
    s_mov_b32 s55, 0x00020000
    s_mov_b32 s56, s42
    s_and_b32 s57, s43, 0xffff
    s_mov_b32 s58, 268435456
    s_mov_b32 s59, 0x00020000
    s_and_b32 s66, s2, 31
    s_lshr_b32 s67, s2, 5
    v_lshrrev_b32 v11, 3, v1
    s_lshl_b32 s69, s67, 8
    s_lshl_b32 s70, s64, 5
    s_add_u32 s69, s69, s70
    v_add_u32 v11, s69, v11
    v_lshlrev_b32 v11, 10, v11
    v_lshrrev_b32 v12, 4, v1
    v_and_b32 v13, 7, v1
    v_xor_b32 v14, v13, v12
    v_lshl_add_u32 v2, v14, 4, v11
    v_xor_b32 v14, 4, v14
    v_lshl_add_u32 v3, v14, 4, v11
    v_add_u32 v3, 8192, v3
    v_and_b32 v13, 15, v1
    v_lshlrev_b32 v14, 2, v12
    v_xor_b32 v13, v13, v14
    v_lshlrev_b32 v13, 4, v13
    v_lshl_add_u32 v4, v12, 13, v13
    s_lshl_b32 s69, s66, 8
    v_add_u32 v4, s69, v4
    v_and_b32 v11, 31, v1
    s_and_b32 s69, s64, 1
    s_lshl_b32 s69, s69, 7
    v_add_u32 v12, s69, v11
    v_lshlrev_b32 v12, 7, v12
    v_bfe_u32 v13, v1, 1, 3
    v_lshrrev_b32 v14, 5, v1
    v_add_u32 v15, 0, v14
    v_xor_b32 v15, v15, v13
    v_lshl_add_u32 v5, v15, 4, v12
    v_add_u32 v15, 2, v14
    v_xor_b32 v15, v15, v13
    v_lshl_add_u32 v6, v15, 4, v12
    v_add_u32 v15, 4, v14
    v_xor_b32 v15, v15, v13
    v_lshl_add_u32 v7, v15, 4, v12
    v_add_u32 v15, 6, v14
    v_xor_b32 v15, v15, v13
    v_lshl_add_u32 v8, v15, 4, v12
    v_bfe_u32 v11, v1, 2, 2
    v_lshrrev_b32 v12, 5, v1
    v_lshl_add_u32 v12, v12, 3, v11
    v_lshlrev_b32 v12, 8, v12
    v_bfe_u32 v13, v1, 4, 1
    v_bfe_u32 v14, v1, 1, 1
    v_lshl_add_u32 v13, v13, 1, v14
    v_lshl_add_u32 v12, v13, 4, v12
    v_and_b32 v13, 1, v1
    v_lshl_add_u32 v12, v13, 3, v12
    s_lshr_b32 s69, s64, 2
    s_lshl_b32 s69, s69, 14
    s_add_u32 s69, s69, 32768
    v_add_u32 v12, s69, v12
    s_and_b32 s69, s64, 2
    s_add_u32 s70, s69, 0
    v_xor_b32 v13, s70, v11
    v_lshl_add_u32 v9, v13, 6, v12
    s_add_u32 s70, s69, 1
    v_xor_b32 v13, s70, v11
    v_lshl_add_u32 v10, v13, 6, v12
    s_lshl_b32 s75, s64, 12
    s_lshl_b32 s76, s64, 11
    s_add_u32 s76, s76, 32768
    s_lshl_b32 s74, s64, 16
    s_mov_b32 s73, 0
    s_add_u32 m0, s75, 0
    s_nop 0
    buffer_load_dwordx4 v2, s[44:47], s73 offen lds
    s_add_u32 m0, s75, 1024
    s_nop 0
    buffer_load_dwordx4 v3, s[44:47], s73 offen lds
    s_add_u32 m0, s75, 2048
    s_add_u32 s69, s73, 16384
    buffer_load_dwordx4 v2, s[44:47], s69 offen lds
    s_add_u32 m0, s75, 3072
    s_add_u32 s69, s73, 16384
    buffer_load_dwordx4 v3, s[44:47], s69 offen lds
    s_add_u32 s69, s74, 0
    s_add_u32 m0, s76, 0
    s_nop 0
    buffer_load_dwordx4 v4, s[48:51], s69 offen lds
    s_add_u32 m0, s76, 16384
    s_nop 0
    buffer_load_dwordx4 v4, s[52:55], s69 offen lds
    s_add_u32 s69, s74, 32768
    s_add_u32 m0, s76, 1024
    s_nop 0
    buffer_load_dwordx4 v4, s[48:51], s69 offen lds
    s_add_u32 m0, s76, 17408
    s_nop 0
    buffer_load_dwordx4 v4, s[52:55], s69 offen lds
    s_add_u32 s73, s73, 128
    s_add_u32 s74, s74, 524288
    s_add_u32 m0, s75, 65536
    s_nop 0
    buffer_load_dwordx4 v2, s[44:47], s73 offen lds
    s_add_u32 m0, s75, 66560
    s_nop 0
    buffer_load_dwordx4 v3, s[44:47], s73 offen lds
    s_add_u32 m0, s75, 67584
    s_add_u32 s69, s73, 16384
    buffer_load_dwordx4 v2, s[44:47], s69 offen lds
    s_add_u32 m0, s75, 68608
    s_add_u32 s69, s73, 16384
    buffer_load_dwordx4 v3, s[44:47], s69 offen lds
    s_add_u32 s69, s74, 0
    s_add_u32 m0, s76, 65536
    s_nop 0
    buffer_load_dwordx4 v4, s[48:51], s69 offen lds
    s_add_u32 m0, s76, 81920
    s_nop 0
    buffer_load_dwordx4 v4, s[52:55], s69 offen lds
    s_add_u32 s69, s74, 32768
    s_add_u32 m0, s76, 66560
    s_nop 0
    buffer_load_dwordx4 v4, s[48:51], s69 offen lds
    s_add_u32 m0, s76, 82944
    s_nop 0
    buffer_load_dwordx4 v4, s[52:55], s69 offen lds
    s_add_u32 s73, s73, 128
    s_add_u32 s74, s74, 524288
    s_sub_u32 s13, s2, 160
    s_lshr_b32 s13, s13, 3
    s_mul_i32 s12, s13, 342
    v_add_u32 v100, s12, v0
    v_cmp_gt_u32 vcc, 342, v0
    v_lshrrev_b32 v101, 1, v100
    v_lshlrev_b32 v101, 10, v101
    v_and_b32 v102, 1, v100
    v_lshl_add_u32 v101, v102, 7, v101
    v_cndmask_b32 v101, -1, v101, vcc
    s_mul_i32 s12, s13, 86
    v_add_u32 v100, s12, v0
    v_cmp_gt_u32 vcc, 86, v0
    v_lshrrev_b32 v102, 8, v100
    v_lshlrev_b32 v102, 11, v102
    s_and_b32 s12, s2, 7
    s_lshl_b32 s12, s12, 8
    v_add_u32 v102, s12, v102
    v_bfe_u32 v103, v100, 1, 7
    v_lshl_add_u32 v102, v103, 13, v102
    v_and_b32 v103, 1, v100
    v_lshl_add_u32 v102, v103, 7, v102
    s_mov_b64 s[10:11], vcc
    v_cmp_gt_u32 vcc, 1024, v100
    s_and_b64 vcc, vcc, s[10:11]
    s_nop 1
    v_cndmask_b32 v102, -1, v102, vcc
    v_mov_b32 v108, v101
    v_mov_b32 v109, v102
    s_mov_b32 s12, 0
    s_mov_b32 s13, 0
    buffer_load_dword v104, v108, s[44:47], s12 offen
    buffer_load_dword v105, v109, s[48:51], s13 offen
    buffer_load_dword v106, v109, s[52:55], s13 offen
    s_mov_b32 s12, 256
    s_mov_b32 s13, 1048576
    buffer_load_dword v104, v108, s[44:47], s12 offen
    buffer_load_dword v105, v109, s[48:51], s13 offen
    buffer_load_dword v106, v109, s[52:55], s13 offen
    s_waitcnt vmcnt(14)
F_AP_5:
    s_waitcnt vmcnt(63)
    s_barrier
    ds_read_b128 v[16:19], v5 offset:0
    ds_read_b128 v[20:23], v5 offset:4096
    ds_read_b128 v[24:27], v5 offset:8192
    ds_read_b128 v[28:31], v5 offset:12288
    ds_read_b64_tr_b16 v[32:33], v9 offset:0
    ds_read_b64_tr_b16 v[34:35], v9 offset:1024
    ds_read_b64_tr_b16 v[36:37], v10 offset:0
    ds_read_b64_tr_b16 v[38:39], v10 offset:1024
    s_cmp_ge_u32 s64, 4
    s_cbranch_scc1 KV_V_15
    s_waitcnt lgkmcnt(0)
    v_mfma_f32_32x32x16_bf16 v[128:143], v[32:35], v[16:19], 0
    ds_read_b128 v[40:43], v6 offset:0
    ds_read_b128 v[44:47], v6 offset:4096
    v_mfma_f32_32x32x16_bf16 v[144:159], v[36:39], v[16:19], 0
    ds_read_b128 v[48:51], v6 offset:8192
    ds_read_b128 v[52:55], v6 offset:12288
    v_mfma_f32_32x32x16_bf16 v[160:175], v[32:35], v[20:23], 0
    ds_read_b64_tr_b16 v[56:57], v9 offset:4096
    ds_read_b64_tr_b16 v[58:59], v9 offset:5120
    v_mfma_f32_32x32x16_bf16 v[176:191], v[36:39], v[20:23], 0
    ds_read_b64_tr_b16 v[60:61], v10 offset:4096
    ds_read_b64_tr_b16 v[62:63], v10 offset:5120
    v_mfma_f32_32x32x16_bf16 v[192:207], v[32:35], v[24:27], 0
    v_mfma_f32_32x32x16_bf16 v[208:223], v[36:39], v[24:27], 0
    v_mfma_f32_32x32x16_bf16 v[224:239], v[32:35], v[28:31], 0
    v_mfma_f32_32x32x16_bf16 v[240:255], v[36:39], v[28:31], 0
    s_waitcnt lgkmcnt(0)
    v_mfma_f32_32x32x16_bf16 v[128:143], v[56:59], v[40:43], v[128:143]
    ds_read_b128 v[16:19], v7 offset:0
    ds_read_b128 v[20:23], v7 offset:4096
    v_mfma_f32_32x32x16_bf16 v[144:159], v[60:63], v[40:43], v[144:159]
    ds_read_b128 v[24:27], v7 offset:8192
    ds_read_b128 v[28:31], v7 offset:12288
    v_mfma_f32_32x32x16_bf16 v[160:175], v[56:59], v[44:47], v[160:175]
    ds_read_b64_tr_b16 v[32:33], v9 offset:8192
    ds_read_b64_tr_b16 v[34:35], v9 offset:9216
    v_mfma_f32_32x32x16_bf16 v[176:191], v[60:63], v[44:47], v[176:191]
    ds_read_b64_tr_b16 v[36:37], v10 offset:8192
    ds_read_b64_tr_b16 v[38:39], v10 offset:9216
    v_mfma_f32_32x32x16_bf16 v[192:207], v[56:59], v[48:51], v[192:207]
    v_mfma_f32_32x32x16_bf16 v[208:223], v[60:63], v[48:51], v[208:223]
    v_mfma_f32_32x32x16_bf16 v[224:239], v[56:59], v[52:55], v[224:239]
    v_mfma_f32_32x32x16_bf16 v[240:255], v[60:63], v[52:55], v[240:255]
    s_waitcnt lgkmcnt(0)
    v_mfma_f32_32x32x16_bf16 v[128:143], v[32:35], v[16:19], v[128:143]
    ds_read_b128 v[40:43], v8 offset:0
    ds_read_b128 v[44:47], v8 offset:4096
    v_mfma_f32_32x32x16_bf16 v[144:159], v[36:39], v[16:19], v[144:159]
    ds_read_b128 v[48:51], v8 offset:8192
    ds_read_b128 v[52:55], v8 offset:12288
    v_mfma_f32_32x32x16_bf16 v[160:175], v[32:35], v[20:23], v[160:175]
    ds_read_b64_tr_b16 v[56:57], v9 offset:12288
    ds_read_b64_tr_b16 v[58:59], v9 offset:13312
    v_mfma_f32_32x32x16_bf16 v[176:191], v[36:39], v[20:23], v[176:191]
    ds_read_b64_tr_b16 v[60:61], v10 offset:12288
    ds_read_b64_tr_b16 v[62:63], v10 offset:13312
    v_mfma_f32_32x32x16_bf16 v[192:207], v[32:35], v[24:27], v[192:207]
    v_mfma_f32_32x32x16_bf16 v[208:223], v[36:39], v[24:27], v[208:223]
    v_mfma_f32_32x32x16_bf16 v[224:239], v[32:35], v[28:31], v[224:239]
    v_mfma_f32_32x32x16_bf16 v[240:255], v[36:39], v[28:31], v[240:255]
    s_waitcnt vmcnt(0) lgkmcnt(0)
    s_barrier
    v_mfma_f32_32x32x16_bf16 v[128:143], v[56:59], v[40:43], v[128:143]
    v_xor_b32 v5, 0x10000, v5
    v_xor_b32 v6, 0x10000, v6
    v_xor_b32 v7, 0x10000, v7
    v_mfma_f32_32x32x16_bf16 v[144:159], v[60:63], v[40:43], v[144:159]
    v_xor_b32 v8, 0x10000, v8
    v_xor_b32 v9, 0x10000, v9
    v_xor_b32 v10, 0x10000, v10
    s_add_u32 m0, s75, 0
    s_nop 0
    buffer_load_dwordx4 v2, s[44:47], s73 offen lds
    v_mfma_f32_32x32x16_bf16 v[160:175], v[56:59], v[44:47], v[160:175]
    ds_read_b128 v[16:19], v5 offset:0
    ds_read_b128 v[20:23], v5 offset:4096
    ds_read_b128 v[24:27], v5 offset:8192
    v_mfma_f32_32x32x16_bf16 v[176:191], v[60:63], v[44:47], v[176:191]
    ds_read_b128 v[28:31], v5 offset:12288
    ds_read_b64_tr_b16 v[32:33], v9 offset:0
    ds_read_b64_tr_b16 v[34:35], v9 offset:1024
    s_add_u32 m0, s75, 1024
    s_nop 0
    buffer_load_dwordx4 v3, s[44:47], s73 offen lds
    v_mfma_f32_32x32x16_bf16 v[192:207], v[56:59], v[48:51], v[192:207]
    ds_read_b64_tr_b16 v[36:37], v10 offset:0
    ds_read_b64_tr_b16 v[38:39], v10 offset:1024
    v_mfma_f32_32x32x16_bf16 v[208:223], v[60:63], v[48:51], v[208:223]
    s_add_u32 m0, s75, 2048
    s_add_u32 s69, s73, 16384
    buffer_load_dwordx4 v2, s[44:47], s69 offen lds
    v_mfma_f32_32x32x16_bf16 v[224:239], v[56:59], v[52:55], v[224:239]
    v_mfma_f32_32x32x16_bf16 v[240:255], v[60:63], v[52:55], v[240:255]
    s_add_u32 m0, s75, 3072
    s_add_u32 s69, s73, 16384
    buffer_load_dwordx4 v3, s[44:47], s69 offen lds
    s_waitcnt lgkmcnt(0)
    v_mfma_f32_32x32x16_bf16 v[128:143], v[32:35], v[16:19], v[128:143]
    ds_read_b128 v[40:43], v6 offset:0
    ds_read_b128 v[44:47], v6 offset:4096
    v_mfma_f32_32x32x16_bf16 v[144:159], v[36:39], v[16:19], v[144:159]
    ds_read_b128 v[48:51], v6 offset:8192
    ds_read_b128 v[52:55], v6 offset:12288
    s_add_u32 s69, s74, 0
    s_add_u32 m0, s76, 0
    s_nop 0
    buffer_load_dwordx4 v4, s[48:51], s69 offen lds
    v_mfma_f32_32x32x16_bf16 v[160:175], v[32:35], v[20:23], v[160:175]
    ds_read_b64_tr_b16 v[56:57], v9 offset:4096
    ds_read_b64_tr_b16 v[58:59], v9 offset:5120
    v_mfma_f32_32x32x16_bf16 v[176:191], v[36:39], v[20:23], v[176:191]
    ds_read_b64_tr_b16 v[60:61], v10 offset:4096
    ds_read_b64_tr_b16 v[62:63], v10 offset:5120
    s_add_u32 m0, s76, 16384
    s_nop 0
    buffer_load_dwordx4 v4, s[52:55], s69 offen lds
    v_mfma_f32_32x32x16_bf16 v[192:207], v[32:35], v[24:27], v[192:207]
    v_mfma_f32_32x32x16_bf16 v[208:223], v[36:39], v[24:27], v[208:223]
    s_add_u32 s69, s74, 32768
    s_add_u32 m0, s76, 1024
    s_nop 0
    buffer_load_dwordx4 v4, s[48:51], s69 offen lds
    v_mfma_f32_32x32x16_bf16 v[224:239], v[32:35], v[28:31], v[224:239]
    v_mfma_f32_32x32x16_bf16 v[240:255], v[36:39], v[28:31], v[240:255]
    s_add_u32 m0, s76, 17408
    s_nop 0
    buffer_load_dwordx4 v4, s[52:55], s69 offen lds
    s_waitcnt lgkmcnt(0)
    v_mfma_f32_32x32x16_bf16 v[128:143], v[56:59], v[40:43], v[128:143]
    ds_read_b128 v[16:19], v7 offset:0
    ds_read_b128 v[20:23], v7 offset:4096
    v_mfma_f32_32x32x16_bf16 v[144:159], v[60:63], v[40:43], v[144:159]
    ds_read_b128 v[24:27], v7 offset:8192
    ds_read_b128 v[28:31], v7 offset:12288
    s_add_u32 s73, s73, 128
    s_add_u32 s74, s74, 524288
    v_mfma_f32_32x32x16_bf16 v[160:175], v[56:59], v[44:47], v[160:175]
    ds_read_b64_tr_b16 v[32:33], v9 offset:8192
    ds_read_b64_tr_b16 v[34:35], v9 offset:9216
    v_mfma_f32_32x32x16_bf16 v[176:191], v[60:63], v[44:47], v[176:191]
    ds_read_b64_tr_b16 v[36:37], v10 offset:8192
    ds_read_b64_tr_b16 v[38:39], v10 offset:9216
    v_mfma_f32_32x32x16_bf16 v[192:207], v[56:59], v[48:51], v[192:207]
    v_mfma_f32_32x32x16_bf16 v[208:223], v[60:63], v[48:51], v[208:223]
    v_mfma_f32_32x32x16_bf16 v[224:239], v[56:59], v[52:55], v[224:239]
    v_mfma_f32_32x32x16_bf16 v[240:255], v[60:63], v[52:55], v[240:255]
    s_cmp_ge_u32 s2, 160
    s_cbranch_scc1 F_S_17
    s_lshl_b32 s10, s2, 3
    s_add_u32 s10, s10, 4096
    s_cmp_lg_u32 s64, 4
    s_cbranch_scc1 SY_18
    s_memrealtime s[12:13]
    v_mov_b32 v122, s10
    s_mov_b32 s8, 62914560
    s_waitcnt lgkmcnt(0)
    v_mov_b32 v120, s12
    v_mov_b32 v121, s13
    s_mov_b64 exec, 1
    buffer_store_dwordx2 v[120:121], v122, s[56:59], s8 offen sc1
    s_mov_b64 exec, -1
SY_18:
F_S_17:
    s_mov_b32 s12, 512
    s_mov_b32 s13, 2097152
    buffer_load_dword v104, v108, s[44:47], s12 offen
    buffer_load_dword v105, v109, s[48:51], s13 offen
    buffer_load_dword v106, v109, s[52:55], s13 offen
    s_waitcnt lgkmcnt(0)
    v_mfma_f32_32x32x16_bf16 v[128:143], v[32:35], v[16:19], v[128:143]
    ds_read_b128 v[40:43], v8 offset:0
    ds_read_b128 v[44:47], v8 offset:4096
    v_mfma_f32_32x32x16_bf16 v[144:159], v[36:39], v[16:19], v[144:159]
    ds_read_b128 v[48:51], v8 offset:8192
    ds_read_b128 v[52:55], v8 offset:12288
    v_mfma_f32_32x32x16_bf16 v[160:175], v[32:35], v[20:23], v[160:175]
    ds_read_b64_tr_b16 v[56:57], v9 offset:12288
    ds_read_b64_tr_b16 v[58:59], v9 offset:13312
    v_mfma_f32_32x32x16_bf16 v[176:191], v[36:39], v[20:23], v[176:191]
    ds_read_b64_tr_b16 v[60:61], v10 offset:12288
    ds_read_b64_tr_b16 v[62:63], v10 offset:13312
    v_mfma_f32_32x32x16_bf16 v[192:207], v[32:35], v[24:27], v[192:207]
    v_mfma_f32_32x32x16_bf16 v[208:223], v[36:39], v[24:27], v[208:223]
    v_mfma_f32_32x32x16_bf16 v[224:239], v[32:35], v[28:31], v[224:239]
    v_mfma_f32_32x32x16_bf16 v[240:255], v[36:39], v[28:31], v[240:255]
    s_waitcnt vmcnt(3) lgkmcnt(0)
    s_barrier
    v_mfma_f32_32x32x16_bf16 v[128:143], v[56:59], v[40:43], v[128:143]
    v_xor_b32 v5, 0x10000, v5
    v_xor_b32 v6, 0x10000, v6
    v_xor_b32 v7, 0x10000, v7
    v_mfma_f32_32x32x16_bf16 v[144:159], v[60:63], v[40:43], v[144:159]
    v_xor_b32 v8, 0x10000, v8
    v_xor_b32 v9, 0x10000, v9
    v_xor_b32 v10, 0x10000, v10
    s_add_u32 m0, s75, 65536
    s_nop 0
    buffer_load_dwordx4 v2, s[44:47], s73 offen lds
    v_mfma_f32_32x32x16_bf16 v[160:175], v[56:59], v[44:47], v[160:175]
    ds_read_b128 v[16:19], v5 offset:0
    ds_read_b128 v[20:23], v5 offset:4096
    ds_read_b128 v[24:27], v5 offset:8192
    v_mfma_f32_32x32x16_bf16 v[176:191], v[60:63], v[44:47], v[176:191]
    ds_read_b128 v[28:31], v5 offset:12288
    ds_read_b64_tr_b16 v[32:33], v9 offset:0
    ds_read_b64_tr_b16 v[34:35], v9 offset:1024
    s_add_u32 m0, s75, 66560
    s_nop 0
    buffer_load_dwordx4 v3, s[44:47], s73 offen lds
    v_mfma_f32_32x32x16_bf16 v[192:207], v[56:59], v[48:51], v[192:207]
    ds_read_b64_tr_b16 v[36:37], v10 offset:0
    ds_read_b64_tr_b16 v[38:39], v10 offset:1024
    v_mfma_f32_32x32x16_bf16 v[208:223], v[60:63], v[48:51], v[208:223]
    s_add_u32 m0, s75, 67584
    s_add_u32 s69, s73, 16384
    buffer_load_dwordx4 v2, s[44:47], s69 offen lds
    v_mfma_f32_32x32x16_bf16 v[224:239], v[56:59], v[52:55], v[224:239]
    v_mfma_f32_32x32x16_bf16 v[240:255], v[60:63], v[52:55], v[240:255]
    s_add_u32 m0, s75, 68608
    s_add_u32 s69, s73, 16384
    buffer_load_dwordx4 v3, s[44:47], s69 offen lds
    s_waitcnt lgkmcnt(0)
    v_mfma_f32_32x32x16_bf16 v[128:143], v[32:35], v[16:19], v[128:143]
    ds_read_b128 v[40:43], v6 offset:0
    ds_read_b128 v[44:47], v6 offset:4096
    v_mfma_f32_32x32x16_bf16 v[144:159], v[36:39], v[16:19], v[144:159]
    ds_read_b128 v[48:51], v6 offset:8192
    ds_read_b128 v[52:55], v6 offset:12288
    s_add_u32 s69, s74, 0
    s_add_u32 m0, s76, 65536
    s_nop 0
    buffer_load_dwordx4 v4, s[48:51], s69 offen lds
    v_mfma_f32_32x32x16_bf16 v[160:175], v[32:35], v[20:23], v[160:175]
    ds_read_b64_tr_b16 v[56:57], v9 offset:4096
    ds_read_b64_tr_b16 v[58:59], v9 offset:5120
    v_mfma_f32_32x32x16_bf16 v[176:191], v[36:39], v[20:23], v[176:191]
    ds_read_b64_tr_b16 v[60:61], v10 offset:4096
    ds_read_b64_tr_b16 v[62:63], v10 offset:5120
    s_add_u32 m0, s76, 81920
    s_nop 0
    buffer_load_dwordx4 v4, s[52:55], s69 offen lds
    v_mfma_f32_32x32x16_bf16 v[192:207], v[32:35], v[24:27], v[192:207]
    v_mfma_f32_32x32x16_bf16 v[208:223], v[36:39], v[24:27], v[208:223]
    s_add_u32 s69, s74, 32768
    s_add_u32 m0, s76, 66560
    s_nop 0
    buffer_load_dwordx4 v4, s[48:51], s69 offen lds
    v_mfma_f32_32x32x16_bf16 v[224:239], v[32:35], v[28:31], v[224:239]
    v_mfma_f32_32x32x16_bf16 v[240:255], v[36:39], v[28:31], v[240:255]
    s_add_u32 m0, s76, 82944
    s_nop 0
    buffer_load_dwordx4 v4, s[52:55], s69 offen lds
    s_waitcnt lgkmcnt(0)
    v_mfma_f32_32x32x16_bf16 v[128:143], v[56:59], v[40:43], v[128:143]
    ds_read_b128 v[16:19], v7 offset:0
    ds_read_b128 v[20:23], v7 offset:4096
    v_mfma_f32_32x32x16_bf16 v[144:159], v[60:63], v[40:43], v[144:159]
    ds_read_b128 v[24:27], v7 offset:8192
    ds_read_b128 v[28:31], v7 offset:12288
    s_add_u32 s73, s73, 128
    s_add_u32 s74, s74, 524288
    v_mfma_f32_32x32x16_bf16 v[160:175], v[56:59], v[44:47], v[160:175]
    ds_read_b64_tr_b16 v[32:33], v9 offset:8192
    ds_read_b64_tr_b16 v[34:35], v9 offset:9216
    v_mfma_f32_32x32x16_bf16 v[176:191], v[60:63], v[44:47], v[176:191]
    ds_read_b64_tr_b16 v[36:37], v10 offset:8192
    ds_read_b64_tr_b16 v[38:39], v10 offset:9216
    v_mfma_f32_32x32x16_bf16 v[192:207], v[56:59], v[48:51], v[192:207]
    v_mfma_f32_32x32x16_bf16 v[208:223], v[60:63], v[48:51], v[208:223]
    v_mfma_f32_32x32x16_bf16 v[224:239], v[56:59], v[52:55], v[224:239]
    v_mfma_f32_32x32x16_bf16 v[240:255], v[60:63], v[52:55], v[240:255]
    s_mov_b32 s12, 768
    s_mov_b32 s13, 3145728
    buffer_load_dword v104, v108, s[44:47], s12 offen
    buffer_load_dword v105, v109, s[48:51], s13 offen
    buffer_load_dword v106, v109, s[52:55], s13 offen
    s_waitcnt lgkmcnt(0)
    v_mfma_f32_32x32x16_bf16 v[128:143], v[32:35], v[16:19], v[128:143]
    ds_read_b128 v[40:43], v8 offset:0
    ds_read_b128 v[44:47], v8 offset:4096
    v_mfma_f32_32x32x16_bf16 v[144:159], v[36:39], v[16:19], v[144:159]
    ds_read_b128 v[48:51], v8 offset:8192
    ds_read_b128 v[52:55], v8 offset:12288
    v_mfma_f32_32x32x16_bf16 v[160:175], v[32:35], v[20:23], v[160:175]
    ds_read_b64_tr_b16 v[56:57], v9 offset:12288
    ds_read_b64_tr_b16 v[58:59], v9 offset:13312
    v_mfma_f32_32x32x16_bf16 v[176:191], v[36:39], v[20:23], v[176:191]
    ds_read_b64_tr_b16 v[60:61], v10 offset:12288
    ds_read_b64_tr_b16 v[62:63], v10 offset:13312
    v_mfma_f32_32x32x16_bf16 v[192:207], v[32:35], v[24:27], v[192:207]
    v_mfma_f32_32x32x16_bf16 v[208:223], v[36:39], v[24:27], v[208:223]
    v_mfma_f32_32x32x16_bf16 v[224:239], v[32:35], v[28:31], v[224:239]
    v_mfma_f32_32x32x16_bf16 v[240:255], v[36:39], v[28:31], v[240:255]
    s_waitcnt vmcnt(3) lgkmcnt(0)
    s_barrier
    v_mfma_f32_32x32x16_bf16 v[128:143], v[56:59], v[40:43], v[128:143]
    v_xor_b32 v5, 0x10000, v5
    v_xor_b32 v6, 0x10000, v6
    v_xor_b32 v7, 0x10000, v7
    v_mfma_f32_32x32x16_bf16 v[144:159], v[60:63], v[40:43], v[144:159]
    v_xor_b32 v8, 0x10000, v8
    v_xor_b32 v9, 0x10000, v9
    v_xor_b32 v10, 0x10000, v10
    s_add_u32 m0, s75, 0
    s_nop 0
    buffer_load_dwordx4 v2, s[44:47], s73 offen lds
    v_mfma_f32_32x32x16_bf16 v[160:175], v[56:59], v[44:47], v[160:175]
    ds_read_b128 v[16:19], v5 offset:0
    ds_read_b128 v[20:23], v5 offset:4096
    ds_read_b128 v[24:27], v5 offset:8192
    v_mfma_f32_32x32x16_bf16 v[176:191], v[60:63], v[44:47], v[176:191]
    ds_read_b128 v[28:31], v5 offset:12288
    ds_read_b64_tr_b16 v[32:33], v9 offset:0
    ds_read_b64_tr_b16 v[34:35], v9 offset:1024
    s_add_u32 m0, s75, 1024
    s_nop 0
    buffer_load_dwordx4 v3, s[44:47], s73 offen lds
    v_mfma_f32_32x32x16_bf16 v[192:207], v[56:59], v[48:51], v[192:207]
    ds_read_b64_tr_b16 v[36:37], v10 offset:0
    ds_read_b64_tr_b16 v[38:39], v10 offset:1024
    v_mfma_f32_32x32x16_bf16 v[208:223], v[60:63], v[48:51], v[208:223]
    s_add_u32 m0, s75, 2048
    s_add_u32 s69, s73, 16384
    buffer_load_dwordx4 v2, s[44:47], s69 offen lds
    v_mfma_f32_32x32x16_bf16 v[224:239], v[56:59], v[52:55], v[224:239]
    v_mfma_f32_32x32x16_bf16 v[240:255], v[60:63], v[52:55], v[240:255]
    s_add_u32 m0, s75, 3072
    s_add_u32 s69, s73, 16384
    buffer_load_dwordx4 v3, s[44:47], s69 offen lds
    s_waitcnt lgkmcnt(0)
    v_mfma_f32_32x32x16_bf16 v[128:143], v[32:35], v[16:19], v[128:143]
    ds_read_b128 v[40:43], v6 offset:0
    ds_read_b128 v[44:47], v6 offset:4096
    v_mfma_f32_32x32x16_bf16 v[144:159], v[36:39], v[16:19], v[144:159]
    ds_read_b128 v[48:51], v6 offset:8192
    ds_read_b128 v[52:55], v6 offset:12288
    s_add_u32 s69, s74, 0
    s_add_u32 m0, s76, 0
    s_nop 0
    buffer_load_dwordx4 v4, s[48:51], s69 offen lds
    v_mfma_f32_32x32x16_bf16 v[160:175], v[32:35], v[20:23], v[160:175]
    ds_read_b64_tr_b16 v[56:57], v9 offset:4096
    ds_read_b64_tr_b16 v[58:59], v9 offset:5120
    v_mfma_f32_32x32x16_bf16 v[176:191], v[36:39], v[20:23], v[176:191]
    ds_read_b64_tr_b16 v[60:61], v10 offset:4096
    ds_read_b64_tr_b16 v[62:63], v10 offset:5120
    s_add_u32 m0, s76, 16384
    s_nop 0
    buffer_load_dwordx4 v4, s[52:55], s69 offen lds
    v_mfma_f32_32x32x16_bf16 v[192:207], v[32:35], v[24:27], v[192:207]
    v_mfma_f32_32x32x16_bf16 v[208:223], v[36:39], v[24:27], v[208:223]
    s_add_u32 s69, s74, 32768
    s_add_u32 m0, s76, 1024
    s_nop 0
    buffer_load_dwordx4 v4, s[48:51], s69 offen lds
    v_mfma_f32_32x32x16_bf16 v[224:239], v[32:35], v[28:31], v[224:239]
    v_mfma_f32_32x32x16_bf16 v[240:255], v[36:39], v[28:31], v[240:255]
    s_add_u32 m0, s76, 17408
    s_nop 0
    buffer_load_dwordx4 v4, s[52:55], s69 offen lds
    s_waitcnt lgkmcnt(0)
    v_mfma_f32_32x32x16_bf16 v[128:143], v[56:59], v[40:43], v[128:143]
    ds_read_b128 v[16:19], v7 offset:0
    ds_read_b128 v[20:23], v7 offset:4096
    v_mfma_f32_32x32x16_bf16 v[144:159], v[60:63], v[40:43], v[144:159]
    ds_read_b128 v[24:27], v7 offset:8192
    ds_read_b128 v[28:31], v7 offset:12288
    s_add_u32 s73, s73, 128
    s_add_u32 s74, s74, 524288
    v_mfma_f32_32x32x16_bf16 v[160:175], v[56:59], v[44:47], v[160:175]
    ds_read_b64_tr_b16 v[32:33], v9 offset:8192
    ds_read_b64_tr_b16 v[34:35], v9 offset:9216
    v_mfma_f32_32x32x16_bf16 v[176:191], v[60:63], v[44:47], v[176:191]
    ds_read_b64_tr_b16 v[36:37], v10 offset:8192
    ds_read_b64_tr_b16 v[38:39], v10 offset:9216
    v_mfma_f32_32x32x16_bf16 v[192:207], v[56:59], v[48:51], v[192:207]
    v_mfma_f32_32x32x16_bf16 v[208:223], v[60:63], v[48:51], v[208:223]
    v_mfma_f32_32x32x16_bf16 v[224:239], v[56:59], v[52:55], v[224:239]
    v_mfma_f32_32x32x16_bf16 v[240:255], v[60:63], v[52:55], v[240:255]
    s_mov_b32 s60, s26
    s_and_b32 s61, s27, 0xffff
    s_mov_b32 s62, 2359296
    s_mov_b32 s63, 0x00020000
    s_lshr_b32 s13, s2, 3
    s_mul_i32 s13, s13, 576
    v_add_u32 v100, s13, v0
    v_lshlrev_b32 v100, 7, v100
    buffer_load_dword v101, v100, s[60:63], 0 offen
    v_cmp_gt_u32 vcc, 64, v0
    v_add_u32 v100, 0x10000, v100
    s_nop 0
    v_cndmask_b32 v100, -1, v100, vcc
    buffer_load_dword v102, v100, s[60:63], 0 offen
    s_waitcnt lgkmcnt(0)
    v_mfma_f32_32x32x16_bf16 v[128:143], v[32:35], v[16:19], v[128:143]
    ds_read_b128 v[40:43], v8 offset:0
    ds_read_b128 v[44:47], v8 offset:4096
    v_mfma_f32_32x32x16_bf16 v[144:159], v[36:39], v[16:19], v[144:159]
    ds_read_b128 v[48:51], v8 offset:8192
    ds_read_b128 v[52:55], v8 offset:12288
    v_mfma_f32_32x32x16_bf16 v[160:175], v[32:35], v[20:23], v[160:175]
    ds_read_b64_tr_b16 v[56:57], v9 offset:12288
    ds_read_b64_tr_b16 v[58:59], v9 offset:13312
    v_mfma_f32_32x32x16_bf16 v[176:191], v[36:39], v[20:23], v[176:191]
    ds_read_b64_tr_b16 v[60:61], v10 offset:12288
    ds_read_b64_tr_b16 v[62:63], v10 offset:13312
    v_mfma_f32_32x32x16_bf16 v[192:207], v[32:35], v[24:27], v[192:207]
    v_mfma_f32_32x32x16_bf16 v[208:223], v[36:39], v[24:27], v[208:223]
    v_mfma_f32_32x32x16_bf16 v[224:239], v[32:35], v[28:31], v[224:239]
    v_mfma_f32_32x32x16_bf16 v[240:255], v[36:39], v[28:31], v[240:255]
    s_waitcnt vmcnt(2) lgkmcnt(0)
    s_barrier
    v_mfma_f32_32x32x16_bf16 v[128:143], v[56:59], v[40:43], v[128:143]
    v_xor_b32 v5, 0x10000, v5
    v_xor_b32 v6, 0x10000, v6
    v_xor_b32 v7, 0x10000, v7
    v_mfma_f32_32x32x16_bf16 v[144:159], v[60:63], v[40:43], v[144:159]
    v_xor_b32 v8, 0x10000, v8
    v_xor_b32 v9, 0x10000, v9
    v_xor_b32 v10, 0x10000, v10
    s_add_u32 m0, s75, 65536
    s_nop 0
    buffer_load_dwordx4 v2, s[44:47], s73 offen lds
    v_mfma_f32_32x32x16_bf16 v[160:175], v[56:59], v[44:47], v[160:175]
    ds_read_b128 v[16:19], v5 offset:0
    ds_read_b128 v[20:23], v5 offset:4096
    ds_read_b128 v[24:27], v5 offset:8192
    v_mfma_f32_32x32x16_bf16 v[176:191], v[60:63], v[44:47], v[176:191]
    ds_read_b128 v[28:31], v5 offset:12288
    ds_read_b64_tr_b16 v[32:33], v9 offset:0
    ds_read_b64_tr_b16 v[34:35], v9 offset:1024
    s_add_u32 m0, s75, 66560
    s_nop 0
    buffer_load_dwordx4 v3, s[44:47], s73 offen lds
    v_mfma_f32_32x32x16_bf16 v[192:207], v[56:59], v[48:51], v[192:207]
    ds_read_b64_tr_b16 v[36:37], v10 offset:0
    ds_read_b64_tr_b16 v[38:39], v10 offset:1024
    v_mfma_f32_32x32x16_bf16 v[208:223], v[60:63], v[48:51], v[208:223]
    s_add_u32 m0, s75, 67584
    s_add_u32 s69, s73, 16384
    buffer_load_dwordx4 v2, s[44:47], s69 offen lds
    v_mfma_f32_32x32x16_bf16 v[224:239], v[56:59], v[52:55], v[224:239]
    v_mfma_f32_32x32x16_bf16 v[240:255], v[60:63], v[52:55], v[240:255]
    s_add_u32 m0, s75, 68608
    s_add_u32 s69, s73, 16384
    buffer_load_dwordx4 v3, s[44:47], s69 offen lds
    s_waitcnt lgkmcnt(0)
    v_mfma_f32_32x32x16_bf16 v[128:143], v[32:35], v[16:19], v[128:143]
    ds_read_b128 v[40:43], v6 offset:0
    ds_read_b128 v[44:47], v6 offset:4096
    v_mfma_f32_32x32x16_bf16 v[144:159], v[36:39], v[16:19], v[144:159]
    ds_read_b128 v[48:51], v6 offset:8192
    ds_read_b128 v[52:55], v6 offset:12288
    s_add_u32 s69, s74, 0
    s_add_u32 m0, s76, 65536
    s_nop 0
    buffer_load_dwordx4 v4, s[48:51], s69 offen lds
    v_mfma_f32_32x32x16_bf16 v[160:175], v[32:35], v[20:23], v[160:175]
    ds_read_b64_tr_b16 v[56:57], v9 offset:4096
    ds_read_b64_tr_b16 v[58:59], v9 offset:5120
    v_mfma_f32_32x32x16_bf16 v[176:191], v[36:39], v[20:23], v[176:191]
    ds_read_b64_tr_b16 v[60:61], v10 offset:4096
    ds_read_b64_tr_b16 v[62:63], v10 offset:5120
    s_add_u32 m0, s76, 81920
    s_nop 0
    buffer_load_dwordx4 v4, s[52:55], s69 offen lds
    v_mfma_f32_32x32x16_bf16 v[192:207], v[32:35], v[24:27], v[192:207]
    v_mfma_f32_32x32x16_bf16 v[208:223], v[36:39], v[24:27], v[208:223]
    s_add_u32 s69, s74, 32768
    s_add_u32 m0, s76, 66560
    s_nop 0
    buffer_load_dwordx4 v4, s[48:51], s69 offen lds
    v_mfma_f32_32x32x16_bf16 v[224:239], v[32:35], v[28:31], v[224:239]
    v_mfma_f32_32x32x16_bf16 v[240:255], v[36:39], v[28:31], v[240:255]
    s_add_u32 m0, s76, 82944
    s_nop 0
    buffer_load_dwordx4 v4, s[52:55], s69 offen lds
    s_waitcnt lgkmcnt(0)
    v_mfma_f32_32x32x16_bf16 v[128:143], v[56:59], v[40:43], v[128:143]
    ds_read_b128 v[16:19], v7 offset:0
    ds_read_b128 v[20:23], v7 offset:4096
    v_mfma_f32_32x32x16_bf16 v[144:159], v[60:63], v[40:43], v[144:159]
    ds_read_b128 v[24:27], v7 offset:8192
    ds_read_b128 v[28:31], v7 offset:12288
    s_add_u32 s73, s73, 128
    s_add_u32 s74, s74, 524288
    v_mfma_f32_32x32x16_bf16 v[160:175], v[56:59], v[44:47], v[160:175]
    ds_read_b64_tr_b16 v[32:33], v9 offset:8192
    ds_read_b64_tr_b16 v[34:35], v9 offset:9216
    v_mfma_f32_32x32x16_bf16 v[176:191], v[60:63], v[44:47], v[176:191]
    ds_read_b64_tr_b16 v[36:37], v10 offset:8192
    ds_read_b64_tr_b16 v[38:39], v10 offset:9216
    v_mfma_f32_32x32x16_bf16 v[192:207], v[56:59], v[48:51], v[192:207]
    v_mfma_f32_32x32x16_bf16 v[208:223], v[60:63], v[48:51], v[208:223]
    v_mfma_f32_32x32x16_bf16 v[224:239], v[56:59], v[52:55], v[224:239]
    v_mfma_f32_32x32x16_bf16 v[240:255], v[60:63], v[52:55], v[240:255]
    s_mov_b32 s60, s30
    s_and_b32 s61, s31, 0xffff
    s_mov_b32 s62, 4718592
    s_mov_b32 s63, 0x00020000
    s_lshr_b32 s13, s2, 5
    s_mul_i32 s13, s13, 72
    v_lshrrev_b32 v100, 1, v0
    v_add_u32 v100, s13, v100
    v_lshlrev_b32 v100, 13, v100
    v_and_b32 v101, 1, v0
    v_lshl_add_u32 v100, v101, 7, v100
    s_and_b32 s13, s2, 31
    s_lshl_b32 s13, s13, 8
    v_add_u32 v100, s13, v100
    v_cmp_gt_u32 vcc, 144, v0
    s_nop 1
    v_cndmask_b32 v100, -1, v100, vcc
    buffer_load_dword v103, v100, s[60:63], 0 offen
    s_waitcnt lgkmcnt(0)
    v_mfma_f32_32x32x16_bf16 v[128:143], v[32:35], v[16:19], v[128:143]
    ds_read_b128 v[40:43], v8 offset:0
    ds_read_b128 v[44:47], v8 offset:4096
    v_mfma_f32_32x32x16_bf16 v[144:159], v[36:39], v[16:19], v[144:159]
    ds_read_b128 v[48:51], v8 offset:8192
    ds_read_b128 v[52:55], v8 offset:12288
    v_mfma_f32_32x32x16_bf16 v[160:175], v[32:35], v[20:23], v[160:175]
    ds_read_b64_tr_b16 v[56:57], v9 offset:12288
    ds_read_b64_tr_b16 v[58:59], v9 offset:13312
    v_mfma_f32_32x32x16_bf16 v[176:191], v[36:39], v[20:23], v[176:191]
    ds_read_b64_tr_b16 v[60:61], v10 offset:12288
    ds_read_b64_tr_b16 v[62:63], v10 offset:13312
    v_mfma_f32_32x32x16_bf16 v[192:207], v[32:35], v[24:27], v[192:207]
    v_mfma_f32_32x32x16_bf16 v[208:223], v[36:39], v[24:27], v[208:223]
    v_mfma_f32_32x32x16_bf16 v[224:239], v[32:35], v[28:31], v[224:239]
    v_mfma_f32_32x32x16_bf16 v[240:255], v[36:39], v[28:31], v[240:255]
    s_waitcnt vmcnt(1) lgkmcnt(0)
    s_barrier
    v_mfma_f32_32x32x16_bf16 v[128:143], v[56:59], v[40:43], v[128:143]
    v_xor_b32 v5, 0x10000, v5
    v_xor_b32 v6, 0x10000, v6
    v_xor_b32 v7, 0x10000, v7
    v_mfma_f32_32x32x16_bf16 v[144:159], v[60:63], v[40:43], v[144:159]
    v_xor_b32 v8, 0x10000, v8
    v_xor_b32 v9, 0x10000, v9
    v_xor_b32 v10, 0x10000, v10
    s_add_u32 m0, s75, 0
    s_nop 0
    buffer_load_dwordx4 v2, s[44:47], s73 offen lds
    v_mfma_f32_32x32x16_bf16 v[160:175], v[56:59], v[44:47], v[160:175]
    ds_read_b128 v[16:19], v5 offset:0
    ds_read_b128 v[20:23], v5 offset:4096
    ds_read_b128 v[24:27], v5 offset:8192
    v_mfma_f32_32x32x16_bf16 v[176:191], v[60:63], v[44:47], v[176:191]
    ds_read_b128 v[28:31], v5 offset:12288
    ds_read_b64_tr_b16 v[32:33], v9 offset:0
    ds_read_b64_tr_b16 v[34:35], v9 offset:1024
    s_add_u32 m0, s75, 1024
    s_nop 0
    buffer_load_dwordx4 v3, s[44:47], s73 offen lds
    v_mfma_f32_32x32x16_bf16 v[192:207], v[56:59], v[48:51], v[192:207]
    ds_read_b64_tr_b16 v[36:37], v10 offset:0
    ds_read_b64_tr_b16 v[38:39], v10 offset:1024
    v_mfma_f32_32x32x16_bf16 v[208:223], v[60:63], v[48:51], v[208:223]
    s_add_u32 m0, s75, 2048
    s_add_u32 s69, s73, 16384
    buffer_load_dwordx4 v2, s[44:47], s69 offen lds
    v_mfma_f32_32x32x16_bf16 v[224:239], v[56:59], v[52:55], v[224:239]
    v_mfma_f32_32x32x16_bf16 v[240:255], v[60:63], v[52:55], v[240:255]
    s_add_u32 m0, s75, 3072
    s_add_u32 s69, s73, 16384
    buffer_load_dwordx4 v3, s[44:47], s69 offen lds
    s_waitcnt lgkmcnt(0)
    v_mfma_f32_32x32x16_bf16 v[128:143], v[32:35], v[16:19], v[128:143]
    ds_read_b128 v[40:43], v6 offset:0
    ds_read_b128 v[44:47], v6 offset:4096
    v_mfma_f32_32x32x16_bf16 v[144:159], v[36:39], v[16:19], v[144:159]
    ds_read_b128 v[48:51], v6 offset:8192
    ds_read_b128 v[52:55], v6 offset:12288
    s_add_u32 s69, s74, 0
    s_add_u32 m0, s76, 0
    s_nop 0
    buffer_load_dwordx4 v4, s[48:51], s69 offen lds
    v_mfma_f32_32x32x16_bf16 v[160:175], v[32:35], v[20:23], v[160:175]
    ds_read_b64_tr_b16 v[56:57], v9 offset:4096
    ds_read_b64_tr_b16 v[58:59], v9 offset:5120
    v_mfma_f32_32x32x16_bf16 v[176:191], v[36:39], v[20:23], v[176:191]
    ds_read_b64_tr_b16 v[60:61], v10 offset:4096
    ds_read_b64_tr_b16 v[62:63], v10 offset:5120
    s_add_u32 m0, s76, 16384
    s_nop 0
    buffer_load_dwordx4 v4, s[52:55], s69 offen lds
    v_mfma_f32_32x32x16_bf16 v[192:207], v[32:35], v[24:27], v[192:207]
    v_mfma_f32_32x32x16_bf16 v[208:223], v[36:39], v[24:27], v[208:223]
    s_add_u32 s69, s74, 32768
    s_add_u32 m0, s76, 1024
    s_nop 0
    buffer_load_dwordx4 v4, s[48:51], s69 offen lds
    v_mfma_f32_32x32x16_bf16 v[224:239], v[32:35], v[28:31], v[224:239]
    v_mfma_f32_32x32x16_bf16 v[240:255], v[36:39], v[28:31], v[240:255]
    s_add_u32 m0, s76, 17408
    s_nop 0
    buffer_load_dwordx4 v4, s[52:55], s69 offen lds
    s_waitcnt lgkmcnt(0)
    v_mfma_f32_32x32x16_bf16 v[128:143], v[56:59], v[40:43], v[128:143]
    ds_read_b128 v[16:19], v7 offset:0
    ds_read_b128 v[20:23], v7 offset:4096
    v_mfma_f32_32x32x16_bf16 v[144:159], v[60:63], v[40:43], v[144:159]
    ds_read_b128 v[24:27], v7 offset:8192
    ds_read_b128 v[28:31], v7 offset:12288
    s_add_u32 s73, s73, 128
    s_add_u32 s74, s74, 524288
    v_mfma_f32_32x32x16_bf16 v[160:175], v[56:59], v[44:47], v[160:175]
    ds_read_b64_tr_b16 v[32:33], v9 offset:8192
    ds_read_b64_tr_b16 v[34:35], v9 offset:9216
    v_mfma_f32_32x32x16_bf16 v[176:191], v[60:63], v[44:47], v[176:191]
    ds_read_b64_tr_b16 v[36:37], v10 offset:8192
    ds_read_b64_tr_b16 v[38:39], v10 offset:9216
    v_mfma_f32_32x32x16_bf16 v[192:207], v[56:59], v[48:51], v[192:207]
    v_mfma_f32_32x32x16_bf16 v[208:223], v[60:63], v[48:51], v[208:223]
    v_mfma_f32_32x32x16_bf16 v[224:239], v[56:59], v[52:55], v[224:239]
    v_mfma_f32_32x32x16_bf16 v[240:255], v[60:63], v[52:55], v[240:255]
    s_getpc_b64 s[12:13]
CWH_19:
    s_add_u32 s12, s12, L_P2-CWH_19
    s_addc_u32 s13, s13, 0
    s_mul_i32 s8, s64, 64
    v_min_u32 v100, 63, v1
    v_add_u32 v100, s8, v100
    v_lshlrev_b32 v100, 7, v100
    v_min_u32 v100, L_P4-L_P2-4, v100
    global_load_dword v101, v100, s[12:13]
    s_waitcnt lgkmcnt(0)
    v_mfma_f32_32x32x16_bf16 v[128:143], v[32:35], v[16:19], v[128:143]
    ds_read_b128 v[40:43], v8 offset:0
    ds_read_b128 v[44:47], v8 offset:4096
    v_mfma_f32_32x32x16_bf16 v[144:159], v[36:39], v[16:19], v[144:159]
    ds_read_b128 v[48:51], v8 offset:8192
    ds_read_b128 v[52:55], v8 offset:12288
    v_mfma_f32_32x32x16_bf16 v[160:175], v[32:35], v[20:23], v[160:175]
    ds_read_b64_tr_b16 v[56:57], v9 offset:12288
    ds_read_b64_tr_b16 v[58:59], v9 offset:13312
    v_mfma_f32_32x32x16_bf16 v[176:191], v[36:39], v[20:23], v[176:191]
    ds_read_b64_tr_b16 v[60:61], v10 offset:12288
    ds_read_b64_tr_b16 v[62:63], v10 offset:13312
    v_mfma_f32_32x32x16_bf16 v[192:207], v[32:35], v[24:27], v[192:207]
    v_mfma_f32_32x32x16_bf16 v[208:223], v[36:39], v[24:27], v[208:223]
    v_mfma_f32_32x32x16_bf16 v[224:239], v[32:35], v[28:31], v[224:239]
    v_mfma_f32_32x32x16_bf16 v[240:255], v[36:39], v[28:31], v[240:255]
    s_cmp_lg_u32 s64, 4
    s_cbranch_scc1 SY_20
    v_lshlrev_b32 v118, 3, v1
    v_add_u32 v118, 4096, v118
    s_mov_b32 s8, 62914560
    s_mov_b32 s10, 0
FW_21:
    buffer_load_dwordx2 v[112:113], v118, s[56:59], s8 offen offset:0 sc1
    buffer_load_dwordx2 v[114:115], v118, s[56:59], s8 offen offset:512 sc1
    buffer_load_dwordx2 v[116:117], v118, s[56:59], s8 offen offset:1024 sc1
    s_waitcnt vmcnt(0)
FW_23:
    s_memrealtime s[12:13]
    s_waitcnt lgkmcnt(0)
    s_add_u32 s12, s12, 200
    s_addc_u32 s13, s13, 0
    v_cmp_gt_u64 vcc, s[14:15], v[112:113]
    s_cbranch_vccnz FW_24
    v_cmp_lt_u64 vcc, s[12:13], v[112:113]
    s_cbranch_vccnz FW_24
    v_cmp_gt_u64 vcc, s[14:15], v[114:115]
    s_cbranch_vccnz FW_24
    v_cmp_lt_u64 vcc, s[12:13], v[114:115]
    s_cbranch_vccnz FW_24
    s_mov_b64 exec, 0xffffffff
    v_cmp_gt_u64 vcc, s[14:15], v[116:117]
    s_cbranch_vccnz FW_24
    v_cmp_lt_u64 vcc, s[12:13], v[116:117]
    s_cbranch_vccnz FW_24
    s_branch FW_22
FW_24:
    s_mov_b64 exec, -1
    s_sleep 2
    s_and_b32 s12, s10, 31
    s_cmp_lg_u32 s12, 31
    s_cbranch_scc1 EP_25
    v_mov_b32 v112, 248
    buffer_load_dwordx2 v[112:113], v112, s[4:7], 0 offen sc1
    s_waitcnt vmcnt(0)
    v_readfirstlane_b32 s12, v112
    v_readfirstlane_b32 s13, v113
    s_nop 3
    s_not_b64 s[14:15], s[12:13]
EP_25:
    s_add_u32 s10, s10, 1
    s_cmp_lt_u32 s10, 0x80000
    s_cbranch_scc1 FW_21
FW_22:
    s_mov_b64 exec, -1
SY_20:
    s_waitcnt vmcnt(1) lgkmcnt(0)
    s_barrier
    v_mfma_f32_32x32x16_bf16 v[128:143], v[56:59], v[40:43], v[128:143]
    v_xor_b32 v5, 0x10000, v5
    v_xor_b32 v6, 0x10000, v6
    v_xor_b32 v7, 0x10000, v7
    v_mfma_f32_32x32x16_bf16 v[144:159], v[60:63], v[40:43], v[144:159]
    v_xor_b32 v8, 0x10000, v8
    v_xor_b32 v9, 0x10000, v9
    v_xor_b32 v10, 0x10000, v10
    s_add_u32 m0, s75, 65536
    s_nop 0
    buffer_load_dwordx4 v2, s[44:47], s73 offen lds
    v_mfma_f32_32x32x16_bf16 v[160:175], v[56:59], v[44:47], v[160:175]
    ds_read_b128 v[16:19], v5 offset:0
    ds_read_b128 v[20:23], v5 offset:4096
    ds_read_b128 v[24:27], v5 offset:8192
    v_mfma_f32_32x32x16_bf16 v[176:191], v[60:63], v[44:47], v[176:191]
    ds_read_b128 v[28:31], v5 offset:12288
    ds_read_b64_tr_b16 v[32:33], v9 offset:0
    ds_read_b64_tr_b16 v[34:35], v9 offset:1024
    s_add_u32 m0, s75, 66560
    s_nop 0
    buffer_load_dwordx4 v3, s[44:47], s73 offen lds
    v_mfma_f32_32x32x16_bf16 v[192:207], v[56:59], v[48:51], v[192:207]
    ds_read_b64_tr_b16 v[36:37], v10 offset:0
    ds_read_b64_tr_b16 v[38:39], v10 offset:1024
    v_mfma_f32_32x32x16_bf16 v[208:223], v[60:63], v[48:51], v[208:223]
    s_add_u32 m0, s75, 67584
    s_add_u32 s69, s73, 16384
    buffer_load_dwordx4 v2, s[44:47], s69 offen lds
    v_mfma_f32_32x32x16_bf16 v[224:239], v[56:59], v[52:55], v[224:239]
    v_mfma_f32_32x32x16_bf16 v[240:255], v[60:63], v[52:55], v[240:255]
    s_add_u32 m0, s75, 68608
    s_add_u32 s69, s73, 16384
    buffer_load_dwordx4 v3, s[44:47], s69 offen lds
    s_waitcnt lgkmcnt(0)
    v_mfma_f32_32x32x16_bf16 v[128:143], v[32:35], v[16:19], v[128:143]
    ds_read_b128 v[40:43], v6 offset:0
    ds_read_b128 v[44:47], v6 offset:4096
    v_mfma_f32_32x32x16_bf16 v[144:159], v[36:39], v[16:19], v[144:159]
    ds_read_b128 v[48:51], v6 offset:8192
    ds_read_b128 v[52:55], v6 offset:12288
    s_add_u32 s69, s74, 0
    s_add_u32 m0, s76, 65536
    s_nop 0
    buffer_load_dwordx4 v4, s[48:51], s69 offen lds
    v_mfma_f32_32x32x16_bf16 v[160:175], v[32:35], v[20:23], v[160:175]
    ds_read_b64_tr_b16 v[56:57], v9 offset:4096
    ds_read_b64_tr_b16 v[58:59], v9 offset:5120
    v_mfma_f32_32x32x16_bf16 v[176:191], v[36:39], v[20:23], v[176:191]
    ds_read_b64_tr_b16 v[60:61], v10 offset:4096
    ds_read_b64_tr_b16 v[62:63], v10 offset:5120
    s_add_u32 m0, s76, 81920
    s_nop 0
    buffer_load_dwordx4 v4, s[52:55], s69 offen lds
    v_mfma_f32_32x32x16_bf16 v[192:207], v[32:35], v[24:27], v[192:207]
    v_mfma_f32_32x32x16_bf16 v[208:223], v[36:39], v[24:27], v[208:223]
    s_add_u32 s69, s74, 32768
    s_add_u32 m0, s76, 66560
    s_nop 0
    buffer_load_dwordx4 v4, s[48:51], s69 offen lds
    v_mfma_f32_32x32x16_bf16 v[224:239], v[32:35], v[28:31], v[224:239]
    v_mfma_f32_32x32x16_bf16 v[240:255], v[36:39], v[28:31], v[240:255]
    s_add_u32 m0, s76, 82944
    s_nop 0
    buffer_load_dwordx4 v4, s[52:55], s69 offen lds
    s_waitcnt lgkmcnt(0)
    v_mfma_f32_32x32x16_bf16 v[128:143], v[56:59], v[40:43], v[128:143]
    ds_read_b128 v[16:19], v7 offset:0
    ds_read_b128 v[20:23], v7 offset:4096
    v_mfma_f32_32x32x16_bf16 v[144:159], v[60:63], v[40:43], v[144:159]
    ds_read_b128 v[24:27], v7 offset:8192
    ds_read_b128 v[28:31], v7 offset:12288
    s_add_u32 s73, s73, 128
    s_add_u32 s74, s74, 524288
    v_mfma_f32_32x32x16_bf16 v[160:175], v[56:59], v[44:47], v[160:175]
    ds_read_b64_tr_b16 v[32:33], v9 offset:8192
    ds_read_b64_tr_b16 v[34:35], v9 offset:9216
    v_mfma_f32_32x32x16_bf16 v[176:191], v[60:63], v[44:47], v[176:191]
    ds_read_b64_tr_b16 v[36:37], v10 offset:8192
    ds_read_b64_tr_b16 v[38:39], v10 offset:9216
    v_mfma_f32_32x32x16_bf16 v[192:207], v[56:59], v[48:51], v[192:207]
    v_mfma_f32_32x32x16_bf16 v[208:223], v[60:63], v[48:51], v[208:223]
    v_mfma_f32_32x32x16_bf16 v[224:239], v[56:59], v[52:55], v[224:239]
    v_mfma_f32_32x32x16_bf16 v[240:255], v[60:63], v[52:55], v[240:255]
    s_waitcnt lgkmcnt(0)
    v_mfma_f32_32x32x16_bf16 v[128:143], v[32:35], v[16:19], v[128:143]
    ds_read_b128 v[40:43], v8 offset:0
    ds_read_b128 v[44:47], v8 offset:4096
    v_mfma_f32_32x32x16_bf16 v[144:159], v[36:39], v[16:19], v[144:159]
    ds_read_b128 v[48:51], v8 offset:8192
    ds_read_b128 v[52:55], v8 offset:12288
    v_mfma_f32_32x32x16_bf16 v[160:175], v[32:35], v[20:23], v[160:175]
    ds_read_b64_tr_b16 v[56:57], v9 offset:12288
    ds_read_b64_tr_b16 v[58:59], v9 offset:13312
    v_mfma_f32_32x32x16_bf16 v[176:191], v[36:39], v[20:23], v[176:191]
    ds_read_b64_tr_b16 v[60:61], v10 offset:12288
    ds_read_b64_tr_b16 v[62:63], v10 offset:13312
    v_mfma_f32_32x32x16_bf16 v[192:207], v[32:35], v[24:27], v[192:207]
    v_mfma_f32_32x32x16_bf16 v[208:223], v[36:39], v[24:27], v[208:223]
    v_mfma_f32_32x32x16_bf16 v[224:239], v[32:35], v[28:31], v[224:239]
    v_mfma_f32_32x32x16_bf16 v[240:255], v[36:39], v[28:31], v[240:255]
    s_waitcnt vmcnt(0) lgkmcnt(0)
    s_barrier
    v_mfma_f32_32x32x16_bf16 v[128:143], v[56:59], v[40:43], v[128:143]
    v_xor_b32 v5, 0x10000, v5
    v_xor_b32 v6, 0x10000, v6
    v_xor_b32 v7, 0x10000, v7
    v_mfma_f32_32x32x16_bf16 v[144:159], v[60:63], v[40:43], v[144:159]
    v_xor_b32 v8, 0x10000, v8
    v_xor_b32 v9, 0x10000, v9
    v_xor_b32 v10, 0x10000, v10
    v_mfma_f32_32x32x16_bf16 v[160:175], v[56:59], v[44:47], v[160:175]
    ds_read_b128 v[16:19], v5 offset:0
    ds_read_b128 v[20:23], v5 offset:4096
    ds_read_b128 v[24:27], v5 offset:8192
    v_mfma_f32_32x32x16_bf16 v[176:191], v[60:63], v[44:47], v[176:191]
    ds_read_b128 v[28:31], v5 offset:12288
    ds_read_b64_tr_b16 v[32:33], v9 offset:0
    ds_read_b64_tr_b16 v[34:35], v9 offset:1024
    v_mfma_f32_32x32x16_bf16 v[192:207], v[56:59], v[48:51], v[192:207]
    ds_read_b64_tr_b16 v[36:37], v10 offset:0
    ds_read_b64_tr_b16 v[38:39], v10 offset:1024
    v_mfma_f32_32x32x16_bf16 v[208:223], v[60:63], v[48:51], v[208:223]
    v_mfma_f32_32x32x16_bf16 v[224:239], v[56:59], v[52:55], v[224:239]
    v_mfma_f32_32x32x16_bf16 v[240:255], v[60:63], v[52:55], v[240:255]
    s_waitcnt lgkmcnt(0)
    v_mfma_f32_32x32x16_bf16 v[128:143], v[32:35], v[16:19], v[128:143]
    ds_read_b128 v[40:43], v6 offset:0
    ds_read_b128 v[44:47], v6 offset:4096
    v_mfma_f32_32x32x16_bf16 v[144:159], v[36:39], v[16:19], v[144:159]
    ds_read_b128 v[48:51], v6 offset:8192
    ds_read_b128 v[52:55], v6 offset:12288
    v_mfma_f32_32x32x16_bf16 v[160:175], v[32:35], v[20:23], v[160:175]
    ds_read_b64_tr_b16 v[56:57], v9 offset:4096
    ds_read_b64_tr_b16 v[58:59], v9 offset:5120
    v_mfma_f32_32x32x16_bf16 v[176:191], v[36:39], v[20:23], v[176:191]
    ds_read_b64_tr_b16 v[60:61], v10 offset:4096
    ds_read_b64_tr_b16 v[62:63], v10 offset:5120
    v_mfma_f32_32x32x16_bf16 v[192:207], v[32:35], v[24:27], v[192:207]
    v_mfma_f32_32x32x16_bf16 v[208:223], v[36:39], v[24:27], v[208:223]
    v_mfma_f32_32x32x16_bf16 v[224:239], v[32:35], v[28:31], v[224:239]
    v_mfma_f32_32x32x16_bf16 v[240:255], v[36:39], v[28:31], v[240:255]
    s_waitcnt lgkmcnt(0)
    v_mfma_f32_32x32x16_bf16 v[128:143], v[56:59], v[40:43], v[128:143]
    ds_read_b128 v[16:19], v7 offset:0
    ds_read_b128 v[20:23], v7 offset:4096
    v_mfma_f32_32x32x16_bf16 v[144:159], v[60:63], v[40:43], v[144:159]
    ds_read_b128 v[24:27], v7 offset:8192
    ds_read_b128 v[28:31], v7 offset:12288
    v_mfma_f32_32x32x16_bf16 v[160:175], v[56:59], v[44:47], v[160:175]
    ds_read_b64_tr_b16 v[32:33], v9 offset:8192
    ds_read_b64_tr_b16 v[34:35], v9 offset:9216
    v_mfma_f32_32x32x16_bf16 v[176:191], v[60:63], v[44:47], v[176:191]
    ds_read_b64_tr_b16 v[36:37], v10 offset:8192
    ds_read_b64_tr_b16 v[38:39], v10 offset:9216
    v_mfma_f32_32x32x16_bf16 v[192:207], v[56:59], v[48:51], v[192:207]
    v_mfma_f32_32x32x16_bf16 v[208:223], v[60:63], v[48:51], v[208:223]
    v_mfma_f32_32x32x16_bf16 v[224:239], v[56:59], v[52:55], v[224:239]
    v_mfma_f32_32x32x16_bf16 v[240:255], v[60:63], v[52:55], v[240:255]
    s_waitcnt lgkmcnt(0)
    v_mfma_f32_32x32x16_bf16 v[128:143], v[32:35], v[16:19], v[128:143]
    ds_read_b128 v[40:43], v8 offset:0
    ds_read_b128 v[44:47], v8 offset:4096
    v_mfma_f32_32x32x16_bf16 v[144:159], v[36:39], v[16:19], v[144:159]
    ds_read_b128 v[48:51], v8 offset:8192
    ds_read_b128 v[52:55], v8 offset:12288
    v_mfma_f32_32x32x16_bf16 v[160:175], v[32:35], v[20:23], v[160:175]
    ds_read_b64_tr_b16 v[56:57], v9 offset:12288
    ds_read_b64_tr_b16 v[58:59], v9 offset:13312
    v_mfma_f32_32x32x16_bf16 v[176:191], v[36:39], v[20:23], v[176:191]
    ds_read_b64_tr_b16 v[60:61], v10 offset:12288
    ds_read_b64_tr_b16 v[62:63], v10 offset:13312
    v_mfma_f32_32x32x16_bf16 v[192:207], v[32:35], v[24:27], v[192:207]
    v_mfma_f32_32x32x16_bf16 v[208:223], v[36:39], v[24:27], v[208:223]
    v_mfma_f32_32x32x16_bf16 v[224:239], v[32:35], v[28:31], v[224:239]
    v_mfma_f32_32x32x16_bf16 v[240:255], v[36:39], v[28:31], v[240:255]
    s_waitcnt lgkmcnt(0)
    v_mfma_f32_32x32x16_bf16 v[128:143], v[56:59], v[40:43], v[128:143]
    v_mfma_f32_32x32x16_bf16 v[144:159], v[60:63], v[40:43], v[144:159]
    v_mfma_f32_32x32x16_bf16 v[160:175], v[56:59], v[44:47], v[160:175]
    v_mfma_f32_32x32x16_bf16 v[176:191], v[60:63], v[44:47], v[176:191]
    v_mfma_f32_32x32x16_bf16 v[192:207], v[56:59], v[48:51], v[192:207]
    v_mfma_f32_32x32x16_bf16 v[208:223], v[60:63], v[48:51], v[208:223]
    v_mfma_f32_32x32x16_bf16 v[224:239], v[56:59], v[52:55], v[224:239]
    v_mfma_f32_32x32x16_bf16 v[240:255], v[60:63], v[52:55], v[240:255]
    s_branch KV_END_16
KV_V_15:
    s_waitcnt lgkmcnt(0)
    v_mfma_f32_32x32x16_bf16 v[128:143], v[16:19], v[32:35], 0
    ds_read_b128 v[40:43], v6 offset:0
    ds_read_b128 v[44:47], v6 offset:4096
    v_mfma_f32_32x32x16_bf16 v[144:159], v[16:19], v[36:39], 0
    ds_read_b128 v[48:51], v6 offset:8192
    ds_read_b128 v[52:55], v6 offset:12288
    v_mfma_f32_32x32x16_bf16 v[160:175], v[20:23], v[32:35], 0
    ds_read_b64_tr_b16 v[56:57], v9 offset:4096
    ds_read_b64_tr_b16 v[58:59], v9 offset:5120
    v_mfma_f32_32x32x16_bf16 v[176:191], v[20:23], v[36:39], 0
    ds_read_b64_tr_b16 v[60:61], v10 offset:4096
    ds_read_b64_tr_b16 v[62:63], v10 offset:5120
    v_mfma_f32_32x32x16_bf16 v[192:207], v[24:27], v[32:35], 0
    v_mfma_f32_32x32x16_bf16 v[208:223], v[24:27], v[36:39], 0
    v_mfma_f32_32x32x16_bf16 v[224:239], v[28:31], v[32:35], 0
    v_mfma_f32_32x32x16_bf16 v[240:255], v[28:31], v[36:39], 0
    s_waitcnt lgkmcnt(0)
    v_mfma_f32_32x32x16_bf16 v[128:143], v[40:43], v[56:59], v[128:143]
    ds_read_b128 v[16:19], v7 offset:0
    ds_read_b128 v[20:23], v7 offset:4096
    v_mfma_f32_32x32x16_bf16 v[144:159], v[40:43], v[60:63], v[144:159]
    ds_read_b128 v[24:27], v7 offset:8192
    ds_read_b128 v[28:31], v7 offset:12288
    v_mfma_f32_32x32x16_bf16 v[160:175], v[44:47], v[56:59], v[160:175]
    ds_read_b64_tr_b16 v[32:33], v9 offset:8192
    ds_read_b64_tr_b16 v[34:35], v9 offset:9216
    v_mfma_f32_32x32x16_bf16 v[176:191], v[44:47], v[60:63], v[176:191]
    ds_read_b64_tr_b16 v[36:37], v10 offset:8192
    ds_read_b64_tr_b16 v[38:39], v10 offset:9216
    v_mfma_f32_32x32x16_bf16 v[192:207], v[48:51], v[56:59], v[192:207]
    v_mfma_f32_32x32x16_bf16 v[208:223], v[48:51], v[60:63], v[208:223]
    v_mfma_f32_32x32x16_bf16 v[224:239], v[52:55], v[56:59], v[224:239]
    v_mfma_f32_32x32x16_bf16 v[240:255], v[52:55], v[60:63], v[240:255]
    s_waitcnt lgkmcnt(0)
    v_mfma_f32_32x32x16_bf16 v[128:143], v[16:19], v[32:35], v[128:143]
    ds_read_b128 v[40:43], v8 offset:0
    ds_read_b128 v[44:47], v8 offset:4096
    v_mfma_f32_32x32x16_bf16 v[144:159], v[16:19], v[36:39], v[144:159]
    ds_read_b128 v[48:51], v8 offset:8192
    ds_read_b128 v[52:55], v8 offset:12288
    v_mfma_f32_32x32x16_bf16 v[160:175], v[20:23], v[32:35], v[160:175]
    ds_read_b64_tr_b16 v[56:57], v9 offset:12288
    ds_read_b64_tr_b16 v[58:59], v9 offset:13312
    v_mfma_f32_32x32x16_bf16 v[176:191], v[20:23], v[36:39], v[176:191]
    ds_read_b64_tr_b16 v[60:61], v10 offset:12288
    ds_read_b64_tr_b16 v[62:63], v10 offset:13312
    v_mfma_f32_32x32x16_bf16 v[192:207], v[24:27], v[32:35], v[192:207]
    v_mfma_f32_32x32x16_bf16 v[208:223], v[24:27], v[36:39], v[208:223]
    v_mfma_f32_32x32x16_bf16 v[224:239], v[28:31], v[32:35], v[224:239]
    v_mfma_f32_32x32x16_bf16 v[240:255], v[28:31], v[36:39], v[240:255]
    s_waitcnt vmcnt(0) lgkmcnt(0)
    s_barrier
    v_mfma_f32_32x32x16_bf16 v[128:143], v[40:43], v[56:59], v[128:143]
    v_xor_b32 v5, 0x10000, v5
    v_xor_b32 v6, 0x10000, v6
    v_xor_b32 v7, 0x10000, v7
    v_mfma_f32_32x32x16_bf16 v[144:159], v[40:43], v[60:63], v[144:159]
    v_xor_b32 v8, 0x10000, v8
    v_xor_b32 v9, 0x10000, v9
    v_xor_b32 v10, 0x10000, v10
    s_add_u32 m0, s75, 0
    s_nop 0
    buffer_load_dwordx4 v2, s[44:47], s73 offen lds
    v_mfma_f32_32x32x16_bf16 v[160:175], v[44:47], v[56:59], v[160:175]
    ds_read_b128 v[16:19], v5 offset:0
    ds_read_b128 v[20:23], v5 offset:4096
    ds_read_b128 v[24:27], v5 offset:8192
    v_mfma_f32_32x32x16_bf16 v[176:191], v[44:47], v[60:63], v[176:191]
    ds_read_b128 v[28:31], v5 offset:12288
    ds_read_b64_tr_b16 v[32:33], v9 offset:0
    ds_read_b64_tr_b16 v[34:35], v9 offset:1024
    s_add_u32 m0, s75, 1024
    s_nop 0
    buffer_load_dwordx4 v3, s[44:47], s73 offen lds
    v_mfma_f32_32x32x16_bf16 v[192:207], v[48:51], v[56:59], v[192:207]
    ds_read_b64_tr_b16 v[36:37], v10 offset:0
    ds_read_b64_tr_b16 v[38:39], v10 offset:1024
    v_mfma_f32_32x32x16_bf16 v[208:223], v[48:51], v[60:63], v[208:223]
    s_add_u32 m0, s75, 2048
    s_add_u32 s69, s73, 16384
    buffer_load_dwordx4 v2, s[44:47], s69 offen lds
    v_mfma_f32_32x32x16_bf16 v[224:239], v[52:55], v[56:59], v[224:239]
    v_mfma_f32_32x32x16_bf16 v[240:255], v[52:55], v[60:63], v[240:255]
    s_add_u32 m0, s75, 3072
    s_add_u32 s69, s73, 16384
    buffer_load_dwordx4 v3, s[44:47], s69 offen lds
    s_waitcnt lgkmcnt(0)
    v_mfma_f32_32x32x16_bf16 v[128:143], v[16:19], v[32:35], v[128:143]
    ds_read_b128 v[40:43], v6 offset:0
    ds_read_b128 v[44:47], v6 offset:4096
    v_mfma_f32_32x32x16_bf16 v[144:159], v[16:19], v[36:39], v[144:159]
    ds_read_b128 v[48:51], v6 offset:8192
    ds_read_b128 v[52:55], v6 offset:12288
    s_add_u32 s69, s74, 0
    s_add_u32 m0, s76, 0
    s_nop 0
    buffer_load_dwordx4 v4, s[48:51], s69 offen lds
    v_mfma_f32_32x32x16_bf16 v[160:175], v[20:23], v[32:35], v[160:175]
    ds_read_b64_tr_b16 v[56:57], v9 offset:4096
    ds_read_b64_tr_b16 v[58:59], v9 offset:5120
    v_mfma_f32_32x32x16_bf16 v[176:191], v[20:23], v[36:39], v[176:191]
    ds_read_b64_tr_b16 v[60:61], v10 offset:4096
    ds_read_b64_tr_b16 v[62:63], v10 offset:5120
    s_add_u32 m0, s76, 16384
    s_nop 0
    buffer_load_dwordx4 v4, s[52:55], s69 offen lds
    v_mfma_f32_32x32x16_bf16 v[192:207], v[24:27], v[32:35], v[192:207]
    v_mfma_f32_32x32x16_bf16 v[208:223], v[24:27], v[36:39], v[208:223]
    s_add_u32 s69, s74, 32768
    s_add_u32 m0, s76, 1024
    s_nop 0
    buffer_load_dwordx4 v4, s[48:51], s69 offen lds
    v_mfma_f32_32x32x16_bf16 v[224:239], v[28:31], v[32:35], v[224:239]
    v_mfma_f32_32x32x16_bf16 v[240:255], v[28:31], v[36:39], v[240:255]
    s_add_u32 m0, s76, 17408
    s_nop 0
    buffer_load_dwordx4 v4, s[52:55], s69 offen lds
    s_waitcnt lgkmcnt(0)
    v_mfma_f32_32x32x16_bf16 v[128:143], v[40:43], v[56:59], v[128:143]
    ds_read_b128 v[16:19], v7 offset:0
    ds_read_b128 v[20:23], v7 offset:4096
    v_mfma_f32_32x32x16_bf16 v[144:159], v[40:43], v[60:63], v[144:159]
    ds_read_b128 v[24:27], v7 offset:8192
    ds_read_b128 v[28:31], v7 offset:12288
    s_add_u32 s73, s73, 128
    s_add_u32 s74, s74, 524288
    v_mfma_f32_32x32x16_bf16 v[160:175], v[44:47], v[56:59], v[160:175]
    ds_read_b64_tr_b16 v[32:33], v9 offset:8192
    ds_read_b64_tr_b16 v[34:35], v9 offset:9216
    v_mfma_f32_32x32x16_bf16 v[176:191], v[44:47], v[60:63], v[176:191]
    ds_read_b64_tr_b16 v[36:37], v10 offset:8192
    ds_read_b64_tr_b16 v[38:39], v10 offset:9216
    v_mfma_f32_32x32x16_bf16 v[192:207], v[48:51], v[56:59], v[192:207]
    v_mfma_f32_32x32x16_bf16 v[208:223], v[48:51], v[60:63], v[208:223]
    v_mfma_f32_32x32x16_bf16 v[224:239], v[52:55], v[56:59], v[224:239]
    v_mfma_f32_32x32x16_bf16 v[240:255], v[52:55], v[60:63], v[240:255]
    s_cmp_ge_u32 s2, 160
    s_cbranch_scc1 F_S_26
    s_lshl_b32 s10, s2, 3
    s_add_u32 s10, s10, 4096
    s_cmp_lg_u32 s64, 4
    s_cbranch_scc1 SY_27
    s_memrealtime s[12:13]
    v_mov_b32 v122, s10
    s_mov_b32 s8, 62914560
    s_waitcnt lgkmcnt(0)
    v_mov_b32 v120, s12
    v_mov_b32 v121, s13
    s_mov_b64 exec, 1
    buffer_store_dwordx2 v[120:121], v122, s[56:59], s8 offen sc1
    s_mov_b64 exec, -1
SY_27:
F_S_26:
    s_mov_b32 s12, 512
    s_mov_b32 s13, 2097152
    buffer_load_dword v104, v108, s[44:47], s12 offen
    buffer_load_dword v105, v109, s[48:51], s13 offen
    buffer_load_dword v106, v109, s[52:55], s13 offen
    s_waitcnt lgkmcnt(0)
    v_mfma_f32_32x32x16_bf16 v[128:143], v[16:19], v[32:35], v[128:143]
    ds_read_b128 v[40:43], v8 offset:0
    ds_read_b128 v[44:47], v8 offset:4096
    v_mfma_f32_32x32x16_bf16 v[144:159], v[16:19], v[36:39], v[144:159]
    ds_read_b128 v[48:51], v8 offset:8192
    ds_read_b128 v[52:55], v8 offset:12288
    v_mfma_f32_32x32x16_bf16 v[160:175], v[20:23], v[32:35], v[160:175]
    ds_read_b64_tr_b16 v[56:57], v9 offset:12288
    ds_read_b64_tr_b16 v[58:59], v9 offset:13312
    v_mfma_f32_32x32x16_bf16 v[176:191], v[20:23], v[36:39], v[176:191]
    ds_read_b64_tr_b16 v[60:61], v10 offset:12288
    ds_read_b64_tr_b16 v[62:63], v10 offset:13312
    v_mfma_f32_32x32x16_bf16 v[192:207], v[24:27], v[32:35], v[192:207]
    v_mfma_f32_32x32x16_bf16 v[208:223], v[24:27], v[36:39], v[208:223]
    v_mfma_f32_32x32x16_bf16 v[224:239], v[28:31], v[32:35], v[224:239]
    v_mfma_f32_32x32x16_bf16 v[240:255], v[28:31], v[36:39], v[240:255]
    s_waitcnt vmcnt(3) lgkmcnt(0)
    s_barrier
    v_mfma_f32_32x32x16_bf16 v[128:143], v[40:43], v[56:59], v[128:143]
    v_xor_b32 v5, 0x10000, v5
    v_xor_b32 v6, 0x10000, v6
    v_xor_b32 v7, 0x10000, v7
    v_mfma_f32_32x32x16_bf16 v[144:159], v[40:43], v[60:63], v[144:159]
    v_xor_b32 v8, 0x10000, v8
    v_xor_b32 v9, 0x10000, v9
    v_xor_b32 v10, 0x10000, v10
    s_add_u32 m0, s75, 65536
    s_nop 0
    buffer_load_dwordx4 v2, s[44:47], s73 offen lds
    v_mfma_f32_32x32x16_bf16 v[160:175], v[44:47], v[56:59], v[160:175]
    ds_read_b128 v[16:19], v5 offset:0
    ds_read_b128 v[20:23], v5 offset:4096
    ds_read_b128 v[24:27], v5 offset:8192
    v_mfma_f32_32x32x16_bf16 v[176:191], v[44:47], v[60:63], v[176:191]
    ds_read_b128 v[28:31], v5 offset:12288
    ds_read_b64_tr_b16 v[32:33], v9 offset:0
    ds_read_b64_tr_b16 v[34:35], v9 offset:1024
    s_add_u32 m0, s75, 66560
    s_nop 0
    buffer_load_dwordx4 v3, s[44:47], s73 offen lds
    v_mfma_f32_32x32x16_bf16 v[192:207], v[48:51], v[56:59], v[192:207]
    ds_read_b64_tr_b16 v[36:37], v10 offset:0
    ds_read_b64_tr_b16 v[38:39], v10 offset:1024
    v_mfma_f32_32x32x16_bf16 v[208:223], v[48:51], v[60:63], v[208:223]
    s_add_u32 m0, s75, 67584
    s_add_u32 s69, s73, 16384
    buffer_load_dwordx4 v2, s[44:47], s69 offen lds
    v_mfma_f32_32x32x16_bf16 v[224:239], v[52:55], v[56:59], v[224:239]
    v_mfma_f32_32x32x16_bf16 v[240:255], v[52:55], v[60:63], v[240:255]
    s_add_u32 m0, s75, 68608
    s_add_u32 s69, s73, 16384
    buffer_load_dwordx4 v3, s[44:47], s69 offen lds
    s_waitcnt lgkmcnt(0)
    v_mfma_f32_32x32x16_bf16 v[128:143], v[16:19], v[32:35], v[128:143]
    ds_read_b128 v[40:43], v6 offset:0
    ds_read_b128 v[44:47], v6 offset:4096
    v_mfma_f32_32x32x16_bf16 v[144:159], v[16:19], v[36:39], v[144:159]
    ds_read_b128 v[48:51], v6 offset:8192
    ds_read_b128 v[52:55], v6 offset:12288
    s_add_u32 s69, s74, 0
    s_add_u32 m0, s76, 65536
    s_nop 0
    buffer_load_dwordx4 v4, s[48:51], s69 offen lds
    v_mfma_f32_32x32x16_bf16 v[160:175], v[20:23], v[32:35], v[160:175]
    ds_read_b64_tr_b16 v[56:57], v9 offset:4096
    ds_read_b64_tr_b16 v[58:59], v9 offset:5120
    v_mfma_f32_32x32x16_bf16 v[176:191], v[20:23], v[36:39], v[176:191]
    ds_read_b64_tr_b16 v[60:61], v10 offset:4096
    ds_read_b64_tr_b16 v[62:63], v10 offset:5120
    s_add_u32 m0, s76, 81920
    s_nop 0
    buffer_load_dwordx4 v4, s[52:55], s69 offen lds
    v_mfma_f32_32x32x16_bf16 v[192:207], v[24:27], v[32:35], v[192:207]
    v_mfma_f32_32x32x16_bf16 v[208:223], v[24:27], v[36:39], v[208:223]
    s_add_u32 s69, s74, 32768
    s_add_u32 m0, s76, 66560
    s_nop 0
    buffer_load_dwordx4 v4, s[48:51], s69 offen lds
    v_mfma_f32_32x32x16_bf16 v[224:239], v[28:31], v[32:35], v[224:239]
    v_mfma_f32_32x32x16_bf16 v[240:255], v[28:31], v[36:39], v[240:255]
    s_add_u32 m0, s76, 82944
    s_nop 0
    buffer_load_dwordx4 v4, s[52:55], s69 offen lds
    s_waitcnt lgkmcnt(0)
    v_mfma_f32_32x32x16_bf16 v[128:143], v[40:43], v[56:59], v[128:143]
    ds_read_b128 v[16:19], v7 offset:0
    ds_read_b128 v[20:23], v7 offset:4096
    v_mfma_f32_32x32x16_bf16 v[144:159], v[40:43], v[60:63], v[144:159]
    ds_read_b128 v[24:27], v7 offset:8192
    ds_read_b128 v[28:31], v7 offset:12288
    s_add_u32 s73, s73, 128
    s_add_u32 s74, s74, 524288
    v_mfma_f32_32x32x16_bf16 v[160:175], v[44:47], v[56:59], v[160:175]
    ds_read_b64_tr_b16 v[32:33], v9 offset:8192
    ds_read_b64_tr_b16 v[34:35], v9 offset:9216
    v_mfma_f32_32x32x16_bf16 v[176:191], v[44:47], v[60:63], v[176:191]
    ds_read_b64_tr_b16 v[36:37], v10 offset:8192
    ds_read_b64_tr_b16 v[38:39], v10 offset:9216
    v_mfma_f32_32x32x16_bf16 v[192:207], v[48:51], v[56:59], v[192:207]
    v_mfma_f32_32x32x16_bf16 v[208:223], v[48:51], v[60:63], v[208:223]
    v_mfma_f32_32x32x16_bf16 v[224:239], v[52:55], v[56:59], v[224:239]
    v_mfma_f32_32x32x16_bf16 v[240:255], v[52:55], v[60:63], v[240:255]
    s_mov_b32 s12, 768
    s_mov_b32 s13, 3145728
    buffer_load_dword v104, v108, s[44:47], s12 offen
    buffer_load_dword v105, v109, s[48:51], s13 offen
    buffer_load_dword v106, v109, s[52:55], s13 offen
    s_waitcnt lgkmcnt(0)
    v_mfma_f32_32x32x16_bf16 v[128:143], v[16:19], v[32:35], v[128:143]
    ds_read_b128 v[40:43], v8 offset:0
    ds_read_b128 v[44:47], v8 offset:4096
    v_mfma_f32_32x32x16_bf16 v[144:159], v[16:19], v[36:39], v[144:159]
    ds_read_b128 v[48:51], v8 offset:8192
    ds_read_b128 v[52:55], v8 offset:12288
    v_mfma_f32_32x32x16_bf16 v[160:175], v[20:23], v[32:35], v[160:175]
    ds_read_b64_tr_b16 v[56:57], v9 offset:12288
    ds_read_b64_tr_b16 v[58:59], v9 offset:13312
    v_mfma_f32_32x32x16_bf16 v[176:191], v[20:23], v[36:39], v[176:191]
    ds_read_b64_tr_b16 v[60:61], v10 offset:12288
    ds_read_b64_tr_b16 v[62:63], v10 offset:13312
    v_mfma_f32_32x32x16_bf16 v[192:207], v[24:27], v[32:35], v[192:207]
    v_mfma_f32_32x32x16_bf16 v[208:223], v[24:27], v[36:39], v[208:223]
    v_mfma_f32_32x32x16_bf16 v[224:239], v[28:31], v[32:35], v[224:239]
    v_mfma_f32_32x32x16_bf16 v[240:255], v[28:31], v[36:39], v[240:255]
    s_waitcnt vmcnt(3) lgkmcnt(0)
    s_barrier
    v_mfma_f32_32x32x16_bf16 v[128:143], v[40:43], v[56:59], v[128:143]
    v_xor_b32 v5, 0x10000, v5
    v_xor_b32 v6, 0x10000, v6
    v_xor_b32 v7, 0x10000, v7
    v_mfma_f32_32x32x16_bf16 v[144:159], v[40:43], v[60:63], v[144:159]
    v_xor_b32 v8, 0x10000, v8
    v_xor_b32 v9, 0x10000, v9
    v_xor_b32 v10, 0x10000, v10
    s_add_u32 m0, s75, 0
    s_nop 0
    buffer_load_dwordx4 v2, s[44:47], s73 offen lds
    v_mfma_f32_32x32x16_bf16 v[160:175], v[44:47], v[56:59], v[160:175]
    ds_read_b128 v[16:19], v5 offset:0
    ds_read_b128 v[20:23], v5 offset:4096
    ds_read_b128 v[24:27], v5 offset:8192
    v_mfma_f32_32x32x16_bf16 v[176:191], v[44:47], v[60:63], v[176:191]
    ds_read_b128 v[28:31], v5 offset:12288
    ds_read_b64_tr_b16 v[32:33], v9 offset:0
    ds_read_b64_tr_b16 v[34:35], v9 offset:1024
    s_add_u32 m0, s75, 1024
    s_nop 0
    buffer_load_dwordx4 v3, s[44:47], s73 offen lds
    v_mfma_f32_32x32x16_bf16 v[192:207], v[48:51], v[56:59], v[192:207]
    ds_read_b64_tr_b16 v[36:37], v10 offset:0
    ds_read_b64_tr_b16 v[38:39], v10 offset:1024
    v_mfma_f32_32x32x16_bf16 v[208:223], v[48:51], v[60:63], v[208:223]
    s_add_u32 m0, s75, 2048
    s_add_u32 s69, s73, 16384
    buffer_load_dwordx4 v2, s[44:47], s69 offen lds
    v_mfma_f32_32x32x16_bf16 v[224:239], v[52:55], v[56:59], v[224:239]
    v_mfma_f32_32x32x16_bf16 v[240:255], v[52:55], v[60:63], v[240:255]
    s_add_u32 m0, s75, 3072
    s_add_u32 s69, s73, 16384
    buffer_load_dwordx4 v3, s[44:47], s69 offen lds
    s_waitcnt lgkmcnt(0)
    v_mfma_f32_32x32x16_bf16 v[128:143], v[16:19], v[32:35], v[128:143]
    ds_read_b128 v[40:43], v6 offset:0
    ds_read_b128 v[44:47], v6 offset:4096
    v_mfma_f32_32x32x16_bf16 v[144:159], v[16:19], v[36:39], v[144:159]
    ds_read_b128 v[48:51], v6 offset:8192
    ds_read_b128 v[52:55], v6 offset:12288
    s_add_u32 s69, s74, 0
    s_add_u32 m0, s76, 0
    s_nop 0
    buffer_load_dwordx4 v4, s[48:51], s69 offen lds
    v_mfma_f32_32x32x16_bf16 v[160:175], v[20:23], v[32:35], v[160:175]
    ds_read_b64_tr_b16 v[56:57], v9 offset:4096
    ds_read_b64_tr_b16 v[58:59], v9 offset:5120
    v_mfma_f32_32x32x16_bf16 v[176:191], v[20:23], v[36:39], v[176:191]
    ds_read_b64_tr_b16 v[60:61], v10 offset:4096
    ds_read_b64_tr_b16 v[62:63], v10 offset:5120
    s_add_u32 m0, s76, 16384
    s_nop 0
    buffer_load_dwordx4 v4, s[52:55], s69 offen lds
    v_mfma_f32_32x32x16_bf16 v[192:207], v[24:27], v[32:35], v[192:207]
    v_mfma_f32_32x32x16_bf16 v[208:223], v[24:27], v[36:39], v[208:223]
    s_add_u32 s69, s74, 32768
    s_add_u32 m0, s76, 1024
    s_nop 0
    buffer_load_dwordx4 v4, s[48:51], s69 offen lds
    v_mfma_f32_32x32x16_bf16 v[224:239], v[28:31], v[32:35], v[224:239]
    v_mfma_f32_32x32x16_bf16 v[240:255], v[28:31], v[36:39], v[240:255]
    s_add_u32 m0, s76, 17408
    s_nop 0
    buffer_load_dwordx4 v4, s[52:55], s69 offen lds
    s_waitcnt lgkmcnt(0)
    v_mfma_f32_32x32x16_bf16 v[128:143], v[40:43], v[56:59], v[128:143]
    ds_read_b128 v[16:19], v7 offset:0
    ds_read_b128 v[20:23], v7 offset:4096
    v_mfma_f32_32x32x16_bf16 v[144:159], v[40:43], v[60:63], v[144:159]
    ds_read_b128 v[24:27], v7 offset:8192
    ds_read_b128 v[28:31], v7 offset:12288
    s_add_u32 s73, s73, 128
    s_add_u32 s74, s74, 524288
    v_mfma_f32_32x32x16_bf16 v[160:175], v[44:47], v[56:59], v[160:175]
    ds_read_b64_tr_b16 v[32:33], v9 offset:8192
    ds_read_b64_tr_b16 v[34:35], v9 offset:9216
    v_mfma_f32_32x32x16_bf16 v[176:191], v[44:47], v[60:63], v[176:191]
    ds_read_b64_tr_b16 v[36:37], v10 offset:8192
    ds_read_b64_tr_b16 v[38:39], v10 offset:9216
    v_mfma_f32_32x32x16_bf16 v[192:207], v[48:51], v[56:59], v[192:207]
    v_mfma_f32_32x32x16_bf16 v[208:223], v[48:51], v[60:63], v[208:223]
    v_mfma_f32_32x32x16_bf16 v[224:239], v[52:55], v[56:59], v[224:239]
    v_mfma_f32_32x32x16_bf16 v[240:255], v[52:55], v[60:63], v[240:255]
    s_mov_b32 s60, s26
    s_and_b32 s61, s27, 0xffff
    s_mov_b32 s62, 2359296
    s_mov_b32 s63, 0x00020000
    s_lshr_b32 s13, s2, 3
    s_mul_i32 s13, s13, 576
    v_add_u32 v100, s13, v0
    v_lshlrev_b32 v100, 7, v100
    buffer_load_dword v101, v100, s[60:63], 0 offen
    v_cmp_gt_u32 vcc, 64, v0
    v_add_u32 v100, 0x10000, v100
    s_nop 0
    v_cndmask_b32 v100, -1, v100, vcc
    buffer_load_dword v102, v100, s[60:63], 0 offen
    s_waitcnt lgkmcnt(0)
    v_mfma_f32_32x32x16_bf16 v[128:143], v[16:19], v[32:35], v[128:143]
    ds_read_b128 v[40:43], v8 offset:0
    ds_read_b128 v[44:47], v8 offset:4096
    v_mfma_f32_32x32x16_bf16 v[144:159], v[16:19], v[36:39], v[144:159]
    ds_read_b128 v[48:51], v8 offset:8192
    ds_read_b128 v[52:55], v8 offset:12288
    v_mfma_f32_32x32x16_bf16 v[160:175], v[20:23], v[32:35], v[160:175]
    ds_read_b64_tr_b16 v[56:57], v9 offset:12288
    ds_read_b64_tr_b16 v[58:59], v9 offset:13312
    v_mfma_f32_32x32x16_bf16 v[176:191], v[20:23], v[36:39], v[176:191]
    ds_read_b64_tr_b16 v[60:61], v10 offset:12288
    ds_read_b64_tr_b16 v[62:63], v10 offset:13312
    v_mfma_f32_32x32x16_bf16 v[192:207], v[24:27], v[32:35], v[192:207]
    v_mfma_f32_32x32x16_bf16 v[208:223], v[24:27], v[36:39], v[208:223]
    v_mfma_f32_32x32x16_bf16 v[224:239], v[28:31], v[32:35], v[224:239]
    v_mfma_f32_32x32x16_bf16 v[240:255], v[28:31], v[36:39], v[240:255]
    s_waitcnt vmcnt(2) lgkmcnt(0)
    s_barrier
    v_mfma_f32_32x32x16_bf16 v[128:143], v[40:43], v[56:59], v[128:143]
    v_xor_b32 v5, 0x10000, v5
    v_xor_b32 v6, 0x10000, v6
    v_xor_b32 v7, 0x10000, v7
    v_mfma_f32_32x32x16_bf16 v[144:159], v[40:43], v[60:63], v[144:159]
    v_xor_b32 v8, 0x10000, v8
    v_xor_b32 v9, 0x10000, v9
    v_xor_b32 v10, 0x10000, v10
    s_add_u32 m0, s75, 65536
    s_nop 0
    buffer_load_dwordx4 v2, s[44:47], s73 offen lds
    v_mfma_f32_32x32x16_bf16 v[160:175], v[44:47], v[56:59], v[160:175]
    ds_read_b128 v[16:19], v5 offset:0
    ds_read_b128 v[20:23], v5 offset:4096
    ds_read_b128 v[24:27], v5 offset:8192
    v_mfma_f32_32x32x16_bf16 v[176:191], v[44:47], v[60:63], v[176:191]
    ds_read_b128 v[28:31], v5 offset:12288
    ds_read_b64_tr_b16 v[32:33], v9 offset:0
    ds_read_b64_tr_b16 v[34:35], v9 offset:1024
    s_add_u32 m0, s75, 66560
    s_nop 0
    buffer_load_dwordx4 v3, s[44:47], s73 offen lds
    v_mfma_f32_32x32x16_bf16 v[192:207], v[48:51], v[56:59], v[192:207]
    ds_read_b64_tr_b16 v[36:37], v10 offset:0
    ds_read_b64_tr_b16 v[38:39], v10 offset:1024
    v_mfma_f32_32x32x16_bf16 v[208:223], v[48:51], v[60:63], v[208:223]
    s_add_u32 m0, s75, 67584
    s_add_u32 s69, s73, 16384
    buffer_load_dwordx4 v2, s[44:47], s69 offen lds
    v_mfma_f32_32x32x16_bf16 v[224:239], v[52:55], v[56:59], v[224:239]
    v_mfma_f32_32x32x16_bf16 v[240:255], v[52:55], v[60:63], v[240:255]
    s_add_u32 m0, s75, 68608
    s_add_u32 s69, s73, 16384
    buffer_load_dwordx4 v3, s[44:47], s69 offen lds
    s_waitcnt lgkmcnt(0)
    v_mfma_f32_32x32x16_bf16 v[128:143], v[16:19], v[32:35], v[128:143]
    ds_read_b128 v[40:43], v6 offset:0
    ds_read_b128 v[44:47], v6 offset:4096
    v_mfma_f32_32x32x16_bf16 v[144:159], v[16:19], v[36:39], v[144:159]
    ds_read_b128 v[48:51], v6 offset:8192
    ds_read_b128 v[52:55], v6 offset:12288
    s_add_u32 s69, s74, 0
    s_add_u32 m0, s76, 65536
    s_nop 0
    buffer_load_dwordx4 v4, s[48:51], s69 offen lds
    v_mfma_f32_32x32x16_bf16 v[160:175], v[20:23], v[32:35], v[160:175]
    ds_read_b64_tr_b16 v[56:57], v9 offset:4096
    ds_read_b64_tr_b16 v[58:59], v9 offset:5120
    v_mfma_f32_32x32x16_bf16 v[176:191], v[20:23], v[36:39], v[176:191]
    ds_read_b64_tr_b16 v[60:61], v10 offset:4096
    ds_read_b64_tr_b16 v[62:63], v10 offset:5120
    s_add_u32 m0, s76, 81920
    s_nop 0
    buffer_load_dwordx4 v4, s[52:55], s69 offen lds
    v_mfma_f32_32x32x16_bf16 v[192:207], v[24:27], v[32:35], v[192:207]
    v_mfma_f32_32x32x16_bf16 v[208:223], v[24:27], v[36:39], v[208:223]
    s_add_u32 s69, s74, 32768
    s_add_u32 m0, s76, 66560
    s_nop 0
    buffer_load_dwordx4 v4, s[48:51], s69 offen lds
    v_mfma_f32_32x32x16_bf16 v[224:239], v[28:31], v[32:35], v[224:239]
    v_mfma_f32_32x32x16_bf16 v[240:255], v[28:31], v[36:39], v[240:255]
    s_add_u32 m0, s76, 82944
    s_nop 0
    buffer_load_dwordx4 v4, s[52:55], s69 offen lds
    s_waitcnt lgkmcnt(0)
    v_mfma_f32_32x32x16_bf16 v[128:143], v[40:43], v[56:59], v[128:143]
    ds_read_b128 v[16:19], v7 offset:0
    ds_read_b128 v[20:23], v7 offset:4096
    v_mfma_f32_32x32x16_bf16 v[144:159], v[40:43], v[60:63], v[144:159]
    ds_read_b128 v[24:27], v7 offset:8192
    ds_read_b128 v[28:31], v7 offset:12288
    s_add_u32 s73, s73, 128
    s_add_u32 s74, s74, 524288
    v_mfma_f32_32x32x16_bf16 v[160:175], v[44:47], v[56:59], v[160:175]
    ds_read_b64_tr_b16 v[32:33], v9 offset:8192
    ds_read_b64_tr_b16 v[34:35], v9 offset:9216
    v_mfma_f32_32x32x16_bf16 v[176:191], v[44:47], v[60:63], v[176:191]
    ds_read_b64_tr_b16 v[36:37], v10 offset:8192
    ds_read_b64_tr_b16 v[38:39], v10 offset:9216
    v_mfma_f32_32x32x16_bf16 v[192:207], v[48:51], v[56:59], v[192:207]
    v_mfma_f32_32x32x16_bf16 v[208:223], v[48:51], v[60:63], v[208:223]
    v_mfma_f32_32x32x16_bf16 v[224:239], v[52:55], v[56:59], v[224:239]
    v_mfma_f32_32x32x16_bf16 v[240:255], v[52:55], v[60:63], v[240:255]
    s_mov_b32 s60, s30
    s_and_b32 s61, s31, 0xffff
    s_mov_b32 s62, 4718592
    s_mov_b32 s63, 0x00020000
    s_lshr_b32 s13, s2, 5
    s_mul_i32 s13, s13, 72
    v_lshrrev_b32 v100, 1, v0
    v_add_u32 v100, s13, v100
    v_lshlrev_b32 v100, 13, v100
    v_and_b32 v101, 1, v0
    v_lshl_add_u32 v100, v101, 7, v100
    s_and_b32 s13, s2, 31
    s_lshl_b32 s13, s13, 8
    v_add_u32 v100, s13, v100
    v_cmp_gt_u32 vcc, 144, v0
    s_nop 1
    v_cndmask_b32 v100, -1, v100, vcc
    buffer_load_dword v103, v100, s[60:63], 0 offen
    s_waitcnt lgkmcnt(0)
    v_mfma_f32_32x32x16_bf16 v[128:143], v[16:19], v[32:35], v[128:143]
    ds_read_b128 v[40:43], v8 offset:0
    ds_read_b128 v[44:47], v8 offset:4096
    v_mfma_f32_32x32x16_bf16 v[144:159], v[16:19], v[36:39], v[144:159]
    ds_read_b128 v[48:51], v8 offset:8192
    ds_read_b128 v[52:55], v8 offset:12288
    v_mfma_f32_32x32x16_bf16 v[160:175], v[20:23], v[32:35], v[160:175]
    ds_read_b64_tr_b16 v[56:57], v9 offset:12288
    ds_read_b64_tr_b16 v[58:59], v9 offset:13312
    v_mfma_f32_32x32x16_bf16 v[176:191], v[20:23], v[36:39], v[176:191]
    ds_read_b64_tr_b16 v[60:61], v10 offset:12288
    ds_read_b64_tr_b16 v[62:63], v10 offset:13312
    v_mfma_f32_32x32x16_bf16 v[192:207], v[24:27], v[32:35], v[192:207]
    v_mfma_f32_32x32x16_bf16 v[208:223], v[24:27], v[36:39], v[208:223]
    v_mfma_f32_32x32x16_bf16 v[224:239], v[28:31], v[32:35], v[224:239]
    v_mfma_f32_32x32x16_bf16 v[240:255], v[28:31], v[36:39], v[240:255]
    s_waitcnt vmcnt(1) lgkmcnt(0)
    s_barrier
    v_mfma_f32_32x32x16_bf16 v[128:143], v[40:43], v[56:59], v[128:143]
    v_xor_b32 v5, 0x10000, v5
    v_xor_b32 v6, 0x10000, v6
    v_xor_b32 v7, 0x10000, v7
    v_mfma_f32_32x32x16_bf16 v[144:159], v[40:43], v[60:63], v[144:159]
    v_xor_b32 v8, 0x10000, v8
    v_xor_b32 v9, 0x10000, v9
    v_xor_b32 v10, 0x10000, v10
    s_add_u32 m0, s75, 0
    s_nop 0
    buffer_load_dwordx4 v2, s[44:47], s73 offen lds
    v_mfma_f32_32x32x16_bf16 v[160:175], v[44:47], v[56:59], v[160:175]
    ds_read_b128 v[16:19], v5 offset:0
    ds_read_b128 v[20:23], v5 offset:4096
    ds_read_b128 v[24:27], v5 offset:8192
    v_mfma_f32_32x32x16_bf16 v[176:191], v[44:47], v[60:63], v[176:191]
    ds_read_b128 v[28:31], v5 offset:12288
    ds_read_b64_tr_b16 v[32:33], v9 offset:0
    ds_read_b64_tr_b16 v[34:35], v9 offset:1024
    s_add_u32 m0, s75, 1024
    s_nop 0
    buffer_load_dwordx4 v3, s[44:47], s73 offen lds
    v_mfma_f32_32x32x16_bf16 v[192:207], v[48:51], v[56:59], v[192:207]
    ds_read_b64_tr_b16 v[36:37], v10 offset:0
    ds_read_b64_tr_b16 v[38:39], v10 offset:1024
    v_mfma_f32_32x32x16_bf16 v[208:223], v[48:51], v[60:63], v[208:223]
    s_add_u32 m0, s75, 2048
    s_add_u32 s69, s73, 16384
    buffer_load_dwordx4 v2, s[44:47], s69 offen lds
    v_mfma_f32_32x32x16_bf16 v[224:239], v[52:55], v[56:59], v[224:239]
    v_mfma_f32_32x32x16_bf16 v[240:255], v[52:55], v[60:63], v[240:255]
    s_add_u32 m0, s75, 3072
    s_add_u32 s69, s73, 16384
    buffer_load_dwordx4 v3, s[44:47], s69 offen lds
    s_waitcnt lgkmcnt(0)
    v_mfma_f32_32x32x16_bf16 v[128:143], v[16:19], v[32:35], v[128:143]
    ds_read_b128 v[40:43], v6 offset:0
    ds_read_b128 v[44:47], v6 offset:4096
    v_mfma_f32_32x32x16_bf16 v[144:159], v[16:19], v[36:39], v[144:159]
    ds_read_b128 v[48:51], v6 offset:8192
    ds_read_b128 v[52:55], v6 offset:12288
    s_add_u32 s69, s74, 0
    s_add_u32 m0, s76, 0
    s_nop 0
    buffer_load_dwordx4 v4, s[48:51], s69 offen lds
    v_mfma_f32_32x32x16_bf16 v[160:175], v[20:23], v[32:35], v[160:175]
    ds_read_b64_tr_b16 v[56:57], v9 offset:4096
    ds_read_b64_tr_b16 v[58:59], v9 offset:5120
    v_mfma_f32_32x32x16_bf16 v[176:191], v[20:23], v[36:39], v[176:191]
    ds_read_b64_tr_b16 v[60:61], v10 offset:4096
    ds_read_b64_tr_b16 v[62:63], v10 offset:5120
    s_add_u32 m0, s76, 16384
    s_nop 0
    buffer_load_dwordx4 v4, s[52:55], s69 offen lds
    v_mfma_f32_32x32x16_bf16 v[192:207], v[24:27], v[32:35], v[192:207]
    v_mfma_f32_32x32x16_bf16 v[208:223], v[24:27], v[36:39], v[208:223]
    s_add_u32 s69, s74, 32768
    s_add_u32 m0, s76, 1024
    s_nop 0
    buffer_load_dwordx4 v4, s[48:51], s69 offen lds
    v_mfma_f32_32x32x16_bf16 v[224:239], v[28:31], v[32:35], v[224:239]
    v_mfma_f32_32x32x16_bf16 v[240:255], v[28:31], v[36:39], v[240:255]
    s_add_u32 m0, s76, 17408
    s_nop 0
    buffer_load_dwordx4 v4, s[52:55], s69 offen lds
    s_waitcnt lgkmcnt(0)
    v_mfma_f32_32x32x16_bf16 v[128:143], v[40:43], v[56:59], v[128:143]
    ds_read_b128 v[16:19], v7 offset:0
    ds_read_b128 v[20:23], v7 offset:4096
    v_mfma_f32_32x32x16_bf16 v[144:159], v[40:43], v[60:63], v[144:159]
    ds_read_b128 v[24:27], v7 offset:8192
    ds_read_b128 v[28:31], v7 offset:12288
    s_add_u32 s73, s73, 128
    s_add_u32 s74, s74, 524288
    v_mfma_f32_32x32x16_bf16 v[160:175], v[44:47], v[56:59], v[160:175]
    ds_read_b64_tr_b16 v[32:33], v9 offset:8192
    ds_read_b64_tr_b16 v[34:35], v9 offset:9216
    v_mfma_f32_32x32x16_bf16 v[176:191], v[44:47], v[60:63], v[176:191]
    ds_read_b64_tr_b16 v[36:37], v10 offset:8192
    ds_read_b64_tr_b16 v[38:39], v10 offset:9216
    v_mfma_f32_32x32x16_bf16 v[192:207], v[48:51], v[56:59], v[192:207]
    v_mfma_f32_32x32x16_bf16 v[208:223], v[48:51], v[60:63], v[208:223]
    v_mfma_f32_32x32x16_bf16 v[224:239], v[52:55], v[56:59], v[224:239]
    v_mfma_f32_32x32x16_bf16 v[240:255], v[52:55], v[60:63], v[240:255]
    s_getpc_b64 s[12:13]
CWH_28:
    s_add_u32 s12, s12, L_P2-CWH_28
    s_addc_u32 s13, s13, 0
    s_mul_i32 s8, s64, 64
    v_min_u32 v100, 63, v1
    v_add_u32 v100, s8, v100
    v_lshlrev_b32 v100, 7, v100
    v_min_u32 v100, L_P4-L_P2-4, v100
    global_load_dword v101, v100, s[12:13]
    s_waitcnt lgkmcnt(0)
    v_mfma_f32_32x32x16_bf16 v[128:143], v[16:19], v[32:35], v[128:143]
    ds_read_b128 v[40:43], v8 offset:0
    ds_read_b128 v[44:47], v8 offset:4096
    v_mfma_f32_32x32x16_bf16 v[144:159], v[16:19], v[36:39], v[144:159]
    ds_read_b128 v[48:51], v8 offset:8192
    ds_read_b128 v[52:55], v8 offset:12288
    v_mfma_f32_32x32x16_bf16 v[160:175], v[20:23], v[32:35], v[160:175]
    ds_read_b64_tr_b16 v[56:57], v9 offset:12288
    ds_read_b64_tr_b16 v[58:59], v9 offset:13312
    v_mfma_f32_32x32x16_bf16 v[176:191], v[20:23], v[36:39], v[176:191]
    ds_read_b64_tr_b16 v[60:61], v10 offset:12288
    ds_read_b64_tr_b16 v[62:63], v10 offset:13312
    v_mfma_f32_32x32x16_bf16 v[192:207], v[24:27], v[32:35], v[192:207]
    v_mfma_f32_32x32x16_bf16 v[208:223], v[24:27], v[36:39], v[208:223]
    v_mfma_f32_32x32x16_bf16 v[224:239], v[28:31], v[32:35], v[224:239]
    v_mfma_f32_32x32x16_bf16 v[240:255], v[28:31], v[36:39], v[240:255]
    s_cmp_lg_u32 s64, 4
    s_cbranch_scc1 SY_29
    v_lshlrev_b32 v118, 3, v1
    v_add_u32 v118, 4096, v118
    s_mov_b32 s8, 62914560
    s_mov_b32 s10, 0
FW_30:
    buffer_load_dwordx2 v[112:113], v118, s[56:59], s8 offen offset:0 sc1
    buffer_load_dwordx2 v[114:115], v118, s[56:59], s8 offen offset:512 sc1
    buffer_load_dwordx2 v[116:117], v118, s[56:59], s8 offen offset:1024 sc1
    s_waitcnt vmcnt(0)
FW_32:
    s_memrealtime s[12:13]
    s_waitcnt lgkmcnt(0)
    s_add_u32 s12, s12, 200
    s_addc_u32 s13, s13, 0
    v_cmp_gt_u64 vcc, s[14:15], v[112:113]
    s_cbranch_vccnz FW_33
    v_cmp_lt_u64 vcc, s[12:13], v[112:113]
    s_cbranch_vccnz FW_33
    v_cmp_gt_u64 vcc, s[14:15], v[114:115]
    s_cbranch_vccnz FW_33
    v_cmp_lt_u64 vcc, s[12:13], v[114:115]
    s_cbranch_vccnz FW_33
    s_mov_b64 exec, 0xffffffff
    v_cmp_gt_u64 vcc, s[14:15], v[116:117]
    s_cbranch_vccnz FW_33
    v_cmp_lt_u64 vcc, s[12:13], v[116:117]
    s_cbranch_vccnz FW_33
    s_branch FW_31
FW_33:
    s_mov_b64 exec, -1
    s_sleep 2
    s_and_b32 s12, s10, 31
    s_cmp_lg_u32 s12, 31
    s_cbranch_scc1 EP_34
    v_mov_b32 v112, 248
    buffer_load_dwordx2 v[112:113], v112, s[4:7], 0 offen sc1
    s_waitcnt vmcnt(0)
    v_readfirstlane_b32 s12, v112
    v_readfirstlane_b32 s13, v113
    s_nop 3
    s_not_b64 s[14:15], s[12:13]
EP_34:
    s_add_u32 s10, s10, 1
    s_cmp_lt_u32 s10, 0x80000
    s_cbranch_scc1 FW_30
FW_31:
    s_mov_b64 exec, -1
SY_29:
    s_waitcnt vmcnt(1) lgkmcnt(0)
    s_barrier
    v_mfma_f32_32x32x16_bf16 v[128:143], v[40:43], v[56:59], v[128:143]
    v_xor_b32 v5, 0x10000, v5
    v_xor_b32 v6, 0x10000, v6
    v_xor_b32 v7, 0x10000, v7
    v_mfma_f32_32x32x16_bf16 v[144:159], v[40:43], v[60:63], v[144:159]
    v_xor_b32 v8, 0x10000, v8
    v_xor_b32 v9, 0x10000, v9
    v_xor_b32 v10, 0x10000, v10
    s_add_u32 m0, s75, 65536
    s_nop 0
    buffer_load_dwordx4 v2, s[44:47], s73 offen lds
    v_mfma_f32_32x32x16_bf16 v[160:175], v[44:47], v[56:59], v[160:175]
    ds_read_b128 v[16:19], v5 offset:0
    ds_read_b128 v[20:23], v5 offset:4096
    ds_read_b128 v[24:27], v5 offset:8192
    v_mfma_f32_32x32x16_bf16 v[176:191], v[44:47], v[60:63], v[176:191]
    ds_read_b128 v[28:31], v5 offset:12288
    ds_read_b64_tr_b16 v[32:33], v9 offset:0
    ds_read_b64_tr_b16 v[34:35], v9 offset:1024
    s_add_u32 m0, s75, 66560
    s_nop 0
    buffer_load_dwordx4 v3, s[44:47], s73 offen lds
    v_mfma_f32_32x32x16_bf16 v[192:207], v[48:51], v[56:59], v[192:207]
    ds_read_b64_tr_b16 v[36:37], v10 offset:0
    ds_read_b64_tr_b16 v[38:39], v10 offset:1024
    v_mfma_f32_32x32x16_bf16 v[208:223], v[48:51], v[60:63], v[208:223]
    s_add_u32 m0, s75, 67584
    s_add_u32 s69, s73, 16384
    buffer_load_dwordx4 v2, s[44:47], s69 offen lds
    v_mfma_f32_32x32x16_bf16 v[224:239], v[52:55], v[56:59], v[224:239]
    v_mfma_f32_32x32x16_bf16 v[240:255], v[52:55], v[60:63], v[240:255]
    s_add_u32 m0, s75, 68608
    s_add_u32 s69, s73, 16384
    buffer_load_dwordx4 v3, s[44:47], s69 offen lds
    s_waitcnt lgkmcnt(0)
    v_mfma_f32_32x32x16_bf16 v[128:143], v[16:19], v[32:35], v[128:143]
    ds_read_b128 v[40:43], v6 offset:0
    ds_read_b128 v[44:47], v6 offset:4096
    v_mfma_f32_32x32x16_bf16 v[144:159], v[16:19], v[36:39], v[144:159]
    ds_read_b128 v[48:51], v6 offset:8192
    ds_read_b128 v[52:55], v6 offset:12288
    s_add_u32 s69, s74, 0
    s_add_u32 m0, s76, 65536
    s_nop 0
    buffer_load_dwordx4 v4, s[48:51], s69 offen lds
    v_mfma_f32_32x32x16_bf16 v[160:175], v[20:23], v[32:35], v[160:175]
    ds_read_b64_tr_b16 v[56:57], v9 offset:4096
    ds_read_b64_tr_b16 v[58:59], v9 offset:5120
    v_mfma_f32_32x32x16_bf16 v[176:191], v[20:23], v[36:39], v[176:191]
    ds_read_b64_tr_b16 v[60:61], v10 offset:4096
    ds_read_b64_tr_b16 v[62:63], v10 offset:5120
    s_add_u32 m0, s76, 81920
    s_nop 0
    buffer_load_dwordx4 v4, s[52:55], s69 offen lds
    v_mfma_f32_32x32x16_bf16 v[192:207], v[24:27], v[32:35], v[192:207]
    v_mfma_f32_32x32x16_bf16 v[208:223], v[24:27], v[36:39], v[208:223]
    s_add_u32 s69, s74, 32768
    s_add_u32 m0, s76, 66560
    s_nop 0
    buffer_load_dwordx4 v4, s[48:51], s69 offen lds
    v_mfma_f32_32x32x16_bf16 v[224:239], v[28:31], v[32:35], v[224:239]
    v_mfma_f32_32x32x16_bf16 v[240:255], v[28:31], v[36:39], v[240:255]
    s_add_u32 m0, s76, 82944
    s_nop 0
    buffer_load_dwordx4 v4, s[52:55], s69 offen lds
    s_waitcnt lgkmcnt(0)
    v_mfma_f32_32x32x16_bf16 v[128:143], v[40:43], v[56:59], v[128:143]
    ds_read_b128 v[16:19], v7 offset:0
    ds_read_b128 v[20:23], v7 offset:4096
    v_mfma_f32_32x32x16_bf16 v[144:159], v[40:43], v[60:63], v[144:159]
    ds_read_b128 v[24:27], v7 offset:8192
    ds_read_b128 v[28:31], v7 offset:12288
    s_add_u32 s73, s73, 128
    s_add_u32 s74, s74, 524288
    v_mfma_f32_32x32x16_bf16 v[160:175], v[44:47], v[56:59], v[160:175]
    ds_read_b64_tr_b16 v[32:33], v9 offset:8192
    ds_read_b64_tr_b16 v[34:35], v9 offset:9216
    v_mfma_f32_32x32x16_bf16 v[176:191], v[44:47], v[60:63], v[176:191]
    ds_read_b64_tr_b16 v[36:37], v10 offset:8192
    ds_read_b64_tr_b16 v[38:39], v10 offset:9216
    v_mfma_f32_32x32x16_bf16 v[192:207], v[48:51], v[56:59], v[192:207]
    v_mfma_f32_32x32x16_bf16 v[208:223], v[48:51], v[60:63], v[208:223]
    v_mfma_f32_32x32x16_bf16 v[224:239], v[52:55], v[56:59], v[224:239]
    v_mfma_f32_32x32x16_bf16 v[240:255], v[52:55], v[60:63], v[240:255]
    s_waitcnt lgkmcnt(0)
    v_mfma_f32_32x32x16_bf16 v[128:143], v[16:19], v[32:35], v[128:143]
    ds_read_b128 v[40:43], v8 offset:0
    ds_read_b128 v[44:47], v8 offset:4096
    v_mfma_f32_32x32x16_bf16 v[144:159], v[16:19], v[36:39], v[144:159]
    ds_read_b128 v[48:51], v8 offset:8192
    ds_read_b128 v[52:55], v8 offset:12288
    v_mfma_f32_32x32x16_bf16 v[160:175], v[20:23], v[32:35], v[160:175]
    ds_read_b64_tr_b16 v[56:57], v9 offset:12288
    ds_read_b64_tr_b16 v[58:59], v9 offset:13312
    v_mfma_f32_32x32x16_bf16 v[176:191], v[20:23], v[36:39], v[176:191]
    ds_read_b64_tr_b16 v[60:61], v10 offset:12288
    ds_read_b64_tr_b16 v[62:63], v10 offset:13312
    v_mfma_f32_32x32x16_bf16 v[192:207], v[24:27], v[32:35], v[192:207]
    v_mfma_f32_32x32x16_bf16 v[208:223], v[24:27], v[36:39], v[208:223]
    v_mfma_f32_32x32x16_bf16 v[224:239], v[28:31], v[32:35], v[224:239]
    v_mfma_f32_32x32x16_bf16 v[240:255], v[28:31], v[36:39], v[240:255]
    s_waitcnt vmcnt(0) lgkmcnt(0)
    s_barrier
    v_mfma_f32_32x32x16_bf16 v[128:143], v[40:43], v[56:59], v[128:143]
    v_xor_b32 v5, 0x10000, v5
    v_xor_b32 v6, 0x10000, v6
    v_xor_b32 v7, 0x10000, v7
    v_mfma_f32_32x32x16_bf16 v[144:159], v[40:43], v[60:63], v[144:159]
    v_xor_b32 v8, 0x10000, v8
    v_xor_b32 v9, 0x10000, v9
    v_xor_b32 v10, 0x10000, v10
    v_mfma_f32_32x32x16_bf16 v[160:175], v[44:47], v[56:59], v[160:175]
    ds_read_b128 v[16:19], v5 offset:0
    ds_read_b128 v[20:23], v5 offset:4096
    ds_read_b128 v[24:27], v5 offset:8192
    v_mfma_f32_32x32x16_bf16 v[176:191], v[44:47], v[60:63], v[176:191]
    ds_read_b128 v[28:31], v5 offset:12288
    ds_read_b64_tr_b16 v[32:33], v9 offset:0
    ds_read_b64_tr_b16 v[34:35], v9 offset:1024
    v_mfma_f32_32x32x16_bf16 v[192:207], v[48:51], v[56:59], v[192:207]
    ds_read_b64_tr_b16 v[36:37], v10 offset:0
    ds_read_b64_tr_b16 v[38:39], v10 offset:1024
    v_mfma_f32_32x32x16_bf16 v[208:223], v[48:51], v[60:63], v[208:223]
    v_mfma_f32_32x32x16_bf16 v[224:239], v[52:55], v[56:59], v[224:239]
    v_mfma_f32_32x32x16_bf16 v[240:255], v[52:55], v[60:63], v[240:255]
    s_waitcnt lgkmcnt(0)
    v_mfma_f32_32x32x16_bf16 v[128:143], v[16:19], v[32:35], v[128:143]
    ds_read_b128 v[40:43], v6 offset:0
    ds_read_b128 v[44:47], v6 offset:4096
    v_mfma_f32_32x32x16_bf16 v[144:159], v[16:19], v[36:39], v[144:159]
    ds_read_b128 v[48:51], v6 offset:8192
    ds_read_b128 v[52:55], v6 offset:12288
    v_mfma_f32_32x32x16_bf16 v[160:175], v[20:23], v[32:35], v[160:175]
    ds_read_b64_tr_b16 v[56:57], v9 offset:4096
    ds_read_b64_tr_b16 v[58:59], v9 offset:5120
    v_mfma_f32_32x32x16_bf16 v[176:191], v[20:23], v[36:39], v[176:191]
    ds_read_b64_tr_b16 v[60:61], v10 offset:4096
    ds_read_b64_tr_b16 v[62:63], v10 offset:5120
    v_mfma_f32_32x32x16_bf16 v[192:207], v[24:27], v[32:35], v[192:207]
    v_mfma_f32_32x32x16_bf16 v[208:223], v[24:27], v[36:39], v[208:223]
    v_mfma_f32_32x32x16_bf16 v[224:239], v[28:31], v[32:35], v[224:239]
    v_mfma_f32_32x32x16_bf16 v[240:255], v[28:31], v[36:39], v[240:255]
    s_waitcnt lgkmcnt(0)
    v_mfma_f32_32x32x16_bf16 v[128:143], v[40:43], v[56:59], v[128:143]
    ds_read_b128 v[16:19], v7 offset:0
    ds_read_b128 v[20:23], v7 offset:4096
    v_mfma_f32_32x32x16_bf16 v[144:159], v[40:43], v[60:63], v[144:159]
    ds_read_b128 v[24:27], v7 offset:8192
    ds_read_b128 v[28:31], v7 offset:12288
    v_mfma_f32_32x32x16_bf16 v[160:175], v[44:47], v[56:59], v[160:175]
    ds_read_b64_tr_b16 v[32:33], v9 offset:8192
    ds_read_b64_tr_b16 v[34:35], v9 offset:9216
    v_mfma_f32_32x32x16_bf16 v[176:191], v[44:47], v[60:63], v[176:191]
    ds_read_b64_tr_b16 v[36:37], v10 offset:8192
    ds_read_b64_tr_b16 v[38:39], v10 offset:9216
    v_mfma_f32_32x32x16_bf16 v[192:207], v[48:51], v[56:59], v[192:207]
    v_mfma_f32_32x32x16_bf16 v[208:223], v[48:51], v[60:63], v[208:223]
    v_mfma_f32_32x32x16_bf16 v[224:239], v[52:55], v[56:59], v[224:239]
    v_mfma_f32_32x32x16_bf16 v[240:255], v[52:55], v[60:63], v[240:255]
    s_waitcnt lgkmcnt(0)
    v_mfma_f32_32x32x16_bf16 v[128:143], v[16:19], v[32:35], v[128:143]
    ds_read_b128 v[40:43], v8 offset:0
    ds_read_b128 v[44:47], v8 offset:4096
    v_mfma_f32_32x32x16_bf16 v[144:159], v[16:19], v[36:39], v[144:159]
    ds_read_b128 v[48:51], v8 offset:8192
    ds_read_b128 v[52:55], v8 offset:12288
    v_mfma_f32_32x32x16_bf16 v[160:175], v[20:23], v[32:35], v[160:175]
    ds_read_b64_tr_b16 v[56:57], v9 offset:12288
    ds_read_b64_tr_b16 v[58:59], v9 offset:13312
    v_mfma_f32_32x32x16_bf16 v[176:191], v[20:23], v[36:39], v[176:191]
    ds_read_b64_tr_b16 v[60:61], v10 offset:12288
    ds_read_b64_tr_b16 v[62:63], v10 offset:13312
    v_mfma_f32_32x32x16_bf16 v[192:207], v[24:27], v[32:35], v[192:207]
    v_mfma_f32_32x32x16_bf16 v[208:223], v[24:27], v[36:39], v[208:223]
    v_mfma_f32_32x32x16_bf16 v[224:239], v[28:31], v[32:35], v[224:239]
    v_mfma_f32_32x32x16_bf16 v[240:255], v[28:31], v[36:39], v[240:255]
    s_waitcnt lgkmcnt(0)
    v_mfma_f32_32x32x16_bf16 v[128:143], v[40:43], v[56:59], v[128:143]
    v_mfma_f32_32x32x16_bf16 v[144:159], v[40:43], v[60:63], v[144:159]
    v_mfma_f32_32x32x16_bf16 v[160:175], v[44:47], v[56:59], v[160:175]
    v_mfma_f32_32x32x16_bf16 v[176:191], v[44:47], v[60:63], v[176:191]
    v_mfma_f32_32x32x16_bf16 v[192:207], v[48:51], v[56:59], v[192:207]
    v_mfma_f32_32x32x16_bf16 v[208:223], v[48:51], v[60:63], v[208:223]
    v_mfma_f32_32x32x16_bf16 v[224:239], v[52:55], v[56:59], v[224:239]
    v_mfma_f32_32x32x16_bf16 v[240:255], v[52:55], v[60:63], v[240:255]
KV_END_16:
    s_lshl_b32 s69, s66, 6
    s_lshl_b32 s70, s67, 3
    s_add_u32 s69, s69, s70
    s_and_b32 s70, s64, 1
    s_lshl_b32 s70, s70, 2
    s_add_u32 s69, s69, s70
    s_lshl_b32 s69, s69, 3
    s_and_b32 s70, s64, 2
    s_lshl_b32 s70, s70, 1
    s_add_u32 s69, s69, s70
    s_lshl_b32 s69, s69, 10
    s_lshr_b32 s70, s64, 2
    s_lshl_b32 s70, s70, 24
    s_add_u32 s69, s69, s70
    s_mov_b32 s3, s69
    s_barrier
    s_cmp_ge_u32 s64, 4
    s_cbranch_scc1 P2_35
    s_and_b32 s66, s2, 3
    s_lshl_b32 s66, s66, 2
    s_add_u32 s66, s66, s64
    s_lshr_b32 s67, s2, 2
    v_lshlrev_b32 v2, 4, v1
    v_and_b32 v6, 31, v1
    s_lshl_b32 s68, s67, 5
    v_add_u32 v6, s68, v6
    v_mul_u32_u24 v6, 1152, v6
    v_lshrrev_b32 v7, 5, v1
    v_lshl_add_u32 v8, v7, 3, v6
    s_mul_i32 s68, s66, 36
    s_add_u32 s68, s68, 50331648
    buffer_load_dwordx2 v[16:17], v8, s[56:59], s68 offen
    buffer_load_dwordx2 v[18:19], v8, s[56:59], s68 offen offset:16
    buffer_load_dword v20, v6, s[56:59], s68 offen offset:32
    v_lshlrev_b32 v7, 2, v1
    s_mov_b32 s68, 62922752
    buffer_load_dword v11, v7, s[56:59], s68 offen
    s_mul_i32 s69, s64, 2368
    s_add_u32 m0, s69, 131072
    s_add_u32 s68, s69, 54525952
    buffer_load_dwordx4 v2, s[56:59], s68 offen lds
    buffer_load_dwordx4 v2, s[56:59], s68 offen offset:1024 lds
    s_mov_b64 exec, 0xfffff
    buffer_load_dwordx4 v2, s[56:59], s68 offen offset:2048 lds
    s_mov_b64 exec, -1
    s_mul_i32 s69, s64, 2368
    s_add_u32 m0, s69, 147456
    s_add_u32 s68, s69, 54535424
    buffer_load_dwordx4 v2, s[56:59], s68 offen lds
    buffer_load_dwordx4 v2, s[56:59], s68 offen offset:1024 lds
    s_mov_b64 exec, 0xfffff
    buffer_load_dwordx4 v2, s[56:59], s68 offen offset:2048 lds
    s_mov_b64 exec, -1
    s_branch P2_36
P2_35:
    s_mov_b32 s44, s26
    s_and_b32 s45, s27, 0xffff
    s_mov_b32 s46, 2359296
    s_mov_b32 s47, 0x00020000
    s_mov_b32 s48, s30
    s_and_b32 s49, s31, 0xffff
    s_mov_b32 s50, 4718592
    s_mov_b32 s51, 0x00020000
    s_and_b32 s66, s2, 31
    s_lshr_b32 s67, s2, 5
    s_sub_u32 s74, s64, 4
    s_lshl_b32 s68, s67, 2
    s_add_u32 s75, s68, s74
    s_sub_u32 s76, 63, s75
    v_lshlrev_b32 v7, 4, v1
    v_lshrrev_b32 v65, 4, v1
    v_and_b32 v66, 7, v1
    v_xor_b32 v67, v66, v65
    v_xor_b32 v68, 4, v67
    v_lshrrev_b32 v64, 3, v1
    s_lshl_b32 s68, s75, 5
    v_add_u32 v64, s68, v64
    v_mul_u32_u24 v64, 1152, v64
    v_lshl_add_u32 v2, v67, 4, v64
    v_lshl_add_u32 v3, v68, 4, v64
    v_add_u32 v3, 9216, v3
    v_lshrrev_b32 v64, 3, v1
    s_lshl_b32 s68, s76, 5
    v_add_u32 v64, s68, v64
    v_mul_u32_u24 v64, 1152, v64
    v_lshl_add_u32 v4, v67, 4, v64
    v_lshl_add_u32 v5, v68, 4, v64
    v_add_u32 v5, 9216, v5
    v_and_b32 v66, 15, v1
    v_lshlrev_b32 v67, 2, v65
    v_xor_b32 v66, v66, v67
    v_lshlrev_b32 v66, 4, v66
    v_lshl_add_u32 v6, v65, 13, v66
    s_lshl_b32 s68, s66, 8
    v_add_u32 v6, s68, v6
    v_and_b32 v64, 31, v1
    s_lshl_b32 s68, s74, 6
    v_add_u32 v65, s68, v64
    v_lshlrev_b32 v65, 7, v65
    v_bfe_u32 v66, v1, 1, 3
    v_lshrrev_b32 v67, 5, v1
    v_add_u32 v68, 0, v67
    v_xor_b32 v68, v68, v66
    v_lshl_add_u32 v8, v68, 4, v65
    v_add_u32 v68, 2, v67
    v_xor_b32 v68, v68, v66
    v_lshl_add_u32 v9, v68, 4, v65
    v_add_u32 v68, 4, v67
    v_xor_b32 v68, v68, v66
    v_lshl_add_u32 v10, v68, 4, v65
    v_add_u32 v68, 6, v67
    v_xor_b32 v68, v68, v66
    v_lshl_add_u32 v11, v68, 4, v65
    v_bfe_u32 v64, v1, 2, 2
    v_lshrrev_b32 v65, 5, v1
    v_lshl_add_u32 v65, v65, 3, v64
    v_lshlrev_b32 v65, 8, v65
    v_bfe_u32 v66, v1, 4, 1
    v_bfe_u32 v67, v1, 1, 1
    v_lshl_add_u32 v66, v66, 1, v67
    v_lshl_add_u32 v65, v66, 4, v65
    v_and_b32 v66, 1, v1
    v_lshl_add_u32 v65, v66, 3, v65
    v_add_u32 v65, 65536, v65
    v_xor_b32 v66, 0, v64
    v_lshl_add_u32 v12, v66, 6, v65
    v_xor_b32 v66, 1, v64
    v_lshl_add_u32 v13, v66, 6, v65
    v_xor_b32 v66, 2, v64
    v_lshl_add_u32 v14, v66, 6, v65
    v_xor_b32 v66, 3, v64
    v_lshl_add_u32 v15, v66, 6, v65
    s_lshl_b32 s72, s74, 13
    s_lshl_b32 s73, s74, 11
    s_add_u32 s73, s73, 65536
    s_lshl_b32 s71, s74, 16
    s_add_u32 m0, s72, 0
    s_mov_b32 s68, 0
    buffer_load_dwordx4 v2, s[44:47], s68 offen lds
    s_add_u32 m0, s72, 1024
    s_mov_b32 s68, 0
    buffer_load_dwordx4 v3, s[44:47], s68 offen lds
    s_add_u32 m0, s72, 2048
    s_mov_b32 s68, 18432
    buffer_load_dwordx4 v2, s[44:47], s68 offen lds
    s_add_u32 m0, s72, 3072
    s_mov_b32 s68, 18432
    buffer_load_dwordx4 v3, s[44:47], s68 offen lds
    s_add_u32 m0, s72, 4096
    s_mov_b32 s68, 0
    buffer_load_dwordx4 v4, s[44:47], s68 offen lds
    s_add_u32 m0, s72, 5120
    s_mov_b32 s68, 0
    buffer_load_dwordx4 v5, s[44:47], s68 offen lds
    s_add_u32 m0, s72, 6144
    s_mov_b32 s68, 18432
    buffer_load_dwordx4 v4, s[44:47], s68 offen lds
    s_add_u32 m0, s72, 7168
    s_mov_b32 s68, 18432
    buffer_load_dwordx4 v5, s[44:47], s68 offen lds
    s_add_u32 m0, s73, 0
    s_add_u32 s68, s71, 0
    buffer_load_dwordx4 v6, s[48:51], s68 offen lds
    s_add_u32 m0, s73, 1024
    s_add_u32 s68, s71, 32768
    buffer_load_dwordx4 v6, s[48:51], s68 offen lds
    s_add_u32 m0, s73, 8192
    s_add_u32 s68, s71, 262144
    buffer_load_dwordx4 v6, s[48:51], s68 offen lds
    s_add_u32 m0, s73, 9216
    s_add_u32 s68, s71, 294912
    buffer_load_dwordx4 v6, s[48:51], s68 offen lds
    s_add_u32 m0, s72, 32768
    s_mov_b32 s68, 128
    buffer_load_dwordx4 v2, s[44:47], s68 offen lds
    s_add_u32 m0, s72, 33792
    s_mov_b32 s68, 128
    buffer_load_dwordx4 v3, s[44:47], s68 offen lds
    s_add_u32 m0, s72, 34816
    s_mov_b32 s68, 18560
    buffer_load_dwordx4 v2, s[44:47], s68 offen lds
    s_add_u32 m0, s72, 35840
    s_mov_b32 s68, 18560
    buffer_load_dwordx4 v3, s[44:47], s68 offen lds
    s_add_u32 m0, s72, 36864
    s_mov_b32 s68, 128
    buffer_load_dwordx4 v4, s[44:47], s68 offen lds
    s_add_u32 m0, s72, 37888
    s_mov_b32 s68, 128
    buffer_load_dwordx4 v5, s[44:47], s68 offen lds
    s_add_u32 m0, s72, 38912
    s_mov_b32 s68, 18560
    buffer_load_dwordx4 v4, s[44:47], s68 offen lds
    s_add_u32 m0, s72, 39936
    s_mov_b32 s68, 18560
    buffer_load_dwordx4 v5, s[44:47], s68 offen lds
    s_add_u32 m0, s73, 16384
    s_add_u32 s68, s71, 524288
    buffer_load_dwordx4 v6, s[48:51], s68 offen lds
    s_add_u32 m0, s73, 17408
    s_add_u32 s68, s71, 557056
    buffer_load_dwordx4 v6, s[48:51], s68 offen lds
    s_add_u32 m0, s73, 24576
    s_add_u32 s68, s71, 786432
    buffer_load_dwordx4 v6, s[48:51], s68 offen lds
    s_add_u32 m0, s73, 25600
    s_add_u32 s68, s71, 819200
    buffer_load_dwordx4 v6, s[48:51], s68 offen lds
P2_36:
    s_nop 7
    s_nop 7
    v_cvt_pk_bf16_f32 v64, v240, v241
    v_cvt_pk_bf16_f32 v65, v242, v243
    v_cvt_pk_bf16_f32 v68, v244, v245
    v_cvt_pk_bf16_f32 v69, v246, v247
    v_cvt_pk_bf16_f32 v66, v248, v249
    v_cvt_pk_bf16_f32 v67, v250, v251
    v_cvt_pk_bf16_f32 v70, v252, v253
    v_cvt_pk_bf16_f32 v71, v254, v255
    v_mov_b32 v248, v64
    v_mov_b32 v249, v65
    v_mov_b32 v250, v66
    v_mov_b32 v251, v67
    v_mov_b32 v252, v68
    v_mov_b32 v253, v69
    v_mov_b32 v254, v70
    v_mov_b32 v255, v71
    v_cvt_pk_bf16_f32 v240, v224, v225
    v_cvt_pk_bf16_f32 v241, v226, v227
    v_cvt_pk_bf16_f32 v244, v228, v229
    v_cvt_pk_bf16_f32 v245, v230, v231
    v_cvt_pk_bf16_f32 v242, v232, v233
    v_cvt_pk_bf16_f32 v243, v234, v235
    v_cvt_pk_bf16_f32 v246, v236, v237
    v_cvt_pk_bf16_f32 v247, v238, v239
    v_cvt_pk_bf16_f32 v232, v208, v209
    v_cvt_pk_bf16_f32 v233, v210, v211
    v_cvt_pk_bf16_f32 v236, v212, v213
    v_cvt_pk_bf16_f32 v237, v214, v215
    v_cvt_pk_bf16_f32 v234, v216, v217
    v_cvt_pk_bf16_f32 v235, v218, v219
    v_cvt_pk_bf16_f32 v238, v220, v221
    v_cvt_pk_bf16_f32 v239, v222, v223
    v_cvt_pk_bf16_f32 v224, v192, v193
    v_cvt_pk_bf16_f32 v225, v194, v195
    v_cvt_pk_bf16_f32 v228, v196, v197
    v_cvt_pk_bf16_f32 v229, v198, v199
    v_cvt_pk_bf16_f32 v226, v200, v201
    v_cvt_pk_bf16_f32 v227, v202, v203
    v_cvt_pk_bf16_f32 v230, v204, v205
    v_cvt_pk_bf16_f32 v231, v206, v207
    v_cvt_pk_bf16_f32 v216, v176, v177
    v_cvt_pk_bf16_f32 v217, v178, v179
    v_cvt_pk_bf16_f32 v220, v180, v181
    v_cvt_pk_bf16_f32 v221, v182, v183
    v_cvt_pk_bf16_f32 v218, v184, v185
    v_cvt_pk_bf16_f32 v219, v186, v187
    v_cvt_pk_bf16_f32 v222, v188, v189
    v_cvt_pk_bf16_f32 v223, v190, v191
    v_cvt_pk_bf16_f32 v208, v160, v161
    v_cvt_pk_bf16_f32 v209, v162, v163
    v_cvt_pk_bf16_f32 v212, v164, v165
    v_cvt_pk_bf16_f32 v213, v166, v167
    v_cvt_pk_bf16_f32 v210, v168, v169
    v_cvt_pk_bf16_f32 v211, v170, v171
    v_cvt_pk_bf16_f32 v214, v172, v173
    v_cvt_pk_bf16_f32 v215, v174, v175
    v_cvt_pk_bf16_f32 v200, v144, v145
    v_cvt_pk_bf16_f32 v201, v146, v147
    v_cvt_pk_bf16_f32 v204, v148, v149
    v_cvt_pk_bf16_f32 v205, v150, v151
    v_cvt_pk_bf16_f32 v202, v152, v153
    v_cvt_pk_bf16_f32 v203, v154, v155
    v_cvt_pk_bf16_f32 v206, v156, v157
    v_cvt_pk_bf16_f32 v207, v158, v159
    v_cvt_pk_bf16_f32 v192, v128, v129
    v_cvt_pk_bf16_f32 v193, v130, v131
    v_cvt_pk_bf16_f32 v196, v132, v133
    v_cvt_pk_bf16_f32 v197, v134, v135
    v_cvt_pk_bf16_f32 v194, v136, v137
    v_cvt_pk_bf16_f32 v195, v138, v139
    v_cvt_pk_bf16_f32 v198, v140, v141
    v_cvt_pk_bf16_f32 v199, v142, v143
L_P2:
    s_cmp_ge_u32 s64, 4
    s_cbranch_scc1 P2G_37
    s_mov_b32 s71, 0x40004000
    v_mov_b32 v32, 0
    v_mov_b32 v33, 0
    v_mov_b32 v34, 0
    v_mov_b32 v35, 0
    v_mov_b32 v36, 0
    v_mov_b32 v37, 0
    v_mov_b32 v38, 0
    v_mov_b32 v39, 0
    v_mov_b32 v40, 0
    v_mov_b32 v41, 0
    v_mov_b32 v42, 0
    v_mov_b32 v43, 0
    v_mov_b32 v44, 0
    v_mov_b32 v45, 0
    v_mov_b32 v46, 0
    v_mov_b32 v47, 0
    v_mov_b32 v88, 0
    v_mov_b32 v89, 0
    v_mov_b32 v90, 0
    v_mov_b32 v91, 0
    v_mov_b32 v92, 0
    v_mov_b32 v93, 0
    v_mov_b32 v94, 0
    v_mov_b32 v95, 0
    v_mov_b32 v21, 0
    v_mov_b32 v22, 0
    v_mov_b32 v23, 0
    v_and_b32 v174, 15, v1
    v_lshlrev_b32 v174, 4, v174
    v_bfe_u32 v7, v1, 4, 1
    v_lshl_add_u32 v174, v7, 10, v174
    v_lshrrev_b32 v7, 5, v1
    v_lshl_add_u32 v174, v7, 8, v174
    v_mov_b32 v170, v2
    v_and_b32 v171, 31, v1
    v_min_u32 v172, 18, v171
    v_lshlrev_b32 v171, 2, v171
    v_lshrrev_b32 v7, 5, v1
    v_mul_u32_u24 v7, 304, v7
    v_lshl_add_u32 v172, v172, 4, v7
    v_add_u32 v160, 131072, v170
    v_add_u32 v161, 131072, v170
    v_add_u32 v162, 147456, v170
    v_add_u32 v163, 131072, v171
    v_add_u32 v164, 131072, v171
    v_add_u32 v165, 147456, v171
    v_add_u32 v166, 131072, v172
    v_add_u32 v167, 131072, v172
    v_add_u32 v168, 147456, v172
    v_mov_b32 v117, 0
    v_mov_b32 v118, 0
    v_mov_b32 v119, 0
    v_mov_b32 v133, 0
    v_mov_b32 v134, 0
    v_mov_b32 v135, 0
    s_mul_i32 s76, s64, 2368
    s_add_u32 s70, s76, 54544896
    s_add_u32 s77, s76, 54668032
    s_mov_b32 s75, 114688
    s_mov_b32 s74, 0
    v_cmp_gt_u32 vcc, 32, v1
    s_waitcnt vmcnt(0)
    s_nop 0
    v_cndmask_b32 v20, 0, v20, vcc
    s_barrier
    ds_swizzle_b32 v7, v11 offset:0x41f
    s_waitcnt lgkmcnt(0)
    v_max_u32 v11, v11, v7
    ds_swizzle_b32 v7, v11 offset:0x81f
    s_waitcnt lgkmcnt(0)
    v_max_u32 v11, v11, v7
    ds_swizzle_b32 v7, v11 offset:0x101f
    s_waitcnt lgkmcnt(0)
    v_max_u32 v11, v11, v7
    ds_swizzle_b32 v7, v11 offset:0x201f
    s_waitcnt lgkmcnt(0)
    v_max_u32 v11, v11, v7
    ds_swizzle_b32 v7, v11 offset:0x401f
    s_waitcnt lgkmcnt(0)
    v_max_u32 v11, v11, v7
    v_mov_b32 v7, v11
    s_nop 1
    v_permlane32_swap_b32 v11, v7
    s_nop 1
    v_max_u32 v11, v11, v7
    ds_read_b128 v[112:115], v161
    ds_read_b32 v116, v164 offset:1024
    v_mov_b32 v7, 0
    v_lshlrev_b32 v12, 16, v16
    v_and_b32 v13, 0xffff0000, v16
    v_fmac_f32 v7, v12, v12
    v_fmac_f32 v7, v13, v13
    v_lshlrev_b32 v12, 16, v17
    v_and_b32 v13, 0xffff0000, v17
    v_fmac_f32 v7, v12, v12
    v_fmac_f32 v7, v13, v13
    v_lshlrev_b32 v12, 16, v18
    v_and_b32 v13, 0xffff0000, v18
    v_fmac_f32 v7, v12, v12
    v_fmac_f32 v7, v13, v13
    v_lshlrev_b32 v12, 16, v19
    v_and_b32 v13, 0xffff0000, v19
    v_fmac_f32 v7, v12, v12
    v_fmac_f32 v7, v13, v13
    v_lshlrev_b32 v12, 16, v20
    v_and_b32 v13, 0xffff0000, v20
    v_fmac_f32 v7, v12, v12
    v_fmac_f32 v7, v13, v13
    v_mov_b32 v8, v7
    s_nop 1
    v_permlane32_swap_b32 v7, v8
    s_nop 1
    v_add_f32 v7, v7, v8
    v_mul_f32 v7, v7, v11
    v_sqrt_f32 v7, v7
    s_nop 0
    v_mul_f32 v7, 0x3f828f5c, v7
    v_add_f32 v7, 0x3c23d70a, v7
    v_cmp_nge_f32 vcc, 0x42200000, v7
    s_cbranch_vccnz AA_CHK_39
    v_sub_f32 v96, 0, v7
    v_sub_f32 v97, 0, v7
    v_sub_f32 v98, 0, v7
    v_sub_f32 v99, 0, v7
    v_sub_f32 v100, 0, v7
    v_sub_f32 v101, 0, v7
    v_sub_f32 v102, 0, v7
    v_sub_f32 v103, 0, v7
    v_sub_f32 v104, 0, v7
    v_sub_f32 v105, 0, v7
    v_sub_f32 v106, 0, v7
    v_sub_f32 v107, 0, v7
    v_sub_f32 v108, 0, v7
    v_sub_f32 v109, 0, v7
    v_sub_f32 v110, 0, v7
    v_sub_f32 v111, 0, v7
    v_mov_b32 v11, 0
    s_waitcnt lgkmcnt(0)
    s_nop 0
    v_mfma_f32_32x32x16_bf16 v[48:63], v[112:115], v[16:19], v[96:111]
    v_mfma_f32_32x32x16_bf16 v[48:63], v[116:119], v[20:23], v[48:63]
    ds_read_b128 v[112:115], v161 offset:2368
    ds_read_b32 v116, v164 offset:3392
    ds_read_b128 v[120:123], v166 offset:8256
    ds_read_b128 v[124:127], v166 offset:8864
    s_nop 15
AA_LOOP_41:
    s_waitcnt lgkmcnt(2)
    v_mfma_f32_32x32x16_bf16 v[64:79], v[112:115], v[16:19], v[96:111]
    s_lshl_b32 s69, s74, 3
    s_set_gpr_idx_on s69, 1
    s_nop 0
    v_mov_b32 v148, v192
    v_mov_b32 v149, v193
    v_mov_b32 v150, v194
    v_mov_b32 v151, v195
    s_set_gpr_idx_off
    ds_read_b128 v[128:131], v161 offset:4736
    v_exp_f32 v180, v48
    v_exp_f32 v181, v49
    v_exp_f32 v182, v50
    v_exp_f32 v183, v51
    v_mfma_f32_32x32x16_bf16 v[64:79], v[116:119], v[20:23], v[64:79]
    ds_read_b32 v132, v164 offset:5760
    v_exp_f32 v184, v52
    v_exp_f32 v185, v53
    v_cvt_pk_bf16_f32 v80, v180, v181
    v_exp_f32 v186, v54
    v_cvt_pk_bf16_f32 v81, v182, v183
    v_exp_f32 v187, v55
    s_waitcnt lgkmcnt(2)
    v_mfma_f32_32x32x16_bf16 v[32:47], v[120:123], v[88:91], v[32:47]
    s_lshl_b32 s69, s74, 3
    s_add_u32 s69, s69, 4
    s_set_gpr_idx_on s69, 1
    s_nop 0
    v_mov_b32 v152, v192
    v_mov_b32 v153, v193
    v_mov_b32 v154, v194
    v_mov_b32 v155, v195
    s_set_gpr_idx_off
    ds_read_b128 v[136:139], v167 offset:1152
    v_exp_f32 v180, v56
    v_exp_f32 v181, v57
    v_cvt_pk_bf16_f32 v82, v184, v185
    v_exp_f32 v182, v58
    v_cvt_pk_bf16_f32 v83, v186, v187
    v_exp_f32 v183, v59
    v_mfma_f32_32x32x16_bf16 v[32:47], v[124:127], v[92:95], v[32:47]
    ds_read_b128 v[140:143], v167 offset:1760
    v_exp_f32 v184, v60
    v_exp_f32 v185, v61
    v_cvt_pk_bf16_f32 v84, v180, v181
    v_exp_f32 v186, v62
    v_cvt_pk_bf16_f32 v85, v182, v183
    v_exp_f32 v187, v63
    v_cvt_pk_bf16_f32 v86, v184, v185
    s_nop 0
    v_cvt_pk_bf16_f32 v87, v186, v187
    s_waitcnt lgkmcnt(2)
    v_mfma_f32_32x32x16_bf16 v[48:63], v[128:131], v[16:19], v[96:111]
    ds_read_b128 v[112:115], v161 offset:7104
    v_exp_f32 v180, v64
    v_exp_f32 v181, v65
    v_exp_f32 v182, v66
    v_exp_f32 v183, v67
    v_mfma_f32_32x32x16_bf16 v[48:63], v[132:135], v[20:23], v[48:63]
    ds_read_b32 v116, v164 offset:8128
    v_exp_f32 v184, v68
    v_exp_f32 v185, v69
    v_cvt_pk_bf16_f32 v88, v180, v181
    v_exp_f32 v186, v70
    v_cvt_pk_bf16_f32 v89, v182, v183
    v_exp_f32 v187, v71
    s_waitcnt lgkmcnt(2)
    v_mfma_f32_32x32x16_bf16 v[32:47], v[136:139], v[80:83], v[32:47]
    s_waitcnt vmcnt(2)
    s_barrier
    s_add_u32 m0, s75, s76
    s_nop 0
    buffer_load_dwordx4 v2, s[56:59], s70 offen lds
    buffer_load_dwordx4 v2, s[56:59], s70 offen offset:1024 lds
    s_mov_b64 exec, 0xfffff
    buffer_load_dwordx4 v2, s[56:59], s70 offen offset:2048 lds
    s_mov_b64 exec, -1
    s_add_u32 s70, s70, 9472
    s_min_u32 s70, s70, s77
    ds_read_b128 v[120:123], v167 offset:3520
    v_exp_f32 v180, v72
    v_exp_f32 v181, v73
    v_cvt_pk_bf16_f32 v90, v184, v185
    v_exp_f32 v182, v74
    v_cvt_pk_bf16_f32 v91, v186, v187
    v_exp_f32 v183, v75
    v_mfma_f32_32x32x16_bf16 v[32:47], v[140:143], v[84:87], v[32:47]
    s_lshr_b32 s69, s74, 1
    s_lshl_b32 s69, s69, 13
    s_and_b32 s68, s74, 1
    s_lshl_b32 s68, s68, 11
    s_add_u32 s69, s69, s68
    s_add_u32 s69, s69, s3
    buffer_store_dwordx4 v[148:151], v174, s[56:59], s69 offen sc1
    buffer_store_dwordx4 v[152:155], v174, s[56:59], s69 offen offset:512 sc1
    ds_read_b128 v[124:127], v167 offset:4128
    v_exp_f32 v184, v76
    v_exp_f32 v185, v77
    v_cvt_pk_bf16_f32 v92, v180, v181
    v_exp_f32 v186, v78
    v_cvt_pk_bf16_f32 v93, v182, v183
    v_exp_f32 v187, v79
    v_cvt_pk_bf16_f32 v94, v184, v185
    s_nop 0
    v_cvt_pk_bf16_f32 v95, v186, v187
    s_waitcnt lgkmcnt(2)
    v_mfma_f32_32x32x16_bf16 v[64:79], v[112:115], v[16:19], v[96:111]
    ds_read_b128 v[128:131], v162 offset:0
    v_exp_f32 v180, v48
    v_exp_f32 v181, v49
    v_exp_f32 v182, v50
    v_exp_f32 v183, v51
    v_mfma_f32_32x32x16_bf16 v[64:79], v[116:119], v[20:23], v[64:79]
    ds_read_b32 v132, v165 offset:1024
    v_exp_f32 v184, v52
    v_exp_f32 v185, v53
    v_cvt_pk_bf16_f32 v80, v180, v181
    v_exp_f32 v186, v54
    v_cvt_pk_bf16_f32 v81, v182, v183
    v_exp_f32 v187, v55
    s_waitcnt lgkmcnt(2)
    v_mfma_f32_32x32x16_bf16 v[32:47], v[120:123], v[88:91], v[32:47]
    ds_read_b128 v[136:139], v167 offset:5888
    v_exp_f32 v180, v56
    v_exp_f32 v181, v57
    v_cvt_pk_bf16_f32 v82, v184, v185
    v_exp_f32 v182, v58
    v_cvt_pk_bf16_f32 v83, v186, v187
    v_exp_f32 v183, v59
    v_mfma_f32_32x32x16_bf16 v[32:47], v[124:127], v[92:95], v[32:47]
    ds_read_b128 v[140:143], v167 offset:6496
    v_exp_f32 v184, v60
    v_exp_f32 v185, v61
    v_cvt_pk_bf16_f32 v84, v180, v181
    v_exp_f32 v186, v62
    v_cvt_pk_bf16_f32 v85, v182, v183
    v_exp_f32 v187, v63
    v_cvt_pk_bf16_f32 v86, v184, v185
    s_nop 0
    v_cvt_pk_bf16_f32 v87, v186, v187
    s_waitcnt lgkmcnt(2)
    v_mfma_f32_32x32x16_bf16 v[48:63], v[128:131], v[16:19], v[96:111]
    ds_read_b128 v[112:115], v162 offset:2368
    v_exp_f32 v180, v64
    v_exp_f32 v181, v65
    v_exp_f32 v182, v66
    v_exp_f32 v183, v67
    v_mfma_f32_32x32x16_bf16 v[48:63], v[132:135], v[20:23], v[48:63]
    ds_read_b32 v116, v165 offset:3392
    v_exp_f32 v184, v68
    s_add_u32 s74, s74, 1
    s_mov_b32 s68, s75
    v_exp_f32 v185, v69
    v_cvt_pk_bf16_f32 v88, v180, v181
    s_add_u32 s75, s75, 16384
    v_exp_f32 v186, v70
    v_cvt_pk_bf16_f32 v89, v182, v183
    s_cmp_ge_u32 s75, 163840
    v_exp_f32 v187, v71
    s_cselect_b32 s75, 114688, s75
    s_waitcnt lgkmcnt(2)
    v_mfma_f32_32x32x16_bf16 v[32:47], v[136:139], v[80:83], v[32:47]
    s_barrier
    ds_read_b128 v[120:123], v167 offset:8256
    v_exp_f32 v180, v72
    v_exp_f32 v181, v73
    v_cvt_pk_bf16_f32 v90, v184, v185
    v_exp_f32 v182, v74
    v_cvt_pk_bf16_f32 v91, v186, v187
    v_exp_f32 v183, v75
    v_mfma_f32_32x32x16_bf16 v[32:47], v[140:143], v[84:87], v[32:47]
    ds_read_b128 v[124:127], v167 offset:8864
    v_exp_f32 v184, v76
    v_exp_f32 v185, v77
    v_cvt_pk_bf16_f32 v92, v180, v181
    v_exp_f32 v186, v78
    v_cvt_pk_bf16_f32 v93, v182, v183
    v_exp_f32 v187, v79
    v_cvt_pk_bf16_f32 v94, v184, v185
    v_mov_b32 v166, v167
    v_cvt_pk_bf16_f32 v95, v186, v187
    v_mov_b32 v161, v162
    v_add_u32 v162, s68, v170
    v_mov_b32 v164, v165
    v_add_u32 v165, s68, v171
    v_mov_b32 v167, v168
    v_add_u32 v168, s68, v172
    s_cmp_lt_u32 s74, 8
    s_cbranch_scc1 AA_LOOP_41
AA_LOOP_42:
    s_waitcnt lgkmcnt(2)
    v_mfma_f32_32x32x16_bf16 v[64:79], v[112:115], v[16:19], v[96:111]
    ds_read_b128 v[128:131], v161 offset:4736
    v_exp_f32 v180, v48
    v_exp_f32 v181, v49
    v_exp_f32 v182, v50
    v_exp_f32 v183, v51
    v_mfma_f32_32x32x16_bf16 v[64:79], v[116:119], v[20:23], v[64:79]
    ds_read_b32 v132, v164 offset:5760
    v_exp_f32 v184, v52
    v_exp_f32 v185, v53
    v_cvt_pk_bf16_f32 v80, v180, v181
    v_exp_f32 v186, v54
    v_cvt_pk_bf16_f32 v81, v182, v183
    v_exp_f32 v187, v55
    s_waitcnt lgkmcnt(2)
    v_mfma_f32_32x32x16_bf16 v[32:47], v[120:123], v[88:91], v[32:47]
    ds_read_b128 v[136:139], v167 offset:1152
    v_exp_f32 v180, v56
    v_exp_f32 v181, v57
    v_cvt_pk_bf16_f32 v82, v184, v185
    v_exp_f32 v182, v58
    v_cvt_pk_bf16_f32 v83, v186, v187
    v_exp_f32 v183, v59
    v_mfma_f32_32x32x16_bf16 v[32:47], v[124:127], v[92:95], v[32:47]
    ds_read_b128 v[140:143], v167 offset:1760
    v_exp_f32 v184, v60
    v_exp_f32 v185, v61
    v_cvt_pk_bf16_f32 v84, v180, v181
    v_exp_f32 v186, v62
    v_cvt_pk_bf16_f32 v85, v182, v183
    v_exp_f32 v187, v63
    v_cvt_pk_bf16_f32 v86, v184, v185
    s_nop 0
    v_cvt_pk_bf16_f32 v87, v186, v187
    s_waitcnt lgkmcnt(2)
    v_mfma_f32_32x32x16_bf16 v[48:63], v[128:131], v[16:19], v[96:111]
    ds_read_b128 v[112:115], v161 offset:7104
    v_exp_f32 v180, v64
    v_exp_f32 v181, v65
    v_exp_f32 v182, v66
    v_exp_f32 v183, v67
    v_mfma_f32_32x32x16_bf16 v[48:63], v[132:135], v[20:23], v[48:63]
    ds_read_b32 v116, v164 offset:8128
    v_exp_f32 v184, v68
    v_exp_f32 v185, v69
    v_cvt_pk_bf16_f32 v88, v180, v181
    v_exp_f32 v186, v70
    v_cvt_pk_bf16_f32 v89, v182, v183
    v_exp_f32 v187, v71
    s_waitcnt lgkmcnt(2)
    v_mfma_f32_32x32x16_bf16 v[32:47], v[136:139], v[80:83], v[32:47]
    s_waitcnt vmcnt(0)
    s_barrier
    s_add_u32 m0, s75, s76
    s_nop 0
    buffer_load_dwordx4 v2, s[56:59], s70 offen lds
    buffer_load_dwordx4 v2, s[56:59], s70 offen offset:1024 lds
    s_mov_b64 exec, 0xfffff
    buffer_load_dwordx4 v2, s[56:59], s70 offen offset:2048 lds
    s_mov_b64 exec, -1
    s_add_u32 s70, s70, 9472
    s_min_u32 s70, s70, s77
    ds_read_b128 v[120:123], v167 offset:3520
    v_exp_f32 v180, v72
    v_exp_f32 v181, v73
    v_cvt_pk_bf16_f32 v90, v184, v185
    v_exp_f32 v182, v74
    v_cvt_pk_bf16_f32 v91, v186, v187
    v_exp_f32 v183, v75
    v_mfma_f32_32x32x16_bf16 v[32:47], v[140:143], v[84:87], v[32:47]
    ds_read_b128 v[124:127], v167 offset:4128
    v_exp_f32 v184, v76
    v_exp_f32 v185, v77
    v_cvt_pk_bf16_f32 v92, v180, v181
    v_exp_f32 v186, v78
    v_cvt_pk_bf16_f32 v93, v182, v183
    v_exp_f32 v187, v79
    v_cvt_pk_bf16_f32 v94, v184, v185
    s_nop 0
    v_cvt_pk_bf16_f32 v95, v186, v187
    s_waitcnt lgkmcnt(2)
    v_mfma_f32_32x32x16_bf16 v[64:79], v[112:115], v[16:19], v[96:111]
    ds_read_b128 v[128:131], v162 offset:0
    v_exp_f32 v180, v48
    v_exp_f32 v181, v49
    v_exp_f32 v182, v50
    v_exp_f32 v183, v51
    v_mfma_f32_32x32x16_bf16 v[64:79], v[116:119], v[20:23], v[64:79]
    ds_read_b32 v132, v165 offset:1024
    v_exp_f32 v184, v52
    v_exp_f32 v185, v53
    v_cvt_pk_bf16_f32 v80, v180, v181
    v_exp_f32 v186, v54
    v_cvt_pk_bf16_f32 v81, v182, v183
    v_exp_f32 v187, v55
    s_waitcnt lgkmcnt(2)
    v_mfma_f32_32x32x16_bf16 v[32:47], v[120:123], v[88:91], v[32:47]
    ds_read_b128 v[136:139], v167 offset:5888
    v_exp_f32 v180, v56
    v_exp_f32 v181, v57
    v_cvt_pk_bf16_f32 v82, v184, v185
    v_exp_f32 v182, v58
    v_cvt_pk_bf16_f32 v83, v186, v187
    v_exp_f32 v183, v59
    v_mfma_f32_32x32x16_bf16 v[32:47], v[124:127], v[92:95], v[32:47]
    ds_read_b128 v[140:143], v167 offset:6496
    v_exp_f32 v184, v60
    v_exp_f32 v185, v61
    v_cvt_pk_bf16_f32 v84, v180, v181
    v_exp_f32 v186, v62
    v_cvt_pk_bf16_f32 v85, v182, v183
    v_exp_f32 v187, v63
    v_cvt_pk_bf16_f32 v86, v184, v185
    s_nop 0
    v_cvt_pk_bf16_f32 v87, v186, v187
    s_waitcnt lgkmcnt(2)
    v_mfma_f32_32x32x16_bf16 v[48:63], v[128:131], v[16:19], v[96:111]
    ds_read_b128 v[112:115], v162 offset:2368
    v_exp_f32 v180, v64
    v_exp_f32 v181, v65
    v_exp_f32 v182, v66
    v_exp_f32 v183, v67
    v_mfma_f32_32x32x16_bf16 v[48:63], v[132:135], v[20:23], v[48:63]
    ds_read_b32 v116, v165 offset:3392
    v_exp_f32 v184, v68
    s_add_u32 s74, s74, 1
    s_mov_b32 s68, s75
    v_exp_f32 v185, v69
    v_cvt_pk_bf16_f32 v88, v180, v181
    s_add_u32 s75, s75, 16384
    v_exp_f32 v186, v70
    v_cvt_pk_bf16_f32 v89, v182, v183
    s_cmp_ge_u32 s75, 163840
    v_exp_f32 v187, v71
    s_cselect_b32 s75, 114688, s75
    s_waitcnt lgkmcnt(2)
    v_mfma_f32_32x32x16_bf16 v[32:47], v[136:139], v[80:83], v[32:47]
    s_barrier
    ds_read_b128 v[120:123], v167 offset:8256
    v_exp_f32 v180, v72
    v_exp_f32 v181, v73
    v_cvt_pk_bf16_f32 v90, v184, v185
    v_exp_f32 v182, v74
    v_cvt_pk_bf16_f32 v91, v186, v187
    v_exp_f32 v183, v75
    v_mfma_f32_32x32x16_bf16 v[32:47], v[140:143], v[84:87], v[32:47]
    ds_read_b128 v[124:127], v167 offset:8864
    v_exp_f32 v184, v76
    v_exp_f32 v185, v77
    v_cvt_pk_bf16_f32 v92, v180, v181
    v_exp_f32 v186, v78
    v_cvt_pk_bf16_f32 v93, v182, v183
    v_exp_f32 v187, v79
    v_cvt_pk_bf16_f32 v94, v184, v185
    v_mov_b32 v166, v167
    v_cvt_pk_bf16_f32 v95, v186, v187
    v_mov_b32 v161, v162
    v_add_u32 v162, s68, v170
    v_mov_b32 v164, v165
    v_add_u32 v165, s68, v171
    v_mov_b32 v167, v168
    v_add_u32 v168, s68, v172
    s_cmp_lt_u32 s74, 16
    s_cbranch_scc1 AA_LOOP_42
    s_branch AA_J_40
AA_CHK_39:
    v_mov_b32 v11, 1
    s_waitcnt lgkmcnt(0)
    v_mfma_f32_32x32x16_bf16 v[48:63], v[112:115], v[16:19], 0
    v_mfma_f32_32x32x16_bf16 v[48:63], v[116:119], v[20:23], v[48:63]
    s_nop 15
    v_max3_f32 v7, v48, v49, v50
    v_max3_f32 v7, v7, v51, v52
    v_max3_f32 v7, v7, v53, v54
    v_max3_f32 v7, v7, v55, v56
    v_max3_f32 v7, v7, v57, v58
    v_max3_f32 v7, v7, v59, v60
    v_max3_f32 v7, v7, v61, v62
    v_max_f32 v7, v7, v63
    v_mov_b32 v8, v7
    s_nop 1
    v_permlane32_swap_b32 v7, v8
    s_nop 1
    v_max_f32 v7, v7, v8
    v_add_f32 v7, 0x42800000, v7
    v_sub_f32 v96, 0, v7
    v_sub_f32 v48, v48, v7
    v_sub_f32 v97, 0, v7
    v_sub_f32 v49, v49, v7
    v_sub_f32 v98, 0, v7
    v_sub_f32 v50, v50, v7
    v_sub_f32 v99, 0, v7
    v_sub_f32 v51, v51, v7
    v_sub_f32 v100, 0, v7
    v_sub_f32 v52, v52, v7
    v_sub_f32 v101, 0, v7
    v_sub_f32 v53, v53, v7
    v_sub_f32 v102, 0, v7
    v_sub_f32 v54, v54, v7
    v_sub_f32 v103, 0, v7
    v_sub_f32 v55, v55, v7
    v_sub_f32 v104, 0, v7
    v_sub_f32 v56, v56, v7
    v_sub_f32 v105, 0, v7
    v_sub_f32 v57, v57, v7
    v_sub_f32 v106, 0, v7
    v_sub_f32 v58, v58, v7
    v_sub_f32 v107, 0, v7
    v_sub_f32 v59, v59, v7
    v_sub_f32 v108, 0, v7
    v_sub_f32 v60, v60, v7
    v_sub_f32 v109, 0, v7
    v_sub_f32 v61, v61, v7
    v_sub_f32 v110, 0, v7
    v_sub_f32 v62, v62, v7
    v_sub_f32 v111, 0, v7
    v_sub_f32 v63, v63, v7
    ds_read_b128 v[112:115], v161 offset:2368
    ds_read_b32 v116, v164 offset:3392
    ds_read_b128 v[120:123], v166 offset:8256
    ds_read_b128 v[124:127], v166 offset:8864
AA_LOOP_43:
    s_waitcnt lgkmcnt(2)
    v_mfma_f32_32x32x16_bf16 v[64:79], v[112:115], v[16:19], v[96:111]
    s_lshl_b32 s69, s74, 3
    s_set_gpr_idx_on s69, 1
    s_nop 0
    v_mov_b32 v148, v192
    v_mov_b32 v149, v193
    v_mov_b32 v150, v194
    v_mov_b32 v151, v195
    s_set_gpr_idx_off
    ds_read_b128 v[128:131], v161 offset:4736
    v_exp_f32 v180, v48
    v_exp_f32 v181, v49
    v_exp_f32 v182, v50
    v_exp_f32 v183, v51
    v_mfma_f32_32x32x16_bf16 v[64:79], v[116:119], v[20:23], v[64:79]
    ds_read_b32 v132, v164 offset:5760
    v_exp_f32 v184, v52
    v_exp_f32 v185, v53
    v_cvt_pk_bf16_f32 v80, v180, v181
    v_exp_f32 v186, v54
    v_cvt_pk_bf16_f32 v81, v182, v183
    v_exp_f32 v187, v55
    s_waitcnt lgkmcnt(2)
    v_mfma_f32_32x32x16_bf16 v[32:47], v[120:123], v[88:91], v[32:47]
    s_lshl_b32 s69, s74, 3
    s_add_u32 s69, s69, 4
    s_set_gpr_idx_on s69, 1
    s_nop 0
    v_mov_b32 v152, v192
    v_mov_b32 v153, v193
    v_mov_b32 v154, v194
    v_mov_b32 v155, v195
    s_set_gpr_idx_off
    ds_read_b128 v[136:139], v167 offset:1152
    v_exp_f32 v180, v56
    v_or_b32 v10, v80, v81
    v_exp_f32 v181, v57
    v_cvt_pk_bf16_f32 v82, v184, v185
    v_exp_f32 v182, v58
    v_cvt_pk_bf16_f32 v83, v186, v187
    v_exp_f32 v183, v59
    v_mfma_f32_32x32x16_bf16 v[32:47], v[124:127], v[92:95], v[32:47]
    ds_read_b128 v[140:143], v167 offset:1760
    v_exp_f32 v184, v60
    v_or3_b32 v10, v10, v82, v83
    v_exp_f32 v185, v61
    v_cvt_pk_bf16_f32 v84, v180, v181
    v_exp_f32 v186, v62
    v_cvt_pk_bf16_f32 v85, v182, v183
    v_exp_f32 v187, v63
    v_cvt_pk_bf16_f32 v86, v184, v185
    v_or3_b32 v10, v10, v84, v85
    v_cvt_pk_bf16_f32 v87, v186, v187
    s_nop 1
    v_or3_b32 v10, v10, v86, v87
    v_and_b32 v10, s71, v10
    v_cmp_ne_u32 vcc, 0, v10
    s_cbranch_vccnz AA_SLOW_44
AA_BACK_45:
    s_waitcnt lgkmcnt(2)
    v_mfma_f32_32x32x16_bf16 v[48:63], v[128:131], v[16:19], v[96:111]
    ds_read_b128 v[112:115], v161 offset:7104
    v_exp_f32 v180, v64
    v_exp_f32 v181, v65
    v_exp_f32 v182, v66
    v_exp_f32 v183, v67
    v_mfma_f32_32x32x16_bf16 v[48:63], v[132:135], v[20:23], v[48:63]
    ds_read_b32 v116, v164 offset:8128
    v_exp_f32 v184, v68
    v_exp_f32 v185, v69
    v_cvt_pk_bf16_f32 v88, v180, v181
    v_exp_f32 v186, v70
    v_cvt_pk_bf16_f32 v89, v182, v183
    v_exp_f32 v187, v71
    s_waitcnt lgkmcnt(2)
    v_mfma_f32_32x32x16_bf16 v[32:47], v[136:139], v[80:83], v[32:47]
    s_waitcnt vmcnt(2)
    s_barrier
    s_add_u32 m0, s75, s76
    s_nop 0
    buffer_load_dwordx4 v2, s[56:59], s70 offen lds
    buffer_load_dwordx4 v2, s[56:59], s70 offen offset:1024 lds
    s_mov_b64 exec, 0xfffff
    buffer_load_dwordx4 v2, s[56:59], s70 offen offset:2048 lds
    s_mov_b64 exec, -1
    s_add_u32 s70, s70, 9472
    s_min_u32 s70, s70, s77
    ds_read_b128 v[120:123], v167 offset:3520
    v_exp_f32 v180, v72
    v_or_b32 v10, v88, v89
    v_exp_f32 v181, v73
    v_cvt_pk_bf16_f32 v90, v184, v185
    v_exp_f32 v182, v74
    v_cvt_pk_bf16_f32 v91, v186, v187
    v_exp_f32 v183, v75
    v_mfma_f32_32x32x16_bf16 v[32:47], v[140:143], v[84:87], v[32:47]
    s_lshr_b32 s69, s74, 1
    s_lshl_b32 s69, s69, 13
    s_and_b32 s68, s74, 1
    s_lshl_b32 s68, s68, 11
    s_add_u32 s69, s69, s68
    s_add_u32 s69, s69, s3
    buffer_store_dwordx4 v[148:151], v174, s[56:59], s69 offen sc1
    buffer_store_dwordx4 v[152:155], v174, s[56:59], s69 offen offset:512 sc1
    ds_read_b128 v[124:127], v167 offset:4128
    v_exp_f32 v184, v76
    v_or3_b32 v10, v10, v90, v91
    v_exp_f32 v185, v77
    v_cvt_pk_bf16_f32 v92, v180, v181
    v_exp_f32 v186, v78
    v_cvt_pk_bf16_f32 v93, v182, v183
    v_exp_f32 v187, v79
    v_cvt_pk_bf16_f32 v94, v184, v185
    v_or3_b32 v10, v10, v92, v93
    v_cvt_pk_bf16_f32 v95, v186, v187
    s_nop 1
    v_or3_b32 v10, v10, v94, v95
    v_and_b32 v10, s71, v10
    v_cmp_ne_u32 vcc, 0, v10
    s_cbranch_vccnz AA_SLOW_46
AA_BACK_47:
    s_waitcnt lgkmcnt(2)
    v_mfma_f32_32x32x16_bf16 v[64:79], v[112:115], v[16:19], v[96:111]
    ds_read_b128 v[128:131], v162 offset:0
    v_exp_f32 v180, v48
    v_exp_f32 v181, v49
    v_exp_f32 v182, v50
    v_exp_f32 v183, v51
    v_mfma_f32_32x32x16_bf16 v[64:79], v[116:119], v[20:23], v[64:79]
    ds_read_b32 v132, v165 offset:1024
    v_exp_f32 v184, v52
    v_exp_f32 v185, v53
    v_cvt_pk_bf16_f32 v80, v180, v181
    v_exp_f32 v186, v54
    v_cvt_pk_bf16_f32 v81, v182, v183
    v_exp_f32 v187, v55
    s_waitcnt lgkmcnt(2)
    v_mfma_f32_32x32x16_bf16 v[32:47], v[120:123], v[88:91], v[32:47]
    ds_read_b128 v[136:139], v167 offset:5888
    v_exp_f32 v180, v56
    v_or_b32 v10, v80, v81
    v_exp_f32 v181, v57
    v_cvt_pk_bf16_f32 v82, v184, v185
    v_exp_f32 v182, v58
    v_cvt_pk_bf16_f32 v83, v186, v187
    v_exp_f32 v183, v59
    v_mfma_f32_32x32x16_bf16 v[32:47], v[124:127], v[92:95], v[32:47]
    ds_read_b128 v[140:143], v167 offset:6496
    v_exp_f32 v184, v60
    v_or3_b32 v10, v10, v82, v83
    v_exp_f32 v185, v61
    v_cvt_pk_bf16_f32 v84, v180, v181
    v_exp_f32 v186, v62
    v_cvt_pk_bf16_f32 v85, v182, v183
    v_exp_f32 v187, v63
    v_cvt_pk_bf16_f32 v86, v184, v185
    v_or3_b32 v10, v10, v84, v85
    v_cvt_pk_bf16_f32 v87, v186, v187
    s_nop 1
    v_or3_b32 v10, v10, v86, v87
    v_and_b32 v10, s71, v10
    v_cmp_ne_u32 vcc, 0, v10
    s_cbranch_vccnz AA_SLOW_48
AA_BACK_49:
    s_waitcnt lgkmcnt(2)
    v_mfma_f32_32x32x16_bf16 v[48:63], v[128:131], v[16:19], v[96:111]
    ds_read_b128 v[112:115], v162 offset:2368
    v_exp_f32 v180, v64
    v_exp_f32 v181, v65
    v_exp_f32 v182, v66
    v_exp_f32 v183, v67
    v_mfma_f32_32x32x16_bf16 v[48:63], v[132:135], v[20:23], v[48:63]
    ds_read_b32 v116, v165 offset:3392
    v_exp_f32 v184, v68
    s_add_u32 s74, s74, 1
    s_mov_b32 s68, s75
    v_exp_f32 v185, v69
    v_cvt_pk_bf16_f32 v88, v180, v181
    s_add_u32 s75, s75, 16384
    v_exp_f32 v186, v70
    v_cvt_pk_bf16_f32 v89, v182, v183
    s_cmp_ge_u32 s75, 163840
    v_exp_f32 v187, v71
    s_cselect_b32 s75, 114688, s75
    s_waitcnt lgkmcnt(2)
    v_mfma_f32_32x32x16_bf16 v[32:47], v[136:139], v[80:83], v[32:47]
    s_barrier
    ds_read_b128 v[120:123], v167 offset:8256
    v_exp_f32 v180, v72
    v_or_b32 v10, v88, v89
    v_exp_f32 v181, v73
    v_cvt_pk_bf16_f32 v90, v184, v185
    v_exp_f32 v182, v74
    v_cvt_pk_bf16_f32 v91, v186, v187
    v_exp_f32 v183, v75
    v_mfma_f32_32x32x16_bf16 v[32:47], v[140:143], v[84:87], v[32:47]
    ds_read_b128 v[124:127], v167 offset:8864
    v_exp_f32 v184, v76
    v_or3_b32 v10, v10, v90, v91
    v_exp_f32 v185, v77
    v_cvt_pk_bf16_f32 v92, v180, v181
    v_exp_f32 v186, v78
    v_cvt_pk_bf16_f32 v93, v182, v183
    v_exp_f32 v187, v79
    v_cvt_pk_bf16_f32 v94, v184, v185
    v_or3_b32 v10, v10, v92, v93
    v_cvt_pk_bf16_f32 v95, v186, v187
    v_mov_b32 v166, v167
    s_nop 1
    v_or3_b32 v10, v10, v94, v95
    v_and_b32 v10, s71, v10
    v_cmp_ne_u32 vcc, 0, v10
    v_mov_b32 v161, v162
    v_add_u32 v162, s68, v170
    v_mov_b32 v164, v165
    v_add_u32 v165, s68, v171
    v_mov_b32 v167, v168
    v_add_u32 v168, s68, v172
    s_cbranch_vccnz AA_SLOW_50
AA_BACK_51:
    s_cmp_lt_u32 s74, 8
    s_cbranch_scc1 AA_LOOP_43
AA_LOOP_52:
    s_waitcnt lgkmcnt(2)
    v_mfma_f32_32x32x16_bf16 v[64:79], v[112:115], v[16:19], v[96:111]
    ds_read_b128 v[128:131], v161 offset:4736
    v_exp_f32 v180, v48
    v_exp_f32 v181, v49
    v_exp_f32 v182, v50
    v_exp_f32 v183, v51
    v_mfma_f32_32x32x16_bf16 v[64:79], v[116:119], v[20:23], v[64:79]
    ds_read_b32 v132, v164 offset:5760
    v_exp_f32 v184, v52
    v_exp_f32 v185, v53
    v_cvt_pk_bf16_f32 v80, v180, v181
    v_exp_f32 v186, v54
    v_cvt_pk_bf16_f32 v81, v182, v183
    v_exp_f32 v187, v55
    s_waitcnt lgkmcnt(2)
    v_mfma_f32_32x32x16_bf16 v[32:47], v[120:123], v[88:91], v[32:47]
    ds_read_b128 v[136:139], v167 offset:1152
    v_exp_f32 v180, v56
    v_or_b32 v10, v80, v81
    v_exp_f32 v181, v57
    v_cvt_pk_bf16_f32 v82, v184, v185
    v_exp_f32 v182, v58
    v_cvt_pk_bf16_f32 v83, v186, v187
    v_exp_f32 v183, v59
    v_mfma_f32_32x32x16_bf16 v[32:47], v[124:127], v[92:95], v[32:47]
    ds_read_b128 v[140:143], v167 offset:1760
    v_exp_f32 v184, v60
    v_or3_b32 v10, v10, v82, v83
    v_exp_f32 v185, v61
    v_cvt_pk_bf16_f32 v84, v180, v181
    v_exp_f32 v186, v62
    v_cvt_pk_bf16_f32 v85, v182, v183
    v_exp_f32 v187, v63
    v_cvt_pk_bf16_f32 v86, v184, v185
    v_or3_b32 v10, v10, v84, v85
    v_cvt_pk_bf16_f32 v87, v186, v187
    s_nop 1
    v_or3_b32 v10, v10, v86, v87
    v_and_b32 v10, s71, v10
    v_cmp_ne_u32 vcc, 0, v10
    s_cbranch_vccnz AA_SLOW_53
AA_BACK_54:
    s_waitcnt lgkmcnt(2)
    v_mfma_f32_32x32x16_bf16 v[48:63], v[128:131], v[16:19], v[96:111]
    ds_read_b128 v[112:115], v161 offset:7104
    v_exp_f32 v180, v64
    v_exp_f32 v181, v65
    v_exp_f32 v182, v66
    v_exp_f32 v183, v67
    v_mfma_f32_32x32x16_bf16 v[48:63], v[132:135], v[20:23], v[48:63]
    ds_read_b32 v116, v164 offset:8128
    v_exp_f32 v184, v68
    v_exp_f32 v185, v69
    v_cvt_pk_bf16_f32 v88, v180, v181
    v_exp_f32 v186, v70
    v_cvt_pk_bf16_f32 v89, v182, v183
    v_exp_f32 v187, v71
    s_waitcnt lgkmcnt(2)
    v_mfma_f32_32x32x16_bf16 v[32:47], v[136:139], v[80:83], v[32:47]
    s_waitcnt vmcnt(0)
    s_barrier
    s_add_u32 m0, s75, s76
    s_nop 0
    buffer_load_dwordx4 v2, s[56:59], s70 offen lds
    buffer_load_dwordx4 v2, s[56:59], s70 offen offset:1024 lds
    s_mov_b64 exec, 0xfffff
    buffer_load_dwordx4 v2, s[56:59], s70 offen offset:2048 lds
    s_mov_b64 exec, -1
    s_add_u32 s70, s70, 9472
    s_min_u32 s70, s70, s77
    ds_read_b128 v[120:123], v167 offset:3520
    v_exp_f32 v180, v72
    v_or_b32 v10, v88, v89
    v_exp_f32 v181, v73
    v_cvt_pk_bf16_f32 v90, v184, v185
    v_exp_f32 v182, v74
    v_cvt_pk_bf16_f32 v91, v186, v187
    v_exp_f32 v183, v75
    v_mfma_f32_32x32x16_bf16 v[32:47], v[140:143], v[84:87], v[32:47]
    ds_read_b128 v[124:127], v167 offset:4128
    v_exp_f32 v184, v76
    v_or3_b32 v10, v10, v90, v91
    v_exp_f32 v185, v77
    v_cvt_pk_bf16_f32 v92, v180, v181
    v_exp_f32 v186, v78
    v_cvt_pk_bf16_f32 v93, v182, v183
    v_exp_f32 v187, v79
    v_cvt_pk_bf16_f32 v94, v184, v185
    v_or3_b32 v10, v10, v92, v93
    v_cvt_pk_bf16_f32 v95, v186, v187
    s_nop 1
    v_or3_b32 v10, v10, v94, v95
    v_and_b32 v10, s71, v10
    v_cmp_ne_u32 vcc, 0, v10
    s_cbranch_vccnz AA_SLOW_55
AA_BACK_56:
    s_waitcnt lgkmcnt(2)
    v_mfma_f32_32x32x16_bf16 v[64:79], v[112:115], v[16:19], v[96:111]
    ds_read_b128 v[128:131], v162 offset:0
    v_exp_f32 v180, v48
    v_exp_f32 v181, v49
    v_exp_f32 v182, v50
    v_exp_f32 v183, v51
    v_mfma_f32_32x32x16_bf16 v[64:79], v[116:119], v[20:23], v[64:79]
    ds_read_b32 v132, v165 offset:1024
    v_exp_f32 v184, v52
    v_exp_f32 v185, v53
    v_cvt_pk_bf16_f32 v80, v180, v181
    v_exp_f32 v186, v54
    v_cvt_pk_bf16_f32 v81, v182, v183
    v_exp_f32 v187, v55
    s_waitcnt lgkmcnt(2)
    v_mfma_f32_32x32x16_bf16 v[32:47], v[120:123], v[88:91], v[32:47]
    ds_read_b128 v[136:139], v167 offset:5888
    v_exp_f32 v180, v56
    v_or_b32 v10, v80, v81
    v_exp_f32 v181, v57
    v_cvt_pk_bf16_f32 v82, v184, v185
    v_exp_f32 v182, v58
    v_cvt_pk_bf16_f32 v83, v186, v187
    v_exp_f32 v183, v59
    v_mfma_f32_32x32x16_bf16 v[32:47], v[124:127], v[92:95], v[32:47]
    ds_read_b128 v[140:143], v167 offset:6496
    v_exp_f32 v184, v60
    v_or3_b32 v10, v10, v82, v83
    v_exp_f32 v185, v61
    v_cvt_pk_bf16_f32 v84, v180, v181
    v_exp_f32 v186, v62
    v_cvt_pk_bf16_f32 v85, v182, v183
    v_exp_f32 v187, v63
    v_cvt_pk_bf16_f32 v86, v184, v185
    v_or3_b32 v10, v10, v84, v85
    v_cvt_pk_bf16_f32 v87, v186, v187
    s_nop 1
    v_or3_b32 v10, v10, v86, v87
    v_and_b32 v10, s71, v10
    v_cmp_ne_u32 vcc, 0, v10
    s_cbranch_vccnz AA_SLOW_57
AA_BACK_58:
    s_waitcnt lgkmcnt(2)
    v_mfma_f32_32x32x16_bf16 v[48:63], v[128:131], v[16:19], v[96:111]
    ds_read_b128 v[112:115], v162 offset:2368
    v_exp_f32 v180, v64
    v_exp_f32 v181, v65
    v_exp_f32 v182, v66
    v_exp_f32 v183, v67
    v_mfma_f32_32x32x16_bf16 v[48:63], v[132:135], v[20:23], v[48:63]
    ds_read_b32 v116, v165 offset:3392
    v_exp_f32 v184, v68
    s_add_u32 s74, s74, 1
    s_mov_b32 s68, s75
    v_exp_f32 v185, v69
    v_cvt_pk_bf16_f32 v88, v180, v181
    s_add_u32 s75, s75, 16384
    v_exp_f32 v186, v70
    v_cvt_pk_bf16_f32 v89, v182, v183
    s_cmp_ge_u32 s75, 163840
    v_exp_f32 v187, v71
    s_cselect_b32 s75, 114688, s75
    s_waitcnt lgkmcnt(2)
    v_mfma_f32_32x32x16_bf16 v[32:47], v[136:139], v[80:83], v[32:47]
    s_barrier
    ds_read_b128 v[120:123], v167 offset:8256
    v_exp_f32 v180, v72
    v_or_b32 v10, v88, v89
    v_exp_f32 v181, v73
    v_cvt_pk_bf16_f32 v90, v184, v185
    v_exp_f32 v182, v74
    v_cvt_pk_bf16_f32 v91, v186, v187
    v_exp_f32 v183, v75
    v_mfma_f32_32x32x16_bf16 v[32:47], v[140:143], v[84:87], v[32:47]
    ds_read_b128 v[124:127], v167 offset:8864
    v_exp_f32 v184, v76
    v_or3_b32 v10, v10, v90, v91
    v_exp_f32 v185, v77
    v_cvt_pk_bf16_f32 v92, v180, v181
    v_exp_f32 v186, v78
    v_cvt_pk_bf16_f32 v93, v182, v183
    v_exp_f32 v187, v79
    v_cvt_pk_bf16_f32 v94, v184, v185
    v_or3_b32 v10, v10, v92, v93
    v_cvt_pk_bf16_f32 v95, v186, v187
    v_mov_b32 v166, v167
    s_nop 1
    v_or3_b32 v10, v10, v94, v95
    v_and_b32 v10, s71, v10
    v_cmp_ne_u32 vcc, 0, v10
    v_mov_b32 v161, v162
    v_add_u32 v162, s68, v170
    v_mov_b32 v164, v165
    v_add_u32 v165, s68, v171
    v_mov_b32 v167, v168
    v_add_u32 v168, s68, v172
    s_cbranch_vccnz AA_SLOW_59
AA_BACK_60:
    s_cmp_lt_u32 s74, 16
    s_cbranch_scc1 AA_LOOP_52
AA_J_40:
    s_waitcnt lgkmcnt(0)
    v_mfma_f32_32x32x16_bf16 v[32:47], v[120:123], v[88:91], v[32:47]
    v_mfma_f32_32x32x16_bf16 v[32:47], v[124:127], v[92:95], v[32:47]
    s_nop 15
    v_rcp_f32 v7, v42
    s_nop 0
    v_mul_f32 v32, v32, v7
    v_mul_f32 v33, v33, v7
    v_mul_f32 v34, v34, v7
    v_mul_f32 v35, v35, v7
    v_mul_f32 v36, v36, v7
    v_mul_f32 v37, v37, v7
    v_mul_f32 v38, v38, v7
    v_mul_f32 v39, v39, v7
    v_mul_f32 v40, v40, v7
    v_mul_f32 v41, v41, v7
    v_cvt_pk_bf16_f32 v80, v32, v33
    v_cvt_pk_bf16_f32 v81, v34, v35
    v_cvt_pk_bf16_f32 v82, v36, v37
    v_cvt_pk_bf16_f32 v83, v38, v39
    v_cvt_pk_bf16_f32 v84, v40, v41
    v_lshrrev_b32 v6, 1, v6
    v_lshrrev_b32 v7, 5, v1
    v_lshl_add_u32 v8, v7, 3, v6
    s_and_b32 s68, s66, 15
    s_mul_i32 s68, s68, 36
    s_add_u32 s68, s68, 56623104
    buffer_store_dwordx2 v[80:81], v8, s[56:59], s68 offen sc1
    buffer_store_dwordx2 v[82:83], v8, s[56:59], s68 offen offset:16 sc1
    v_cmp_gt_u32 vcc, 32, v1
    s_and_saveexec_b64 s[72:73], vcc
    buffer_store_dword v84, v6, s[56:59], s68 offen offset:32 sc1
    s_mov_b64 exec, s[72:73]
    s_branch AA_END_61
AA_SLOW_44:
    s_nop 15
    v_max3_f32 v7, v48, v49, v50
    v_max3_f32 v7, v7, v51, v52
    v_max3_f32 v7, v7, v53, v54
    v_max3_f32 v7, v7, v55, v56
    v_max3_f32 v7, v7, v57, v58
    v_max3_f32 v7, v7, v59, v60
    v_max3_f32 v7, v7, v61, v62
    v_max_f32 v7, v7, v63
    v_mov_b32 v8, v7
    s_nop 1
    v_permlane32_swap_b32 v7, v8
    s_nop 1
    v_max_f32 v7, v7, v8
    v_add_f32 v7, 0x42800000, v7
    v_max_f32 v7, 0, v7
    v_sub_f32 v96, v96, v7
    v_sub_f32 v48, v48, v7
    v_sub_f32 v64, v64, v7
    v_sub_f32 v97, v97, v7
    v_sub_f32 v49, v49, v7
    v_sub_f32 v65, v65, v7
    v_sub_f32 v98, v98, v7
    v_sub_f32 v50, v50, v7
    v_sub_f32 v66, v66, v7
    v_sub_f32 v99, v99, v7
    v_sub_f32 v51, v51, v7
    v_sub_f32 v67, v67, v7
    v_sub_f32 v100, v100, v7
    v_sub_f32 v52, v52, v7
    v_sub_f32 v68, v68, v7
    v_sub_f32 v101, v101, v7
    v_sub_f32 v53, v53, v7
    v_sub_f32 v69, v69, v7
    v_sub_f32 v102, v102, v7
    v_sub_f32 v54, v54, v7
    v_sub_f32 v70, v70, v7
    v_sub_f32 v103, v103, v7
    v_sub_f32 v55, v55, v7
    v_sub_f32 v71, v71, v7
    v_sub_f32 v104, v104, v7
    v_sub_f32 v56, v56, v7
    v_sub_f32 v72, v72, v7
    v_sub_f32 v105, v105, v7
    v_sub_f32 v57, v57, v7
    v_sub_f32 v73, v73, v7
    v_sub_f32 v106, v106, v7
    v_sub_f32 v58, v58, v7
    v_sub_f32 v74, v74, v7
    v_sub_f32 v107, v107, v7
    v_sub_f32 v59, v59, v7
    v_sub_f32 v75, v75, v7
    v_sub_f32 v108, v108, v7
    v_sub_f32 v60, v60, v7
    v_sub_f32 v76, v76, v7
    v_sub_f32 v109, v109, v7
    v_sub_f32 v61, v61, v7
    v_sub_f32 v77, v77, v7
    v_sub_f32 v110, v110, v7
    v_sub_f32 v62, v62, v7
    v_sub_f32 v78, v78, v7
    v_sub_f32 v111, v111, v7
    v_sub_f32 v63, v63, v7
    v_sub_f32 v79, v79, v7
    v_exp_f32 v8, -v7
    s_nop 0
    v_mul_f32 v32, v32, v8
    v_mul_f32 v33, v33, v8
    v_mul_f32 v34, v34, v8
    v_mul_f32 v35, v35, v8
    v_mul_f32 v36, v36, v8
    v_mul_f32 v37, v37, v8
    v_mul_f32 v38, v38, v8
    v_mul_f32 v39, v39, v8
    v_mul_f32 v40, v40, v8
    v_mul_f32 v41, v41, v8
    v_mul_f32 v42, v42, v8
    v_mul_f32 v43, v43, v8
    v_mul_f32 v44, v44, v8
    v_mul_f32 v45, v45, v8
    v_mul_f32 v46, v46, v8
    v_mul_f32 v47, v47, v8
    v_exp_f32 v12, v48
    v_exp_f32 v13, v49
    s_nop 0
    v_cvt_pk_bf16_f32 v80, v12, v13
    v_exp_f32 v14, v50
    v_exp_f32 v15, v51
    s_nop 0
    v_cvt_pk_bf16_f32 v81, v14, v15
    v_exp_f32 v12, v52
    v_exp_f32 v13, v53
    s_nop 0
    v_cvt_pk_bf16_f32 v82, v12, v13
    v_exp_f32 v14, v54
    v_exp_f32 v15, v55
    s_nop 0
    v_cvt_pk_bf16_f32 v83, v14, v15
    v_exp_f32 v12, v56
    v_exp_f32 v13, v57
    s_nop 0
    v_cvt_pk_bf16_f32 v84, v12, v13
    v_exp_f32 v14, v58
    v_exp_f32 v15, v59
    s_nop 0
    v_cvt_pk_bf16_f32 v85, v14, v15
    v_exp_f32 v12, v60
    v_exp_f32 v13, v61
    s_nop 0
    v_cvt_pk_bf16_f32 v86, v12, v13
    v_exp_f32 v14, v62
    v_exp_f32 v15, v63
    s_nop 0
    v_cvt_pk_bf16_f32 v87, v14, v15
    s_nop 1
    s_branch AA_BACK_45
AA_SLOW_46:
    s_nop 15
    v_max3_f32 v7, v64, v65, v66
    v_max3_f32 v7, v7, v67, v68
    v_max3_f32 v7, v7, v69, v70
    v_max3_f32 v7, v7, v71, v72
    v_max3_f32 v7, v7, v73, v74
    v_max3_f32 v7, v7, v75, v76
    v_max3_f32 v7, v7, v77, v78
    v_max_f32 v7, v7, v79
    v_mov_b32 v8, v7
    s_nop 1
    v_permlane32_swap_b32 v7, v8
    s_nop 1
    v_max_f32 v7, v7, v8
    v_add_f32 v7, 0x42800000, v7
    v_max_f32 v7, 0, v7
    v_sub_f32 v96, v96, v7
    v_sub_f32 v64, v64, v7
    v_sub_f32 v48, v48, v7
    v_sub_f32 v97, v97, v7
    v_sub_f32 v65, v65, v7
    v_sub_f32 v49, v49, v7
    v_sub_f32 v98, v98, v7
    v_sub_f32 v66, v66, v7
    v_sub_f32 v50, v50, v7
    v_sub_f32 v99, v99, v7
    v_sub_f32 v67, v67, v7
    v_sub_f32 v51, v51, v7
    v_sub_f32 v100, v100, v7
    v_sub_f32 v68, v68, v7
    v_sub_f32 v52, v52, v7
    v_sub_f32 v101, v101, v7
    v_sub_f32 v69, v69, v7
    v_sub_f32 v53, v53, v7
    v_sub_f32 v102, v102, v7
    v_sub_f32 v70, v70, v7
    v_sub_f32 v54, v54, v7
    v_sub_f32 v103, v103, v7
    v_sub_f32 v71, v71, v7
    v_sub_f32 v55, v55, v7
    v_sub_f32 v104, v104, v7
    v_sub_f32 v72, v72, v7
    v_sub_f32 v56, v56, v7
    v_sub_f32 v105, v105, v7
    v_sub_f32 v73, v73, v7
    v_sub_f32 v57, v57, v7
    v_sub_f32 v106, v106, v7
    v_sub_f32 v74, v74, v7
    v_sub_f32 v58, v58, v7
    v_sub_f32 v107, v107, v7
    v_sub_f32 v75, v75, v7
    v_sub_f32 v59, v59, v7
    v_sub_f32 v108, v108, v7
    v_sub_f32 v76, v76, v7
    v_sub_f32 v60, v60, v7
    v_sub_f32 v109, v109, v7
    v_sub_f32 v77, v77, v7
    v_sub_f32 v61, v61, v7
    v_sub_f32 v110, v110, v7
    v_sub_f32 v78, v78, v7
    v_sub_f32 v62, v62, v7
    v_sub_f32 v111, v111, v7
    v_sub_f32 v79, v79, v7
    v_sub_f32 v63, v63, v7
    v_exp_f32 v8, -v7
    s_nop 0
    v_mul_f32 v32, v32, v8
    v_mul_f32 v33, v33, v8
    v_mul_f32 v34, v34, v8
    v_mul_f32 v35, v35, v8
    v_mul_f32 v36, v36, v8
    v_mul_f32 v37, v37, v8
    v_mul_f32 v38, v38, v8
    v_mul_f32 v39, v39, v8
    v_mul_f32 v40, v40, v8
    v_mul_f32 v41, v41, v8
    v_mul_f32 v42, v42, v8
    v_mul_f32 v43, v43, v8
    v_mul_f32 v44, v44, v8
    v_mul_f32 v45, v45, v8
    v_mul_f32 v46, v46, v8
    v_mul_f32 v47, v47, v8
    v_exp_f32 v12, v64
    v_exp_f32 v13, v65
    s_nop 0
    v_cvt_pk_bf16_f32 v88, v12, v13
    v_exp_f32 v14, v66
    v_exp_f32 v15, v67
    s_nop 0
    v_cvt_pk_bf16_f32 v89, v14, v15
    v_exp_f32 v12, v68
    v_exp_f32 v13, v69
    s_nop 0
    v_cvt_pk_bf16_f32 v90, v12, v13
    v_exp_f32 v14, v70
    v_exp_f32 v15, v71
    s_nop 0
    v_cvt_pk_bf16_f32 v91, v14, v15
    v_exp_f32 v12, v72
    v_exp_f32 v13, v73
    s_nop 0
    v_cvt_pk_bf16_f32 v92, v12, v13
    v_exp_f32 v14, v74
    v_exp_f32 v15, v75
    s_nop 0
    v_cvt_pk_bf16_f32 v93, v14, v15
    v_exp_f32 v12, v76
    v_exp_f32 v13, v77
    s_nop 0
    v_cvt_pk_bf16_f32 v94, v12, v13
    v_exp_f32 v14, v78
    v_exp_f32 v15, v79
    s_nop 0
    v_cvt_pk_bf16_f32 v95, v14, v15
    s_nop 1
    s_branch AA_BACK_47
AA_SLOW_48:
    s_nop 15
    v_max3_f32 v7, v48, v49, v50
    v_max3_f32 v7, v7, v51, v52
    v_max3_f32 v7, v7, v53, v54
    v_max3_f32 v7, v7, v55, v56
    v_max3_f32 v7, v7, v57, v58
    v_max3_f32 v7, v7, v59, v60
    v_max3_f32 v7, v7, v61, v62
    v_max_f32 v7, v7, v63
    v_mov_b32 v8, v7
    s_nop 1
    v_permlane32_swap_b32 v7, v8
    s_nop 1
    v_max_f32 v7, v7, v8
    v_add_f32 v7, 0x42800000, v7
    v_max_f32 v7, 0, v7
    v_sub_f32 v96, v96, v7
    v_sub_f32 v48, v48, v7
    v_sub_f32 v64, v64, v7
    v_sub_f32 v97, v97, v7
    v_sub_f32 v49, v49, v7
    v_sub_f32 v65, v65, v7
    v_sub_f32 v98, v98, v7
    v_sub_f32 v50, v50, v7
    v_sub_f32 v66, v66, v7
    v_sub_f32 v99, v99, v7
    v_sub_f32 v51, v51, v7
    v_sub_f32 v67, v67, v7
    v_sub_f32 v100, v100, v7
    v_sub_f32 v52, v52, v7
    v_sub_f32 v68, v68, v7
    v_sub_f32 v101, v101, v7
    v_sub_f32 v53, v53, v7
    v_sub_f32 v69, v69, v7
    v_sub_f32 v102, v102, v7
    v_sub_f32 v54, v54, v7
    v_sub_f32 v70, v70, v7
    v_sub_f32 v103, v103, v7
    v_sub_f32 v55, v55, v7
    v_sub_f32 v71, v71, v7
    v_sub_f32 v104, v104, v7
    v_sub_f32 v56, v56, v7
    v_sub_f32 v72, v72, v7
    v_sub_f32 v105, v105, v7
    v_sub_f32 v57, v57, v7
    v_sub_f32 v73, v73, v7
    v_sub_f32 v106, v106, v7
    v_sub_f32 v58, v58, v7
    v_sub_f32 v74, v74, v7
    v_sub_f32 v107, v107, v7
    v_sub_f32 v59, v59, v7
    v_sub_f32 v75, v75, v7
    v_sub_f32 v108, v108, v7
    v_sub_f32 v60, v60, v7
    v_sub_f32 v76, v76, v7
    v_sub_f32 v109, v109, v7
    v_sub_f32 v61, v61, v7
    v_sub_f32 v77, v77, v7
    v_sub_f32 v110, v110, v7
    v_sub_f32 v62, v62, v7
    v_sub_f32 v78, v78, v7
    v_sub_f32 v111, v111, v7
    v_sub_f32 v63, v63, v7
    v_sub_f32 v79, v79, v7
    v_exp_f32 v8, -v7
    s_nop 0
    v_mul_f32 v32, v32, v8
    v_mul_f32 v33, v33, v8
    v_mul_f32 v34, v34, v8
    v_mul_f32 v35, v35, v8
    v_mul_f32 v36, v36, v8
    v_mul_f32 v37, v37, v8
    v_mul_f32 v38, v38, v8
    v_mul_f32 v39, v39, v8
    v_mul_f32 v40, v40, v8
    v_mul_f32 v41, v41, v8
    v_mul_f32 v42, v42, v8
    v_mul_f32 v43, v43, v8
    v_mul_f32 v44, v44, v8
    v_mul_f32 v45, v45, v8
    v_mul_f32 v46, v46, v8
    v_mul_f32 v47, v47, v8
    v_exp_f32 v12, v48
    v_exp_f32 v13, v49
    s_nop 0
    v_cvt_pk_bf16_f32 v80, v12, v13
    v_exp_f32 v14, v50
    v_exp_f32 v15, v51
    s_nop 0
    v_cvt_pk_bf16_f32 v81, v14, v15
    v_exp_f32 v12, v52
    v_exp_f32 v13, v53
    s_nop 0
    v_cvt_pk_bf16_f32 v82, v12, v13
    v_exp_f32 v14, v54
    v_exp_f32 v15, v55
    s_nop 0
    v_cvt_pk_bf16_f32 v83, v14, v15
    v_exp_f32 v12, v56
    v_exp_f32 v13, v57
    s_nop 0
    v_cvt_pk_bf16_f32 v84, v12, v13
    v_exp_f32 v14, v58
    v_exp_f32 v15, v59
    s_nop 0
    v_cvt_pk_bf16_f32 v85, v14, v15
    v_exp_f32 v12, v60
    v_exp_f32 v13, v61
    s_nop 0
    v_cvt_pk_bf16_f32 v86, v12, v13
    v_exp_f32 v14, v62
    v_exp_f32 v15, v63
    s_nop 0
    v_cvt_pk_bf16_f32 v87, v14, v15
    s_nop 1
    s_branch AA_BACK_49
AA_SLOW_50:
    s_nop 15
    v_max3_f32 v7, v64, v65, v66
    v_max3_f32 v7, v7, v67, v68
    v_max3_f32 v7, v7, v69, v70
    v_max3_f32 v7, v7, v71, v72
    v_max3_f32 v7, v7, v73, v74
    v_max3_f32 v7, v7, v75, v76
    v_max3_f32 v7, v7, v77, v78
    v_max_f32 v7, v7, v79
    v_mov_b32 v8, v7
    s_nop 1
    v_permlane32_swap_b32 v7, v8
    s_nop 1
    v_max_f32 v7, v7, v8
    v_add_f32 v7, 0x42800000, v7
    v_max_f32 v7, 0, v7
    v_sub_f32 v96, v96, v7
    v_sub_f32 v64, v64, v7
    v_sub_f32 v48, v48, v7
    v_sub_f32 v97, v97, v7
    v_sub_f32 v65, v65, v7
    v_sub_f32 v49, v49, v7
    v_sub_f32 v98, v98, v7
    v_sub_f32 v66, v66, v7
    v_sub_f32 v50, v50, v7
    v_sub_f32 v99, v99, v7
    v_sub_f32 v67, v67, v7
    v_sub_f32 v51, v51, v7
    v_sub_f32 v100, v100, v7
    v_sub_f32 v68, v68, v7
    v_sub_f32 v52, v52, v7
    v_sub_f32 v101, v101, v7
    v_sub_f32 v69, v69, v7
    v_sub_f32 v53, v53, v7
    v_sub_f32 v102, v102, v7
    v_sub_f32 v70, v70, v7
    v_sub_f32 v54, v54, v7
    v_sub_f32 v103, v103, v7
    v_sub_f32 v71, v71, v7
    v_sub_f32 v55, v55, v7
    v_sub_f32 v104, v104, v7
    v_sub_f32 v72, v72, v7
    v_sub_f32 v56, v56, v7
    v_sub_f32 v105, v105, v7
    v_sub_f32 v73, v73, v7
    v_sub_f32 v57, v57, v7
    v_sub_f32 v106, v106, v7
    v_sub_f32 v74, v74, v7
    v_sub_f32 v58, v58, v7
    v_sub_f32 v107, v107, v7
    v_sub_f32 v75, v75, v7
    v_sub_f32 v59, v59, v7
    v_sub_f32 v108, v108, v7
    v_sub_f32 v76, v76, v7
    v_sub_f32 v60, v60, v7
    v_sub_f32 v109, v109, v7
    v_sub_f32 v77, v77, v7
    v_sub_f32 v61, v61, v7
    v_sub_f32 v110, v110, v7
    v_sub_f32 v78, v78, v7
    v_sub_f32 v62, v62, v7
    v_sub_f32 v111, v111, v7
    v_sub_f32 v79, v79, v7
    v_sub_f32 v63, v63, v7
    v_exp_f32 v8, -v7
    s_nop 0
    v_mul_f32 v32, v32, v8
    v_mul_f32 v33, v33, v8
    v_mul_f32 v34, v34, v8
    v_mul_f32 v35, v35, v8
    v_mul_f32 v36, v36, v8
    v_mul_f32 v37, v37, v8
    v_mul_f32 v38, v38, v8
    v_mul_f32 v39, v39, v8
    v_mul_f32 v40, v40, v8
    v_mul_f32 v41, v41, v8
    v_mul_f32 v42, v42, v8
    v_mul_f32 v43, v43, v8
    v_mul_f32 v44, v44, v8
    v_mul_f32 v45, v45, v8
    v_mul_f32 v46, v46, v8
    v_mul_f32 v47, v47, v8
    v_exp_f32 v12, v64
    v_exp_f32 v13, v65
    s_nop 0
    v_cvt_pk_bf16_f32 v88, v12, v13
    v_exp_f32 v14, v66
    v_exp_f32 v15, v67
    s_nop 0
    v_cvt_pk_bf16_f32 v89, v14, v15
    v_exp_f32 v12, v68
    v_exp_f32 v13, v69
    s_nop 0
    v_cvt_pk_bf16_f32 v90, v12, v13
    v_exp_f32 v14, v70
    v_exp_f32 v15, v71
    s_nop 0
    v_cvt_pk_bf16_f32 v91, v14, v15
    v_exp_f32 v12, v72
    v_exp_f32 v13, v73
    s_nop 0
    v_cvt_pk_bf16_f32 v92, v12, v13
    v_exp_f32 v14, v74
    v_exp_f32 v15, v75
    s_nop 0
    v_cvt_pk_bf16_f32 v93, v14, v15
    v_exp_f32 v12, v76
    v_exp_f32 v13, v77
    s_nop 0
    v_cvt_pk_bf16_f32 v94, v12, v13
    v_exp_f32 v14, v78
    v_exp_f32 v15, v79
    s_nop 0
    v_cvt_pk_bf16_f32 v95, v14, v15
    s_nop 1
    s_branch AA_BACK_51
AA_SLOW_53:
    s_nop 15
    v_max3_f32 v7, v48, v49, v50
    v_max3_f32 v7, v7, v51, v52
    v_max3_f32 v7, v7, v53, v54
    v_max3_f32 v7, v7, v55, v56
    v_max3_f32 v7, v7, v57, v58
    v_max3_f32 v7, v7, v59, v60
    v_max3_f32 v7, v7, v61, v62
    v_max_f32 v7, v7, v63
    v_mov_b32 v8, v7
    s_nop 1
    v_permlane32_swap_b32 v7, v8
    s_nop 1
    v_max_f32 v7, v7, v8
    v_add_f32 v7, 0x42800000, v7
    v_max_f32 v7, 0, v7
    v_sub_f32 v96, v96, v7
    v_sub_f32 v48, v48, v7
    v_sub_f32 v64, v64, v7
    v_sub_f32 v97, v97, v7
    v_sub_f32 v49, v49, v7
    v_sub_f32 v65, v65, v7
    v_sub_f32 v98, v98, v7
    v_sub_f32 v50, v50, v7
    v_sub_f32 v66, v66, v7
    v_sub_f32 v99, v99, v7
    v_sub_f32 v51, v51, v7
    v_sub_f32 v67, v67, v7
    v_sub_f32 v100, v100, v7
    v_sub_f32 v52, v52, v7
    v_sub_f32 v68, v68, v7
    v_sub_f32 v101, v101, v7
    v_sub_f32 v53, v53, v7
    v_sub_f32 v69, v69, v7
    v_sub_f32 v102, v102, v7
    v_sub_f32 v54, v54, v7
    v_sub_f32 v70, v70, v7
    v_sub_f32 v103, v103, v7
    v_sub_f32 v55, v55, v7
    v_sub_f32 v71, v71, v7
    v_sub_f32 v104, v104, v7
    v_sub_f32 v56, v56, v7
    v_sub_f32 v72, v72, v7
    v_sub_f32 v105, v105, v7
    v_sub_f32 v57, v57, v7
    v_sub_f32 v73, v73, v7
    v_sub_f32 v106, v106, v7
    v_sub_f32 v58, v58, v7
    v_sub_f32 v74, v74, v7
    v_sub_f32 v107, v107, v7
    v_sub_f32 v59, v59, v7
    v_sub_f32 v75, v75, v7
    v_sub_f32 v108, v108, v7
    v_sub_f32 v60, v60, v7
    v_sub_f32 v76, v76, v7
    v_sub_f32 v109, v109, v7
    v_sub_f32 v61, v61, v7
    v_sub_f32 v77, v77, v7
    v_sub_f32 v110, v110, v7
    v_sub_f32 v62, v62, v7
    v_sub_f32 v78, v78, v7
    v_sub_f32 v111, v111, v7
    v_sub_f32 v63, v63, v7
    v_sub_f32 v79, v79, v7
    v_exp_f32 v8, -v7
    s_nop 0
    v_mul_f32 v32, v32, v8
    v_mul_f32 v33, v33, v8
    v_mul_f32 v34, v34, v8
    v_mul_f32 v35, v35, v8
    v_mul_f32 v36, v36, v8
    v_mul_f32 v37, v37, v8
    v_mul_f32 v38, v38, v8
    v_mul_f32 v39, v39, v8
    v_mul_f32 v40, v40, v8
    v_mul_f32 v41, v41, v8
    v_mul_f32 v42, v42, v8
    v_mul_f32 v43, v43, v8
    v_mul_f32 v44, v44, v8
    v_mul_f32 v45, v45, v8
    v_mul_f32 v46, v46, v8
    v_mul_f32 v47, v47, v8
    v_exp_f32 v12, v48
    v_exp_f32 v13, v49
    s_nop 0
    v_cvt_pk_bf16_f32 v80, v12, v13
    v_exp_f32 v14, v50
    v_exp_f32 v15, v51
    s_nop 0
    v_cvt_pk_bf16_f32 v81, v14, v15
    v_exp_f32 v12, v52
    v_exp_f32 v13, v53
    s_nop 0
    v_cvt_pk_bf16_f32 v82, v12, v13
    v_exp_f32 v14, v54
    v_exp_f32 v15, v55
    s_nop 0
    v_cvt_pk_bf16_f32 v83, v14, v15
    v_exp_f32 v12, v56
    v_exp_f32 v13, v57
    s_nop 0
    v_cvt_pk_bf16_f32 v84, v12, v13
    v_exp_f32 v14, v58
    v_exp_f32 v15, v59
    s_nop 0
    v_cvt_pk_bf16_f32 v85, v14, v15
    v_exp_f32 v12, v60
    v_exp_f32 v13, v61
    s_nop 0
    v_cvt_pk_bf16_f32 v86, v12, v13
    v_exp_f32 v14, v62
    v_exp_f32 v15, v63
    s_nop 0
    v_cvt_pk_bf16_f32 v87, v14, v15
    s_nop 1
    s_branch AA_BACK_54
AA_SLOW_55:
    s_nop 15
    v_max3_f32 v7, v64, v65, v66
    v_max3_f32 v7, v7, v67, v68
    v_max3_f32 v7, v7, v69, v70
    v_max3_f32 v7, v7, v71, v72
    v_max3_f32 v7, v7, v73, v74
    v_max3_f32 v7, v7, v75, v76
    v_max3_f32 v7, v7, v77, v78
    v_max_f32 v7, v7, v79
    v_mov_b32 v8, v7
    s_nop 1
    v_permlane32_swap_b32 v7, v8
    s_nop 1
    v_max_f32 v7, v7, v8
    v_add_f32 v7, 0x42800000, v7
    v_max_f32 v7, 0, v7
    v_sub_f32 v96, v96, v7
    v_sub_f32 v64, v64, v7
    v_sub_f32 v48, v48, v7
    v_sub_f32 v97, v97, v7
    v_sub_f32 v65, v65, v7
    v_sub_f32 v49, v49, v7
    v_sub_f32 v98, v98, v7
    v_sub_f32 v66, v66, v7
    v_sub_f32 v50, v50, v7
    v_sub_f32 v99, v99, v7
    v_sub_f32 v67, v67, v7
    v_sub_f32 v51, v51, v7
    v_sub_f32 v100, v100, v7
    v_sub_f32 v68, v68, v7
    v_sub_f32 v52, v52, v7
    v_sub_f32 v101, v101, v7
    v_sub_f32 v69, v69, v7
    v_sub_f32 v53, v53, v7
    v_sub_f32 v102, v102, v7
    v_sub_f32 v70, v70, v7
    v_sub_f32 v54, v54, v7
    v_sub_f32 v103, v103, v7
    v_sub_f32 v71, v71, v7
    v_sub_f32 v55, v55, v7
    v_sub_f32 v104, v104, v7
    v_sub_f32 v72, v72, v7
    v_sub_f32 v56, v56, v7
    v_sub_f32 v105, v105, v7
    v_sub_f32 v73, v73, v7
    v_sub_f32 v57, v57, v7
    v_sub_f32 v106, v106, v7
    v_sub_f32 v74, v74, v7
    v_sub_f32 v58, v58, v7
    v_sub_f32 v107, v107, v7
    v_sub_f32 v75, v75, v7
    v_sub_f32 v59, v59, v7
    v_sub_f32 v108, v108, v7
    v_sub_f32 v76, v76, v7
    v_sub_f32 v60, v60, v7
    v_sub_f32 v109, v109, v7
    v_sub_f32 v77, v77, v7
    v_sub_f32 v61, v61, v7
    v_sub_f32 v110, v110, v7
    v_sub_f32 v78, v78, v7
    v_sub_f32 v62, v62, v7
    v_sub_f32 v111, v111, v7
    v_sub_f32 v79, v79, v7
    v_sub_f32 v63, v63, v7
    v_exp_f32 v8, -v7
    s_nop 0
    v_mul_f32 v32, v32, v8
    v_mul_f32 v33, v33, v8
    v_mul_f32 v34, v34, v8
    v_mul_f32 v35, v35, v8
    v_mul_f32 v36, v36, v8
    v_mul_f32 v37, v37, v8
    v_mul_f32 v38, v38, v8
    v_mul_f32 v39, v39, v8
    v_mul_f32 v40, v40, v8
    v_mul_f32 v41, v41, v8
    v_mul_f32 v42, v42, v8
    v_mul_f32 v43, v43, v8
    v_mul_f32 v44, v44, v8
    v_mul_f32 v45, v45, v8
    v_mul_f32 v46, v46, v8
    v_mul_f32 v47, v47, v8
    v_exp_f32 v12, v64
    v_exp_f32 v13, v65
    s_nop 0
    v_cvt_pk_bf16_f32 v88, v12, v13
    v_exp_f32 v14, v66
    v_exp_f32 v15, v67
    s_nop 0
    v_cvt_pk_bf16_f32 v89, v14, v15
    v_exp_f32 v12, v68
    v_exp_f32 v13, v69
    s_nop 0
    v_cvt_pk_bf16_f32 v90, v12, v13
    v_exp_f32 v14, v70
    v_exp_f32 v15, v71
    s_nop 0
    v_cvt_pk_bf16_f32 v91, v14, v15
    v_exp_f32 v12, v72
    v_exp_f32 v13, v73
    s_nop 0
    v_cvt_pk_bf16_f32 v92, v12, v13
    v_exp_f32 v14, v74
    v_exp_f32 v15, v75
    s_nop 0
    v_cvt_pk_bf16_f32 v93, v14, v15
    v_exp_f32 v12, v76
    v_exp_f32 v13, v77
    s_nop 0
    v_cvt_pk_bf16_f32 v94, v12, v13
    v_exp_f32 v14, v78
    v_exp_f32 v15, v79
    s_nop 0
    v_cvt_pk_bf16_f32 v95, v14, v15
    s_nop 1
    s_branch AA_BACK_56
AA_SLOW_57:
    s_nop 15
    v_max3_f32 v7, v48, v49, v50
    v_max3_f32 v7, v7, v51, v52
    v_max3_f32 v7, v7, v53, v54
    v_max3_f32 v7, v7, v55, v56
    v_max3_f32 v7, v7, v57, v58
    v_max3_f32 v7, v7, v59, v60
    v_max3_f32 v7, v7, v61, v62
    v_max_f32 v7, v7, v63
    v_mov_b32 v8, v7
    s_nop 1
    v_permlane32_swap_b32 v7, v8
    s_nop 1
    v_max_f32 v7, v7, v8
    v_add_f32 v7, 0x42800000, v7
    v_max_f32 v7, 0, v7
    v_sub_f32 v96, v96, v7
    v_sub_f32 v48, v48, v7
    v_sub_f32 v64, v64, v7
    v_sub_f32 v97, v97, v7
    v_sub_f32 v49, v49, v7
    v_sub_f32 v65, v65, v7
    v_sub_f32 v98, v98, v7
    v_sub_f32 v50, v50, v7
    v_sub_f32 v66, v66, v7
    v_sub_f32 v99, v99, v7
    v_sub_f32 v51, v51, v7
    v_sub_f32 v67, v67, v7
    v_sub_f32 v100, v100, v7
    v_sub_f32 v52, v52, v7
    v_sub_f32 v68, v68, v7
    v_sub_f32 v101, v101, v7
    v_sub_f32 v53, v53, v7
    v_sub_f32 v69, v69, v7
    v_sub_f32 v102, v102, v7
    v_sub_f32 v54, v54, v7
    v_sub_f32 v70, v70, v7
    v_sub_f32 v103, v103, v7
    v_sub_f32 v55, v55, v7
    v_sub_f32 v71, v71, v7
    v_sub_f32 v104, v104, v7
    v_sub_f32 v56, v56, v7
    v_sub_f32 v72, v72, v7
    v_sub_f32 v105, v105, v7
    v_sub_f32 v57, v57, v7
    v_sub_f32 v73, v73, v7
    v_sub_f32 v106, v106, v7
    v_sub_f32 v58, v58, v7
    v_sub_f32 v74, v74, v7
    v_sub_f32 v107, v107, v7
    v_sub_f32 v59, v59, v7
    v_sub_f32 v75, v75, v7
    v_sub_f32 v108, v108, v7
    v_sub_f32 v60, v60, v7
    v_sub_f32 v76, v76, v7
    v_sub_f32 v109, v109, v7
    v_sub_f32 v61, v61, v7
    v_sub_f32 v77, v77, v7
    v_sub_f32 v110, v110, v7
    v_sub_f32 v62, v62, v7
    v_sub_f32 v78, v78, v7
    v_sub_f32 v111, v111, v7
    v_sub_f32 v63, v63, v7
    v_sub_f32 v79, v79, v7
    v_exp_f32 v8, -v7
    s_nop 0
    v_mul_f32 v32, v32, v8
    v_mul_f32 v33, v33, v8
    v_mul_f32 v34, v34, v8
    v_mul_f32 v35, v35, v8
    v_mul_f32 v36, v36, v8
    v_mul_f32 v37, v37, v8
    v_mul_f32 v38, v38, v8
    v_mul_f32 v39, v39, v8
    v_mul_f32 v40, v40, v8
    v_mul_f32 v41, v41, v8
    v_mul_f32 v42, v42, v8
    v_mul_f32 v43, v43, v8
    v_mul_f32 v44, v44, v8
    v_mul_f32 v45, v45, v8
    v_mul_f32 v46, v46, v8
    v_mul_f32 v47, v47, v8
    v_exp_f32 v12, v48
    v_exp_f32 v13, v49
    s_nop 0
    v_cvt_pk_bf16_f32 v80, v12, v13
    v_exp_f32 v14, v50
    v_exp_f32 v15, v51
    s_nop 0
    v_cvt_pk_bf16_f32 v81, v14, v15
    v_exp_f32 v12, v52
    v_exp_f32 v13, v53
    s_nop 0
    v_cvt_pk_bf16_f32 v82, v12, v13
    v_exp_f32 v14, v54
    v_exp_f32 v15, v55
    s_nop 0
    v_cvt_pk_bf16_f32 v83, v14, v15
    v_exp_f32 v12, v56
    v_exp_f32 v13, v57
    s_nop 0
    v_cvt_pk_bf16_f32 v84, v12, v13
    v_exp_f32 v14, v58
    v_exp_f32 v15, v59
    s_nop 0
    v_cvt_pk_bf16_f32 v85, v14, v15
    v_exp_f32 v12, v60
    v_exp_f32 v13, v61
    s_nop 0
    v_cvt_pk_bf16_f32 v86, v12, v13
    v_exp_f32 v14, v62
    v_exp_f32 v15, v63
    s_nop 0
    v_cvt_pk_bf16_f32 v87, v14, v15
    s_nop 1
    s_branch AA_BACK_58
AA_SLOW_59:
    s_nop 15
    v_max3_f32 v7, v64, v65, v66
    v_max3_f32 v7, v7, v67, v68
    v_max3_f32 v7, v7, v69, v70
    v_max3_f32 v7, v7, v71, v72
    v_max3_f32 v7, v7, v73, v74
    v_max3_f32 v7, v7, v75, v76
    v_max3_f32 v7, v7, v77, v78
    v_max_f32 v7, v7, v79
    v_mov_b32 v8, v7
    s_nop 1
    v_permlane32_swap_b32 v7, v8
    s_nop 1
    v_max_f32 v7, v7, v8
    v_add_f32 v7, 0x42800000, v7
    v_max_f32 v7, 0, v7
    v_sub_f32 v96, v96, v7
    v_sub_f32 v64, v64, v7
    v_sub_f32 v48, v48, v7
    v_sub_f32 v97, v97, v7
    v_sub_f32 v65, v65, v7
    v_sub_f32 v49, v49, v7
    v_sub_f32 v98, v98, v7
    v_sub_f32 v66, v66, v7
    v_sub_f32 v50, v50, v7
    v_sub_f32 v99, v99, v7
    v_sub_f32 v67, v67, v7
    v_sub_f32 v51, v51, v7
    v_sub_f32 v100, v100, v7
    v_sub_f32 v68, v68, v7
    v_sub_f32 v52, v52, v7
    v_sub_f32 v101, v101, v7
    v_sub_f32 v69, v69, v7
    v_sub_f32 v53, v53, v7
    v_sub_f32 v102, v102, v7
    v_sub_f32 v70, v70, v7
    v_sub_f32 v54, v54, v7
    v_sub_f32 v103, v103, v7
    v_sub_f32 v71, v71, v7
    v_sub_f32 v55, v55, v7
    v_sub_f32 v104, v104, v7
    v_sub_f32 v72, v72, v7
    v_sub_f32 v56, v56, v7
    v_sub_f32 v105, v105, v7
    v_sub_f32 v73, v73, v7
    v_sub_f32 v57, v57, v7
    v_sub_f32 v106, v106, v7
    v_sub_f32 v74, v74, v7
    v_sub_f32 v58, v58, v7
    v_sub_f32 v107, v107, v7
    v_sub_f32 v75, v75, v7
    v_sub_f32 v59, v59, v7
    v_sub_f32 v108, v108, v7
    v_sub_f32 v76, v76, v7
    v_sub_f32 v60, v60, v7
    v_sub_f32 v109, v109, v7
    v_sub_f32 v77, v77, v7
    v_sub_f32 v61, v61, v7
    v_sub_f32 v110, v110, v7
    v_sub_f32 v78, v78, v7
    v_sub_f32 v62, v62, v7
    v_sub_f32 v111, v111, v7
    v_sub_f32 v79, v79, v7
    v_sub_f32 v63, v63, v7
    v_exp_f32 v8, -v7
    s_nop 0
    v_mul_f32 v32, v32, v8
    v_mul_f32 v33, v33, v8
    v_mul_f32 v34, v34, v8
    v_mul_f32 v35, v35, v8
    v_mul_f32 v36, v36, v8
    v_mul_f32 v37, v37, v8
    v_mul_f32 v38, v38, v8
    v_mul_f32 v39, v39, v8
    v_mul_f32 v40, v40, v8
    v_mul_f32 v41, v41, v8
    v_mul_f32 v42, v42, v8
    v_mul_f32 v43, v43, v8
    v_mul_f32 v44, v44, v8
    v_mul_f32 v45, v45, v8
    v_mul_f32 v46, v46, v8
    v_mul_f32 v47, v47, v8
    v_exp_f32 v12, v64
    v_exp_f32 v13, v65
    s_nop 0
    v_cvt_pk_bf16_f32 v88, v12, v13
    v_exp_f32 v14, v66
    v_exp_f32 v15, v67
    s_nop 0
    v_cvt_pk_bf16_f32 v89, v14, v15
    v_exp_f32 v12, v68
    v_exp_f32 v13, v69
    s_nop 0
    v_cvt_pk_bf16_f32 v90, v12, v13
    v_exp_f32 v14, v70
    v_exp_f32 v15, v71
    s_nop 0
    v_cvt_pk_bf16_f32 v91, v14, v15
    v_exp_f32 v12, v72
    v_exp_f32 v13, v73
    s_nop 0
    v_cvt_pk_bf16_f32 v92, v12, v13
    v_exp_f32 v14, v74
    v_exp_f32 v15, v75
    s_nop 0
    v_cvt_pk_bf16_f32 v93, v14, v15
    v_exp_f32 v12, v76
    v_exp_f32 v13, v77
    s_nop 0
    v_cvt_pk_bf16_f32 v94, v12, v13
    v_exp_f32 v14, v78
    v_exp_f32 v15, v79
    s_nop 0
    v_cvt_pk_bf16_f32 v95, v14, v15
    s_nop 1
    s_branch AA_BACK_60
AA_END_61:
    s_lshl_b32 s68, s64, 13
    s_add_u32 s68, s68, 65536
    v_add_u32 v3, s68, v2
    ds_read_b128 v[16:19], v3 offset:0
    ds_read_b128 v[20:23], v3 offset:1024
    ds_read_b128 v[24:27], v3 offset:2048
    ds_read_b128 v[28:31], v3 offset:3072
    ds_read_b128 v[32:35], v3 offset:4096
    ds_read_b128 v[36:39], v3 offset:5120
    ds_read_b128 v[40:43], v3 offset:6144
    ds_read_b128 v[44:47], v3 offset:7168
    s_branch P2J_38
P2G_37:
    v_and_b32 v0, 15, v1
    v_lshlrev_b32 v0, 4, v0
    v_bfe_u32 v16, v1, 4, 1
    v_lshl_add_u32 v0, v16, 10, v0
    v_lshrrev_b32 v16, 5, v1
    v_lshl_add_u32 v0, v16, 8, v0
    s_waitcnt vmcnt(14)
    s_barrier
    ds_read_b128 v[16:19], v8 offset:0
    ds_read_b128 v[20:23], v8 offset:4096
    ds_read_b64_tr_b16 v[24:25], v12 offset:0
    ds_read_b64_tr_b16 v[26:27], v12 offset:1024
    ds_read_b64_tr_b16 v[28:29], v13 offset:0
    ds_read_b64_tr_b16 v[30:31], v13 offset:1024
    ds_read_b64_tr_b16 v[32:33], v14 offset:0
    ds_read_b64_tr_b16 v[34:35], v14 offset:1024
    ds_read_b64_tr_b16 v[36:37], v15 offset:0
    ds_read_b64_tr_b16 v[38:39], v15 offset:1024
    s_waitcnt lgkmcnt(0)
    v_mfma_f32_32x32x16_bf16 v[64:79], v[24:27], v[16:19], 0
    ds_read_b128 v[40:43], v9 offset:0
    ds_read_b128 v[44:47], v9 offset:4096
    ds_read_b64_tr_b16 v[48:49], v12 offset:4096
    v_mfma_f32_32x32x16_bf16 v[80:95], v[28:31], v[16:19], 0
    ds_read_b64_tr_b16 v[50:51], v12 offset:5120
    ds_read_b64_tr_b16 v[52:53], v13 offset:4096
    ds_read_b64_tr_b16 v[54:55], v13 offset:5120
    v_mfma_f32_32x32x16_bf16 v[96:111], v[32:35], v[16:19], 0
    ds_read_b64_tr_b16 v[56:57], v14 offset:4096
    ds_read_b64_tr_b16 v[58:59], v14 offset:5120
    ds_read_b64_tr_b16 v[60:61], v15 offset:4096
    v_mfma_f32_32x32x16_bf16 v[112:127], v[36:39], v[16:19], 0
    ds_read_b64_tr_b16 v[62:63], v15 offset:5120
    v_mfma_f32_32x32x16_bf16 v[128:143], v[24:27], v[20:23], 0
    v_mfma_f32_32x32x16_bf16 v[144:159], v[28:31], v[20:23], 0
    v_mfma_f32_32x32x16_bf16 v[160:175], v[32:35], v[20:23], 0
    v_mfma_f32_32x32x16_bf16 v[176:191], v[36:39], v[20:23], 0
    s_waitcnt vmcnt(12) lgkmcnt(0)
    s_barrier
    v_mfma_f32_32x32x16_bf16 v[64:79], v[48:51], v[40:43], v[64:79]
    ds_read_b128 v[16:19], v10 offset:0
    ds_read_b128 v[20:23], v10 offset:4096
    ds_read_b64_tr_b16 v[24:25], v12 offset:8192
    v_mfma_f32_32x32x16_bf16 v[80:95], v[52:55], v[40:43], v[80:95]
    ds_read_b64_tr_b16 v[26:27], v12 offset:9216
    ds_read_b64_tr_b16 v[28:29], v13 offset:8192
    ds_read_b64_tr_b16 v[30:31], v13 offset:9216
    s_add_u32 s12, s3, 0
    buffer_store_dwordx4 v[192:195], v0, s[56:59], s12 offen offset:0 sc1
    v_mfma_f32_32x32x16_bf16 v[96:111], v[56:59], v[40:43], v[96:111]
    ds_read_b64_tr_b16 v[32:33], v14 offset:8192
    ds_read_b64_tr_b16 v[34:35], v14 offset:9216
    ds_read_b64_tr_b16 v[36:37], v15 offset:8192
    v_mfma_f32_32x32x16_bf16 v[112:127], v[60:63], v[40:43], v[112:127]
    ds_read_b64_tr_b16 v[38:39], v15 offset:9216
    s_add_u32 m0, s73, 0
    s_add_u32 s68, s71, 1048576
    buffer_load_dwordx4 v6, s[48:51], s68 offen lds
    v_mfma_f32_32x32x16_bf16 v[128:143], v[48:51], v[44:47], v[128:143]
    v_mfma_f32_32x32x16_bf16 v[144:159], v[52:55], v[44:47], v[144:159]
    s_add_u32 m0, s73, 1024
    s_add_u32 s68, s71, 1081344
    buffer_load_dwordx4 v6, s[48:51], s68 offen lds
    v_mfma_f32_32x32x16_bf16 v[160:175], v[56:59], v[44:47], v[160:175]
    v_mfma_f32_32x32x16_bf16 v[176:191], v[60:63], v[44:47], v[176:191]
    s_waitcnt lgkmcnt(0)
    v_mfma_f32_32x32x16_bf16 v[64:79], v[24:27], v[16:19], v[64:79]
    ds_read_b128 v[40:43], v11 offset:0
    ds_read_b128 v[44:47], v11 offset:4096
    ds_read_b64_tr_b16 v[48:49], v12 offset:12288
    v_mfma_f32_32x32x16_bf16 v[80:95], v[28:31], v[16:19], v[80:95]
    ds_read_b64_tr_b16 v[50:51], v12 offset:13312
    ds_read_b64_tr_b16 v[52:53], v13 offset:12288
    ds_read_b64_tr_b16 v[54:55], v13 offset:13312
    v_mfma_f32_32x32x16_bf16 v[96:111], v[32:35], v[16:19], v[96:111]
    ds_read_b64_tr_b16 v[56:57], v14 offset:12288
    ds_read_b64_tr_b16 v[58:59], v14 offset:13312
    ds_read_b64_tr_b16 v[60:61], v15 offset:12288
    v_mfma_f32_32x32x16_bf16 v[112:127], v[36:39], v[16:19], v[112:127]
    ds_read_b64_tr_b16 v[62:63], v15 offset:13312
    v_mfma_f32_32x32x16_bf16 v[128:143], v[24:27], v[20:23], v[128:143]
    v_mfma_f32_32x32x16_bf16 v[144:159], v[28:31], v[20:23], v[144:159]
    v_mfma_f32_32x32x16_bf16 v[160:175], v[32:35], v[20:23], v[160:175]
    v_mfma_f32_32x32x16_bf16 v[176:191], v[36:39], v[20:23], v[176:191]
    s_waitcnt vmcnt(5) lgkmcnt(0)
    s_barrier
    v_mfma_f32_32x32x16_bf16 v[64:79], v[48:51], v[40:43], v[64:79]
    ds_read_b128 v[16:19], v8 offset:32768
    ds_read_b128 v[20:23], v8 offset:36864
    ds_read_b64_tr_b16 v[24:25], v12 offset:16384
    s_add_u32 s12, s3, 0
    buffer_store_dwordx4 v[196:199], v0, s[56:59], s12 offen offset:512 sc1
    v_mfma_f32_32x32x16_bf16 v[80:95], v[52:55], v[40:43], v[80:95]
    ds_read_b64_tr_b16 v[26:27], v12 offset:17408
    ds_read_b64_tr_b16 v[28:29], v13 offset:16384
    ds_read_b64_tr_b16 v[30:31], v13 offset:17408
    s_add_u32 m0, s73, 8192
    s_add_u32 s68, s71, 1310720
    buffer_load_dwordx4 v6, s[48:51], s68 offen lds
    v_mfma_f32_32x32x16_bf16 v[96:111], v[56:59], v[40:43], v[96:111]
    ds_read_b64_tr_b16 v[32:33], v14 offset:16384
    ds_read_b64_tr_b16 v[34:35], v14 offset:17408
    ds_read_b64_tr_b16 v[36:37], v15 offset:16384
    s_add_u32 m0, s73, 9216
    s_add_u32 s68, s71, 1343488
    buffer_load_dwordx4 v6, s[48:51], s68 offen lds
    v_mfma_f32_32x32x16_bf16 v[112:127], v[60:63], v[40:43], v[112:127]
    ds_read_b64_tr_b16 v[38:39], v15 offset:17408
    s_add_u32 m0, s72, 0
    s_mov_b32 s68, 256
    buffer_load_dwordx4 v2, s[44:47], s68 offen lds
    v_mfma_f32_32x32x16_bf16 v[128:143], v[48:51], v[44:47], v[128:143]
    s_add_u32 m0, s72, 1024
    s_mov_b32 s68, 256
    buffer_load_dwordx4 v3, s[44:47], s68 offen lds
    v_mfma_f32_32x32x16_bf16 v[144:159], v[52:55], v[44:47], v[144:159]
    s_add_u32 m0, s72, 2048
    s_mov_b32 s68, 18688
    buffer_load_dwordx4 v2, s[44:47], s68 offen lds
    v_mfma_f32_32x32x16_bf16 v[160:175], v[56:59], v[44:47], v[160:175]
    s_add_u32 m0, s72, 3072
    s_mov_b32 s68, 18688
    buffer_load_dwordx4 v3, s[44:47], s68 offen lds
    v_mfma_f32_32x32x16_bf16 v[176:191], v[60:63], v[44:47], v[176:191]
    s_add_u32 m0, s72, 4096
    s_mov_b32 s68, 256
    buffer_load_dwordx4 v4, s[44:47], s68 offen lds
    s_add_u32 m0, s72, 5120
    s_mov_b32 s68, 256
    buffer_load_dwordx4 v5, s[44:47], s68 offen lds
    s_add_u32 m0, s72, 6144
    s_mov_b32 s68, 18688
    buffer_load_dwordx4 v4, s[44:47], s68 offen lds
    s_add_u32 m0, s72, 7168
    s_mov_b32 s68, 18688
    buffer_load_dwordx4 v5, s[44:47], s68 offen lds
    s_barrier
    s_waitcnt lgkmcnt(0)
    v_mfma_f32_32x32x16_bf16 v[64:79], v[24:27], v[16:19], v[64:79]
    ds_read_b128 v[40:43], v9 offset:32768
    ds_read_b128 v[44:47], v9 offset:36864
    ds_read_b64_tr_b16 v[48:49], v12 offset:20480
    v_mfma_f32_32x32x16_bf16 v[80:95], v[28:31], v[16:19], v[80:95]
    ds_read_b64_tr_b16 v[50:51], v12 offset:21504
    ds_read_b64_tr_b16 v[52:53], v13 offset:20480
    ds_read_b64_tr_b16 v[54:55], v13 offset:21504
    s_add_u32 s12, s3, 0
    buffer_store_dwordx4 v[200:203], v0, s[56:59], s12 offen offset:2048 sc1
    v_mfma_f32_32x32x16_bf16 v[96:111], v[32:35], v[16:19], v[96:111]
    ds_read_b64_tr_b16 v[56:57], v14 offset:20480
    ds_read_b64_tr_b16 v[58:59], v14 offset:21504
    ds_read_b64_tr_b16 v[60:61], v15 offset:20480
    v_mfma_f32_32x32x16_bf16 v[112:127], v[36:39], v[16:19], v[112:127]
    ds_read_b64_tr_b16 v[62:63], v15 offset:21504
    v_mfma_f32_32x32x16_bf16 v[128:143], v[24:27], v[20:23], v[128:143]
    v_mfma_f32_32x32x16_bf16 v[144:159], v[28:31], v[20:23], v[144:159]
    v_mfma_f32_32x32x16_bf16 v[160:175], v[32:35], v[20:23], v[160:175]
    v_mfma_f32_32x32x16_bf16 v[176:191], v[36:39], v[20:23], v[176:191]
    s_waitcnt vmcnt(15) lgkmcnt(0)
    s_barrier
    v_mfma_f32_32x32x16_bf16 v[64:79], v[48:51], v[40:43], v[64:79]
    ds_read_b128 v[16:19], v10 offset:32768
    ds_read_b128 v[20:23], v10 offset:36864
    ds_read_b64_tr_b16 v[24:25], v12 offset:24576
    v_mfma_f32_32x32x16_bf16 v[80:95], v[52:55], v[40:43], v[80:95]
    ds_read_b64_tr_b16 v[26:27], v12 offset:25600
    ds_read_b64_tr_b16 v[28:29], v13 offset:24576
    ds_read_b64_tr_b16 v[30:31], v13 offset:25600
    s_add_u32 s12, s3, 0
    buffer_store_dwordx4 v[204:207], v0, s[56:59], s12 offen offset:2560 sc1
    v_mfma_f32_32x32x16_bf16 v[96:111], v[56:59], v[40:43], v[96:111]
    ds_read_b64_tr_b16 v[32:33], v14 offset:24576
    ds_read_b64_tr_b16 v[34:35], v14 offset:25600
    ds_read_b64_tr_b16 v[36:37], v15 offset:24576
    v_mfma_f32_32x32x16_bf16 v[112:127], v[60:63], v[40:43], v[112:127]
    ds_read_b64_tr_b16 v[38:39], v15 offset:25600
    s_add_u32 m0, s73, 16384
    s_add_u32 s68, s71, 1572864
    buffer_load_dwordx4 v6, s[48:51], s68 offen lds
    v_mfma_f32_32x32x16_bf16 v[128:143], v[48:51], v[44:47], v[128:143]
    v_mfma_f32_32x32x16_bf16 v[144:159], v[52:55], v[44:47], v[144:159]
    s_add_u32 m0, s73, 17408
    s_add_u32 s68, s71, 1605632
    buffer_load_dwordx4 v6, s[48:51], s68 offen lds
    v_mfma_f32_32x32x16_bf16 v[160:175], v[56:59], v[44:47], v[160:175]
    v_mfma_f32_32x32x16_bf16 v[176:191], v[60:63], v[44:47], v[176:191]
    s_waitcnt lgkmcnt(0)
    v_mfma_f32_32x32x16_bf16 v[64:79], v[24:27], v[16:19], v[64:79]
    ds_read_b128 v[40:43], v11 offset:32768
    ds_read_b128 v[44:47], v11 offset:36864
    ds_read_b64_tr_b16 v[48:49], v12 offset:28672
    v_mfma_f32_32x32x16_bf16 v[80:95], v[28:31], v[16:19], v[80:95]
    ds_read_b64_tr_b16 v[50:51], v12 offset:29696
    ds_read_b64_tr_b16 v[52:53], v13 offset:28672
    ds_read_b64_tr_b16 v[54:55], v13 offset:29696
    v_mfma_f32_32x32x16_bf16 v[96:111], v[32:35], v[16:19], v[96:111]
    ds_read_b64_tr_b16 v[56:57], v14 offset:28672
    ds_read_b64_tr_b16 v[58:59], v14 offset:29696
    ds_read_b64_tr_b16 v[60:61], v15 offset:28672
    v_mfma_f32_32x32x16_bf16 v[112:127], v[36:39], v[16:19], v[112:127]
    ds_read_b64_tr_b16 v[62:63], v15 offset:29696
    v_mfma_f32_32x32x16_bf16 v[128:143], v[24:27], v[20:23], v[128:143]
    v_mfma_f32_32x32x16_bf16 v[144:159], v[28:31], v[20:23], v[144:159]
    v_mfma_f32_32x32x16_bf16 v[160:175], v[32:35], v[20:23], v[160:175]
    v_mfma_f32_32x32x16_bf16 v[176:191], v[36:39], v[20:23], v[176:191]
    s_waitcnt vmcnt(4) lgkmcnt(0)
    s_barrier
    v_mfma_f32_32x32x16_bf16 v[64:79], v[48:51], v[40:43], v[64:79]
    ds_read_b128 v[16:19], v8 offset:0
    ds_read_b128 v[20:23], v8 offset:4096
    ds_read_b64_tr_b16 v[24:25], v12 offset:0
    s_add_u32 s12, s3, 8192
    buffer_store_dwordx4 v[208:211], v0, s[56:59], s12 offen offset:0 sc1
    v_mfma_f32_32x32x16_bf16 v[80:95], v[52:55], v[40:43], v[80:95]
    ds_read_b64_tr_b16 v[26:27], v12 offset:1024
    ds_read_b64_tr_b16 v[28:29], v13 offset:0
    ds_read_b64_tr_b16 v[30:31], v13 offset:1024
    s_add_u32 m0, s73, 24576
    s_add_u32 s68, s71, 1835008
    buffer_load_dwordx4 v6, s[48:51], s68 offen lds
    v_mfma_f32_32x32x16_bf16 v[96:111], v[56:59], v[40:43], v[96:111]
    ds_read_b64_tr_b16 v[32:33], v14 offset:0
    ds_read_b64_tr_b16 v[34:35], v14 offset:1024
    ds_read_b64_tr_b16 v[36:37], v15 offset:0
    s_add_u32 m0, s73, 25600
    s_add_u32 s68, s71, 1867776
    buffer_load_dwordx4 v6, s[48:51], s68 offen lds
    v_mfma_f32_32x32x16_bf16 v[112:127], v[60:63], v[40:43], v[112:127]
    ds_read_b64_tr_b16 v[38:39], v15 offset:1024
    s_add_u32 m0, s72, 32768
    s_mov_b32 s68, 384
    buffer_load_dwordx4 v2, s[44:47], s68 offen lds
    v_mfma_f32_32x32x16_bf16 v[128:143], v[48:51], v[44:47], v[128:143]
    s_add_u32 m0, s72, 33792
    s_mov_b32 s68, 384
    buffer_load_dwordx4 v3, s[44:47], s68 offen lds
    v_mfma_f32_32x32x16_bf16 v[144:159], v[52:55], v[44:47], v[144:159]
    s_add_u32 m0, s72, 34816
    s_mov_b32 s68, 18816
    buffer_load_dwordx4 v2, s[44:47], s68 offen lds
    v_mfma_f32_32x32x16_bf16 v[160:175], v[56:59], v[44:47], v[160:175]
    s_add_u32 m0, s72, 35840
    s_mov_b32 s68, 18816
    buffer_load_dwordx4 v3, s[44:47], s68 offen lds
    v_mfma_f32_32x32x16_bf16 v[176:191], v[60:63], v[44:47], v[176:191]
    s_add_u32 m0, s72, 36864
    s_mov_b32 s68, 384
    buffer_load_dwordx4 v4, s[44:47], s68 offen lds
    s_add_u32 m0, s72, 37888
    s_mov_b32 s68, 384
    buffer_load_dwordx4 v5, s[44:47], s68 offen lds
    s_add_u32 m0, s72, 38912
    s_mov_b32 s68, 18816
    buffer_load_dwordx4 v4, s[44:47], s68 offen lds
    s_add_u32 m0, s72, 39936
    s_mov_b32 s68, 18816
    buffer_load_dwordx4 v5, s[44:47], s68 offen lds
    s_barrier
    s_waitcnt lgkmcnt(0)
    v_mfma_f32_32x32x16_bf16 v[64:79], v[24:27], v[16:19], v[64:79]
    ds_read_b128 v[40:43], v9 offset:0
    ds_read_b128 v[44:47], v9 offset:4096
    ds_read_b64_tr_b16 v[48:49], v12 offset:4096
    v_mfma_f32_32x32x16_bf16 v[80:95], v[28:31], v[16:19], v[80:95]
    ds_read_b64_tr_b16 v[50:51], v12 offset:5120
    ds_read_b64_tr_b16 v[52:53], v13 offset:4096
    ds_read_b64_tr_b16 v[54:55], v13 offset:5120
    s_add_u32 s12, s3, 8192
    buffer_store_dwordx4 v[212:215], v0, s[56:59], s12 offen offset:512 sc1
    v_mfma_f32_32x32x16_bf16 v[96:111], v[32:35], v[16:19], v[96:111]
    ds_read_b64_tr_b16 v[56:57], v14 offset:4096
    ds_read_b64_tr_b16 v[58:59], v14 offset:5120
    ds_read_b64_tr_b16 v[60:61], v15 offset:4096
    v_mfma_f32_32x32x16_bf16 v[112:127], v[36:39], v[16:19], v[112:127]
    ds_read_b64_tr_b16 v[62:63], v15 offset:5120
    v_mfma_f32_32x32x16_bf16 v[128:143], v[24:27], v[20:23], v[128:143]
    v_mfma_f32_32x32x16_bf16 v[144:159], v[28:31], v[20:23], v[144:159]
    v_mfma_f32_32x32x16_bf16 v[160:175], v[32:35], v[20:23], v[160:175]
    v_mfma_f32_32x32x16_bf16 v[176:191], v[36:39], v[20:23], v[176:191]
    s_waitcnt lgkmcnt(0)
    s_barrier
    v_mfma_f32_32x32x16_bf16 v[64:79], v[48:51], v[40:43], v[64:79]
    ds_read_b128 v[16:19], v10 offset:0
    ds_read_b128 v[20:23], v10 offset:4096
    ds_read_b64_tr_b16 v[24:25], v12 offset:8192
    v_mfma_f32_32x32x16_bf16 v[80:95], v[52:55], v[40:43], v[80:95]
    ds_read_b64_tr_b16 v[26:27], v12 offset:9216
    ds_read_b64_tr_b16 v[28:29], v13 offset:8192
    ds_read_b64_tr_b16 v[30:31], v13 offset:9216
    s_add_u32 s12, s3, 8192
    buffer_store_dwordx4 v[216:219], v0, s[56:59], s12 offen offset:2048 sc1
    v_mfma_f32_32x32x16_bf16 v[96:111], v[56:59], v[40:43], v[96:111]
    ds_read_b64_tr_b16 v[32:33], v14 offset:8192
    ds_read_b64_tr_b16 v[34:35], v14 offset:9216
    ds_read_b64_tr_b16 v[36:37], v15 offset:8192
    v_mfma_f32_32x32x16_bf16 v[112:127], v[60:63], v[40:43], v[112:127]
    ds_read_b64_tr_b16 v[38:39], v15 offset:9216
    s_add_u32 m0, s73, 0
    s_add_u32 s68, s71, 2097152
    buffer_load_dwordx4 v6, s[48:51], s68 offen lds
    v_mfma_f32_32x32x16_bf16 v[128:143], v[48:51], v[44:47], v[128:143]
    v_mfma_f32_32x32x16_bf16 v[144:159], v[52:55], v[44:47], v[144:159]
    s_add_u32 m0, s73, 1024
    s_add_u32 s68, s71, 2129920
    buffer_load_dwordx4 v6, s[48:51], s68 offen lds
    v_mfma_f32_32x32x16_bf16 v[160:175], v[56:59], v[44:47], v[160:175]
    v_mfma_f32_32x32x16_bf16 v[176:191], v[60:63], v[44:47], v[176:191]
    s_waitcnt lgkmcnt(0)
    v_mfma_f32_32x32x16_bf16 v[64:79], v[24:27], v[16:19], v[64:79]
    ds_read_b128 v[40:43], v11 offset:0
    ds_read_b128 v[44:47], v11 offset:4096
    ds_read_b64_tr_b16 v[48:49], v12 offset:12288
    v_mfma_f32_32x32x16_bf16 v[80:95], v[28:31], v[16:19], v[80:95]
    ds_read_b64_tr_b16 v[50:51], v12 offset:13312
    ds_read_b64_tr_b16 v[52:53], v13 offset:12288
    ds_read_b64_tr_b16 v[54:55], v13 offset:13312
    v_mfma_f32_32x32x16_bf16 v[96:111], v[32:35], v[16:19], v[96:111]
    ds_read_b64_tr_b16 v[56:57], v14 offset:12288
    ds_read_b64_tr_b16 v[58:59], v14 offset:13312
    ds_read_b64_tr_b16 v[60:61], v15 offset:12288
    v_mfma_f32_32x32x16_bf16 v[112:127], v[36:39], v[16:19], v[112:127]
    ds_read_b64_tr_b16 v[62:63], v15 offset:13312
    v_mfma_f32_32x32x16_bf16 v[128:143], v[24:27], v[20:23], v[128:143]
    v_mfma_f32_32x32x16_bf16 v[144:159], v[28:31], v[20:23], v[144:159]
    v_mfma_f32_32x32x16_bf16 v[160:175], v[32:35], v[20:23], v[160:175]
    v_mfma_f32_32x32x16_bf16 v[176:191], v[36:39], v[20:23], v[176:191]
    s_waitcnt vmcnt(4) lgkmcnt(0)
    s_barrier
    v_mfma_f32_32x32x16_bf16 v[64:79], v[48:51], v[40:43], v[64:79]
    ds_read_b128 v[16:19], v8 offset:32768
    ds_read_b128 v[20:23], v8 offset:36864
    ds_read_b64_tr_b16 v[24:25], v12 offset:16384
    s_add_u32 s12, s3, 8192
    buffer_store_dwordx4 v[220:223], v0, s[56:59], s12 offen offset:2560 sc1
    v_mfma_f32_32x32x16_bf16 v[80:95], v[52:55], v[40:43], v[80:95]
    ds_read_b64_tr_b16 v[26:27], v12 offset:17408
    ds_read_b64_tr_b16 v[28:29], v13 offset:16384
    ds_read_b64_tr_b16 v[30:31], v13 offset:17408
    s_add_u32 m0, s73, 8192
    s_add_u32 s68, s71, 2359296
    buffer_load_dwordx4 v6, s[48:51], s68 offen lds
    v_mfma_f32_32x32x16_bf16 v[96:111], v[56:59], v[40:43], v[96:111]
    ds_read_b64_tr_b16 v[32:33], v14 offset:16384
    ds_read_b64_tr_b16 v[34:35], v14 offset:17408
    ds_read_b64_tr_b16 v[36:37], v15 offset:16384
    s_add_u32 m0, s73, 9216
    s_add_u32 s68, s71, 2392064
    buffer_load_dwordx4 v6, s[48:51], s68 offen lds
    v_mfma_f32_32x32x16_bf16 v[112:127], v[60:63], v[40:43], v[112:127]
    ds_read_b64_tr_b16 v[38:39], v15 offset:17408
    s_add_u32 m0, s72, 0
    s_mov_b32 s68, 512
    buffer_load_dwordx4 v2, s[44:47], s68 offen lds
    v_mfma_f32_32x32x16_bf16 v[128:143], v[48:51], v[44:47], v[128:143]
    s_add_u32 m0, s72, 1024
    s_mov_b32 s68, 512
    buffer_load_dwordx4 v3, s[44:47], s68 offen lds
    v_mfma_f32_32x32x16_bf16 v[144:159], v[52:55], v[44:47], v[144:159]
    s_add_u32 m0, s72, 2048
    s_mov_b32 s68, 18944
    buffer_load_dwordx4 v2, s[44:47], s68 offen lds
    v_mfma_f32_32x32x16_bf16 v[160:175], v[56:59], v[44:47], v[160:175]
    s_add_u32 m0, s72, 3072
    s_mov_b32 s68, 18944
    buffer_load_dwordx4 v3, s[44:47], s68 offen lds
    v_mfma_f32_32x32x16_bf16 v[176:191], v[60:63], v[44:47], v[176:191]
    s_add_u32 m0, s72, 4096
    s_mov_b32 s68, 512
    buffer_load_dwordx4 v4, s[44:47], s68 offen lds
    s_add_u32 m0, s72, 5120
    s_mov_b32 s68, 512
    buffer_load_dwordx4 v5, s[44:47], s68 offen lds
    s_add_u32 m0, s72, 6144
    s_mov_b32 s68, 18944
    buffer_load_dwordx4 v4, s[44:47], s68 offen lds
    s_add_u32 m0, s72, 7168
    s_mov_b32 s68, 18944
    buffer_load_dwordx4 v5, s[44:47], s68 offen lds
    s_barrier
    s_waitcnt lgkmcnt(0)
    v_mfma_f32_32x32x16_bf16 v[64:79], v[24:27], v[16:19], v[64:79]
    ds_read_b128 v[40:43], v9 offset:32768
    ds_read_b128 v[44:47], v9 offset:36864
    ds_read_b64_tr_b16 v[48:49], v12 offset:20480
    v_mfma_f32_32x32x16_bf16 v[80:95], v[28:31], v[16:19], v[80:95]
    ds_read_b64_tr_b16 v[50:51], v12 offset:21504
    ds_read_b64_tr_b16 v[52:53], v13 offset:20480
    ds_read_b64_tr_b16 v[54:55], v13 offset:21504
    s_add_u32 s12, s3, 16384
    buffer_store_dwordx4 v[224:227], v0, s[56:59], s12 offen offset:0 sc1
    v_mfma_f32_32x32x16_bf16 v[96:111], v[32:35], v[16:19], v[96:111]
    ds_read_b64_tr_b16 v[56:57], v14 offset:20480
    ds_read_b64_tr_b16 v[58:59], v14 offset:21504
    ds_read_b64_tr_b16 v[60:61], v15 offset:20480
    v_mfma_f32_32x32x16_bf16 v[112:127], v[36:39], v[16:19], v[112:127]
    ds_read_b64_tr_b16 v[62:63], v15 offset:21504
    v_mfma_f32_32x32x16_bf16 v[128:143], v[24:27], v[20:23], v[128:143]
    v_mfma_f32_32x32x16_bf16 v[144:159], v[28:31], v[20:23], v[144:159]
    v_mfma_f32_32x32x16_bf16 v[160:175], v[32:35], v[20:23], v[160:175]
    v_mfma_f32_32x32x16_bf16 v[176:191], v[36:39], v[20:23], v[176:191]
    s_waitcnt lgkmcnt(0)
    s_barrier
    v_mfma_f32_32x32x16_bf16 v[64:79], v[48:51], v[40:43], v[64:79]
    ds_read_b128 v[16:19], v10 offset:32768
    ds_read_b128 v[20:23], v10 offset:36864
    ds_read_b64_tr_b16 v[24:25], v12 offset:24576
    v_mfma_f32_32x32x16_bf16 v[80:95], v[52:55], v[40:43], v[80:95]
    ds_read_b64_tr_b16 v[26:27], v12 offset:25600
    ds_read_b64_tr_b16 v[28:29], v13 offset:24576
    ds_read_b64_tr_b16 v[30:31], v13 offset:25600
    s_add_u32 s12, s3, 16384
    buffer_store_dwordx4 v[228:231], v0, s[56:59], s12 offen offset:512 sc1
    v_mfma_f32_32x32x16_bf16 v[96:111], v[56:59], v[40:43], v[96:111]
    ds_read_b64_tr_b16 v[32:33], v14 offset:24576
    ds_read_b64_tr_b16 v[34:35], v14 offset:25600
    ds_read_b64_tr_b16 v[36:37], v15 offset:24576
    v_mfma_f32_32x32x16_bf16 v[112:127], v[60:63], v[40:43], v[112:127]
    ds_read_b64_tr_b16 v[38:39], v15 offset:25600
    s_add_u32 m0, s73, 16384
    s_add_u32 s68, s71, 2621440
    buffer_load_dwordx4 v6, s[48:51], s68 offen lds
    v_mfma_f32_32x32x16_bf16 v[128:143], v[48:51], v[44:47], v[128:143]
    v_mfma_f32_32x32x16_bf16 v[144:159], v[52:55], v[44:47], v[144:159]
    s_add_u32 m0, s73, 17408
    s_add_u32 s68, s71, 2654208
    buffer_load_dwordx4 v6, s[48:51], s68 offen lds
    v_mfma_f32_32x32x16_bf16 v[160:175], v[56:59], v[44:47], v[160:175]
    v_mfma_f32_32x32x16_bf16 v[176:191], v[60:63], v[44:47], v[176:191]
    s_waitcnt lgkmcnt(0)
    v_mfma_f32_32x32x16_bf16 v[64:79], v[24:27], v[16:19], v[64:79]
    ds_read_b128 v[40:43], v11 offset:32768
    ds_read_b128 v[44:47], v11 offset:36864
    ds_read_b64_tr_b16 v[48:49], v12 offset:28672
    v_mfma_f32_32x32x16_bf16 v[80:95], v[28:31], v[16:19], v[80:95]
    ds_read_b64_tr_b16 v[50:51], v12 offset:29696
    ds_read_b64_tr_b16 v[52:53], v13 offset:28672
    ds_read_b64_tr_b16 v[54:55], v13 offset:29696
    v_mfma_f32_32x32x16_bf16 v[96:111], v[32:35], v[16:19], v[96:111]
    ds_read_b64_tr_b16 v[56:57], v14 offset:28672
    ds_read_b64_tr_b16 v[58:59], v14 offset:29696
    ds_read_b64_tr_b16 v[60:61], v15 offset:28672
    v_mfma_f32_32x32x16_bf16 v[112:127], v[36:39], v[16:19], v[112:127]
    ds_read_b64_tr_b16 v[62:63], v15 offset:29696
    v_mfma_f32_32x32x16_bf16 v[128:143], v[24:27], v[20:23], v[128:143]
    v_mfma_f32_32x32x16_bf16 v[144:159], v[28:31], v[20:23], v[144:159]
    v_mfma_f32_32x32x16_bf16 v[160:175], v[32:35], v[20:23], v[160:175]
    v_mfma_f32_32x32x16_bf16 v[176:191], v[36:39], v[20:23], v[176:191]
    s_waitcnt vmcnt(4) lgkmcnt(0)
    s_barrier
    v_mfma_f32_32x32x16_bf16 v[64:79], v[48:51], v[40:43], v[64:79]
    ds_read_b128 v[16:19], v8 offset:0
    ds_read_b128 v[20:23], v8 offset:4096
    ds_read_b64_tr_b16 v[24:25], v12 offset:0
    s_add_u32 s12, s3, 16384
    buffer_store_dwordx4 v[232:235], v0, s[56:59], s12 offen offset:2048 sc1
    v_mfma_f32_32x32x16_bf16 v[80:95], v[52:55], v[40:43], v[80:95]
    ds_read_b64_tr_b16 v[26:27], v12 offset:1024
    ds_read_b64_tr_b16 v[28:29], v13 offset:0
    ds_read_b64_tr_b16 v[30:31], v13 offset:1024
    s_add_u32 m0, s73, 24576
    s_add_u32 s68, s71, 2883584
    buffer_load_dwordx4 v6, s[48:51], s68 offen lds
    v_mfma_f32_32x32x16_bf16 v[96:111], v[56:59], v[40:43], v[96:111]
    ds_read_b64_tr_b16 v[32:33], v14 offset:0
    ds_read_b64_tr_b16 v[34:35], v14 offset:1024
    ds_read_b64_tr_b16 v[36:37], v15 offset:0
    s_add_u32 m0, s73, 25600
    s_add_u32 s68, s71, 2916352
    buffer_load_dwordx4 v6, s[48:51], s68 offen lds
    v_mfma_f32_32x32x16_bf16 v[112:127], v[60:63], v[40:43], v[112:127]
    ds_read_b64_tr_b16 v[38:39], v15 offset:1024
    s_add_u32 m0, s72, 32768
    s_mov_b32 s68, 640
    buffer_load_dwordx4 v2, s[44:47], s68 offen lds
    v_mfma_f32_32x32x16_bf16 v[128:143], v[48:51], v[44:47], v[128:143]
    s_add_u32 m0, s72, 33792
    s_mov_b32 s68, 640
    buffer_load_dwordx4 v3, s[44:47], s68 offen lds
    v_mfma_f32_32x32x16_bf16 v[144:159], v[52:55], v[44:47], v[144:159]
    s_add_u32 m0, s72, 34816
    s_mov_b32 s68, 19072
    buffer_load_dwordx4 v2, s[44:47], s68 offen lds
    v_mfma_f32_32x32x16_bf16 v[160:175], v[56:59], v[44:47], v[160:175]
    s_add_u32 m0, s72, 35840
    s_mov_b32 s68, 19072
    buffer_load_dwordx4 v3, s[44:47], s68 offen lds
    v_mfma_f32_32x32x16_bf16 v[176:191], v[60:63], v[44:47], v[176:191]
    s_add_u32 m0, s72, 36864
    s_mov_b32 s68, 640
    buffer_load_dwordx4 v4, s[44:47], s68 offen lds
    s_add_u32 m0, s72, 37888
    s_mov_b32 s68, 640
    buffer_load_dwordx4 v5, s[44:47], s68 offen lds
    s_add_u32 m0, s72, 38912
    s_mov_b32 s68, 19072
    buffer_load_dwordx4 v4, s[44:47], s68 offen lds
    s_add_u32 m0, s72, 39936
    s_mov_b32 s68, 19072
    buffer_load_dwordx4 v5, s[44:47], s68 offen lds
    s_barrier
    s_waitcnt lgkmcnt(0)
    v_mfma_f32_32x32x16_bf16 v[64:79], v[24:27], v[16:19], v[64:79]
    ds_read_b128 v[40:43], v9 offset:0
    ds_read_b128 v[44:47], v9 offset:4096
    ds_read_b64_tr_b16 v[48:49], v12 offset:4096
    v_mfma_f32_32x32x16_bf16 v[80:95], v[28:31], v[16:19], v[80:95]
    ds_read_b64_tr_b16 v[50:51], v12 offset:5120
    ds_read_b64_tr_b16 v[52:53], v13 offset:4096
    ds_read_b64_tr_b16 v[54:55], v13 offset:5120
    s_add_u32 s12, s3, 16384
    buffer_store_dwordx4 v[236:239], v0, s[56:59], s12 offen offset:2560 sc1
    v_mfma_f32_32x32x16_bf16 v[96:111], v[32:35], v[16:19], v[96:111]
    ds_read_b64_tr_b16 v[56:57], v14 offset:4096
    ds_read_b64_tr_b16 v[58:59], v14 offset:5120
    ds_read_b64_tr_b16 v[60:61], v15 offset:4096
    v_mfma_f32_32x32x16_bf16 v[112:127], v[36:39], v[16:19], v[112:127]
    ds_read_b64_tr_b16 v[62:63], v15 offset:5120
    v_mfma_f32_32x32x16_bf16 v[128:143], v[24:27], v[20:23], v[128:143]
    v_mfma_f32_32x32x16_bf16 v[144:159], v[28:31], v[20:23], v[144:159]
    v_mfma_f32_32x32x16_bf16 v[160:175], v[32:35], v[20:23], v[160:175]
    v_mfma_f32_32x32x16_bf16 v[176:191], v[36:39], v[20:23], v[176:191]
    s_waitcnt lgkmcnt(0)
    s_barrier
    v_mfma_f32_32x32x16_bf16 v[64:79], v[48:51], v[40:43], v[64:79]
    ds_read_b128 v[16:19], v10 offset:0
    ds_read_b128 v[20:23], v10 offset:4096
    ds_read_b64_tr_b16 v[24:25], v12 offset:8192
    v_mfma_f32_32x32x16_bf16 v[80:95], v[52:55], v[40:43], v[80:95]
    ds_read_b64_tr_b16 v[26:27], v12 offset:9216
    ds_read_b64_tr_b16 v[28:29], v13 offset:8192
    ds_read_b64_tr_b16 v[30:31], v13 offset:9216
    s_add_u32 s12, s3, 24576
    buffer_store_dwordx4 v[240:243], v0, s[56:59], s12 offen offset:0 sc1
    v_mfma_f32_32x32x16_bf16 v[96:111], v[56:59], v[40:43], v[96:111]
    ds_read_b64_tr_b16 v[32:33], v14 offset:8192
    ds_read_b64_tr_b16 v[34:35], v14 offset:9216
    ds_read_b64_tr_b16 v[36:37], v15 offset:8192
    v_mfma_f32_32x32x16_bf16 v[112:127], v[60:63], v[40:43], v[112:127]
    ds_read_b64_tr_b16 v[38:39], v15 offset:9216
    s_add_u32 m0, s73, 0
    s_add_u32 s68, s71, 3145728
    buffer_load_dwordx4 v6, s[48:51], s68 offen lds
    v_mfma_f32_32x32x16_bf16 v[128:143], v[48:51], v[44:47], v[128:143]
    v_mfma_f32_32x32x16_bf16 v[144:159], v[52:55], v[44:47], v[144:159]
    s_add_u32 m0, s73, 1024
    s_add_u32 s68, s71, 3178496
    buffer_load_dwordx4 v6, s[48:51], s68 offen lds
    v_mfma_f32_32x32x16_bf16 v[160:175], v[56:59], v[44:47], v[160:175]
    v_mfma_f32_32x32x16_bf16 v[176:191], v[60:63], v[44:47], v[176:191]
    s_waitcnt lgkmcnt(0)
    v_mfma_f32_32x32x16_bf16 v[64:79], v[24:27], v[16:19], v[64:79]
    ds_read_b128 v[40:43], v11 offset:0
    ds_read_b128 v[44:47], v11 offset:4096
    ds_read_b64_tr_b16 v[48:49], v12 offset:12288
    v_mfma_f32_32x32x16_bf16 v[80:95], v[28:31], v[16:19], v[80:95]
    ds_read_b64_tr_b16 v[50:51], v12 offset:13312
    ds_read_b64_tr_b16 v[52:53], v13 offset:12288
    ds_read_b64_tr_b16 v[54:55], v13 offset:13312
    v_mfma_f32_32x32x16_bf16 v[96:111], v[32:35], v[16:19], v[96:111]
    ds_read_b64_tr_b16 v[56:57], v14 offset:12288
    ds_read_b64_tr_b16 v[58:59], v14 offset:13312
    ds_read_b64_tr_b16 v[60:61], v15 offset:12288
    v_mfma_f32_32x32x16_bf16 v[112:127], v[36:39], v[16:19], v[112:127]
    ds_read_b64_tr_b16 v[62:63], v15 offset:13312
    v_mfma_f32_32x32x16_bf16 v[128:143], v[24:27], v[20:23], v[128:143]
    v_mfma_f32_32x32x16_bf16 v[144:159], v[28:31], v[20:23], v[144:159]
    v_mfma_f32_32x32x16_bf16 v[160:175], v[32:35], v[20:23], v[160:175]
    v_mfma_f32_32x32x16_bf16 v[176:191], v[36:39], v[20:23], v[176:191]
    s_waitcnt vmcnt(4) lgkmcnt(0)
    s_barrier
    v_mfma_f32_32x32x16_bf16 v[64:79], v[48:51], v[40:43], v[64:79]
    ds_read_b128 v[16:19], v8 offset:32768
    ds_read_b128 v[20:23], v8 offset:36864
    ds_read_b64_tr_b16 v[24:25], v12 offset:16384
    s_add_u32 s12, s3, 24576
    buffer_store_dwordx4 v[244:247], v0, s[56:59], s12 offen offset:512 sc1
    v_mfma_f32_32x32x16_bf16 v[80:95], v[52:55], v[40:43], v[80:95]
    ds_read_b64_tr_b16 v[26:27], v12 offset:17408
    ds_read_b64_tr_b16 v[28:29], v13 offset:16384
    ds_read_b64_tr_b16 v[30:31], v13 offset:17408
    s_add_u32 m0, s73, 8192
    s_add_u32 s68, s71, 3407872
    buffer_load_dwordx4 v6, s[48:51], s68 offen lds
    v_mfma_f32_32x32x16_bf16 v[96:111], v[56:59], v[40:43], v[96:111]
    ds_read_b64_tr_b16 v[32:33], v14 offset:16384
    ds_read_b64_tr_b16 v[34:35], v14 offset:17408
    ds_read_b64_tr_b16 v[36:37], v15 offset:16384
    s_add_u32 m0, s73, 9216
    s_add_u32 s68, s71, 3440640
    buffer_load_dwordx4 v6, s[48:51], s68 offen lds
    v_mfma_f32_32x32x16_bf16 v[112:127], v[60:63], v[40:43], v[112:127]
    ds_read_b64_tr_b16 v[38:39], v15 offset:17408
    s_add_u32 m0, s72, 0
    s_mov_b32 s68, 768
    buffer_load_dwordx4 v2, s[44:47], s68 offen lds
    v_mfma_f32_32x32x16_bf16 v[128:143], v[48:51], v[44:47], v[128:143]
    s_add_u32 m0, s72, 1024
    s_mov_b32 s68, 768
    buffer_load_dwordx4 v3, s[44:47], s68 offen lds
    v_mfma_f32_32x32x16_bf16 v[144:159], v[52:55], v[44:47], v[144:159]
    s_add_u32 m0, s72, 2048
    s_mov_b32 s68, 19200
    buffer_load_dwordx4 v2, s[44:47], s68 offen lds
    v_mfma_f32_32x32x16_bf16 v[160:175], v[56:59], v[44:47], v[160:175]
    s_add_u32 m0, s72, 3072
    s_mov_b32 s68, 19200
    buffer_load_dwordx4 v3, s[44:47], s68 offen lds
    v_mfma_f32_32x32x16_bf16 v[176:191], v[60:63], v[44:47], v[176:191]
    s_add_u32 m0, s72, 4096
    s_mov_b32 s68, 768
    buffer_load_dwordx4 v4, s[44:47], s68 offen lds
    s_add_u32 m0, s72, 5120
    s_mov_b32 s68, 768
    buffer_load_dwordx4 v5, s[44:47], s68 offen lds
    s_add_u32 m0, s72, 6144
    s_mov_b32 s68, 19200
    buffer_load_dwordx4 v4, s[44:47], s68 offen lds
    s_add_u32 m0, s72, 7168
    s_mov_b32 s68, 19200
    buffer_load_dwordx4 v5, s[44:47], s68 offen lds
    s_barrier
    s_waitcnt lgkmcnt(0)
    v_mfma_f32_32x32x16_bf16 v[64:79], v[24:27], v[16:19], v[64:79]
    ds_read_b128 v[40:43], v9 offset:32768
    ds_read_b128 v[44:47], v9 offset:36864
    ds_read_b64_tr_b16 v[48:49], v12 offset:20480
    v_mfma_f32_32x32x16_bf16 v[80:95], v[28:31], v[16:19], v[80:95]
    ds_read_b64_tr_b16 v[50:51], v12 offset:21504
    ds_read_b64_tr_b16 v[52:53], v13 offset:20480
    ds_read_b64_tr_b16 v[54:55], v13 offset:21504
    s_add_u32 s12, s3, 24576
    buffer_store_dwordx4 v[248:251], v0, s[56:59], s12 offen offset:2048 sc1
    v_mfma_f32_32x32x16_bf16 v[96:111], v[32:35], v[16:19], v[96:111]
    ds_read_b64_tr_b16 v[56:57], v14 offset:20480
    ds_read_b64_tr_b16 v[58:59], v14 offset:21504
    ds_read_b64_tr_b16 v[60:61], v15 offset:20480
    v_mfma_f32_32x32x16_bf16 v[112:127], v[36:39], v[16:19], v[112:127]
    ds_read_b64_tr_b16 v[62:63], v15 offset:21504
    v_mfma_f32_32x32x16_bf16 v[128:143], v[24:27], v[20:23], v[128:143]
    v_mfma_f32_32x32x16_bf16 v[144:159], v[28:31], v[20:23], v[144:159]
    v_mfma_f32_32x32x16_bf16 v[160:175], v[32:35], v[20:23], v[160:175]
    v_mfma_f32_32x32x16_bf16 v[176:191], v[36:39], v[20:23], v[176:191]
    s_waitcnt lgkmcnt(0)
    s_barrier
    v_mfma_f32_32x32x16_bf16 v[64:79], v[48:51], v[40:43], v[64:79]
    ds_read_b128 v[16:19], v10 offset:32768
    ds_read_b128 v[20:23], v10 offset:36864
    ds_read_b64_tr_b16 v[24:25], v12 offset:24576
    v_mfma_f32_32x32x16_bf16 v[80:95], v[52:55], v[40:43], v[80:95]
    ds_read_b64_tr_b16 v[26:27], v12 offset:25600
    ds_read_b64_tr_b16 v[28:29], v13 offset:24576
    ds_read_b64_tr_b16 v[30:31], v13 offset:25600
    s_add_u32 s12, s3, 24576
    buffer_store_dwordx4 v[252:255], v0, s[56:59], s12 offen offset:2560 sc1
    v_mfma_f32_32x32x16_bf16 v[96:111], v[56:59], v[40:43], v[96:111]
    ds_read_b64_tr_b16 v[32:33], v14 offset:24576
    ds_read_b64_tr_b16 v[34:35], v14 offset:25600
    ds_read_b64_tr_b16 v[36:37], v15 offset:24576
    v_mfma_f32_32x32x16_bf16 v[112:127], v[60:63], v[40:43], v[112:127]
    ds_read_b64_tr_b16 v[38:39], v15 offset:25600
    s_add_u32 m0, s73, 16384
    s_add_u32 s68, s71, 3670016
    buffer_load_dwordx4 v6, s[48:51], s68 offen lds
    v_mfma_f32_32x32x16_bf16 v[128:143], v[48:51], v[44:47], v[128:143]
    v_mfma_f32_32x32x16_bf16 v[144:159], v[52:55], v[44:47], v[144:159]
    s_add_u32 m0, s73, 17408
    s_add_u32 s68, s71, 3702784
    buffer_load_dwordx4 v6, s[48:51], s68 offen lds
    v_mfma_f32_32x32x16_bf16 v[160:175], v[56:59], v[44:47], v[160:175]
    v_mfma_f32_32x32x16_bf16 v[176:191], v[60:63], v[44:47], v[176:191]
    s_waitcnt lgkmcnt(0)
    v_mfma_f32_32x32x16_bf16 v[64:79], v[24:27], v[16:19], v[64:79]
    ds_read_b128 v[40:43], v11 offset:32768
    ds_read_b128 v[44:47], v11 offset:36864
    ds_read_b64_tr_b16 v[48:49], v12 offset:28672
    v_mfma_f32_32x32x16_bf16 v[80:95], v[28:31], v[16:19], v[80:95]
    ds_read_b64_tr_b16 v[50:51], v12 offset:29696
    ds_read_b64_tr_b16 v[52:53], v13 offset:28672
    ds_read_b64_tr_b16 v[54:55], v13 offset:29696
    v_mfma_f32_32x32x16_bf16 v[96:111], v[32:35], v[16:19], v[96:111]
    ds_read_b64_tr_b16 v[56:57], v14 offset:28672
    ds_read_b64_tr_b16 v[58:59], v14 offset:29696
    ds_read_b64_tr_b16 v[60:61], v15 offset:28672
    v_mfma_f32_32x32x16_bf16 v[112:127], v[36:39], v[16:19], v[112:127]
    ds_read_b64_tr_b16 v[62:63], v15 offset:29696
    v_mfma_f32_32x32x16_bf16 v[128:143], v[24:27], v[20:23], v[128:143]
    v_mfma_f32_32x32x16_bf16 v[144:159], v[28:31], v[20:23], v[144:159]
    v_mfma_f32_32x32x16_bf16 v[160:175], v[32:35], v[20:23], v[160:175]
    v_mfma_f32_32x32x16_bf16 v[176:191], v[36:39], v[20:23], v[176:191]
    s_waitcnt vmcnt(4) lgkmcnt(0)
    s_barrier
    v_mfma_f32_32x32x16_bf16 v[64:79], v[48:51], v[40:43], v[64:79]
    ds_read_b128 v[16:19], v8 offset:0
    ds_read_b128 v[20:23], v8 offset:4096
    ds_read_b64_tr_b16 v[24:25], v12 offset:0
    s_add_u32 m0, s73, 24576
    s_add_u32 s68, s71, 3932160
    buffer_load_dwordx4 v6, s[48:51], s68 offen lds
    v_mfma_f32_32x32x16_bf16 v[80:95], v[52:55], v[40:43], v[80:95]
    ds_read_b64_tr_b16 v[26:27], v12 offset:1024
    ds_read_b64_tr_b16 v[28:29], v13 offset:0
    ds_read_b64_tr_b16 v[30:31], v13 offset:1024
    s_add_u32 m0, s73, 25600
    s_add_u32 s68, s71, 3964928
    buffer_load_dwordx4 v6, s[48:51], s68 offen lds
    v_mfma_f32_32x32x16_bf16 v[96:111], v[56:59], v[40:43], v[96:111]
    ds_read_b64_tr_b16 v[32:33], v14 offset:0
    ds_read_b64_tr_b16 v[34:35], v14 offset:1024
    ds_read_b64_tr_b16 v[36:37], v15 offset:0
    s_add_u32 m0, s72, 32768
    s_mov_b32 s68, 896
    buffer_load_dwordx4 v2, s[44:47], s68 offen lds
    v_mfma_f32_32x32x16_bf16 v[112:127], v[60:63], v[40:43], v[112:127]
    ds_read_b64_tr_b16 v[38:39], v15 offset:1024
    s_add_u32 m0, s72, 33792
    s_mov_b32 s68, 896
    buffer_load_dwordx4 v3, s[44:47], s68 offen lds
    v_mfma_f32_32x32x16_bf16 v[128:143], v[48:51], v[44:47], v[128:143]
    s_add_u32 m0, s72, 34816
    s_mov_b32 s68, 19328
    buffer_load_dwordx4 v2, s[44:47], s68 offen lds
    v_mfma_f32_32x32x16_bf16 v[144:159], v[52:55], v[44:47], v[144:159]
    s_add_u32 m0, s72, 35840
    s_mov_b32 s68, 19328
    buffer_load_dwordx4 v3, s[44:47], s68 offen lds
    v_mfma_f32_32x32x16_bf16 v[160:175], v[56:59], v[44:47], v[160:175]
    v_mfma_f32_32x32x16_bf16 v[176:191], v[60:63], v[44:47], v[176:191]
    s_add_u32 m0, s72, 36864
    s_mov_b32 s68, 896
    buffer_load_dwordx4 v4, s[44:47], s68 offen lds
    s_add_u32 m0, s72, 37888
    s_mov_b32 s68, 896
    buffer_load_dwordx4 v5, s[44:47], s68 offen lds
    s_add_u32 m0, s72, 38912
    s_mov_b32 s68, 19328
    buffer_load_dwordx4 v4, s[44:47], s68 offen lds
    s_add_u32 m0, s72, 39936
    s_mov_b32 s68, 19328
    buffer_load_dwordx4 v5, s[44:47], s68 offen lds
    s_barrier
    s_waitcnt lgkmcnt(0)
    v_mfma_f32_32x32x16_bf16 v[64:79], v[24:27], v[16:19], v[64:79]
    ds_read_b128 v[40:43], v9 offset:0
    ds_read_b128 v[44:47], v9 offset:4096
    ds_read_b64_tr_b16 v[48:49], v12 offset:4096
    v_mfma_f32_32x32x16_bf16 v[80:95], v[28:31], v[16:19], v[80:95]
    ds_read_b64_tr_b16 v[50:51], v12 offset:5120
    ds_read_b64_tr_b16 v[52:53], v13 offset:4096
    ds_read_b64_tr_b16 v[54:55], v13 offset:5120
    v_mfma_f32_32x32x16_bf16 v[96:111], v[32:35], v[16:19], v[96:111]
    ds_read_b64_tr_b16 v[56:57], v14 offset:4096
    ds_read_b64_tr_b16 v[58:59], v14 offset:5120
    ds_read_b64_tr_b16 v[60:61], v15 offset:4096
    v_mfma_f32_32x32x16_bf16 v[112:127], v[36:39], v[16:19], v[112:127]
    ds_read_b64_tr_b16 v[62:63], v15 offset:5120
    v_mfma_f32_32x32x16_bf16 v[128:143], v[24:27], v[20:23], v[128:143]
    v_mfma_f32_32x32x16_bf16 v[144:159], v[28:31], v[20:23], v[144:159]
    v_mfma_f32_32x32x16_bf16 v[160:175], v[32:35], v[20:23], v[160:175]
    v_mfma_f32_32x32x16_bf16 v[176:191], v[36:39], v[20:23], v[176:191]
    s_waitcnt lgkmcnt(0)
    s_barrier
    v_mfma_f32_32x32x16_bf16 v[64:79], v[48:51], v[40:43], v[64:79]
    ds_read_b128 v[16:19], v10 offset:0
    ds_read_b128 v[20:23], v10 offset:4096
    ds_read_b64_tr_b16 v[24:25], v12 offset:8192
    v_mfma_f32_32x32x16_bf16 v[80:95], v[52:55], v[40:43], v[80:95]
    ds_read_b64_tr_b16 v[26:27], v12 offset:9216
    ds_read_b64_tr_b16 v[28:29], v13 offset:8192
    ds_read_b64_tr_b16 v[30:31], v13 offset:9216
    s_add_u32 m0, s73, 0
    s_add_u32 s68, s71, 4194304
    buffer_load_dwordx4 v6, s[48:51], s68 offen lds
    v_mfma_f32_32x32x16_bf16 v[96:111], v[56:59], v[40:43], v[96:111]
    ds_read_b64_tr_b16 v[32:33], v14 offset:8192
    ds_read_b64_tr_b16 v[34:35], v14 offset:9216
    ds_read_b64_tr_b16 v[36:37], v15 offset:8192
    v_mfma_f32_32x32x16_bf16 v[112:127], v[60:63], v[40:43], v[112:127]
    ds_read_b64_tr_b16 v[38:39], v15 offset:9216
    s_add_u32 m0, s73, 1024
    s_add_u32 s68, s71, 4227072
    buffer_load_dwordx4 v6, s[48:51], s68 offen lds
    v_mfma_f32_32x32x16_bf16 v[128:143], v[48:51], v[44:47], v[128:143]
    v_mfma_f32_32x32x16_bf16 v[144:159], v[52:55], v[44:47], v[144:159]
    v_mfma_f32_32x32x16_bf16 v[160:175], v[56:59], v[44:47], v[160:175]
    v_mfma_f32_32x32x16_bf16 v[176:191], v[60:63], v[44:47], v[176:191]
    s_waitcnt lgkmcnt(0)
    v_mfma_f32_32x32x16_bf16 v[64:79], v[24:27], v[16:19], v[64:79]
    ds_read_b128 v[40:43], v11 offset:0
    ds_read_b128 v[44:47], v11 offset:4096
    ds_read_b64_tr_b16 v[48:49], v12 offset:12288
    v_mfma_f32_32x32x16_bf16 v[80:95], v[28:31], v[16:19], v[80:95]
    ds_read_b64_tr_b16 v[50:51], v12 offset:13312
    ds_read_b64_tr_b16 v[52:53], v13 offset:12288
    ds_read_b64_tr_b16 v[54:55], v13 offset:13312
    v_mfma_f32_32x32x16_bf16 v[96:111], v[32:35], v[16:19], v[96:111]
    ds_read_b64_tr_b16 v[56:57], v14 offset:12288
    ds_read_b64_tr_b16 v[58:59], v14 offset:13312
    ds_read_b64_tr_b16 v[60:61], v15 offset:12288
    v_mfma_f32_32x32x16_bf16 v[112:127], v[36:39], v[16:19], v[112:127]
    ds_read_b64_tr_b16 v[62:63], v15 offset:13312
    v_mfma_f32_32x32x16_bf16 v[128:143], v[24:27], v[20:23], v[128:143]
    v_mfma_f32_32x32x16_bf16 v[144:159], v[28:31], v[20:23], v[144:159]
    v_mfma_f32_32x32x16_bf16 v[160:175], v[32:35], v[20:23], v[160:175]
    v_mfma_f32_32x32x16_bf16 v[176:191], v[36:39], v[20:23], v[176:191]
    s_waitcnt vmcnt(2) lgkmcnt(0)
    s_barrier
    s_and_b32 s9, s2, 31
    s_lshl_b32 s9, s9, 7
    s_lshr_b32 s10, s2, 5
    s_lshl_b32 s10, s10, 3
    s_add_u32 s10, s10, s9
    s_cmp_lg_u32 s64, 4
    s_cbranch_scc1 SY_62
    s_memrealtime s[12:13]
    v_mov_b32 v242, s10
    s_mov_b32 s8, 62914560
    s_waitcnt lgkmcnt(0)
    v_mov_b32 v240, s12
    v_mov_b32 v241, s13
    s_mov_b64 exec, 1
    buffer_store_dwordx2 v[240:241], v242, s[56:59], s8 offen sc1
    s_mov_b64 exec, -1
SY_62:
    v_mfma_f32_32x32x16_bf16 v[64:79], v[48:51], v[40:43], v[64:79]
    ds_read_b128 v[16:19], v8 offset:32768
    ds_read_b128 v[20:23], v8 offset:36864
    ds_read_b64_tr_b16 v[24:25], v12 offset:16384
    s_add_u32 m0, s73, 8192
    s_add_u32 s68, s71, 4456448
    buffer_load_dwordx4 v6, s[48:51], s68 offen lds
    v_mfma_f32_32x32x16_bf16 v[80:95], v[52:55], v[40:43], v[80:95]
    ds_read_b64_tr_b16 v[26:27], v12 offset:17408
    ds_read_b64_tr_b16 v[28:29], v13 offset:16384
    ds_read_b64_tr_b16 v[30:31], v13 offset:17408
    s_add_u32 m0, s73, 9216
    s_add_u32 s68, s71, 4489216
    buffer_load_dwordx4 v6, s[48:51], s68 offen lds
    v_mfma_f32_32x32x16_bf16 v[96:111], v[56:59], v[40:43], v[96:111]
    ds_read_b64_tr_b16 v[32:33], v14 offset:16384
    ds_read_b64_tr_b16 v[34:35], v14 offset:17408
    ds_read_b64_tr_b16 v[36:37], v15 offset:16384
    s_add_u32 m0, s72, 0
    s_mov_b32 s68, 1024
    buffer_load_dwordx4 v2, s[44:47], s68 offen lds
    v_mfma_f32_32x32x16_bf16 v[112:127], v[60:63], v[40:43], v[112:127]
    ds_read_b64_tr_b16 v[38:39], v15 offset:17408
    s_add_u32 m0, s72, 1024
    s_mov_b32 s68, 1024
    buffer_load_dwordx4 v3, s[44:47], s68 offen lds
    v_mfma_f32_32x32x16_bf16 v[128:143], v[48:51], v[44:47], v[128:143]
    s_add_u32 m0, s72, 2048
    s_mov_b32 s68, 19456
    buffer_load_dwordx4 v2, s[44:47], s68 offen lds
    v_mfma_f32_32x32x16_bf16 v[144:159], v[52:55], v[44:47], v[144:159]
    s_add_u32 m0, s72, 3072
    s_mov_b32 s68, 19456
    buffer_load_dwordx4 v3, s[44:47], s68 offen lds
    v_mfma_f32_32x32x16_bf16 v[160:175], v[56:59], v[44:47], v[160:175]
    v_mfma_f32_32x32x16_bf16 v[176:191], v[60:63], v[44:47], v[176:191]
    s_add_u32 m0, s72, 4096
    s_mov_b32 s68, 1024
    buffer_load_dwordx4 v4, s[44:47], s68 offen lds
    s_add_u32 m0, s72, 5120
    s_mov_b32 s68, 1024
    buffer_load_dwordx4 v5, s[44:47], s68 offen lds
    s_add_u32 m0, s72, 6144
    s_mov_b32 s68, 19456
    buffer_load_dwordx4 v4, s[44:47], s68 offen lds
    s_add_u32 m0, s72, 7168
    s_mov_b32 s68, 19456
    buffer_load_dwordx4 v5, s[44:47], s68 offen lds
    s_barrier
    s_waitcnt lgkmcnt(0)
    v_mfma_f32_32x32x16_bf16 v[64:79], v[24:27], v[16:19], v[64:79]
    ds_read_b128 v[40:43], v9 offset:32768
    ds_read_b128 v[44:47], v9 offset:36864
    ds_read_b64_tr_b16 v[48:49], v12 offset:20480
    v_mfma_f32_32x32x16_bf16 v[80:95], v[28:31], v[16:19], v[80:95]
    ds_read_b64_tr_b16 v[50:51], v12 offset:21504
    ds_read_b64_tr_b16 v[52:53], v13 offset:20480
    ds_read_b64_tr_b16 v[54:55], v13 offset:21504
    v_mfma_f32_32x32x16_bf16 v[96:111], v[32:35], v[16:19], v[96:111]
    ds_read_b64_tr_b16 v[56:57], v14 offset:20480
    ds_read_b64_tr_b16 v[58:59], v14 offset:21504
    ds_read_b64_tr_b16 v[60:61], v15 offset:20480
    v_mfma_f32_32x32x16_bf16 v[112:127], v[36:39], v[16:19], v[112:127]
    ds_read_b64_tr_b16 v[62:63], v15 offset:21504
    v_mfma_f32_32x32x16_bf16 v[128:143], v[24:27], v[20:23], v[128:143]
    v_mfma_f32_32x32x16_bf16 v[144:159], v[28:31], v[20:23], v[144:159]
    v_mfma_f32_32x32x16_bf16 v[160:175], v[32:35], v[20:23], v[160:175]
    v_mfma_f32_32x32x16_bf16 v[176:191], v[36:39], v[20:23], v[176:191]
    s_waitcnt lgkmcnt(0)
    s_barrier
    v_mfma_f32_32x32x16_bf16 v[64:79], v[48:51], v[40:43], v[64:79]
    ds_read_b128 v[16:19], v10 offset:32768
    ds_read_b128 v[20:23], v10 offset:36864
    ds_read_b64_tr_b16 v[24:25], v12 offset:24576
    v_mfma_f32_32x32x16_bf16 v[80:95], v[52:55], v[40:43], v[80:95]
    ds_read_b64_tr_b16 v[26:27], v12 offset:25600
    ds_read_b64_tr_b16 v[28:29], v13 offset:24576
    ds_read_b64_tr_b16 v[30:31], v13 offset:25600
    v_mfma_f32_32x32x16_bf16 v[96:111], v[56:59], v[40:43], v[96:111]
    ds_read_b64_tr_b16 v[32:33], v14 offset:24576
    ds_read_b64_tr_b16 v[34:35], v14 offset:25600
    ds_read_b64_tr_b16 v[36:37], v15 offset:24576
    v_mfma_f32_32x32x16_bf16 v[112:127], v[60:63], v[40:43], v[112:127]
    ds_read_b64_tr_b16 v[38:39], v15 offset:25600
    v_mfma_f32_32x32x16_bf16 v[128:143], v[48:51], v[44:47], v[128:143]
    v_mfma_f32_32x32x16_bf16 v[144:159], v[52:55], v[44:47], v[144:159]
    v_mfma_f32_32x32x16_bf16 v[160:175], v[56:59], v[44:47], v[160:175]
    v_mfma_f32_32x32x16_bf16 v[176:191], v[60:63], v[44:47], v[176:191]
    s_waitcnt lgkmcnt(0)
    v_mfma_f32_32x32x16_bf16 v[64:79], v[24:27], v[16:19], v[64:79]
    ds_read_b128 v[40:43], v11 offset:32768
    ds_read_b128 v[44:47], v11 offset:36864
    ds_read_b64_tr_b16 v[48:49], v12 offset:28672
    v_mfma_f32_32x32x16_bf16 v[80:95], v[28:31], v[16:19], v[80:95]
    ds_read_b64_tr_b16 v[50:51], v12 offset:29696
    ds_read_b64_tr_b16 v[52:53], v13 offset:28672
    ds_read_b64_tr_b16 v[54:55], v13 offset:29696
    v_mfma_f32_32x32x16_bf16 v[96:111], v[32:35], v[16:19], v[96:111]
    ds_read_b64_tr_b16 v[56:57], v14 offset:28672
    ds_read_b64_tr_b16 v[58:59], v14 offset:29696
    ds_read_b64_tr_b16 v[60:61], v15 offset:28672
    v_mfma_f32_32x32x16_bf16 v[112:127], v[36:39], v[16:19], v[112:127]
    ds_read_b64_tr_b16 v[62:63], v15 offset:29696
    v_mfma_f32_32x32x16_bf16 v[128:143], v[24:27], v[20:23], v[128:143]
    v_mfma_f32_32x32x16_bf16 v[144:159], v[28:31], v[20:23], v[144:159]
    v_mfma_f32_32x32x16_bf16 v[160:175], v[32:35], v[20:23], v[160:175]
    v_mfma_f32_32x32x16_bf16 v[176:191], v[36:39], v[20:23], v[176:191]
    s_waitcnt vmcnt(0) lgkmcnt(0)
    s_barrier
    v_mfma_f32_32x32x16_bf16 v[64:79], v[48:51], v[40:43], v[64:79]
    ds_read_b128 v[16:19], v8 offset:0
    ds_read_b128 v[20:23], v8 offset:4096
    ds_read_b64_tr_b16 v[24:25], v12 offset:0
    v_mfma_f32_32x32x16_bf16 v[80:95], v[52:55], v[40:43], v[80:95]
    ds_read_b64_tr_b16 v[26:27], v12 offset:1024
    ds_read_b64_tr_b16 v[28:29], v13 offset:0
    ds_read_b64_tr_b16 v[30:31], v13 offset:1024
    v_mfma_f32_32x32x16_bf16 v[96:111], v[56:59], v[40:43], v[96:111]
    ds_read_b64_tr_b16 v[32:33], v14 offset:0
    ds_read_b64_tr_b16 v[34:35], v14 offset:1024
    ds_read_b64_tr_b16 v[36:37], v15 offset:0
    v_mfma_f32_32x32x16_bf16 v[112:127], v[60:63], v[40:43], v[112:127]
    ds_read_b64_tr_b16 v[38:39], v15 offset:1024
    v_mfma_f32_32x32x16_bf16 v[128:143], v[48:51], v[44:47], v[128:143]
    v_mfma_f32_32x32x16_bf16 v[144:159], v[52:55], v[44:47], v[144:159]
    v_mfma_f32_32x32x16_bf16 v[160:175], v[56:59], v[44:47], v[160:175]
    v_mfma_f32_32x32x16_bf16 v[176:191], v[60:63], v[44:47], v[176:191]
    s_barrier
    s_waitcnt lgkmcnt(0)
    v_mfma_f32_32x32x16_bf16 v[64:79], v[24:27], v[16:19], v[64:79]
    ds_read_b128 v[40:43], v9 offset:0
    ds_read_b128 v[44:47], v9 offset:4096
    ds_read_b64_tr_b16 v[48:49], v12 offset:4096
    v_mfma_f32_32x32x16_bf16 v[80:95], v[28:31], v[16:19], v[80:95]
    ds_read_b64_tr_b16 v[50:51], v12 offset:5120
    ds_read_b64_tr_b16 v[52:53], v13 offset:4096
    ds_read_b64_tr_b16 v[54:55], v13 offset:5120
    v_mfma_f32_32x32x16_bf16 v[96:111], v[32:35], v[16:19], v[96:111]
    ds_read_b64_tr_b16 v[56:57], v14 offset:4096
    ds_read_b64_tr_b16 v[58:59], v14 offset:5120
    ds_read_b64_tr_b16 v[60:61], v15 offset:4096
    v_mfma_f32_32x32x16_bf16 v[112:127], v[36:39], v[16:19], v[112:127]
    ds_read_b64_tr_b16 v[62:63], v15 offset:5120
    v_mfma_f32_32x32x16_bf16 v[128:143], v[24:27], v[20:23], v[128:143]
    v_mfma_f32_32x32x16_bf16 v[144:159], v[28:31], v[20:23], v[144:159]
    v_mfma_f32_32x32x16_bf16 v[160:175], v[32:35], v[20:23], v[160:175]
    v_mfma_f32_32x32x16_bf16 v[176:191], v[36:39], v[20:23], v[176:191]
    s_waitcnt lgkmcnt(0)
    s_barrier
    v_mfma_f32_32x32x16_bf16 v[64:79], v[48:51], v[40:43], v[64:79]
    ds_read_b128 v[16:19], v10 offset:0
    ds_read_b128 v[20:23], v10 offset:4096
    ds_read_b64_tr_b16 v[24:25], v12 offset:8192
    v_mfma_f32_32x32x16_bf16 v[80:95], v[52:55], v[40:43], v[80:95]
    ds_read_b64_tr_b16 v[26:27], v12 offset:9216
    ds_read_b64_tr_b16 v[28:29], v13 offset:8192
    ds_read_b64_tr_b16 v[30:31], v13 offset:9216
    v_mfma_f32_32x32x16_bf16 v[96:111], v[56:59], v[40:43], v[96:111]
    ds_read_b64_tr_b16 v[32:33], v14 offset:8192
    ds_read_b64_tr_b16 v[34:35], v14 offset:9216
    ds_read_b64_tr_b16 v[36:37], v15 offset:8192
    v_mfma_f32_32x32x16_bf16 v[112:127], v[60:63], v[40:43], v[112:127]
    ds_read_b64_tr_b16 v[38:39], v15 offset:9216
    v_mfma_f32_32x32x16_bf16 v[128:143], v[48:51], v[44:47], v[128:143]
    v_mfma_f32_32x32x16_bf16 v[144:159], v[52:55], v[44:47], v[144:159]
    v_mfma_f32_32x32x16_bf16 v[160:175], v[56:59], v[44:47], v[160:175]
    v_mfma_f32_32x32x16_bf16 v[176:191], v[60:63], v[44:47], v[176:191]
    s_waitcnt lgkmcnt(0)
    v_mfma_f32_32x32x16_bf16 v[64:79], v[24:27], v[16:19], v[64:79]
    ds_read_b128 v[40:43], v11 offset:0
    ds_read_b128 v[44:47], v11 offset:4096
    ds_read_b64_tr_b16 v[48:49], v12 offset:12288
    v_mfma_f32_32x32x16_bf16 v[80:95], v[28:31], v[16:19], v[80:95]
    ds_read_b64_tr_b16 v[50:51], v12 offset:13312
    ds_read_b64_tr_b16 v[52:53], v13 offset:12288
    ds_read_b64_tr_b16 v[54:55], v13 offset:13312
    v_mfma_f32_32x32x16_bf16 v[96:111], v[32:35], v[16:19], v[96:111]
    ds_read_b64_tr_b16 v[56:57], v14 offset:12288
    ds_read_b64_tr_b16 v[58:59], v14 offset:13312
    ds_read_b64_tr_b16 v[60:61], v15 offset:12288
    v_mfma_f32_32x32x16_bf16 v[112:127], v[36:39], v[16:19], v[112:127]
    ds_read_b64_tr_b16 v[62:63], v15 offset:13312
    v_mfma_f32_32x32x16_bf16 v[128:143], v[24:27], v[20:23], v[128:143]
    v_mfma_f32_32x32x16_bf16 v[144:159], v[28:31], v[20:23], v[144:159]
    v_mfma_f32_32x32x16_bf16 v[160:175], v[32:35], v[20:23], v[160:175]
    v_mfma_f32_32x32x16_bf16 v[176:191], v[36:39], v[20:23], v[176:191]
    s_waitcnt lgkmcnt(0)
    s_barrier
    v_mfma_f32_32x32x16_bf16 v[64:79], v[48:51], v[40:43], v[64:79]
    v_mfma_f32_32x32x16_bf16 v[80:95], v[52:55], v[40:43], v[80:95]
    v_mfma_f32_32x32x16_bf16 v[96:111], v[56:59], v[40:43], v[96:111]
    v_mfma_f32_32x32x16_bf16 v[112:127], v[60:63], v[40:43], v[112:127]
    v_mfma_f32_32x32x16_bf16 v[128:143], v[48:51], v[44:47], v[128:143]
    v_mfma_f32_32x32x16_bf16 v[144:159], v[52:55], v[44:47], v[144:159]
    v_mfma_f32_32x32x16_bf16 v[160:175], v[56:59], v[44:47], v[160:175]
    v_mfma_f32_32x32x16_bf16 v[176:191], v[60:63], v[44:47], v[176:191]
    s_mov_b32 s68, 0x3e0293ee
    s_nop 7
    s_nop 7
    v_mul_f32 v64, s68, v64
    v_mul_f32 v65, s68, v65
    v_mul_f32 v66, s68, v66
    v_mul_f32 v67, s68, v67
    v_mul_f32 v68, s68, v68
    v_mul_f32 v69, s68, v69
    v_mul_f32 v70, s68, v70
    v_mul_f32 v71, s68, v71
    v_mul_f32 v72, s68, v72
    v_mul_f32 v73, s68, v73
    v_mul_f32 v74, s68, v74
    v_mul_f32 v75, s68, v75
    v_mul_f32 v76, s68, v76
    v_mul_f32 v77, s68, v77
    v_mul_f32 v78, s68, v78
    v_mul_f32 v79, s68, v79
    v_mul_f32 v80, s68, v80
    v_mul_f32 v81, s68, v81
    v_mul_f32 v82, s68, v82
    v_mul_f32 v83, s68, v83
    v_mul_f32 v84, s68, v84
    v_mul_f32 v85, s68, v85
    v_mul_f32 v86, s68, v86
    v_mul_f32 v87, s68, v87
    v_mul_f32 v88, s68, v88
    v_mul_f32 v89, s68, v89
    v_mul_f32 v90, s68, v90
    v_mul_f32 v91, s68, v91
    v_mul_f32 v92, s68, v92
    v_mul_f32 v93, s68, v93
    v_mul_f32 v94, s68, v94
    v_mul_f32 v95, s68, v95
    v_mul_f32 v96, s68, v96
    v_mul_f32 v97, s68, v97
    v_mul_f32 v98, s68, v98
    v_mul_f32 v99, s68, v99
    v_mul_f32 v100, s68, v100
    v_mul_f32 v101, s68, v101
    v_mul_f32 v102, s68, v102
    v_mul_f32 v103, s68, v103
    v_mul_f32 v104, s68, v104
    v_mul_f32 v105, s68, v105
    v_mul_f32 v106, s68, v106
    v_mul_f32 v107, s68, v107
    v_mul_f32 v108, s68, v108
    v_mul_f32 v109, s68, v109
    v_mul_f32 v110, s68, v110
    v_mul_f32 v111, s68, v111
    v_mul_f32 v112, s68, v112
    v_mul_f32 v113, s68, v113
    v_mul_f32 v114, s68, v114
    v_mul_f32 v115, s68, v115
    v_mul_f32 v116, s68, v116
    v_mul_f32 v117, s68, v117
    v_mul_f32 v118, s68, v118
    v_mul_f32 v119, s68, v119
    v_mul_f32 v120, s68, v120
    v_mul_f32 v121, s68, v121
    v_mul_f32 v122, s68, v122
    v_mul_f32 v123, s68, v123
    v_mul_f32 v124, s68, v124
    v_mul_f32 v125, s68, v125
    v_mul_f32 v126, s68, v126
    v_mul_f32 v127, s68, v127
    v_cvt_pk_bf16_f32 v16, v64, v65
    v_cvt_pk_bf16_f32 v17, v66, v67
    v_cvt_pk_bf16_f32 v20, v68, v69
    v_cvt_pk_bf16_f32 v21, v70, v71
    v_cvt_pk_bf16_f32 v18, v72, v73
    v_cvt_pk_bf16_f32 v19, v74, v75
    v_cvt_pk_bf16_f32 v22, v76, v77
    v_cvt_pk_bf16_f32 v23, v78, v79
    v_cvt_pk_bf16_f32 v24, v80, v81
    v_cvt_pk_bf16_f32 v25, v82, v83
    v_cvt_pk_bf16_f32 v28, v84, v85
    v_cvt_pk_bf16_f32 v29, v86, v87
    v_cvt_pk_bf16_f32 v26, v88, v89
    v_cvt_pk_bf16_f32 v27, v90, v91
    v_cvt_pk_bf16_f32 v30, v92, v93
    v_cvt_pk_bf16_f32 v31, v94, v95
    v_cvt_pk_bf16_f32 v32, v96, v97
    v_cvt_pk_bf16_f32 v33, v98, v99
    v_cvt_pk_bf16_f32 v36, v100, v101
    v_cvt_pk_bf16_f32 v37, v102, v103
    v_cvt_pk_bf16_f32 v34, v104, v105
    v_cvt_pk_bf16_f32 v35, v106, v107
    v_cvt_pk_bf16_f32 v38, v108, v109
    v_cvt_pk_bf16_f32 v39, v110, v111
    v_cvt_pk_bf16_f32 v40, v112, v113
    v_cvt_pk_bf16_f32 v41, v114, v115
    v_cvt_pk_bf16_f32 v44, v116, v117
    v_cvt_pk_bf16_f32 v45, v118, v119
    v_cvt_pk_bf16_f32 v42, v120, v121
    v_cvt_pk_bf16_f32 v43, v122, v123
    v_cvt_pk_bf16_f32 v46, v124, v125
    v_cvt_pk_bf16_f32 v47, v126, v127
    s_lshl_b32 s69, s74, 13
    s_add_u32 s69, s69, 65536
    v_add_u32 v6, s69, v0
    ds_write_b128 v6, v[16:19] offset:0
    ds_write_b128 v6, v[20:23] offset:512
    ds_write_b128 v6, v[24:27] offset:2048
    ds_write_b128 v6, v[28:31] offset:2560
    ds_write_b128 v6, v[32:35] offset:4096
    ds_write_b128 v6, v[36:39] offset:4608
    ds_write_b128 v6, v[40:43] offset:6144
    ds_write_b128 v6, v[44:47] offset:6656
    s_waitcnt lgkmcnt(0)
    s_barrier
    v_mul_f32 v128, s68, v128
    v_mul_f32 v129, s68, v129
    v_mul_f32 v130, s68, v130
    v_mul_f32 v131, s68, v131
    v_mul_f32 v132, s68, v132
    v_mul_f32 v133, s68, v133
    v_mul_f32 v134, s68, v134
    v_mul_f32 v135, s68, v135
    v_mul_f32 v136, s68, v136
    v_mul_f32 v137, s68, v137
    v_mul_f32 v138, s68, v138
    v_mul_f32 v139, s68, v139
    v_mul_f32 v140, s68, v140
    v_mul_f32 v141, s68, v141
    v_mul_f32 v142, s68, v142
    v_mul_f32 v143, s68, v143
    v_mul_f32 v144, s68, v144
    v_mul_f32 v145, s68, v145
    v_mul_f32 v146, s68, v146
    v_mul_f32 v147, s68, v147
    v_mul_f32 v148, s68, v148
    v_mul_f32 v149, s68, v149
    v_mul_f32 v150, s68, v150
    v_mul_f32 v151, s68, v151
    v_mul_f32 v152, s68, v152
    v_mul_f32 v153, s68, v153
    v_mul_f32 v154, s68, v154
    v_mul_f32 v155, s68, v155
    v_mul_f32 v156, s68, v156
    v_mul_f32 v157, s68, v157
    v_mul_f32 v158, s68, v158
    v_mul_f32 v159, s68, v159
    v_mul_f32 v160, s68, v160
    v_mul_f32 v161, s68, v161
    v_mul_f32 v162, s68, v162
    v_mul_f32 v163, s68, v163
    v_mul_f32 v164, s68, v164
    v_mul_f32 v165, s68, v165
    v_mul_f32 v166, s68, v166
    v_mul_f32 v167, s68, v167
    v_mul_f32 v168, s68, v168
    v_mul_f32 v169, s68, v169
    v_mul_f32 v170, s68, v170
    v_mul_f32 v171, s68, v171
    v_mul_f32 v172, s68, v172
    v_mul_f32 v173, s68, v173
    v_mul_f32 v174, s68, v174
    v_mul_f32 v175, s68, v175
    v_mul_f32 v176, s68, v176
    v_mul_f32 v177, s68, v177
    v_mul_f32 v178, s68, v178
    v_mul_f32 v179, s68, v179
    v_mul_f32 v180, s68, v180
    v_mul_f32 v181, s68, v181
    v_mul_f32 v182, s68, v182
    v_mul_f32 v183, s68, v183
    v_mul_f32 v184, s68, v184
    v_mul_f32 v185, s68, v185
    v_mul_f32 v186, s68, v186
    v_mul_f32 v187, s68, v187
    v_mul_f32 v188, s68, v188
    v_mul_f32 v189, s68, v189
    v_mul_f32 v190, s68, v190
    v_mul_f32 v191, s68, v191
    v_cvt_pk_bf16_f32 v16, v128, v129
    v_cvt_pk_bf16_f32 v17, v130, v131
    v_cvt_pk_bf16_f32 v20, v132, v133
    v_cvt_pk_bf16_f32 v21, v134, v135
    v_cvt_pk_bf16_f32 v18, v136, v137
    v_cvt_pk_bf16_f32 v19, v138, v139
    v_cvt_pk_bf16_f32 v22, v140, v141
    v_cvt_pk_bf16_f32 v23, v142, v143
    v_cvt_pk_bf16_f32 v24, v144, v145
    v_cvt_pk_bf16_f32 v25, v146, v147
    v_cvt_pk_bf16_f32 v28, v148, v149
    v_cvt_pk_bf16_f32 v29, v150, v151
    v_cvt_pk_bf16_f32 v26, v152, v153
    v_cvt_pk_bf16_f32 v27, v154, v155
    v_cvt_pk_bf16_f32 v30, v156, v157
    v_cvt_pk_bf16_f32 v31, v158, v159
    v_cvt_pk_bf16_f32 v32, v160, v161
    v_cvt_pk_bf16_f32 v33, v162, v163
    v_cvt_pk_bf16_f32 v36, v164, v165
    v_cvt_pk_bf16_f32 v37, v166, v167
    v_cvt_pk_bf16_f32 v34, v168, v169
    v_cvt_pk_bf16_f32 v35, v170, v171
    v_cvt_pk_bf16_f32 v38, v172, v173
    v_cvt_pk_bf16_f32 v39, v174, v175
    v_cvt_pk_bf16_f32 v40, v176, v177
    v_cvt_pk_bf16_f32 v41, v178, v179
    v_cvt_pk_bf16_f32 v44, v180, v181
    v_cvt_pk_bf16_f32 v45, v182, v183
    v_cvt_pk_bf16_f32 v42, v184, v185
    v_cvt_pk_bf16_f32 v43, v186, v187
    v_cvt_pk_bf16_f32 v46, v188, v189
    v_cvt_pk_bf16_f32 v47, v190, v191
    s_lshl_b32 s69, s74, 13
    v_add_u32 v6, s69, v0
    ds_write_b128 v6, v[16:19] offset:0
    ds_write_b128 v6, v[20:23] offset:512
    ds_write_b128 v6, v[24:27] offset:2048
    ds_write_b128 v6, v[28:31] offset:2560
    ds_write_b128 v6, v[32:35] offset:4096
    ds_write_b128 v6, v[36:39] offset:4608
    ds_write_b128 v6, v[40:43] offset:6144
    ds_write_b128 v6, v[44:47] offset:6656
    s_waitcnt lgkmcnt(0)
    v_add_u32 v6, s69, v7
    ds_read_b128 v[16:19], v6 offset:0
    ds_read_b128 v[20:23], v6 offset:1024
    ds_read_b128 v[24:27], v6 offset:2048
    ds_read_b128 v[28:31], v6 offset:3072
    ds_read_b128 v[32:35], v6 offset:4096
    ds_read_b128 v[36:39], v6 offset:5120
    ds_read_b128 v[40:43], v6 offset:6144
    ds_read_b128 v[44:47], v6 offset:7168
    s_waitcnt lgkmcnt(0)
    s_barrier
    s_cmp_lg_u32 s64, 4
    s_cbranch_scc1 SY_63
    v_lshlrev_b32 v242, 3, v1
    v_add_u32 v242, s9, v242
    s_mov_b32 s8, 62914560
    s_mov_b32 s10, 0
FW_64:
    buffer_load_dwordx2 v[240:241], v242, s[56:59], s8 offen offset:0 sc1
    s_waitcnt vmcnt(0)
FW_66:
    s_memrealtime s[12:13]
    s_waitcnt lgkmcnt(0)
    s_add_u32 s12, s12, 200
    s_addc_u32 s13, s13, 0
    s_mov_b64 exec, 0xff
    v_cmp_gt_u64 vcc, s[14:15], v[240:241]
    s_cbranch_vccnz FW_67
    v_cmp_lt_u64 vcc, s[12:13], v[240:241]
    s_cbranch_vccnz FW_67
    s_branch FW_65
FW_67:
    s_mov_b64 exec, -1
    s_sleep 2
    s_and_b32 s12, s10, 31
    s_cmp_lg_u32 s12, 31
    s_cbranch_scc1 EP_68
    v_mov_b32 v240, 248
    buffer_load_dwordx2 v[240:241], v240, s[4:7], 0 offen sc1
    s_waitcnt vmcnt(0)
    v_readfirstlane_b32 s12, v240
    v_readfirstlane_b32 s13, v241
    s_nop 3
    s_not_b64 s[14:15], s[12:13]
EP_68:
    s_add_u32 s10, s10, 1
    s_cmp_lt_u32 s10, 0x80000
    s_cbranch_scc1 FW_64
FW_65:
    s_mov_b64 exec, -1
SY_63:
    s_barrier
    s_and_b32 s69, s64, 3
    s_lshl_b32 s69, s69, 12
    s_and_b32 s70, s2, 31
    s_lshl_b32 s70, s70, 19
    s_add_u32 s70, s70, s69
    s_add_u32 m0, s69, 0
    s_add_u32 s68, s70, 0
    buffer_load_dwordx4 v7, s[56:59], s68 offen offset:0 lds
    buffer_load_dwordx4 v7, s[56:59], s68 offen offset:1024 lds
    buffer_load_dwordx4 v7, s[56:59], s68 offen offset:2048 lds
    buffer_load_dwordx4 v7, s[56:59], s68 offen offset:3072 lds
    s_add_u32 m0, s69, 16384
    s_add_u32 s68, s70, 16777216
    buffer_load_dwordx4 v7, s[56:59], s68 offen offset:0 lds
    buffer_load_dwordx4 v7, s[56:59], s68 offen offset:1024 lds
    buffer_load_dwordx4 v7, s[56:59], s68 offen offset:2048 lds
    buffer_load_dwordx4 v7, s[56:59], s68 offen offset:3072 lds
    s_add_u32 m0, s69, 32768
    s_add_u32 s68, s70, 16384
    buffer_load_dwordx4 v7, s[56:59], s68 offen offset:0 lds
    buffer_load_dwordx4 v7, s[56:59], s68 offen offset:1024 lds
    buffer_load_dwordx4 v7, s[56:59], s68 offen offset:2048 lds
    buffer_load_dwordx4 v7, s[56:59], s68 offen offset:3072 lds
    s_add_u32 m0, s69, 49152
    s_add_u32 s68, s70, 16777216
    buffer_load_dwordx4 v7, s[56:59], s68 offen offset:0 lds
    buffer_load_dwordx4 v7, s[56:59], s68 offen offset:1024 lds
    buffer_load_dwordx4 v7, s[56:59], s68 offen offset:2048 lds
    buffer_load_dwordx4 v7, s[56:59], s68 offen offset:3072 lds
    s_barrier
    s_barrier
    s_barrier
P2J_38:
    s_and_b32 s66, s2, 31
    s_lshr_b32 s67, s2, 5
    s_lshl_b32 s68, s67, 2
    s_add_u32 s69, s68, s64
    s_sub_u32 s78, 67, s69
    s_cmp_lt_u32 s64, 4
    s_cselect_b32 s78, s69, s78
    s_cselect_b32 s80, 0, 8
    s_mov_b32 s70, s78
    s_lshl_b32 s68, s67, 1
    s_sub_u32 s71, 32, s68
    s_add_u32 s81, s68, 3
    v_lshlrev_b32 v2, 4, v1
    s_lshl_b32 s74, s66, 19
    s_add_u32 s75, s74, 16809984
    s_add_u32 s74, s74, 49152
    s_mov_b32 s76, 98304
    v_mov_b32 v48, 0
    v_mov_b32 v49, 0
    v_mov_b32 v50, 0
    v_mov_b32 v51, 0
    v_mov_b32 v52, 0
    v_mov_b32 v53, 0
    v_mov_b32 v54, 0
    v_mov_b32 v55, 0
    v_mov_b32 v56, 0
    v_mov_b32 v57, 0
    v_mov_b32 v58, 0
    v_mov_b32 v59, 0
    v_mov_b32 v60, 0
    v_mov_b32 v61, 0
    v_mov_b32 v62, 0
    v_mov_b32 v63, 0
    v_mov_b32 v64, 0
    v_mov_b32 v65, 0
    v_mov_b32 v66, 0
    v_mov_b32 v67, 0
    v_mov_b32 v68, 0
    v_mov_b32 v69, 0
    v_mov_b32 v70, 0
    v_mov_b32 v71, 0
    v_mov_b32 v72, 0
    v_mov_b32 v73, 0
    v_mov_b32 v74, 0
    v_mov_b32 v75, 0
    v_mov_b32 v76, 0
    v_mov_b32 v77, 0
    v_mov_b32 v78, 0
    v_mov_b32 v79, 0
    v_mov_b32 v80, 0
    v_mov_b32 v81, 0
    v_mov_b32 v82, 0
    v_mov_b32 v83, 0
    v_mov_b32 v84, 0
    v_mov_b32 v85, 0
    v_mov_b32 v86, 0
    v_mov_b32 v87, 0
    v_mov_b32 v88, 0
    v_mov_b32 v89, 0
    v_mov_b32 v90, 0
    v_mov_b32 v91, 0
    v_mov_b32 v92, 0
    v_mov_b32 v93, 0
    v_mov_b32 v94, 0
    v_mov_b32 v95, 0
    v_mov_b32 v96, 0
    v_mov_b32 v97, 0
    v_mov_b32 v98, 0
    v_mov_b32 v99, 0
    v_mov_b32 v100, 0
    v_mov_b32 v101, 0
    v_mov_b32 v102, 0
    v_mov_b32 v103, 0
    v_mov_b32 v104, 0
    v_mov_b32 v105, 0
    v_mov_b32 v106, 0
    v_mov_b32 v107, 0
    v_mov_b32 v108, 0
    v_mov_b32 v109, 0
    v_mov_b32 v110, 0
    v_mov_b32 v111, 0
    v_mov_b32 v160, 0
    v_mov_b32 v161, 0
    v_mov_b32 v162, 0
    v_mov_b32 v163, 0
    v_mov_b32 v164, 0
    v_mov_b32 v165, 0
    v_mov_b32 v166, 0
    v_mov_b32 v167, 0
    v_mov_b32 v168, 0
    v_mov_b32 v169, 0
    v_mov_b32 v170, 0
    v_mov_b32 v171, 0
    v_mov_b32 v172, 0
    v_mov_b32 v173, 0
    v_mov_b32 v174, 0
    v_mov_b32 v175, 0
    v_mov_b32 v176, 0
    v_mov_b32 v177, 0
    v_mov_b32 v178, 0
    v_mov_b32 v179, 0
    v_mov_b32 v180, 0
    v_mov_b32 v181, 0
    v_mov_b32 v182, 0
    v_mov_b32 v183, 0
    v_mov_b32 v184, 0x3f803f80
    v_mov_b32 v185, 0x3f803f80
    v_mov_b32 v186, 0x3f803f80
    v_mov_b32 v187, 0x3f803f80
    v_mov_b32 v128, 0xff7fffff
    v_mov_b32 v129, 0xff7fffff
    v_mov_b32 v130, 0xff7fffff
    v_mov_b32 v131, 0xff7fffff
    v_mov_b32 v132, 0xff7fffff
    v_mov_b32 v133, 0xff7fffff
    v_mov_b32 v134, 0xff7fffff
    v_mov_b32 v135, 0xff7fffff
    v_mov_b32 v136, 0xff7fffff
    v_mov_b32 v137, 0xff7fffff
    v_mov_b32 v138, 0xff7fffff
    v_mov_b32 v139, 0xff7fffff
    v_mov_b32 v140, 0xff7fffff
    v_mov_b32 v141, 0xff7fffff
    v_mov_b32 v142, 0xff7fffff
    v_mov_b32 v143, 0xff7fffff
    v_mov_b32 v144, 0
    v_mov_b32 v145, 0
    v_mov_b32 v146, 0
    v_mov_b32 v147, 0
    v_mov_b32 v148, 0
    v_mov_b32 v149, 0
    v_mov_b32 v150, 0
    v_mov_b32 v151, 0
    v_and_b32 v15, 15, v1
    v_lshrrev_b32 v5, 4, v1
    v_lshlrev_b32 v5, 2, v5
    v_sub_u32 v15, v15, v5
    v_and_b32 v9, 15, v1
    v_bfe_u32 v5, v1, 4, 1
    v_lshl_add_u32 v9, v5, 5, v9
    v_lshlrev_b32 v9, 4, v9
    v_lshrrev_b32 v5, 5, v1
    v_lshl_add_u32 v9, v5, 10, v9
    v_mov_b32 v3, v2
    v_add_u32 v4, 32768, v2
    s_waitcnt vmcnt(8) lgkmcnt(0)
    s_barrier
    s_cmp_lt_u32 s64, 4
    s_cbranch_scc1 BP_69
    s_and_b32 s69, s64, 3
    s_lshl_b32 s69, s69, 12
    s_and_b32 s73, s2, 31
    s_lshl_b32 s73, s73, 19
    s_add_u32 s73, s73, s69
    s_add_u32 m0, s69, 65536
    s_add_u32 s68, s73, 32768
    buffer_load_dwordx4 v2, s[56:59], s68 offen offset:0 lds
    buffer_load_dwordx4 v2, s[56:59], s68 offen offset:1024 lds
    buffer_load_dwordx4 v2, s[56:59], s68 offen offset:2048 lds
    buffer_load_dwordx4 v2, s[56:59], s68 offen offset:3072 lds
    s_add_u32 m0, s69, 81920
    s_add_u32 s68, s73, 16793600
    buffer_load_dwordx4 v2, s[56:59], s68 offen offset:0 lds
    buffer_load_dwordx4 v2, s[56:59], s68 offen offset:1024 lds
    buffer_load_dwordx4 v2, s[56:59], s68 offen offset:2048 lds
    buffer_load_dwordx4 v2, s[56:59], s68 offen offset:3072 lds
BP_69:
    s_getpc_b64 s[12:13]
CWH_70:
    s_add_u32 s12, s12, L_P4-CWH_70
    s_addc_u32 s13, s13, 0
    s_mul_i32 s8, s64, 32
    v_min_u32 v250, 31, v1
    v_add_u32 v250, s8, v250
    v_lshlrev_b32 v250, 7, v250
    v_min_u32 v250, L_FIN-L_P4-4, v250
    global_load_dword v251, v250, s[12:13]
    s_mov_b32 s72, 0
    s_mov_b32 s77, 0xff7fffff
    s_mov_b32 s79, 0
    ds_read_b128 v[192:195], v3 offset:0
    ds_read_b128 v[196:199], v3 offset:1024
    ds_read_b128 v[200:203], v3 offset:16384
    ds_read_b128 v[204:207], v3 offset:2048
    ds_read_b128 v[208:211], v3 offset:18432
    ds_read_b128 v[212:215], v3 offset:3072
    s_lshr_b32 s83, s70, 1
    s_min_u32 s82, s83, s81
    s_sub_u32 s68, s71, 3
    s_min_u32 s82, s82, s68
    s_branch GENST_75
STEADY1_73:
    s_waitcnt lgkmcnt(4)
    v_mfma_f32_16x16x32_bf16 v[112:115], v[192:195], v[16:19], v[160:163]
    v_exp_f32 v11, v128
    v_mfma_f32_16x16x32_bf16 v[116:119], v[192:195], v[20:23], v[164:167]
    ds_read_b128 v[216:219], v3 offset:20480
    v_exp_f32 v12, v129
    v_mfma_f32_16x16x32_bf16 v[120:123], v[196:199], v[16:19], v[168:171]
    v_cvt_pk_bf16_f32 v152, v11, v12
    v_mfma_f32_16x16x32_bf16 v[124:127], v[196:199], v[20:23], v[172:175]
    ds_read_b128 v[220:223], v3 offset:4096
    s_waitcnt lgkmcnt(4)
    v_mfma_f32_16x16x32_bf16 v[48:51], v[200:203], v[144:147], v[48:51]
    v_exp_f32 v13, v130
    v_mfma_f32_16x16x32_bf16 v[52:55], v[200:203], v[148:151], v[52:55]
    ds_read_b128 v[192:195], v3 offset:22528
    v_exp_f32 v14, v131
    v_mfma_f32_16x16x32_bf16 v[112:115], v[204:207], v[24:27], v[112:115]
    v_cvt_pk_bf16_f32 v153, v13, v14
    v_mfma_f32_16x16x32_bf16 v[116:119], v[204:207], v[28:31], v[116:119]
    ds_read_b128 v[196:199], v3 offset:5120
    s_waitcnt lgkmcnt(4)
    v_mfma_f32_16x16x32_bf16 v[64:67], v[208:211], v[144:147], v[64:67]
    v_exp_f32 v11, v132
    v_mfma_f32_16x16x32_bf16 v[68:71], v[208:211], v[148:151], v[68:71]
    ds_read_b128 v[200:203], v3 offset:17408
    v_exp_f32 v12, v133
    v_mfma_f32_16x16x32_bf16 v[120:123], v[212:215], v[24:27], v[120:123]
    v_cvt_pk_bf16_f32 v156, v11, v12
    v_mfma_f32_16x16x32_bf16 v[124:127], v[212:215], v[28:31], v[124:127]
    ds_read_b128 v[204:207], v3 offset:6144
    v_or_b32 v8, v152, v153
    v_mfma_f32_16x16x32_bf16 v[176:179], v[184:187], v[144:147], v[176:179]
    s_waitcnt lgkmcnt(4)
    v_mfma_f32_16x16x32_bf16 v[80:83], v[216:219], v[144:147], v[80:83]
    v_exp_f32 v13, v134
    v_mfma_f32_16x16x32_bf16 v[84:87], v[216:219], v[148:151], v[84:87]
    ds_read_b128 v[208:211], v3 offset:7168
    v_exp_f32 v14, v135
    v_mfma_f32_16x16x32_bf16 v[112:115], v[220:223], v[32:35], v[112:115]
    v_cvt_pk_bf16_f32 v157, v13, v14
    v_mfma_f32_16x16x32_bf16 v[116:119], v[220:223], v[36:39], v[116:119]
    ds_read_b128 v[212:215], v3 offset:19456
    s_waitcnt lgkmcnt(4)
    v_mfma_f32_16x16x32_bf16 v[96:99], v[192:195], v[144:147], v[96:99]
    v_exp_f32 v11, v136
    v_mfma_f32_16x16x32_bf16 v[100:103], v[192:195], v[148:151], v[100:103]
    ds_read_b128 v[216:219], v3 offset:21504
    v_exp_f32 v12, v137
    v_mfma_f32_16x16x32_bf16 v[120:123], v[196:199], v[32:35], v[120:123]
    v_cvt_pk_bf16_f32 v154, v11, v12
    v_mfma_f32_16x16x32_bf16 v[124:127], v[196:199], v[36:39], v[124:127]
    ds_read_b128 v[220:223], v3 offset:23552
    v_or3_b32 v8, v8, v156, v157
    s_waitcnt lgkmcnt(4)
    v_mfma_f32_16x16x32_bf16 v[56:59], v[200:203], v[144:147], v[56:59]
    v_exp_f32 v13, v138
    v_mfma_f32_16x16x32_bf16 v[60:63], v[200:203], v[148:151], v[60:63]
    ds_read_b128 v[192:195], v3 offset:8192
    v_exp_f32 v14, v139
    v_mfma_f32_16x16x32_bf16 v[112:115], v[204:207], v[40:43], v[112:115]
    v_cvt_pk_bf16_f32 v155, v13, v14
    v_mfma_f32_16x16x32_bf16 v[116:119], v[204:207], v[44:47], v[116:119]
    ds_read_b128 v[196:199], v3 offset:9216
    v_mfma_f32_16x16x32_bf16 v[180:183], v[184:187], v[148:151], v[180:183]
    s_waitcnt lgkmcnt(4)
    v_mfma_f32_16x16x32_bf16 v[120:123], v[208:211], v[40:43], v[120:123]
    v_exp_f32 v11, v140
    v_mfma_f32_16x16x32_bf16 v[124:127], v[208:211], v[44:47], v[124:127]
    ds_read_b128 v[200:203], v3 offset:24576
    v_exp_f32 v12, v141
    v_mfma_f32_16x16x32_bf16 v[72:75], v[212:215], v[144:147], v[72:75]
    v_cvt_pk_bf16_f32 v158, v11, v12
    v_mfma_f32_16x16x32_bf16 v[76:79], v[212:215], v[148:151], v[76:79]
    ds_read_b128 v[204:207], v3 offset:10240
    v_or3_b32 v8, v8, v154, v155
    s_waitcnt lgkmcnt(4)
    v_mfma_f32_16x16x32_bf16 v[88:91], v[216:219], v[144:147], v[88:91]
    v_exp_f32 v13, v142
    v_mfma_f32_16x16x32_bf16 v[92:95], v[216:219], v[148:151], v[92:95]
    ds_read_b128 v[208:211], v3 offset:26624
    v_exp_f32 v14, v143
    v_mfma_f32_16x16x32_bf16 v[104:107], v[220:223], v[144:147], v[104:107]
    v_cvt_pk_bf16_f32 v159, v13, v14
    v_mfma_f32_16x16x32_bf16 v[108:111], v[220:223], v[148:151], v[108:111]
    ds_read_b128 v[212:215], v3 offset:11264
    v_or3_b32 v8, v8, v158, v159
    v_and_b32 v8, 0x40004000, v8
    v_cmp_ne_u32 vcc, s79, v8
    s_cbranch_vccnz SLOW_76
BACK_77:
    s_waitcnt lgkmcnt(4)
    v_mfma_f32_16x16x32_bf16 v[128:131], v[192:195], v[16:19], v[160:163]
    v_exp_f32 v11, v112
    v_mfma_f32_16x16x32_bf16 v[132:135], v[192:195], v[20:23], v[164:167]
    ds_read_b128 v[216:219], v3 offset:28672
    v_exp_f32 v12, v113
    v_mfma_f32_16x16x32_bf16 v[136:139], v[196:199], v[16:19], v[168:171]
    v_cvt_pk_bf16_f32 v144, v11, v12
    v_mfma_f32_16x16x32_bf16 v[140:143], v[196:199], v[20:23], v[172:175]
    ds_read_b128 v[220:223], v3 offset:12288
    s_waitcnt lgkmcnt(4)
    v_mfma_f32_16x16x32_bf16 v[48:51], v[200:203], v[152:155], v[48:51]
    v_exp_f32 v13, v114
    v_mfma_f32_16x16x32_bf16 v[52:55], v[200:203], v[156:159], v[52:55]
    ds_read_b128 v[192:195], v3 offset:30720
    v_exp_f32 v14, v115
    v_mfma_f32_16x16x32_bf16 v[128:131], v[204:207], v[24:27], v[128:131]
    v_cvt_pk_bf16_f32 v145, v13, v14
    v_mfma_f32_16x16x32_bf16 v[132:135], v[204:207], v[28:31], v[132:135]
    ds_read_b128 v[196:199], v3 offset:13312
    s_waitcnt lgkmcnt(4)
    v_mfma_f32_16x16x32_bf16 v[64:67], v[208:211], v[152:155], v[64:67]
    v_exp_f32 v11, v116
    v_mfma_f32_16x16x32_bf16 v[68:71], v[208:211], v[156:159], v[68:71]
    ds_read_b128 v[200:203], v3 offset:25600
    v_exp_f32 v12, v117
    v_mfma_f32_16x16x32_bf16 v[136:139], v[212:215], v[24:27], v[136:139]
    v_cvt_pk_bf16_f32 v148, v11, v12
    v_mfma_f32_16x16x32_bf16 v[140:143], v[212:215], v[28:31], v[140:143]
    ds_read_b128 v[204:207], v3 offset:14336
    v_or_b32 v8, v144, v145
    v_mfma_f32_16x16x32_bf16 v[176:179], v[184:187], v[152:155], v[176:179]
    s_waitcnt lgkmcnt(4)
    v_mfma_f32_16x16x32_bf16 v[80:83], v[216:219], v[152:155], v[80:83]
    v_exp_f32 v13, v118
    v_mfma_f32_16x16x32_bf16 v[84:87], v[216:219], v[156:159], v[84:87]
    ds_read_b128 v[208:211], v3 offset:15360
    v_exp_f32 v14, v119
    v_mfma_f32_16x16x32_bf16 v[128:131], v[220:223], v[32:35], v[128:131]
    v_cvt_pk_bf16_f32 v149, v13, v14
    v_mfma_f32_16x16x32_bf16 v[132:135], v[220:223], v[36:39], v[132:135]
    ds_read_b128 v[212:215], v3 offset:27648
    s_waitcnt lgkmcnt(4)
    v_mfma_f32_16x16x32_bf16 v[96:99], v[192:195], v[152:155], v[96:99]
    v_exp_f32 v11, v120
    v_mfma_f32_16x16x32_bf16 v[100:103], v[192:195], v[156:159], v[100:103]
    s_waitcnt vmcnt(4)
    s_barrier
    ds_read_b128 v[216:219], v3 offset:29696
    v_exp_f32 v12, v121
    v_mfma_f32_16x16x32_bf16 v[136:139], v[196:199], v[32:35], v[136:139]
    v_cvt_pk_bf16_f32 v146, v11, v12
    v_mfma_f32_16x16x32_bf16 v[140:143], v[196:199], v[36:39], v[140:143]
    s_lshl_b32 s69, s64, 11
    s_add_u32 m0, s76, s69
    s_add_u32 s68, s74, s69
    buffer_load_dwordx4 v2, s[56:59], s68 offen lds
    ds_read_b128 v[220:223], v3 offset:31744
    v_or3_b32 v8, v8, v148, v149
    s_waitcnt lgkmcnt(4)
    v_mfma_f32_16x16x32_bf16 v[56:59], v[200:203], v[152:155], v[56:59]
    v_exp_f32 v13, v122
    v_mfma_f32_16x16x32_bf16 v[60:63], v[200:203], v[156:159], v[60:63]
    buffer_load_dwordx4 v2, s[56:59], s68 offen offset:1024 lds
    ds_read_b128 v[192:195], v4 offset:0
    v_exp_f32 v14, v123
    v_mfma_f32_16x16x32_bf16 v[128:131], v[204:207], v[40:43], v[128:131]
    v_cvt_pk_bf16_f32 v147, v13, v14
    v_mfma_f32_16x16x32_bf16 v[132:135], v[204:207], v[44:47], v[132:135]
    s_add_u32 s68, s76, s69
    s_add_u32 m0, s68, 16384
    s_add_u32 s68, s75, s69
    buffer_load_dwordx4 v2, s[56:59], s68 offen lds
    ds_read_b128 v[196:199], v4 offset:1024
    v_mfma_f32_16x16x32_bf16 v[180:183], v[184:187], v[156:159], v[180:183]
    s_waitcnt lgkmcnt(4)
    v_mfma_f32_16x16x32_bf16 v[136:139], v[208:211], v[40:43], v[136:139]
    v_exp_f32 v11, v124
    v_mfma_f32_16x16x32_bf16 v[140:143], v[208:211], v[44:47], v[140:143]
    buffer_load_dwordx4 v2, s[56:59], s68 offen offset:1024 lds
    ds_read_b128 v[200:203], v4 offset:16384
    v_exp_f32 v12, v125
    v_mfma_f32_16x16x32_bf16 v[72:75], v[212:215], v[152:155], v[72:75]
    v_cvt_pk_bf16_f32 v150, v11, v12
    v_mfma_f32_16x16x32_bf16 v[76:79], v[212:215], v[156:159], v[76:79]
    s_add_u32 s74, s74, 16384
    s_add_u32 s75, s75, 16384
    ds_read_b128 v[204:207], v4 offset:2048
    v_or3_b32 v8, v8, v146, v147
    s_waitcnt lgkmcnt(4)
    v_mfma_f32_16x16x32_bf16 v[88:91], v[216:219], v[152:155], v[88:91]
    v_exp_f32 v13, v126
    v_mfma_f32_16x16x32_bf16 v[92:95], v[216:219], v[156:159], v[92:95]
    s_add_u32 s76, s76, 32768
    s_and_b32 s76, s76, 0x1ffff
    s_add_u32 s72, s72, 1
    ds_read_b128 v[208:211], v4 offset:18432
    v_exp_f32 v14, v127
    v_mfma_f32_16x16x32_bf16 v[104:107], v[220:223], v[152:155], v[104:107]
    v_cvt_pk_bf16_f32 v151, v13, v14
    v_mfma_f32_16x16x32_bf16 v[108:111], v[220:223], v[156:159], v[108:111]
    s_add_u32 s68, s72, 1
    s_and_b32 s68, s68, 3
    s_lshl_b32 s68, s68, 15
    ds_read_b128 v[212:215], v4 offset:3072
    v_or3_b32 v8, v8, v150, v151
    v_and_b32 v8, 0x40004000, v8
    v_cmp_ne_u32 vcc, s79, v8
    v_mov_b32 v3, v4
    v_add_u32 v4, s68, v2
    s_cbranch_vccnz SLOW_78
BACK_79:
    s_cmp_lt_u32 s72, s82
    s_cbranch_scc1 STEADY1_73
    s_mov_b32 s80, 4
    s_branch ATT_LOOP_71
STEADY2_74:
    s_waitcnt lgkmcnt(4)
    v_mfma_f32_16x16x32_bf16 v[112:115], v[192:195], v[16:19], v[160:163]
    v_exp_f32 v11, v128
    v_mfma_f32_16x16x32_bf16 v[116:119], v[192:195], v[20:23], v[164:167]
    ds_read_b128 v[216:219], v3 offset:20480
    v_exp_f32 v12, v129
    v_mfma_f32_16x16x32_bf16 v[120:123], v[196:199], v[16:19], v[168:171]
    v_cvt_pk_bf16_f32 v152, v11, v12
    v_mfma_f32_16x16x32_bf16 v[124:127], v[196:199], v[20:23], v[172:175]
    ds_read_b128 v[220:223], v3 offset:4096
    s_waitcnt lgkmcnt(4)
    v_mfma_f32_16x16x32_bf16 v[48:51], v[200:203], v[144:147], v[48:51]
    v_exp_f32 v13, v130
    v_mfma_f32_16x16x32_bf16 v[52:55], v[200:203], v[148:151], v[52:55]
    ds_read_b128 v[192:195], v3 offset:22528
    v_exp_f32 v14, v131
    v_mfma_f32_16x16x32_bf16 v[112:115], v[204:207], v[24:27], v[112:115]
    v_cvt_pk_bf16_f32 v153, v13, v14
    v_mfma_f32_16x16x32_bf16 v[116:119], v[204:207], v[28:31], v[116:119]
    ds_read_b128 v[196:199], v3 offset:5120
    s_waitcnt lgkmcnt(4)
    v_mfma_f32_16x16x32_bf16 v[64:67], v[208:211], v[144:147], v[64:67]
    v_exp_f32 v11, v132
    v_mfma_f32_16x16x32_bf16 v[68:71], v[208:211], v[148:151], v[68:71]
    ds_read_b128 v[200:203], v3 offset:17408
    v_exp_f32 v12, v133
    v_mfma_f32_16x16x32_bf16 v[120:123], v[212:215], v[24:27], v[120:123]
    v_cvt_pk_bf16_f32 v156, v11, v12
    v_mfma_f32_16x16x32_bf16 v[124:127], v[212:215], v[28:31], v[124:127]
    ds_read_b128 v[204:207], v3 offset:6144
    v_or_b32 v8, v152, v153
    v_mfma_f32_16x16x32_bf16 v[176:179], v[184:187], v[144:147], v[176:179]
    s_waitcnt lgkmcnt(4)
    v_mfma_f32_16x16x32_bf16 v[80:83], v[216:219], v[144:147], v[80:83]
    v_exp_f32 v13, v134
    v_mfma_f32_16x16x32_bf16 v[84:87], v[216:219], v[148:151], v[84:87]
    ds_read_b128 v[208:211], v3 offset:7168
    v_exp_f32 v14, v135
    v_mfma_f32_16x16x32_bf16 v[112:115], v[220:223], v[32:35], v[112:115]
    v_cvt_pk_bf16_f32 v157, v13, v14
    v_mfma_f32_16x16x32_bf16 v[116:119], v[220:223], v[36:39], v[116:119]
    ds_read_b128 v[212:215], v3 offset:19456
    s_waitcnt lgkmcnt(4)
    v_mfma_f32_16x16x32_bf16 v[96:99], v[192:195], v[144:147], v[96:99]
    v_exp_f32 v11, v136
    v_mfma_f32_16x16x32_bf16 v[100:103], v[192:195], v[148:151], v[100:103]
    ds_read_b128 v[216:219], v3 offset:21504
    v_exp_f32 v12, v137
    v_mfma_f32_16x16x32_bf16 v[120:123], v[196:199], v[32:35], v[120:123]
    v_cvt_pk_bf16_f32 v154, v11, v12
    v_mfma_f32_16x16x32_bf16 v[124:127], v[196:199], v[36:39], v[124:127]
    ds_read_b128 v[220:223], v3 offset:23552
    v_or3_b32 v8, v8, v156, v157
    s_waitcnt lgkmcnt(4)
    v_mfma_f32_16x16x32_bf16 v[56:59], v[200:203], v[144:147], v[56:59]
    v_exp_f32 v13, v138
    v_mfma_f32_16x16x32_bf16 v[60:63], v[200:203], v[148:151], v[60:63]
    ds_read_b128 v[192:195], v3 offset:8192
    v_exp_f32 v14, v139
    v_mfma_f32_16x16x32_bf16 v[112:115], v[204:207], v[40:43], v[112:115]
    v_cvt_pk_bf16_f32 v155, v13, v14
    v_mfma_f32_16x16x32_bf16 v[116:119], v[204:207], v[44:47], v[116:119]
    ds_read_b128 v[196:199], v3 offset:9216
    v_mfma_f32_16x16x32_bf16 v[180:183], v[184:187], v[148:151], v[180:183]
    s_waitcnt lgkmcnt(4)
    v_mfma_f32_16x16x32_bf16 v[120:123], v[208:211], v[40:43], v[120:123]
    v_exp_f32 v11, v140
    v_mfma_f32_16x16x32_bf16 v[124:127], v[208:211], v[44:47], v[124:127]
    ds_read_b128 v[200:203], v3 offset:24576
    v_exp_f32 v12, v141
    v_mfma_f32_16x16x32_bf16 v[72:75], v[212:215], v[144:147], v[72:75]
    v_cvt_pk_bf16_f32 v158, v11, v12
    v_mfma_f32_16x16x32_bf16 v[76:79], v[212:215], v[148:151], v[76:79]
    ds_read_b128 v[204:207], v3 offset:10240
    v_or3_b32 v8, v8, v154, v155
    s_waitcnt lgkmcnt(4)
    v_mfma_f32_16x16x32_bf16 v[88:91], v[216:219], v[144:147], v[88:91]
    v_exp_f32 v13, v142
    v_mfma_f32_16x16x32_bf16 v[92:95], v[216:219], v[148:151], v[92:95]
    ds_read_b128 v[208:211], v3 offset:26624
    v_exp_f32 v14, v143
    v_mfma_f32_16x16x32_bf16 v[104:107], v[220:223], v[144:147], v[104:107]
    v_cvt_pk_bf16_f32 v159, v13, v14
    v_mfma_f32_16x16x32_bf16 v[108:111], v[220:223], v[148:151], v[108:111]
    ds_read_b128 v[212:215], v3 offset:11264
    v_or3_b32 v8, v8, v158, v159
    v_and_b32 v8, 0x40004000, v8
    v_cmp_ne_u32 vcc, s79, v8
    s_cbranch_vccnz SLOW_80
BACK_81:
    s_waitcnt lgkmcnt(4)
    v_mfma_f32_16x16x32_bf16 v[128:131], v[192:195], v[16:19], v[160:163]
    v_exp_f32 v11, v112
    v_mfma_f32_16x16x32_bf16 v[132:135], v[192:195], v[20:23], v[164:167]
    ds_read_b128 v[216:219], v3 offset:28672
    v_exp_f32 v12, v113
    v_mfma_f32_16x16x32_bf16 v[136:139], v[196:199], v[16:19], v[168:171]
    v_cvt_pk_bf16_f32 v144, v11, v12
    v_mfma_f32_16x16x32_bf16 v[140:143], v[196:199], v[20:23], v[172:175]
    ds_read_b128 v[220:223], v3 offset:12288
    s_waitcnt lgkmcnt(4)
    v_mfma_f32_16x16x32_bf16 v[48:51], v[200:203], v[152:155], v[48:51]
    v_exp_f32 v13, v114
    v_mfma_f32_16x16x32_bf16 v[52:55], v[200:203], v[156:159], v[52:55]
    ds_read_b128 v[192:195], v3 offset:30720
    v_exp_f32 v14, v115
    v_mfma_f32_16x16x32_bf16 v[128:131], v[204:207], v[24:27], v[128:131]
    v_cvt_pk_bf16_f32 v145, v13, v14
    v_mfma_f32_16x16x32_bf16 v[132:135], v[204:207], v[28:31], v[132:135]
    ds_read_b128 v[196:199], v3 offset:13312
    s_waitcnt lgkmcnt(4)
    v_mfma_f32_16x16x32_bf16 v[64:67], v[208:211], v[152:155], v[64:67]
    v_exp_f32 v11, v116
    v_mfma_f32_16x16x32_bf16 v[68:71], v[208:211], v[156:159], v[68:71]
    ds_read_b128 v[200:203], v3 offset:25600
    v_exp_f32 v12, v117
    v_mfma_f32_16x16x32_bf16 v[136:139], v[212:215], v[24:27], v[136:139]
    v_cvt_pk_bf16_f32 v148, v11, v12
    v_mfma_f32_16x16x32_bf16 v[140:143], v[212:215], v[28:31], v[140:143]
    ds_read_b128 v[204:207], v3 offset:14336
    v_or_b32 v8, v144, v145
    v_mfma_f32_16x16x32_bf16 v[176:179], v[184:187], v[152:155], v[176:179]
    s_waitcnt lgkmcnt(4)
    v_mfma_f32_16x16x32_bf16 v[80:83], v[216:219], v[152:155], v[80:83]
    v_exp_f32 v13, v118
    v_mfma_f32_16x16x32_bf16 v[84:87], v[216:219], v[156:159], v[84:87]
    ds_read_b128 v[208:211], v3 offset:15360
    v_exp_f32 v14, v119
    v_mfma_f32_16x16x32_bf16 v[128:131], v[220:223], v[32:35], v[128:131]
    v_cvt_pk_bf16_f32 v149, v13, v14
    v_mfma_f32_16x16x32_bf16 v[132:135], v[220:223], v[36:39], v[132:135]
    ds_read_b128 v[212:215], v3 offset:27648
    s_waitcnt lgkmcnt(4)
    v_mfma_f32_16x16x32_bf16 v[96:99], v[192:195], v[152:155], v[96:99]
    v_exp_f32 v11, v120
    v_mfma_f32_16x16x32_bf16 v[100:103], v[192:195], v[156:159], v[100:103]
    s_waitcnt vmcnt(0)
    s_barrier
    ds_read_b128 v[216:219], v3 offset:29696
    v_exp_f32 v12, v121
    v_mfma_f32_16x16x32_bf16 v[136:139], v[196:199], v[32:35], v[136:139]
    v_cvt_pk_bf16_f32 v146, v11, v12
    v_mfma_f32_16x16x32_bf16 v[140:143], v[196:199], v[36:39], v[140:143]
    ds_read_b128 v[220:223], v3 offset:31744
    v_or3_b32 v8, v8, v148, v149
    s_waitcnt lgkmcnt(4)
    v_mfma_f32_16x16x32_bf16 v[56:59], v[200:203], v[152:155], v[56:59]
    v_exp_f32 v13, v122
    v_mfma_f32_16x16x32_bf16 v[60:63], v[200:203], v[156:159], v[60:63]
    ds_read_b128 v[192:195], v4 offset:0
    v_exp_f32 v14, v123
    v_mfma_f32_16x16x32_bf16 v[128:131], v[204:207], v[40:43], v[128:131]
    v_cvt_pk_bf16_f32 v147, v13, v14
    v_mfma_f32_16x16x32_bf16 v[132:135], v[204:207], v[44:47], v[132:135]
    ds_read_b128 v[196:199], v4 offset:1024
    v_mfma_f32_16x16x32_bf16 v[180:183], v[184:187], v[156:159], v[180:183]
    s_waitcnt lgkmcnt(4)
    v_mfma_f32_16x16x32_bf16 v[136:139], v[208:211], v[40:43], v[136:139]
    v_exp_f32 v11, v124
    v_mfma_f32_16x16x32_bf16 v[140:143], v[208:211], v[44:47], v[140:143]
    ds_read_b128 v[200:203], v4 offset:16384
    v_exp_f32 v12, v125
    v_mfma_f32_16x16x32_bf16 v[72:75], v[212:215], v[152:155], v[72:75]
    v_cvt_pk_bf16_f32 v150, v11, v12
    v_mfma_f32_16x16x32_bf16 v[76:79], v[212:215], v[156:159], v[76:79]
    s_add_u32 s74, s74, 16384
    s_add_u32 s75, s75, 16384
    ds_read_b128 v[204:207], v4 offset:2048
    v_or3_b32 v8, v8, v146, v147
    s_waitcnt lgkmcnt(4)
    v_mfma_f32_16x16x32_bf16 v[88:91], v[216:219], v[152:155], v[88:91]
    v_exp_f32 v13, v126
    v_mfma_f32_16x16x32_bf16 v[92:95], v[216:219], v[156:159], v[92:95]
    s_add_u32 s76, s76, 32768
    s_and_b32 s76, s76, 0x1ffff
    s_add_u32 s72, s72, 1
    ds_read_b128 v[208:211], v4 offset:18432
    v_exp_f32 v14, v127
    v_mfma_f32_16x16x32_bf16 v[104:107], v[220:223], v[152:155], v[104:107]
    v_cvt_pk_bf16_f32 v151, v13, v14
    v_mfma_f32_16x16x32_bf16 v[108:111], v[220:223], v[156:159], v[108:111]
    s_add_u32 s68, s72, 1
    s_and_b32 s68, s68, 3
    s_lshl_b32 s68, s68, 15
    ds_read_b128 v[212:215], v4 offset:3072
    v_or3_b32 v8, v8, v150, v151
    v_and_b32 v8, 0x40004000, v8
    v_cmp_ne_u32 vcc, s79, v8
    v_mov_b32 v3, v4
    v_add_u32 v4, s68, v2
    s_cbranch_vccnz SLOW_82
BACK_83:
    s_cmp_lt_u32 s72, s83
    s_cbranch_scc1 STEADY2_74
    s_mov_b32 s80, 0
ATT_LOOP_71:
    s_cmp_lt_u32 s72, s82
    s_cbranch_scc1 STEADY1_73
    s_cmp_lt_u32 s72, s81
    s_cbranch_scc1 GENST_75
    s_cmp_lt_u32 s72, s83
    s_cbranch_scc1 STEADY2_74
GENST_75:
    s_lshl_b32 s73, s72, 1
    s_sub_i32 s73, s73, 1
    s_add_i32 s68, s73, 1
    s_cmp_lg_u32 s68, s70
    s_cbranch_scc1 NOMASK_89
    v_mov_b32 v5, 0xff7fffff
    v_cmp_gt_i32 vcc, 0, v15
    s_nop 1
    v_cndmask_b32 v160, v160, v5, vcc
    v_cmp_gt_i32 vcc, 1, v15
    s_nop 1
    v_cndmask_b32 v161, v161, v5, vcc
    v_cmp_gt_i32 vcc, 2, v15
    s_nop 1
    v_cndmask_b32 v162, v162, v5, vcc
    v_cmp_gt_i32 vcc, 3, v15
    s_nop 1
    v_cndmask_b32 v163, v163, v5, vcc
    v_cmp_gt_i32 vcc, -16, v15
    s_nop 1
    v_cndmask_b32 v164, v164, v5, vcc
    v_cmp_gt_i32 vcc, -15, v15
    s_nop 1
    v_cndmask_b32 v165, v165, v5, vcc
    v_cmp_gt_i32 vcc, -14, v15
    s_nop 1
    v_cndmask_b32 v166, v166, v5, vcc
    v_cmp_gt_i32 vcc, -13, v15
    s_nop 1
    v_cndmask_b32 v167, v167, v5, vcc
    v_cmp_gt_i32 vcc, 16, v15
    s_nop 1
    v_cndmask_b32 v168, v168, v5, vcc
    v_cmp_gt_i32 vcc, 17, v15
    s_nop 1
    v_cndmask_b32 v169, v169, v5, vcc
    v_cmp_gt_i32 vcc, 18, v15
    s_nop 1
    v_cndmask_b32 v170, v170, v5, vcc
    v_cmp_gt_i32 vcc, 19, v15
    s_nop 1
    v_cndmask_b32 v171, v171, v5, vcc
    v_cmp_gt_i32 vcc, 0, v15
    s_nop 1
    v_cndmask_b32 v172, v172, v5, vcc
    v_cmp_gt_i32 vcc, 1, v15
    s_nop 1
    v_cndmask_b32 v173, v173, v5, vcc
    v_cmp_gt_i32 vcc, 2, v15
    s_nop 1
    v_cndmask_b32 v174, v174, v5, vcc
    v_cmp_gt_i32 vcc, 3, v15
    s_nop 1
    v_cndmask_b32 v175, v175, v5, vcc
    s_nop 1
NOMASK_89:
    s_cmp_lt_i32 s73, 1
    s_cbranch_scc1 FIRST_84
    s_cmp_ge_i32 s73, s70
    s_cbranch_scc1 LAST_85
    s_waitcnt lgkmcnt(4)
    v_mfma_f32_16x16x32_bf16 v[112:115], v[192:195], v[16:19], v[160:163]
    v_exp_f32 v11, v128
    v_mfma_f32_16x16x32_bf16 v[116:119], v[192:195], v[20:23], v[164:167]
    ds_read_b128 v[216:219], v3 offset:20480
    v_exp_f32 v12, v129
    v_mfma_f32_16x16x32_bf16 v[120:123], v[196:199], v[16:19], v[168:171]
    v_cvt_pk_bf16_f32 v152, v11, v12
    v_mfma_f32_16x16x32_bf16 v[124:127], v[196:199], v[20:23], v[172:175]
    ds_read_b128 v[220:223], v3 offset:4096
    s_waitcnt lgkmcnt(4)
    v_mfma_f32_16x16x32_bf16 v[48:51], v[200:203], v[144:147], v[48:51]
    v_exp_f32 v13, v130
    v_mfma_f32_16x16x32_bf16 v[52:55], v[200:203], v[148:151], v[52:55]
    ds_read_b128 v[192:195], v3 offset:22528
    v_exp_f32 v14, v131
    v_mfma_f32_16x16x32_bf16 v[112:115], v[204:207], v[24:27], v[112:115]
    v_cvt_pk_bf16_f32 v153, v13, v14
    v_mfma_f32_16x16x32_bf16 v[116:119], v[204:207], v[28:31], v[116:119]
    ds_read_b128 v[196:199], v3 offset:5120
    s_waitcnt lgkmcnt(4)
    v_mfma_f32_16x16x32_bf16 v[64:67], v[208:211], v[144:147], v[64:67]
    v_exp_f32 v11, v132
    v_mfma_f32_16x16x32_bf16 v[68:71], v[208:211], v[148:151], v[68:71]
    ds_read_b128 v[200:203], v3 offset:17408
    v_exp_f32 v12, v133
    v_mfma_f32_16x16x32_bf16 v[120:123], v[212:215], v[24:27], v[120:123]
    v_cvt_pk_bf16_f32 v156, v11, v12
    v_mfma_f32_16x16x32_bf16 v[124:127], v[212:215], v[28:31], v[124:127]
    ds_read_b128 v[204:207], v3 offset:6144
    v_or_b32 v8, v152, v153
    v_mfma_f32_16x16x32_bf16 v[176:179], v[184:187], v[144:147], v[176:179]
    s_waitcnt lgkmcnt(4)
    v_mfma_f32_16x16x32_bf16 v[80:83], v[216:219], v[144:147], v[80:83]
    v_exp_f32 v13, v134
    v_mfma_f32_16x16x32_bf16 v[84:87], v[216:219], v[148:151], v[84:87]
    ds_read_b128 v[208:211], v3 offset:7168
    v_exp_f32 v14, v135
    v_mfma_f32_16x16x32_bf16 v[112:115], v[220:223], v[32:35], v[112:115]
    v_cvt_pk_bf16_f32 v157, v13, v14
    v_mfma_f32_16x16x32_bf16 v[116:119], v[220:223], v[36:39], v[116:119]
    ds_read_b128 v[212:215], v3 offset:19456
    s_waitcnt lgkmcnt(4)
    v_mfma_f32_16x16x32_bf16 v[96:99], v[192:195], v[144:147], v[96:99]
    v_exp_f32 v11, v136
    v_mfma_f32_16x16x32_bf16 v[100:103], v[192:195], v[148:151], v[100:103]
    ds_read_b128 v[216:219], v3 offset:21504
    v_exp_f32 v12, v137
    v_mfma_f32_16x16x32_bf16 v[120:123], v[196:199], v[32:35], v[120:123]
    v_cvt_pk_bf16_f32 v154, v11, v12
    v_mfma_f32_16x16x32_bf16 v[124:127], v[196:199], v[36:39], v[124:127]
    ds_read_b128 v[220:223], v3 offset:23552
    v_or3_b32 v8, v8, v156, v157
    s_waitcnt lgkmcnt(4)
    v_mfma_f32_16x16x32_bf16 v[56:59], v[200:203], v[144:147], v[56:59]
    v_exp_f32 v13, v138
    v_mfma_f32_16x16x32_bf16 v[60:63], v[200:203], v[148:151], v[60:63]
    ds_read_b128 v[192:195], v3 offset:8192
    v_exp_f32 v14, v139
    v_mfma_f32_16x16x32_bf16 v[112:115], v[204:207], v[40:43], v[112:115]
    v_cvt_pk_bf16_f32 v155, v13, v14
    v_mfma_f32_16x16x32_bf16 v[116:119], v[204:207], v[44:47], v[116:119]
    ds_read_b128 v[196:199], v3 offset:9216
    v_mfma_f32_16x16x32_bf16 v[180:183], v[184:187], v[148:151], v[180:183]
    s_waitcnt lgkmcnt(4)
    v_mfma_f32_16x16x32_bf16 v[120:123], v[208:211], v[40:43], v[120:123]
    v_exp_f32 v11, v140
    v_mfma_f32_16x16x32_bf16 v[124:127], v[208:211], v[44:47], v[124:127]
    ds_read_b128 v[200:203], v3 offset:24576
    v_exp_f32 v12, v141
    v_mfma_f32_16x16x32_bf16 v[72:75], v[212:215], v[144:147], v[72:75]
    v_cvt_pk_bf16_f32 v158, v11, v12
    v_mfma_f32_16x16x32_bf16 v[76:79], v[212:215], v[148:151], v[76:79]
    ds_read_b128 v[204:207], v3 offset:10240
    v_or3_b32 v8, v8, v154, v155
    s_waitcnt lgkmcnt(4)
    v_mfma_f32_16x16x32_bf16 v[88:91], v[216:219], v[144:147], v[88:91]
    v_exp_f32 v13, v142
    v_mfma_f32_16x16x32_bf16 v[92:95], v[216:219], v[148:151], v[92:95]
    ds_read_b128 v[208:211], v3 offset:26624
    v_exp_f32 v14, v143
    v_mfma_f32_16x16x32_bf16 v[104:107], v[220:223], v[144:147], v[104:107]
    v_cvt_pk_bf16_f32 v159, v13, v14
    v_mfma_f32_16x16x32_bf16 v[108:111], v[220:223], v[148:151], v[108:111]
    ds_read_b128 v[212:215], v3 offset:11264
    v_or3_b32 v8, v8, v158, v159
    v_and_b32 v8, 0x40004000, v8
    v_cmp_ne_u32 vcc, s79, v8
    s_cbranch_vccnz SLOW_90
BACK_91:
    s_branch NEXT_88
FIRST_84:
    s_waitcnt lgkmcnt(4)
    v_mfma_f32_16x16x32_bf16 v[112:115], v[192:195], v[16:19], v[160:163]
    v_mfma_f32_16x16x32_bf16 v[116:119], v[192:195], v[20:23], v[164:167]
    ds_read_b128 v[216:219], v3 offset:20480
    v_mfma_f32_16x16x32_bf16 v[120:123], v[196:199], v[16:19], v[168:171]
    v_mfma_f32_16x16x32_bf16 v[124:127], v[196:199], v[20:23], v[172:175]
    ds_read_b128 v[220:223], v3 offset:4096
    s_waitcnt lgkmcnt(4)
    ds_read_b128 v[192:195], v3 offset:22528
    v_mfma_f32_16x16x32_bf16 v[112:115], v[204:207], v[24:27], v[112:115]
    v_mfma_f32_16x16x32_bf16 v[116:119], v[204:207], v[28:31], v[116:119]
    ds_read_b128 v[196:199], v3 offset:5120
    s_waitcnt lgkmcnt(4)
    ds_read_b128 v[200:203], v3 offset:17408
    v_mfma_f32_16x16x32_bf16 v[120:123], v[212:215], v[24:27], v[120:123]
    v_mfma_f32_16x16x32_bf16 v[124:127], v[212:215], v[28:31], v[124:127]
    ds_read_b128 v[204:207], v3 offset:6144
    s_waitcnt lgkmcnt(4)
    ds_read_b128 v[208:211], v3 offset:7168
    v_mfma_f32_16x16x32_bf16 v[112:115], v[220:223], v[32:35], v[112:115]
    v_mfma_f32_16x16x32_bf16 v[116:119], v[220:223], v[36:39], v[116:119]
    ds_read_b128 v[212:215], v3 offset:19456
    s_waitcnt lgkmcnt(4)
    ds_read_b128 v[216:219], v3 offset:21504
    v_mfma_f32_16x16x32_bf16 v[120:123], v[196:199], v[32:35], v[120:123]
    v_mfma_f32_16x16x32_bf16 v[124:127], v[196:199], v[36:39], v[124:127]
    ds_read_b128 v[220:223], v3 offset:23552
    s_waitcnt lgkmcnt(4)
    ds_read_b128 v[192:195], v3 offset:8192
    v_mfma_f32_16x16x32_bf16 v[112:115], v[204:207], v[40:43], v[112:115]
    v_mfma_f32_16x16x32_bf16 v[116:119], v[204:207], v[44:47], v[116:119]
    ds_read_b128 v[196:199], v3 offset:9216
    s_waitcnt lgkmcnt(4)
    v_mfma_f32_16x16x32_bf16 v[120:123], v[208:211], v[40:43], v[120:123]
    v_mfma_f32_16x16x32_bf16 v[124:127], v[208:211], v[44:47], v[124:127]
    ds_read_b128 v[200:203], v3 offset:24576
    ds_read_b128 v[204:207], v3 offset:10240
    s_waitcnt lgkmcnt(4)
    ds_read_b128 v[208:211], v3 offset:26624
    ds_read_b128 v[212:215], v3 offset:11264
    s_nop 7
    s_branch NEXT_88
LAST_85:
    s_cmp_gt_i32 s73, s70
    s_cbranch_scc1 PVONLY_86
    s_waitcnt lgkmcnt(4)
    v_exp_f32 v11, v128
    ds_read_b128 v[216:219], v3 offset:20480
    v_exp_f32 v12, v129
    s_nop 0
    v_cvt_pk_bf16_f32 v152, v11, v12
    ds_read_b128 v[220:223], v3 offset:4096
    s_waitcnt lgkmcnt(4)
    v_mfma_f32_16x16x32_bf16 v[48:51], v[200:203], v[144:147], v[48:51]
    v_exp_f32 v13, v130
    v_mfma_f32_16x16x32_bf16 v[52:55], v[200:203], v[148:151], v[52:55]
    ds_read_b128 v[192:195], v3 offset:22528
    v_exp_f32 v14, v131
    s_nop 0
    v_cvt_pk_bf16_f32 v153, v13, v14
    ds_read_b128 v[196:199], v3 offset:5120
    s_waitcnt lgkmcnt(4)
    v_mfma_f32_16x16x32_bf16 v[64:67], v[208:211], v[144:147], v[64:67]
    v_exp_f32 v11, v132
    v_mfma_f32_16x16x32_bf16 v[68:71], v[208:211], v[148:151], v[68:71]
    ds_read_b128 v[200:203], v3 offset:17408
    v_exp_f32 v12, v133
    s_nop 0
    v_cvt_pk_bf16_f32 v156, v11, v12
    ds_read_b128 v[204:207], v3 offset:6144
    v_or_b32 v8, v152, v153
    v_mfma_f32_16x16x32_bf16 v[176:179], v[184:187], v[144:147], v[176:179]
    s_waitcnt lgkmcnt(4)
    v_mfma_f32_16x16x32_bf16 v[80:83], v[216:219], v[144:147], v[80:83]
    v_exp_f32 v13, v134
    v_mfma_f32_16x16x32_bf16 v[84:87], v[216:219], v[148:151], v[84:87]
    ds_read_b128 v[208:211], v3 offset:7168
    v_exp_f32 v14, v135
    s_nop 0
    v_cvt_pk_bf16_f32 v157, v13, v14
    ds_read_b128 v[212:215], v3 offset:19456
    s_waitcnt lgkmcnt(4)
    v_mfma_f32_16x16x32_bf16 v[96:99], v[192:195], v[144:147], v[96:99]
    v_exp_f32 v11, v136
    v_mfma_f32_16x16x32_bf16 v[100:103], v[192:195], v[148:151], v[100:103]
    ds_read_b128 v[216:219], v3 offset:21504
    v_exp_f32 v12, v137
    s_nop 0
    v_cvt_pk_bf16_f32 v154, v11, v12
    ds_read_b128 v[220:223], v3 offset:23552
    v_or3_b32 v8, v8, v156, v157
    s_waitcnt lgkmcnt(4)
    v_mfma_f32_16x16x32_bf16 v[56:59], v[200:203], v[144:147], v[56:59]
    v_exp_f32 v13, v138
    v_mfma_f32_16x16x32_bf16 v[60:63], v[200:203], v[148:151], v[60:63]
    ds_read_b128 v[192:195], v3 offset:8192
    v_exp_f32 v14, v139
    s_nop 0
    v_cvt_pk_bf16_f32 v155, v13, v14
    ds_read_b128 v[196:199], v3 offset:9216
    v_mfma_f32_16x16x32_bf16 v[180:183], v[184:187], v[148:151], v[180:183]
    s_waitcnt lgkmcnt(4)
    v_exp_f32 v11, v140
    ds_read_b128 v[200:203], v3 offset:24576
    v_exp_f32 v12, v141
    v_mfma_f32_16x16x32_bf16 v[72:75], v[212:215], v[144:147], v[72:75]
    v_cvt_pk_bf16_f32 v158, v11, v12
    v_mfma_f32_16x16x32_bf16 v[76:79], v[212:215], v[148:151], v[76:79]
    ds_read_b128 v[204:207], v3 offset:10240
    v_or3_b32 v8, v8, v154, v155
    s_waitcnt lgkmcnt(4)
    v_mfma_f32_16x16x32_bf16 v[88:91], v[216:219], v[144:147], v[88:91]
    v_exp_f32 v13, v142
    v_mfma_f32_16x16x32_bf16 v[92:95], v[216:219], v[148:151], v[92:95]
    ds_read_b128 v[208:211], v3 offset:26624
    v_exp_f32 v14, v143
    v_mfma_f32_16x16x32_bf16 v[104:107], v[220:223], v[144:147], v[104:107]
    v_cvt_pk_bf16_f32 v159, v13, v14
    v_mfma_f32_16x16x32_bf16 v[108:111], v[220:223], v[148:151], v[108:111]
    ds_read_b128 v[212:215], v3 offset:11264
    v_or3_b32 v8, v8, v158, v159
    v_and_b32 v8, 0x40004000, v8
    v_cmp_ne_u32 vcc, s79, v8
    s_cbranch_vccnz SLOW_94
BACK_95:
    s_branch NEXT_88
PVONLY_86:
    s_sub_i32 s68, s73, 1
    s_cmp_gt_i32 s68, s70
    s_cbranch_scc1 IDLE_87
    s_waitcnt lgkmcnt(4)
    ds_read_b128 v[216:219], v3 offset:20480
    ds_read_b128 v[220:223], v3 offset:4096
    s_waitcnt lgkmcnt(4)
    v_mfma_f32_16x16x32_bf16 v[48:51], v[200:203], v[144:147], v[48:51]
    v_mfma_f32_16x16x32_bf16 v[52:55], v[200:203], v[148:151], v[52:55]
    ds_read_b128 v[192:195], v3 offset:22528
    ds_read_b128 v[196:199], v3 offset:5120
    s_waitcnt lgkmcnt(4)
    v_mfma_f32_16x16x32_bf16 v[64:67], v[208:211], v[144:147], v[64:67]
    v_mfma_f32_16x16x32_bf16 v[68:71], v[208:211], v[148:151], v[68:71]
    ds_read_b128 v[200:203], v3 offset:17408
    ds_read_b128 v[204:207], v3 offset:6144
    v_mfma_f32_16x16x32_bf16 v[176:179], v[184:187], v[144:147], v[176:179]
    s_waitcnt lgkmcnt(4)
    v_mfma_f32_16x16x32_bf16 v[80:83], v[216:219], v[144:147], v[80:83]
    v_mfma_f32_16x16x32_bf16 v[84:87], v[216:219], v[148:151], v[84:87]
    ds_read_b128 v[208:211], v3 offset:7168
    ds_read_b128 v[212:215], v3 offset:19456
    s_waitcnt lgkmcnt(4)
    v_mfma_f32_16x16x32_bf16 v[96:99], v[192:195], v[144:147], v[96:99]
    v_mfma_f32_16x16x32_bf16 v[100:103], v[192:195], v[148:151], v[100:103]
    ds_read_b128 v[216:219], v3 offset:21504
    ds_read_b128 v[220:223], v3 offset:23552
    s_waitcnt lgkmcnt(4)
    v_mfma_f32_16x16x32_bf16 v[56:59], v[200:203], v[144:147], v[56:59]
    v_mfma_f32_16x16x32_bf16 v[60:63], v[200:203], v[148:151], v[60:63]
    ds_read_b128 v[192:195], v3 offset:8192
    ds_read_b128 v[196:199], v3 offset:9216
    v_mfma_f32_16x16x32_bf16 v[180:183], v[184:187], v[148:151], v[180:183]
    s_waitcnt lgkmcnt(4)
    ds_read_b128 v[200:203], v3 offset:24576
    v_mfma_f32_16x16x32_bf16 v[72:75], v[212:215], v[144:147], v[72:75]
    v_mfma_f32_16x16x32_bf16 v[76:79], v[212:215], v[148:151], v[76:79]
    ds_read_b128 v[204:207], v3 offset:10240
    s_waitcnt lgkmcnt(4)
    v_mfma_f32_16x16x32_bf16 v[88:91], v[216:219], v[144:147], v[88:91]
    v_mfma_f32_16x16x32_bf16 v[92:95], v[216:219], v[148:151], v[92:95]
    ds_read_b128 v[208:211], v3 offset:26624
    v_mfma_f32_16x16x32_bf16 v[104:107], v[220:223], v[144:147], v[104:107]
    v_mfma_f32_16x16x32_bf16 v[108:111], v[220:223], v[148:151], v[108:111]
    ds_read_b128 v[212:215], v3 offset:11264
    s_nop 15
    v_rcp_f32 v5, v176
    v_rcp_f32 v6, v180
    s_nop 0
    v_mul_f32 v48, v48, v5
    v_mul_f32 v49, v49, v5
    v_mul_f32 v50, v50, v5
    v_mul_f32 v51, v51, v5
    v_mul_f32 v52, v52, v6
    v_mul_f32 v53, v53, v6
    v_mul_f32 v54, v54, v6
    v_mul_f32 v55, v55, v6
    v_mul_f32 v56, v56, v5
    v_mul_f32 v57, v57, v5
    v_mul_f32 v58, v58, v5
    v_mul_f32 v59, v59, v5
    v_mul_f32 v60, v60, v6
    v_mul_f32 v61, v61, v6
    v_mul_f32 v62, v62, v6
    v_mul_f32 v63, v63, v6
    v_mul_f32 v64, v64, v5
    v_mul_f32 v65, v65, v5
    v_mul_f32 v66, v66, v5
    v_mul_f32 v67, v67, v5
    v_mul_f32 v68, v68, v6
    v_mul_f32 v69, v69, v6
    v_mul_f32 v70, v70, v6
    v_mul_f32 v71, v71, v6
    v_mul_f32 v72, v72, v5
    v_mul_f32 v73, v73, v5
    v_mul_f32 v74, v74, v5
    v_mul_f32 v75, v75, v5
    v_mul_f32 v76, v76, v6
    v_mul_f32 v77, v77, v6
    v_mul_f32 v78, v78, v6
    v_mul_f32 v79, v79, v6
    v_mul_f32 v80, v80, v5
    v_mul_f32 v81, v81, v5
    v_mul_f32 v82, v82, v5
    v_mul_f32 v83, v83, v5
    v_mul_f32 v84, v84, v6
    v_mul_f32 v85, v85, v6
    v_mul_f32 v86, v86, v6
    v_mul_f32 v87, v87, v6
    v_mul_f32 v88, v88, v5
    v_mul_f32 v89, v89, v5
    v_mul_f32 v90, v90, v5
    v_mul_f32 v91, v91, v5
    v_mul_f32 v92, v92, v6
    v_mul_f32 v93, v93, v6
    v_mul_f32 v94, v94, v6
    v_mul_f32 v95, v95, v6
    v_mul_f32 v96, v96, v5
    v_mul_f32 v97, v97, v5
    v_mul_f32 v98, v98, v5
    v_mul_f32 v99, v99, v5
    v_mul_f32 v100, v100, v6
    v_mul_f32 v101, v101, v6
    v_mul_f32 v102, v102, v6
    v_mul_f32 v103, v103, v6
    v_mul_f32 v104, v104, v5
    v_mul_f32 v105, v105, v5
    v_mul_f32 v106, v106, v5
    v_mul_f32 v107, v107, v5
    v_mul_f32 v108, v108, v6
    v_mul_f32 v109, v109, v6
    v_mul_f32 v110, v110, v6
    v_mul_f32 v111, v111, v6
    v_cvt_pk_bf16_f32 v16, v48, v49
    v_cvt_pk_bf16_f32 v17, v50, v51
    v_cvt_pk_bf16_f32 v18, v56, v57
    v_cvt_pk_bf16_f32 v19, v58, v59
    v_cvt_pk_bf16_f32 v20, v52, v53
    v_cvt_pk_bf16_f32 v21, v54, v55
    v_cvt_pk_bf16_f32 v22, v60, v61
    v_cvt_pk_bf16_f32 v23, v62, v63
    v_cvt_pk_bf16_f32 v24, v64, v65
    v_cvt_pk_bf16_f32 v25, v66, v67
    v_cvt_pk_bf16_f32 v26, v72, v73
    v_cvt_pk_bf16_f32 v27, v74, v75
    v_cvt_pk_bf16_f32 v28, v68, v69
    v_cvt_pk_bf16_f32 v29, v70, v71
    v_cvt_pk_bf16_f32 v30, v76, v77
    v_cvt_pk_bf16_f32 v31, v78, v79
    v_cvt_pk_bf16_f32 v32, v80, v81
    v_cvt_pk_bf16_f32 v33, v82, v83
    v_cvt_pk_bf16_f32 v34, v88, v89
    v_cvt_pk_bf16_f32 v35, v90, v91
    v_cvt_pk_bf16_f32 v36, v84, v85
    v_cvt_pk_bf16_f32 v37, v86, v87
    v_cvt_pk_bf16_f32 v38, v92, v93
    v_cvt_pk_bf16_f32 v39, v94, v95
    v_cvt_pk_bf16_f32 v40, v96, v97
    v_cvt_pk_bf16_f32 v41, v98, v99
    v_cvt_pk_bf16_f32 v42, v104, v105
    v_cvt_pk_bf16_f32 v43, v106, v107
    v_cvt_pk_bf16_f32 v44, v100, v101
    v_cvt_pk_bf16_f32 v45, v102, v103
    v_cvt_pk_bf16_f32 v46, v108, v109
    v_cvt_pk_bf16_f32 v47, v110, v111
    s_lshl_b32 s68, s78, 8
    s_lshl_b32 s69, s66, 3
    s_add_u32 s68, s68, s69
    s_lshl_b32 s68, s68, 10
    s_add_u32 s68, s68, 33554432
    s_add_u32 s69, s68, 4096
    buffer_store_dwordx4 v[16:19], v9, s[56:59], s68 offen offset:0 sc1
    buffer_store_dwordx4 v[20:23], v9, s[56:59], s68 offen offset:256 sc1
    buffer_store_dwordx4 v[24:27], v9, s[56:59], s68 offen offset:2048 sc1
    buffer_store_dwordx4 v[28:31], v9, s[56:59], s68 offen offset:2304 sc1
    buffer_store_dwordx4 v[32:35], v9, s[56:59], s69 offen offset:0 sc1
    buffer_store_dwordx4 v[36:39], v9, s[56:59], s69 offen offset:256 sc1
    buffer_store_dwordx4 v[40:43], v9, s[56:59], s69 offen offset:2048 sc1
    buffer_store_dwordx4 v[44:47], v9, s[56:59], s69 offen offset:2304 sc1
    s_cmp_ge_u32 s64, 4
    s_cbranch_scc1 EF_98
    s_waitcnt vmcnt(0)
    s_lshl_b32 s10, s78, 5
    s_add_u32 s10, s10, s66
    s_lshl_b32 s10, s10, 3
    s_add_u32 s10, s10, 12288
    s_memrealtime s[12:13]
    v_mov_b32 v250, s10
    s_mov_b32 s8, 62914560
    s_waitcnt lgkmcnt(0)
    v_mov_b32 v248, s12
    v_mov_b32 v249, s13
    s_mov_b64 exec, 1
    buffer_store_dwordx2 v[248:249], v250, s[56:59], s8 offen sc1
    s_mov_b64 exec, -1
SY_99:
EF_98:
    s_branch NEXT_88
IDLE_87:
NEXT_88:
    s_lshl_b32 s73, s72, 1
    s_add_i32 s68, s73, 1
    s_cmp_lg_u32 s68, s70
    s_cbranch_scc1 NOMASK_105
    v_mov_b32 v5, 0xff7fffff
    v_cmp_gt_i32 vcc, 0, v15
    s_nop 1
    v_cndmask_b32 v160, v160, v5, vcc
    v_cmp_gt_i32 vcc, 1, v15
    s_nop 1
    v_cndmask_b32 v161, v161, v5, vcc
    v_cmp_gt_i32 vcc, 2, v15
    s_nop 1
    v_cndmask_b32 v162, v162, v5, vcc
    v_cmp_gt_i32 vcc, 3, v15
    s_nop 1
    v_cndmask_b32 v163, v163, v5, vcc
    v_cmp_gt_i32 vcc, -16, v15
    s_nop 1
    v_cndmask_b32 v164, v164, v5, vcc
    v_cmp_gt_i32 vcc, -15, v15
    s_nop 1
    v_cndmask_b32 v165, v165, v5, vcc
    v_cmp_gt_i32 vcc, -14, v15
    s_nop 1
    v_cndmask_b32 v166, v166, v5, vcc
    v_cmp_gt_i32 vcc, -13, v15
    s_nop 1
    v_cndmask_b32 v167, v167, v5, vcc
    v_cmp_gt_i32 vcc, 16, v15
    s_nop 1
    v_cndmask_b32 v168, v168, v5, vcc
    v_cmp_gt_i32 vcc, 17, v15
    s_nop 1
    v_cndmask_b32 v169, v169, v5, vcc
    v_cmp_gt_i32 vcc, 18, v15
    s_nop 1
    v_cndmask_b32 v170, v170, v5, vcc
    v_cmp_gt_i32 vcc, 19, v15
    s_nop 1
    v_cndmask_b32 v171, v171, v5, vcc
    v_cmp_gt_i32 vcc, 0, v15
    s_nop 1
    v_cndmask_b32 v172, v172, v5, vcc
    v_cmp_gt_i32 vcc, 1, v15
    s_nop 1
    v_cndmask_b32 v173, v173, v5, vcc
    v_cmp_gt_i32 vcc, 2, v15
    s_nop 1
    v_cndmask_b32 v174, v174, v5, vcc
    v_cmp_gt_i32 vcc, 3, v15
    s_nop 1
    v_cndmask_b32 v175, v175, v5, vcc
    s_nop 1
NOMASK_105:
    s_cmp_lt_i32 s73, 1
    s_cbranch_scc1 FIRST_100
    s_cmp_ge_i32 s73, s70
    s_cbranch_scc1 LAST_101
    s_waitcnt lgkmcnt(4)
    v_mfma_f32_16x16x32_bf16 v[128:131], v[192:195], v[16:19], v[160:163]
    v_exp_f32 v11, v112
    v_mfma_f32_16x16x32_bf16 v[132:135], v[192:195], v[20:23], v[164:167]
    ds_read_b128 v[216:219], v3 offset:28672
    v_exp_f32 v12, v113
    v_mfma_f32_16x16x32_bf16 v[136:139], v[196:199], v[16:19], v[168:171]
    v_cvt_pk_bf16_f32 v144, v11, v12
    v_mfma_f32_16x16x32_bf16 v[140:143], v[196:199], v[20:23], v[172:175]
    ds_read_b128 v[220:223], v3 offset:12288
    s_waitcnt lgkmcnt(4)
    v_mfma_f32_16x16x32_bf16 v[48:51], v[200:203], v[152:155], v[48:51]
    v_exp_f32 v13, v114
    v_mfma_f32_16x16x32_bf16 v[52:55], v[200:203], v[156:159], v[52:55]
    ds_read_b128 v[192:195], v3 offset:30720
    v_exp_f32 v14, v115
    v_mfma_f32_16x16x32_bf16 v[128:131], v[204:207], v[24:27], v[128:131]
    v_cvt_pk_bf16_f32 v145, v13, v14
    v_mfma_f32_16x16x32_bf16 v[132:135], v[204:207], v[28:31], v[132:135]
    ds_read_b128 v[196:199], v3 offset:13312
    s_waitcnt lgkmcnt(4)
    v_mfma_f32_16x16x32_bf16 v[64:67], v[208:211], v[152:155], v[64:67]
    v_exp_f32 v11, v116
    v_mfma_f32_16x16x32_bf16 v[68:71], v[208:211], v[156:159], v[68:71]
    ds_read_b128 v[200:203], v3 offset:25600
    v_exp_f32 v12, v117
    v_mfma_f32_16x16x32_bf16 v[136:139], v[212:215], v[24:27], v[136:139]
    v_cvt_pk_bf16_f32 v148, v11, v12
    v_mfma_f32_16x16x32_bf16 v[140:143], v[212:215], v[28:31], v[140:143]
    ds_read_b128 v[204:207], v3 offset:14336
    v_or_b32 v8, v144, v145
    v_mfma_f32_16x16x32_bf16 v[176:179], v[184:187], v[152:155], v[176:179]
    s_waitcnt lgkmcnt(4)
    v_mfma_f32_16x16x32_bf16 v[80:83], v[216:219], v[152:155], v[80:83]
    v_exp_f32 v13, v118
    v_mfma_f32_16x16x32_bf16 v[84:87], v[216:219], v[156:159], v[84:87]
    ds_read_b128 v[208:211], v3 offset:15360
    v_exp_f32 v14, v119
    v_mfma_f32_16x16x32_bf16 v[128:131], v[220:223], v[32:35], v[128:131]
    v_cvt_pk_bf16_f32 v149, v13, v14
    v_mfma_f32_16x16x32_bf16 v[132:135], v[220:223], v[36:39], v[132:135]
    ds_read_b128 v[212:215], v3 offset:27648
    s_waitcnt lgkmcnt(4)
    v_mfma_f32_16x16x32_bf16 v[96:99], v[192:195], v[152:155], v[96:99]
    v_exp_f32 v11, v120
    v_mfma_f32_16x16x32_bf16 v[100:103], v[192:195], v[156:159], v[100:103]
    s_cmp_eq_u32 s80, 4
    s_cbranch_scc1 W_108
    s_cmp_eq_u32 s80, 8
    s_cbranch_scc1 W_109
    s_waitcnt vmcnt(0)
W_108:
    s_waitcnt vmcnt(4)
W_109:
    s_waitcnt vmcnt(8)
    s_barrier
    s_mov_b32 s80, 0
    s_add_u32 s68, s72, 3
    s_cmp_gt_u32 s68, s71
    s_cbranch_scc1 W_111
    s_cmp_eq_u32 s68, s71
    s_cselect_b32 s68, 16384, 0
    s_sub_u32 s74, s74, s68
    s_cmp_ge_u32 s72, s81
    s_cbranch_scc1 W_112
    s_lshl_b32 s69, s64, 11
    s_add_u32 m0, s76, s69
    s_add_u32 s68, s74, s69
    buffer_load_dwordx4 v2, s[56:59], s68 offen lds
    buffer_load_dwordx4 v2, s[56:59], s68 offen offset:1024 lds
    s_add_u32 s68, s76, s69
    s_add_u32 m0, s68, 16384
    s_add_u32 s68, s75, s69
    buffer_load_dwordx4 v2, s[56:59], s68 offen lds
    buffer_load_dwordx4 v2, s[56:59], s68 offen offset:1024 lds
    s_mov_b32 s80, 4
    s_branch W_110
W_112:
    s_cmp_ge_u32 s64, 4
    s_cbranch_scc1 W_110
    s_lshl_b32 s69, s64, 12
    s_add_u32 m0, s76, s69
    s_add_u32 s68, s74, s69
    buffer_load_dwordx4 v2, s[56:59], s68 offen lds
    buffer_load_dwordx4 v2, s[56:59], s68 offen offset:1024 lds
    buffer_load_dwordx4 v2, s[56:59], s68 offen offset:2048 lds
    buffer_load_dwordx4 v2, s[56:59], s68 offen offset:3072 lds
    s_add_u32 s68, s76, s69
    s_add_u32 m0, s68, 16384
    s_add_u32 s68, s75, s69
    buffer_load_dwordx4 v2, s[56:59], s68 offen lds
    buffer_load_dwordx4 v2, s[56:59], s68 offen offset:1024 lds
    buffer_load_dwordx4 v2, s[56:59], s68 offen offset:2048 lds
    buffer_load_dwordx4 v2, s[56:59], s68 offen offset:3072 lds
    s_mov_b32 s80, 8
W_110:
    s_add_u32 s74, s74, 16384
    s_add_u32 s75, s75, 16384
    s_add_u32 s76, s76, 32768
    s_and_b32 s76, s76, 0x1ffff
W_111:
    ds_read_b128 v[216:219], v3 offset:29696
    v_exp_f32 v12, v121
    v_mfma_f32_16x16x32_bf16 v[136:139], v[196:199], v[32:35], v[136:139]
    v_cvt_pk_bf16_f32 v146, v11, v12
    v_mfma_f32_16x16x32_bf16 v[140:143], v[196:199], v[36:39], v[140:143]
    ds_read_b128 v[220:223], v3 offset:31744
    v_or3_b32 v8, v8, v148, v149
    s_waitcnt lgkmcnt(4)
    v_mfma_f32_16x16x32_bf16 v[56:59], v[200:203], v[152:155], v[56:59]
    v_exp_f32 v13, v122
    v_mfma_f32_16x16x32_bf16 v[60:63], v[200:203], v[156:159], v[60:63]
    ds_read_b128 v[192:195], v4 offset:0
    v_exp_f32 v14, v123
    v_mfma_f32_16x16x32_bf16 v[128:131], v[204:207], v[40:43], v[128:131]
    v_cvt_pk_bf16_f32 v147, v13, v14
    v_mfma_f32_16x16x32_bf16 v[132:135], v[204:207], v[44:47], v[132:135]
    ds_read_b128 v[196:199], v4 offset:1024
    v_mfma_f32_16x16x32_bf16 v[180:183], v[184:187], v[156:159], v[180:183]
    s_waitcnt lgkmcnt(4)
    v_mfma_f32_16x16x32_bf16 v[136:139], v[208:211], v[40:43], v[136:139]
    v_exp_f32 v11, v124
    v_mfma_f32_16x16x32_bf16 v[140:143], v[208:211], v[44:47], v[140:143]
    ds_read_b128 v[200:203], v4 offset:16384
    v_exp_f32 v12, v125
    v_mfma_f32_16x16x32_bf16 v[72:75], v[212:215], v[152:155], v[72:75]
    v_cvt_pk_bf16_f32 v150, v11, v12
    v_mfma_f32_16x16x32_bf16 v[76:79], v[212:215], v[156:159], v[76:79]
    ds_read_b128 v[204:207], v4 offset:2048
    v_or3_b32 v8, v8, v146, v147
    s_waitcnt lgkmcnt(4)
    v_mfma_f32_16x16x32_bf16 v[88:91], v[216:219], v[152:155], v[88:91]
    v_exp_f32 v13, v126
    v_mfma_f32_16x16x32_bf16 v[92:95], v[216:219], v[156:159], v[92:95]
    ds_read_b128 v[208:211], v4 offset:18432
    v_exp_f32 v14, v127
    v_mfma_f32_16x16x32_bf16 v[104:107], v[220:223], v[152:155], v[104:107]
    v_cvt_pk_bf16_f32 v151, v13, v14
    v_mfma_f32_16x16x32_bf16 v[108:111], v[220:223], v[156:159], v[108:111]
    ds_read_b128 v[212:215], v4 offset:3072
    v_or3_b32 v8, v8, v150, v151
    v_and_b32 v8, 0x40004000, v8
    v_cmp_ne_u32 vcc, s79, v8
    s_cbranch_vccnz SLOW_106
BACK_107:
    s_branch NEXT_104
FIRST_100:
    s_mov_b32 s79, 1
    s_waitcnt lgkmcnt(4)
    v_mfma_f32_16x16x32_bf16 v[128:131], v[192:195], v[16:19], v[160:163]
    v_exp_f32 v11, v112
    v_mfma_f32_16x16x32_bf16 v[132:135], v[192:195], v[20:23], v[164:167]
    ds_read_b128 v[216:219], v3 offset:28672
    v_exp_f32 v12, v113
    v_mfma_f32_16x16x32_bf16 v[136:139], v[196:199], v[16:19], v[168:171]
    v_cvt_pk_bf16_f32 v144, v11, v12
    v_mfma_f32_16x16x32_bf16 v[140:143], v[196:199], v[20:23], v[172:175]
    ds_read_b128 v[220:223], v3 offset:12288
    s_waitcnt lgkmcnt(4)
    v_exp_f32 v13, v114
    ds_read_b128 v[192:195], v3 offset:30720
    v_exp_f32 v14, v115
    v_mfma_f32_16x16x32_bf16 v[128:131], v[204:207], v[24:27], v[128:131]
    v_cvt_pk_bf16_f32 v145, v13, v14
    v_mfma_f32_16x16x32_bf16 v[132:135], v[204:207], v[28:31], v[132:135]
    ds_read_b128 v[196:199], v3 offset:13312
    s_waitcnt lgkmcnt(4)
    v_exp_f32 v11, v116
    ds_read_b128 v[200:203], v3 offset:25600
    v_exp_f32 v12, v117
    v_mfma_f32_16x16x32_bf16 v[136:139], v[212:215], v[24:27], v[136:139]
    v_cvt_pk_bf16_f32 v148, v11, v12
    v_mfma_f32_16x16x32_bf16 v[140:143], v[212:215], v[28:31], v[140:143]
    ds_read_b128 v[204:207], v3 offset:14336
    v_or_b32 v8, v144, v145
    s_waitcnt lgkmcnt(4)
    v_exp_f32 v13, v118
    ds_read_b128 v[208:211], v3 offset:15360
    v_exp_f32 v14, v119
    v_mfma_f32_16x16x32_bf16 v[128:131], v[220:223], v[32:35], v[128:131]
    v_cvt_pk_bf16_f32 v149, v13, v14
    v_mfma_f32_16x16x32_bf16 v[132:135], v[220:223], v[36:39], v[132:135]
    ds_read_b128 v[212:215], v3 offset:27648
    s_waitcnt lgkmcnt(4)
    v_exp_f32 v11, v120
    s_cmp_eq_u32 s80, 4
    s_cbranch_scc1 W_115
    s_cmp_eq_u32 s80, 8
    s_cbranch_scc1 W_116
    s_waitcnt vmcnt(0)
W_115:
    s_waitcnt vmcnt(4)
W_116:
    s_waitcnt vmcnt(8)
    s_barrier
    s_mov_b32 s80, 0
    s_add_u32 s68, s72, 3
    s_cmp_gt_u32 s68, s71
    s_cbranch_scc1 W_118
    s_cmp_eq_u32 s68, s71
    s_cselect_b32 s68, 16384, 0
    s_sub_u32 s74, s74, s68
    s_cmp_ge_u32 s72, s81
    s_cbranch_scc1 W_119
    s_lshl_b32 s69, s64, 11
    s_add_u32 m0, s76, s69
    s_add_u32 s68, s74, s69
    buffer_load_dwordx4 v2, s[56:59], s68 offen lds
    buffer_load_dwordx4 v2, s[56:59], s68 offen offset:1024 lds
    s_add_u32 s68, s76, s69
    s_add_u32 m0, s68, 16384
    s_add_u32 s68, s75, s69
    buffer_load_dwordx4 v2, s[56:59], s68 offen lds
    buffer_load_dwordx4 v2, s[56:59], s68 offen offset:1024 lds
    s_mov_b32 s80, 4
    s_branch W_117
W_119:
    s_cmp_ge_u32 s64, 4
    s_cbranch_scc1 W_117
    s_lshl_b32 s69, s64, 12
    s_add_u32 m0, s76, s69
    s_add_u32 s68, s74, s69
    buffer_load_dwordx4 v2, s[56:59], s68 offen lds
    buffer_load_dwordx4 v2, s[56:59], s68 offen offset:1024 lds
    buffer_load_dwordx4 v2, s[56:59], s68 offen offset:2048 lds
    buffer_load_dwordx4 v2, s[56:59], s68 offen offset:3072 lds
    s_add_u32 s68, s76, s69
    s_add_u32 m0, s68, 16384
    s_add_u32 s68, s75, s69
    buffer_load_dwordx4 v2, s[56:59], s68 offen lds
    buffer_load_dwordx4 v2, s[56:59], s68 offen offset:1024 lds
    buffer_load_dwordx4 v2, s[56:59], s68 offen offset:2048 lds
    buffer_load_dwordx4 v2, s[56:59], s68 offen offset:3072 lds
    s_mov_b32 s80, 8
W_117:
    s_add_u32 s74, s74, 16384
    s_add_u32 s75, s75, 16384
    s_add_u32 s76, s76, 32768
    s_and_b32 s76, s76, 0x1ffff
W_118:
    ds_read_b128 v[216:219], v3 offset:29696
    v_exp_f32 v12, v121
    v_mfma_f32_16x16x32_bf16 v[136:139], v[196:199], v[32:35], v[136:139]
    v_cvt_pk_bf16_f32 v146, v11, v12
    v_mfma_f32_16x16x32_bf16 v[140:143], v[196:199], v[36:39], v[140:143]
    ds_read_b128 v[220:223], v3 offset:31744
    v_or3_b32 v8, v8, v148, v149
    s_waitcnt lgkmcnt(4)
    v_exp_f32 v13, v122
    ds_read_b128 v[192:195], v4 offset:0
    v_exp_f32 v14, v123
    v_mfma_f32_16x16x32_bf16 v[128:131], v[204:207], v[40:43], v[128:131]
    v_cvt_pk_bf16_f32 v147, v13, v14
    v_mfma_f32_16x16x32_bf16 v[132:135], v[204:207], v[44:47], v[132:135]
    ds_read_b128 v[196:199], v4 offset:1024
    s_waitcnt lgkmcnt(4)
    v_mfma_f32_16x16x32_bf16 v[136:139], v[208:211], v[40:43], v[136:139]
    v_exp_f32 v11, v124
    v_mfma_f32_16x16x32_bf16 v[140:143], v[208:211], v[44:47], v[140:143]
    ds_read_b128 v[200:203], v4 offset:16384
    v_exp_f32 v12, v125
    s_nop 0
    v_cvt_pk_bf16_f32 v150, v11, v12
    ds_read_b128 v[204:207], v4 offset:2048
    v_or3_b32 v8, v8, v146, v147
    s_waitcnt lgkmcnt(4)
    v_exp_f32 v13, v126
    ds_read_b128 v[208:211], v4 offset:18432
    v_exp_f32 v14, v127
    s_nop 0
    v_cvt_pk_bf16_f32 v151, v13, v14
    ds_read_b128 v[212:215], v4 offset:3072
    v_or3_b32 v8, v8, v150, v151
    v_and_b32 v8, 0x40004000, v8
    s_nop 3
    v_cmp_ne_u32 vcc, s79, v8
    s_cbranch_vccnz SLOW_113
BACK_114:
    s_branch NEXT_104
LAST_101:
    s_cmp_gt_i32 s73, s70
    s_cbranch_scc1 PVONLY_102
    s_waitcnt lgkmcnt(4)
    v_exp_f32 v11, v112
    ds_read_b128 v[216:219], v3 offset:28672
    v_exp_f32 v12, v113
    s_nop 0
    v_cvt_pk_bf16_f32 v144, v11, v12
    ds_read_b128 v[220:223], v3 offset:12288
    s_waitcnt lgkmcnt(4)
    v_mfma_f32_16x16x32_bf16 v[48:51], v[200:203], v[152:155], v[48:51]
    v_exp_f32 v13, v114
    v_mfma_f32_16x16x32_bf16 v[52:55], v[200:203], v[156:159], v[52:55]
    ds_read_b128 v[192:195], v3 offset:30720
    v_exp_f32 v14, v115
    s_nop 0
    v_cvt_pk_bf16_f32 v145, v13, v14
    ds_read_b128 v[196:199], v3 offset:13312
    s_waitcnt lgkmcnt(4)
    v_mfma_f32_16x16x32_bf16 v[64:67], v[208:211], v[152:155], v[64:67]
    v_exp_f32 v11, v116
    v_mfma_f32_16x16x32_bf16 v[68:71], v[208:211], v[156:159], v[68:71]
    ds_read_b128 v[200:203], v3 offset:25600
    v_exp_f32 v12, v117
    s_nop 0
    v_cvt_pk_bf16_f32 v148, v11, v12
    ds_read_b128 v[204:207], v3 offset:14336
    v_or_b32 v8, v144, v145
    v_mfma_f32_16x16x32_bf16 v[176:179], v[184:187], v[152:155], v[176:179]
    s_waitcnt lgkmcnt(4)
    v_mfma_f32_16x16x32_bf16 v[80:83], v[216:219], v[152:155], v[80:83]
    v_exp_f32 v13, v118
    v_mfma_f32_16x16x32_bf16 v[84:87], v[216:219], v[156:159], v[84:87]
    ds_read_b128 v[208:211], v3 offset:15360
    v_exp_f32 v14, v119
    s_nop 0
    v_cvt_pk_bf16_f32 v149, v13, v14
    ds_read_b128 v[212:215], v3 offset:27648
    s_waitcnt lgkmcnt(4)
    v_mfma_f32_16x16x32_bf16 v[96:99], v[192:195], v[152:155], v[96:99]
    v_exp_f32 v11, v120
    v_mfma_f32_16x16x32_bf16 v[100:103], v[192:195], v[156:159], v[100:103]
    s_cmp_eq_u32 s80, 4
    s_cbranch_scc1 W_122
    s_cmp_eq_u32 s80, 8
    s_cbranch_scc1 W_123
    s_waitcnt vmcnt(0)
W_122:
    s_waitcnt vmcnt(4)
W_123:
    s_waitcnt vmcnt(8)
    s_barrier
    s_mov_b32 s80, 0
    s_add_u32 s68, s72, 3
    s_cmp_gt_u32 s68, s71
    s_cbranch_scc1 W_125
    s_cmp_eq_u32 s68, s71
    s_cselect_b32 s68, 16384, 0
    s_sub_u32 s74, s74, s68
    s_cmp_ge_u32 s72, s81
    s_cbranch_scc1 W_126
    s_lshl_b32 s69, s64, 11
    s_add_u32 m0, s76, s69
    s_add_u32 s68, s74, s69
    buffer_load_dwordx4 v2, s[56:59], s68 offen lds
    buffer_load_dwordx4 v2, s[56:59], s68 offen offset:1024 lds
    s_add_u32 s68, s76, s69
    s_add_u32 m0, s68, 16384
    s_add_u32 s68, s75, s69
    buffer_load_dwordx4 v2, s[56:59], s68 offen lds
    buffer_load_dwordx4 v2, s[56:59], s68 offen offset:1024 lds
    s_mov_b32 s80, 4
    s_branch W_124
W_126:
    s_cmp_ge_u32 s64, 4
    s_cbranch_scc1 W_124
    s_lshl_b32 s69, s64, 12
    s_add_u32 m0, s76, s69
    s_add_u32 s68, s74, s69
    buffer_load_dwordx4 v2, s[56:59], s68 offen lds
    buffer_load_dwordx4 v2, s[56:59], s68 offen offset:1024 lds
    buffer_load_dwordx4 v2, s[56:59], s68 offen offset:2048 lds
    buffer_load_dwordx4 v2, s[56:59], s68 offen offset:3072 lds
    s_add_u32 s68, s76, s69
    s_add_u32 m0, s68, 16384
    s_add_u32 s68, s75, s69
    buffer_load_dwordx4 v2, s[56:59], s68 offen lds
    buffer_load_dwordx4 v2, s[56:59], s68 offen offset:1024 lds
    buffer_load_dwordx4 v2, s[56:59], s68 offen offset:2048 lds
    buffer_load_dwordx4 v2, s[56:59], s68 offen offset:3072 lds
    s_mov_b32 s80, 8
W_124:
    s_add_u32 s74, s74, 16384
    s_add_u32 s75, s75, 16384
    s_add_u32 s76, s76, 32768
    s_and_b32 s76, s76, 0x1ffff
W_125:
    ds_read_b128 v[216:219], v3 offset:29696
    v_exp_f32 v12, v121
    s_nop 0
    v_cvt_pk_bf16_f32 v146, v11, v12
    ds_read_b128 v[220:223], v3 offset:31744
    v_or3_b32 v8, v8, v148, v149
    s_waitcnt lgkmcnt(4)
    v_mfma_f32_16x16x32_bf16 v[56:59], v[200:203], v[152:155], v[56:59]
    v_exp_f32 v13, v122
    v_mfma_f32_16x16x32_bf16 v[60:63], v[200:203], v[156:159], v[60:63]
    ds_read_b128 v[192:195], v4 offset:0
    v_exp_f32 v14, v123
    s_nop 0
    v_cvt_pk_bf16_f32 v147, v13, v14
    ds_read_b128 v[196:199], v4 offset:1024
    v_mfma_f32_16x16x32_bf16 v[180:183], v[184:187], v[156:159], v[180:183]
    s_waitcnt lgkmcnt(4)
    v_exp_f32 v11, v124
    ds_read_b128 v[200:203], v4 offset:16384
    v_exp_f32 v12, v125
    v_mfma_f32_16x16x32_bf16 v[72:75], v[212:215], v[152:155], v[72:75]
    v_cvt_pk_bf16_f32 v150, v11, v12
    v_mfma_f32_16x16x32_bf16 v[76:79], v[212:215], v[156:159], v[76:79]
    ds_read_b128 v[204:207], v4 offset:2048
    v_or3_b32 v8, v8, v146, v147
    s_waitcnt lgkmcnt(4)
    v_mfma_f32_16x16x32_bf16 v[88:91], v[216:219], v[152:155], v[88:91]
    v_exp_f32 v13, v126
    v_mfma_f32_16x16x32_bf16 v[92:95], v[216:219], v[156:159], v[92:95]
    ds_read_b128 v[208:211], v4 offset:18432
    v_exp_f32 v14, v127
    v_mfma_f32_16x16x32_bf16 v[104:107], v[220:223], v[152:155], v[104:107]
    v_cvt_pk_bf16_f32 v151, v13, v14
    v_mfma_f32_16x16x32_bf16 v[108:111], v[220:223], v[156:159], v[108:111]
    ds_read_b128 v[212:215], v4 offset:3072
    v_or3_b32 v8, v8, v150, v151
    v_and_b32 v8, 0x40004000, v8
    v_cmp_ne_u32 vcc, s79, v8
    s_cbranch_vccnz SLOW_120
BACK_121:
    s_branch NEXT_104
PVONLY_102:
    s_sub_i32 s68, s73, 1
    s_cmp_gt_i32 s68, s70
    s_cbranch_scc1 IDLE_103
    s_waitcnt lgkmcnt(4)
    ds_read_b128 v[216:219], v3 offset:28672
    ds_read_b128 v[220:223], v3 offset:12288
    s_waitcnt lgkmcnt(4)
    v_mfma_f32_16x16x32_bf16 v[48:51], v[200:203], v[152:155], v[48:51]
    v_mfma_f32_16x16x32_bf16 v[52:55], v[200:203], v[156:159], v[52:55]
    ds_read_b128 v[192:195], v3 offset:30720
    ds_read_b128 v[196:199], v3 offset:13312
    s_waitcnt lgkmcnt(4)
    v_mfma_f32_16x16x32_bf16 v[64:67], v[208:211], v[152:155], v[64:67]
    v_mfma_f32_16x16x32_bf16 v[68:71], v[208:211], v[156:159], v[68:71]
    ds_read_b128 v[200:203], v3 offset:25600
    ds_read_b128 v[204:207], v3 offset:14336
    v_mfma_f32_16x16x32_bf16 v[176:179], v[184:187], v[152:155], v[176:179]
    s_waitcnt lgkmcnt(4)
    v_mfma_f32_16x16x32_bf16 v[80:83], v[216:219], v[152:155], v[80:83]
    v_mfma_f32_16x16x32_bf16 v[84:87], v[216:219], v[156:159], v[84:87]
    ds_read_b128 v[208:211], v3 offset:15360
    ds_read_b128 v[212:215], v3 offset:27648
    s_waitcnt lgkmcnt(4)
    v_mfma_f32_16x16x32_bf16 v[96:99], v[192:195], v[152:155], v[96:99]
    v_mfma_f32_16x16x32_bf16 v[100:103], v[192:195], v[156:159], v[100:103]
    s_cmp_eq_u32 s80, 4
    s_cbranch_scc1 W_129
    s_cmp_eq_u32 s80, 8
    s_cbranch_scc1 W_130
    s_waitcnt vmcnt(0)
W_129:
    s_waitcnt vmcnt(4)
W_130:
    s_waitcnt vmcnt(8)
    s_barrier
    s_mov_b32 s80, 0
    s_add_u32 s68, s72, 3
    s_cmp_gt_u32 s68, s71
    s_cbranch_scc1 W_132
    s_cmp_eq_u32 s68, s71
    s_cselect_b32 s68, 16384, 0
    s_sub_u32 s74, s74, s68
    s_cmp_ge_u32 s72, s81
    s_cbranch_scc1 W_133
    s_lshl_b32 s69, s64, 11
    s_add_u32 m0, s76, s69
    s_add_u32 s68, s74, s69
    buffer_load_dwordx4 v2, s[56:59], s68 offen lds
    buffer_load_dwordx4 v2, s[56:59], s68 offen offset:1024 lds
    s_add_u32 s68, s76, s69
    s_add_u32 m0, s68, 16384
    s_add_u32 s68, s75, s69
    buffer_load_dwordx4 v2, s[56:59], s68 offen lds
    buffer_load_dwordx4 v2, s[56:59], s68 offen offset:1024 lds
    s_mov_b32 s80, 4
    s_branch W_131
W_133:
    s_cmp_ge_u32 s64, 4
    s_cbranch_scc1 W_131
    s_lshl_b32 s69, s64, 12
    s_add_u32 m0, s76, s69
    s_add_u32 s68, s74, s69
    buffer_load_dwordx4 v2, s[56:59], s68 offen lds
    buffer_load_dwordx4 v2, s[56:59], s68 offen offset:1024 lds
    buffer_load_dwordx4 v2, s[56:59], s68 offen offset:2048 lds
    buffer_load_dwordx4 v2, s[56:59], s68 offen offset:3072 lds
    s_add_u32 s68, s76, s69
    s_add_u32 m0, s68, 16384
    s_add_u32 s68, s75, s69
    buffer_load_dwordx4 v2, s[56:59], s68 offen lds
    buffer_load_dwordx4 v2, s[56:59], s68 offen offset:1024 lds
    buffer_load_dwordx4 v2, s[56:59], s68 offen offset:2048 lds
    buffer_load_dwordx4 v2, s[56:59], s68 offen offset:3072 lds
    s_mov_b32 s80, 8
W_131:
    s_add_u32 s74, s74, 16384
    s_add_u32 s75, s75, 16384
    s_add_u32 s76, s76, 32768
    s_and_b32 s76, s76, 0x1ffff
W_132:
    ds_read_b128 v[216:219], v3 offset:29696
    ds_read_b128 v[220:223], v3 offset:31744
    s_waitcnt lgkmcnt(4)
    v_mfma_f32_16x16x32_bf16 v[56:59], v[200:203], v[152:155], v[56:59]
    v_mfma_f32_16x16x32_bf16 v[60:63], v[200:203], v[156:159], v[60:63]
    ds_read_b128 v[192:195], v4 offset:0
    ds_read_b128 v[196:199], v4 offset:1024
    v_mfma_f32_16x16x32_bf16 v[180:183], v[184:187], v[156:159], v[180:183]
    s_waitcnt lgkmcnt(4)
    ds_read_b128 v[200:203], v4 offset:16384
    v_mfma_f32_16x16x32_bf16 v[72:75], v[212:215], v[152:155], v[72:75]
    v_mfma_f32_16x16x32_bf16 v[76:79], v[212:215], v[156:159], v[76:79]
    ds_read_b128 v[204:207], v4 offset:2048
    s_waitcnt lgkmcnt(4)
    v_mfma_f32_16x16x32_bf16 v[88:91], v[216:219], v[152:155], v[88:91]
    v_mfma_f32_16x16x32_bf16 v[92:95], v[216:219], v[156:159], v[92:95]
    ds_read_b128 v[208:211], v4 offset:18432
    v_mfma_f32_16x16x32_bf16 v[104:107], v[220:223], v[152:155], v[104:107]
    v_mfma_f32_16x16x32_bf16 v[108:111], v[220:223], v[156:159], v[108:111]
    ds_read_b128 v[212:215], v4 offset:3072
    s_nop 15
    v_rcp_f32 v5, v176
    v_rcp_f32 v6, v180
    s_nop 0
    v_mul_f32 v48, v48, v5
    v_mul_f32 v49, v49, v5
    v_mul_f32 v50, v50, v5
    v_mul_f32 v51, v51, v5
    v_mul_f32 v52, v52, v6
    v_mul_f32 v53, v53, v6
    v_mul_f32 v54, v54, v6
    v_mul_f32 v55, v55, v6
    v_mul_f32 v56, v56, v5
    v_mul_f32 v57, v57, v5
    v_mul_f32 v58, v58, v5
    v_mul_f32 v59, v59, v5
    v_mul_f32 v60, v60, v6
    v_mul_f32 v61, v61, v6
    v_mul_f32 v62, v62, v6
    v_mul_f32 v63, v63, v6
    v_mul_f32 v64, v64, v5
    v_mul_f32 v65, v65, v5
    v_mul_f32 v66, v66, v5
    v_mul_f32 v67, v67, v5
    v_mul_f32 v68, v68, v6
    v_mul_f32 v69, v69, v6
    v_mul_f32 v70, v70, v6
    v_mul_f32 v71, v71, v6
    v_mul_f32 v72, v72, v5
    v_mul_f32 v73, v73, v5
    v_mul_f32 v74, v74, v5
    v_mul_f32 v75, v75, v5
    v_mul_f32 v76, v76, v6
    v_mul_f32 v77, v77, v6
    v_mul_f32 v78, v78, v6
    v_mul_f32 v79, v79, v6
    v_mul_f32 v80, v80, v5
    v_mul_f32 v81, v81, v5
    v_mul_f32 v82, v82, v5
    v_mul_f32 v83, v83, v5
    v_mul_f32 v84, v84, v6
    v_mul_f32 v85, v85, v6
    v_mul_f32 v86, v86, v6
    v_mul_f32 v87, v87, v6
    v_mul_f32 v88, v88, v5
    v_mul_f32 v89, v89, v5
    v_mul_f32 v90, v90, v5
    v_mul_f32 v91, v91, v5
    v_mul_f32 v92, v92, v6
    v_mul_f32 v93, v93, v6
    v_mul_f32 v94, v94, v6
    v_mul_f32 v95, v95, v6
    v_mul_f32 v96, v96, v5
    v_mul_f32 v97, v97, v5
    v_mul_f32 v98, v98, v5
    v_mul_f32 v99, v99, v5
    v_mul_f32 v100, v100, v6
    v_mul_f32 v101, v101, v6
    v_mul_f32 v102, v102, v6
    v_mul_f32 v103, v103, v6
    v_mul_f32 v104, v104, v5
    v_mul_f32 v105, v105, v5
    v_mul_f32 v106, v106, v5
    v_mul_f32 v107, v107, v5
    v_mul_f32 v108, v108, v6
    v_mul_f32 v109, v109, v6
    v_mul_f32 v110, v110, v6
    v_mul_f32 v111, v111, v6
    v_cvt_pk_bf16_f32 v16, v48, v49
    v_cvt_pk_bf16_f32 v17, v50, v51
    v_cvt_pk_bf16_f32 v18, v56, v57
    v_cvt_pk_bf16_f32 v19, v58, v59
    v_cvt_pk_bf16_f32 v20, v52, v53
    v_cvt_pk_bf16_f32 v21, v54, v55
    v_cvt_pk_bf16_f32 v22, v60, v61
    v_cvt_pk_bf16_f32 v23, v62, v63
    v_cvt_pk_bf16_f32 v24, v64, v65
    v_cvt_pk_bf16_f32 v25, v66, v67
    v_cvt_pk_bf16_f32 v26, v72, v73
    v_cvt_pk_bf16_f32 v27, v74, v75
    v_cvt_pk_bf16_f32 v28, v68, v69
    v_cvt_pk_bf16_f32 v29, v70, v71
    v_cvt_pk_bf16_f32 v30, v76, v77
    v_cvt_pk_bf16_f32 v31, v78, v79
    v_cvt_pk_bf16_f32 v32, v80, v81
    v_cvt_pk_bf16_f32 v33, v82, v83
    v_cvt_pk_bf16_f32 v34, v88, v89
    v_cvt_pk_bf16_f32 v35, v90, v91
    v_cvt_pk_bf16_f32 v36, v84, v85
    v_cvt_pk_bf16_f32 v37, v86, v87
    v_cvt_pk_bf16_f32 v38, v92, v93
    v_cvt_pk_bf16_f32 v39, v94, v95
    v_cvt_pk_bf16_f32 v40, v96, v97
    v_cvt_pk_bf16_f32 v41, v98, v99
    v_cvt_pk_bf16_f32 v42, v104, v105
    v_cvt_pk_bf16_f32 v43, v106, v107
    v_cvt_pk_bf16_f32 v44, v100, v101
    v_cvt_pk_bf16_f32 v45, v102, v103
    v_cvt_pk_bf16_f32 v46, v108, v109
    v_cvt_pk_bf16_f32 v47, v110, v111
    s_lshl_b32 s68, s78, 8
    s_lshl_b32 s69, s66, 3
    s_add_u32 s68, s68, s69
    s_lshl_b32 s68, s68, 10
    s_add_u32 s68, s68, 33554432
    s_add_u32 s69, s68, 4096
    buffer_store_dwordx4 v[16:19], v9, s[56:59], s68 offen offset:0 sc1
    buffer_store_dwordx4 v[20:23], v9, s[56:59], s68 offen offset:256 sc1
    buffer_store_dwordx4 v[24:27], v9, s[56:59], s68 offen offset:2048 sc1
    buffer_store_dwordx4 v[28:31], v9, s[56:59], s68 offen offset:2304 sc1
    buffer_store_dwordx4 v[32:35], v9, s[56:59], s69 offen offset:0 sc1
    buffer_store_dwordx4 v[36:39], v9, s[56:59], s69 offen offset:256 sc1
    buffer_store_dwordx4 v[40:43], v9, s[56:59], s69 offen offset:2048 sc1
    buffer_store_dwordx4 v[44:47], v9, s[56:59], s69 offen offset:2304 sc1
    s_cmp_ge_u32 s64, 4
    s_cbranch_scc1 EF_134
    s_waitcnt vmcnt(0)
    s_lshl_b32 s10, s78, 5
    s_add_u32 s10, s10, s66
    s_lshl_b32 s10, s10, 3
    s_add_u32 s10, s10, 12288
    s_memrealtime s[12:13]
    v_mov_b32 v250, s10
    s_mov_b32 s8, 62914560
    s_waitcnt lgkmcnt(0)
    v_mov_b32 v248, s12
    v_mov_b32 v249, s13
    s_mov_b64 exec, 1
    buffer_store_dwordx2 v[248:249], v250, s[56:59], s8 offen sc1
    s_mov_b64 exec, -1
SY_135:
EF_134:
    s_branch NEXT_104
IDLE_103:
    s_cmp_eq_u32 s80, 4
    s_cbranch_scc1 W_136
    s_cmp_eq_u32 s80, 8
    s_cbranch_scc1 W_137
    s_waitcnt vmcnt(0)
W_136:
    s_waitcnt vmcnt(4)
W_137:
    s_waitcnt vmcnt(8)
    s_barrier
    s_mov_b32 s80, 0
    s_add_u32 s68, s72, 3
    s_cmp_gt_u32 s68, s71
    s_cbranch_scc1 W_139
    s_cmp_eq_u32 s68, s71
    s_cselect_b32 s68, 16384, 0
    s_sub_u32 s74, s74, s68
    s_cmp_ge_u32 s72, s81
    s_cbranch_scc1 W_140
    s_lshl_b32 s69, s64, 11
    s_add_u32 m0, s76, s69
    s_add_u32 s68, s74, s69
    buffer_load_dwordx4 v2, s[56:59], s68 offen lds
    buffer_load_dwordx4 v2, s[56:59], s68 offen offset:1024 lds
    s_add_u32 s68, s76, s69
    s_add_u32 m0, s68, 16384
    s_add_u32 s68, s75, s69
    buffer_load_dwordx4 v2, s[56:59], s68 offen lds
    buffer_load_dwordx4 v2, s[56:59], s68 offen offset:1024 lds
    s_mov_b32 s80, 4
    s_branch W_138
W_140:
    s_cmp_ge_u32 s64, 4
    s_cbranch_scc1 W_138
    s_lshl_b32 s69, s64, 12
    s_add_u32 m0, s76, s69
    s_add_u32 s68, s74, s69
    buffer_load_dwordx4 v2, s[56:59], s68 offen lds
    buffer_load_dwordx4 v2, s[56:59], s68 offen offset:1024 lds
    buffer_load_dwordx4 v2, s[56:59], s68 offen offset:2048 lds
    buffer_load_dwordx4 v2, s[56:59], s68 offen offset:3072 lds
    s_add_u32 s68, s76, s69
    s_add_u32 m0, s68, 16384
    s_add_u32 s68, s75, s69
    buffer_load_dwordx4 v2, s[56:59], s68 offen lds
    buffer_load_dwordx4 v2, s[56:59], s68 offen offset:1024 lds
    buffer_load_dwordx4 v2, s[56:59], s68 offen offset:2048 lds
    buffer_load_dwordx4 v2, s[56:59], s68 offen offset:3072 lds
    s_mov_b32 s80, 8
W_138:
    s_add_u32 s74, s74, 16384
    s_add_u32 s75, s75, 16384
    s_add_u32 s76, s76, 32768
    s_and_b32 s76, s76, 0x1ffff
W_139:
NEXT_104:
    v_mov_b32 v3, v4
    s_add_u32 s72, s72, 1
    s_add_u32 s68, s72, 1
    s_and_b32 s68, s68, 3
    s_lshl_b32 s68, s68, 15
    v_add_u32 v4, s68, v2
    s_cmp_le_u32 s72, s71
    s_cbranch_scc1 ATT_LOOP_71
    s_branch ATT_EXIT_72
SLOW_76:
    s_nop 15
    v_max3_f32 v5, v128, v129, v130
    v_max3_f32 v5, v5, v131, v136
    v_max3_f32 v5, v5, v137, v138
    v_max_f32 v5, v5, v139
    v_mov_b32 v7, v5
    s_nop 1
    v_permlane32_swap_b32 v5, v7
    s_nop 1
    v_max_f32 v5, v5, v7
    v_mov_b32 v7, v5
    s_nop 1
    v_permlane16_swap_b32 v5, v7
    s_nop 1
    v_max_f32 v5, v5, v7
    v_add_f32 v5, 0x42800000, v5
    v_max_f32 v5, s77, v5
    v_max3_f32 v6, v132, v133, v134
    v_max3_f32 v6, v6, v135, v140
    v_max3_f32 v6, v6, v141, v142
    v_max_f32 v6, v6, v143
    v_mov_b32 v7, v6
    s_nop 1
    v_permlane32_swap_b32 v6, v7
    s_nop 1
    v_max_f32 v6, v6, v7
    v_mov_b32 v7, v6
    s_nop 1
    v_permlane16_swap_b32 v6, v7
    s_nop 1
    v_max_f32 v6, v6, v7
    v_add_f32 v6, 0x42800000, v6
    v_max_f32 v6, s77, v6
    v_sub_f32 v160, v160, v5
    v_sub_f32 v128, v128, v5
    v_sub_f32 v112, v112, v5
    v_sub_f32 v161, v161, v5
    v_sub_f32 v129, v129, v5
    v_sub_f32 v113, v113, v5
    v_sub_f32 v162, v162, v5
    v_sub_f32 v130, v130, v5
    v_sub_f32 v114, v114, v5
    v_sub_f32 v163, v163, v5
    v_sub_f32 v131, v131, v5
    v_sub_f32 v115, v115, v5
    v_sub_f32 v164, v164, v6
    v_sub_f32 v132, v132, v6
    v_sub_f32 v116, v116, v6
    v_sub_f32 v165, v165, v6
    v_sub_f32 v133, v133, v6
    v_sub_f32 v117, v117, v6
    v_sub_f32 v166, v166, v6
    v_sub_f32 v134, v134, v6
    v_sub_f32 v118, v118, v6
    v_sub_f32 v167, v167, v6
    v_sub_f32 v135, v135, v6
    v_sub_f32 v119, v119, v6
    v_sub_f32 v168, v168, v5
    v_sub_f32 v136, v136, v5
    v_sub_f32 v120, v120, v5
    v_sub_f32 v169, v169, v5
    v_sub_f32 v137, v137, v5
    v_sub_f32 v121, v121, v5
    v_sub_f32 v170, v170, v5
    v_sub_f32 v138, v138, v5
    v_sub_f32 v122, v122, v5
    v_sub_f32 v171, v171, v5
    v_sub_f32 v139, v139, v5
    v_sub_f32 v123, v123, v5
    v_sub_f32 v172, v172, v6
    v_sub_f32 v140, v140, v6
    v_sub_f32 v124, v124, v6
    v_sub_f32 v173, v173, v6
    v_sub_f32 v141, v141, v6
    v_sub_f32 v125, v125, v6
    v_sub_f32 v174, v174, v6
    v_sub_f32 v142, v142, v6
    v_sub_f32 v126, v126, v6
    v_sub_f32 v175, v175, v6
    v_sub_f32 v143, v143, v6
    v_sub_f32 v127, v127, v6
    s_cmp_lg_u32 s77, 0
    s_cbranch_scc1 SLOWF_141
    v_exp_f32 v5, -v5
    v_exp_f32 v6, -v6
    s_nop 0
    v_mul_f32 v48, v48, v5
    v_mul_f32 v49, v49, v5
    v_mul_f32 v50, v50, v5
    v_mul_f32 v51, v51, v5
    v_mul_f32 v52, v52, v6
    v_mul_f32 v53, v53, v6
    v_mul_f32 v54, v54, v6
    v_mul_f32 v55, v55, v6
    v_mul_f32 v56, v56, v5
    v_mul_f32 v57, v57, v5
    v_mul_f32 v58, v58, v5
    v_mul_f32 v59, v59, v5
    v_mul_f32 v60, v60, v6
    v_mul_f32 v61, v61, v6
    v_mul_f32 v62, v62, v6
    v_mul_f32 v63, v63, v6
    v_mul_f32 v64, v64, v5
    v_mul_f32 v65, v65, v5
    v_mul_f32 v66, v66, v5
    v_mul_f32 v67, v67, v5
    v_mul_f32 v68, v68, v6
    v_mul_f32 v69, v69, v6
    v_mul_f32 v70, v70, v6
    v_mul_f32 v71, v71, v6
    v_mul_f32 v72, v72, v5
    v_mul_f32 v73, v73, v5
    v_mul_f32 v74, v74, v5
    v_mul_f32 v75, v75, v5
    v_mul_f32 v76, v76, v6
    v_mul_f32 v77, v77, v6
    v_mul_f32 v78, v78, v6
    v_mul_f32 v79, v79, v6
    v_mul_f32 v80, v80, v5
    v_mul_f32 v81, v81, v5
    v_mul_f32 v82, v82, v5
    v_mul_f32 v83, v83, v5
    v_mul_f32 v84, v84, v6
    v_mul_f32 v85, v85, v6
    v_mul_f32 v86, v86, v6
    v_mul_f32 v87, v87, v6
    v_mul_f32 v88, v88, v5
    v_mul_f32 v89, v89, v5
    v_mul_f32 v90, v90, v5
    v_mul_f32 v91, v91, v5
    v_mul_f32 v92, v92, v6
    v_mul_f32 v93, v93, v6
    v_mul_f32 v94, v94, v6
    v_mul_f32 v95, v95, v6
    v_mul_f32 v96, v96, v5
    v_mul_f32 v97, v97, v5
    v_mul_f32 v98, v98, v5
    v_mul_f32 v99, v99, v5
    v_mul_f32 v100, v100, v6
    v_mul_f32 v101, v101, v6
    v_mul_f32 v102, v102, v6
    v_mul_f32 v103, v103, v6
    v_mul_f32 v104, v104, v5
    v_mul_f32 v105, v105, v5
    v_mul_f32 v106, v106, v5
    v_mul_f32 v107, v107, v5
    v_mul_f32 v108, v108, v6
    v_mul_f32 v109, v109, v6
    v_mul_f32 v110, v110, v6
    v_mul_f32 v111, v111, v6
    v_mul_f32 v176, v176, v5
    v_mul_f32 v177, v177, v5
    v_mul_f32 v178, v178, v5
    v_mul_f32 v179, v179, v5
    v_mul_f32 v180, v180, v6
    v_mul_f32 v181, v181, v6
    v_mul_f32 v182, v182, v6
    v_mul_f32 v183, v183, v6
SLOWF_141:
    s_mov_b32 s77, 0
    s_mov_b32 s79, 0
    v_exp_f32 v11, v128
    v_exp_f32 v12, v129
    s_nop 0
    v_cvt_pk_bf16_f32 v152, v11, v12
    v_exp_f32 v13, v130
    v_exp_f32 v14, v131
    s_nop 0
    v_cvt_pk_bf16_f32 v153, v13, v14
    v_exp_f32 v11, v132
    v_exp_f32 v12, v133
    s_nop 0
    v_cvt_pk_bf16_f32 v156, v11, v12
    v_exp_f32 v13, v134
    v_exp_f32 v14, v135
    s_nop 0
    v_cvt_pk_bf16_f32 v157, v13, v14
    v_exp_f32 v11, v136
    v_exp_f32 v12, v137
    s_nop 0
    v_cvt_pk_bf16_f32 v154, v11, v12
    v_exp_f32 v13, v138
    v_exp_f32 v14, v139
    s_nop 0
    v_cvt_pk_bf16_f32 v155, v13, v14
    v_exp_f32 v11, v140
    v_exp_f32 v12, v141
    s_nop 0
    v_cvt_pk_bf16_f32 v158, v11, v12
    v_exp_f32 v13, v142
    v_exp_f32 v14, v143
    s_nop 0
    v_cvt_pk_bf16_f32 v159, v13, v14
    s_nop 1
    s_branch BACK_77
SLOW_78:
    s_nop 15
    v_max3_f32 v5, v112, v113, v114
    v_max3_f32 v5, v5, v115, v120
    v_max3_f32 v5, v5, v121, v122
    v_max_f32 v5, v5, v123
    v_mov_b32 v7, v5
    s_nop 1
    v_permlane32_swap_b32 v5, v7
    s_nop 1
    v_max_f32 v5, v5, v7
    v_mov_b32 v7, v5
    s_nop 1
    v_permlane16_swap_b32 v5, v7
    s_nop 1
    v_max_f32 v5, v5, v7
    v_add_f32 v5, 0x42800000, v5
    v_max_f32 v5, s77, v5
    v_max3_f32 v6, v116, v117, v118
    v_max3_f32 v6, v6, v119, v124
    v_max3_f32 v6, v6, v125, v126
    v_max_f32 v6, v6, v127
    v_mov_b32 v7, v6
    s_nop 1
    v_permlane32_swap_b32 v6, v7
    s_nop 1
    v_max_f32 v6, v6, v7
    v_mov_b32 v7, v6
    s_nop 1
    v_permlane16_swap_b32 v6, v7
    s_nop 1
    v_max_f32 v6, v6, v7
    v_add_f32 v6, 0x42800000, v6
    v_max_f32 v6, s77, v6
    v_sub_f32 v160, v160, v5
    v_sub_f32 v112, v112, v5
    v_sub_f32 v128, v128, v5
    v_sub_f32 v161, v161, v5
    v_sub_f32 v113, v113, v5
    v_sub_f32 v129, v129, v5
    v_sub_f32 v162, v162, v5
    v_sub_f32 v114, v114, v5
    v_sub_f32 v130, v130, v5
    v_sub_f32 v163, v163, v5
    v_sub_f32 v115, v115, v5
    v_sub_f32 v131, v131, v5
    v_sub_f32 v164, v164, v6
    v_sub_f32 v116, v116, v6
    v_sub_f32 v132, v132, v6
    v_sub_f32 v165, v165, v6
    v_sub_f32 v117, v117, v6
    v_sub_f32 v133, v133, v6
    v_sub_f32 v166, v166, v6
    v_sub_f32 v118, v118, v6
    v_sub_f32 v134, v134, v6
    v_sub_f32 v167, v167, v6
    v_sub_f32 v119, v119, v6
    v_sub_f32 v135, v135, v6
    v_sub_f32 v168, v168, v5
    v_sub_f32 v120, v120, v5
    v_sub_f32 v136, v136, v5
    v_sub_f32 v169, v169, v5
    v_sub_f32 v121, v121, v5
    v_sub_f32 v137, v137, v5
    v_sub_f32 v170, v170, v5
    v_sub_f32 v122, v122, v5
    v_sub_f32 v138, v138, v5
    v_sub_f32 v171, v171, v5
    v_sub_f32 v123, v123, v5
    v_sub_f32 v139, v139, v5
    v_sub_f32 v172, v172, v6
    v_sub_f32 v124, v124, v6
    v_sub_f32 v140, v140, v6
    v_sub_f32 v173, v173, v6
    v_sub_f32 v125, v125, v6
    v_sub_f32 v141, v141, v6
    v_sub_f32 v174, v174, v6
    v_sub_f32 v126, v126, v6
    v_sub_f32 v142, v142, v6
    v_sub_f32 v175, v175, v6
    v_sub_f32 v127, v127, v6
    v_sub_f32 v143, v143, v6
    s_cmp_lg_u32 s77, 0
    s_cbranch_scc1 SLOWF_142
    v_exp_f32 v5, -v5
    v_exp_f32 v6, -v6
    s_nop 0
    v_mul_f32 v48, v48, v5
    v_mul_f32 v49, v49, v5
    v_mul_f32 v50, v50, v5
    v_mul_f32 v51, v51, v5
    v_mul_f32 v52, v52, v6
    v_mul_f32 v53, v53, v6
    v_mul_f32 v54, v54, v6
    v_mul_f32 v55, v55, v6
    v_mul_f32 v56, v56, v5
    v_mul_f32 v57, v57, v5
    v_mul_f32 v58, v58, v5
    v_mul_f32 v59, v59, v5
    v_mul_f32 v60, v60, v6
    v_mul_f32 v61, v61, v6
    v_mul_f32 v62, v62, v6
    v_mul_f32 v63, v63, v6
    v_mul_f32 v64, v64, v5
    v_mul_f32 v65, v65, v5
    v_mul_f32 v66, v66, v5
    v_mul_f32 v67, v67, v5
    v_mul_f32 v68, v68, v6
    v_mul_f32 v69, v69, v6
    v_mul_f32 v70, v70, v6
    v_mul_f32 v71, v71, v6
    v_mul_f32 v72, v72, v5
    v_mul_f32 v73, v73, v5
    v_mul_f32 v74, v74, v5
    v_mul_f32 v75, v75, v5
    v_mul_f32 v76, v76, v6
    v_mul_f32 v77, v77, v6
    v_mul_f32 v78, v78, v6
    v_mul_f32 v79, v79, v6
    v_mul_f32 v80, v80, v5
    v_mul_f32 v81, v81, v5
    v_mul_f32 v82, v82, v5
    v_mul_f32 v83, v83, v5
    v_mul_f32 v84, v84, v6
    v_mul_f32 v85, v85, v6
    v_mul_f32 v86, v86, v6
    v_mul_f32 v87, v87, v6
    v_mul_f32 v88, v88, v5
    v_mul_f32 v89, v89, v5
    v_mul_f32 v90, v90, v5
    v_mul_f32 v91, v91, v5
    v_mul_f32 v92, v92, v6
    v_mul_f32 v93, v93, v6
    v_mul_f32 v94, v94, v6
    v_mul_f32 v95, v95, v6
    v_mul_f32 v96, v96, v5
    v_mul_f32 v97, v97, v5
    v_mul_f32 v98, v98, v5
    v_mul_f32 v99, v99, v5
    v_mul_f32 v100, v100, v6
    v_mul_f32 v101, v101, v6
    v_mul_f32 v102, v102, v6
    v_mul_f32 v103, v103, v6
    v_mul_f32 v104, v104, v5
    v_mul_f32 v105, v105, v5
    v_mul_f32 v106, v106, v5
    v_mul_f32 v107, v107, v5
    v_mul_f32 v108, v108, v6
    v_mul_f32 v109, v109, v6
    v_mul_f32 v110, v110, v6
    v_mul_f32 v111, v111, v6
    v_mul_f32 v176, v176, v5
    v_mul_f32 v177, v177, v5
    v_mul_f32 v178, v178, v5
    v_mul_f32 v179, v179, v5
    v_mul_f32 v180, v180, v6
    v_mul_f32 v181, v181, v6
    v_mul_f32 v182, v182, v6
    v_mul_f32 v183, v183, v6
SLOWF_142:
    s_mov_b32 s77, 0
    s_mov_b32 s79, 0
    v_exp_f32 v11, v112
    v_exp_f32 v12, v113
    s_nop 0
    v_cvt_pk_bf16_f32 v144, v11, v12
    v_exp_f32 v13, v114
    v_exp_f32 v14, v115
    s_nop 0
    v_cvt_pk_bf16_f32 v145, v13, v14
    v_exp_f32 v11, v116
    v_exp_f32 v12, v117
    s_nop 0
    v_cvt_pk_bf16_f32 v148, v11, v12
    v_exp_f32 v13, v118
    v_exp_f32 v14, v119
    s_nop 0
    v_cvt_pk_bf16_f32 v149, v13, v14
    v_exp_f32 v11, v120
    v_exp_f32 v12, v121
    s_nop 0
    v_cvt_pk_bf16_f32 v146, v11, v12
    v_exp_f32 v13, v122
    v_exp_f32 v14, v123
    s_nop 0
    v_cvt_pk_bf16_f32 v147, v13, v14
    v_exp_f32 v11, v124
    v_exp_f32 v12, v125
    s_nop 0
    v_cvt_pk_bf16_f32 v150, v11, v12
    v_exp_f32 v13, v126
    v_exp_f32 v14, v127
    s_nop 0
    v_cvt_pk_bf16_f32 v151, v13, v14
    s_nop 1
    s_branch BACK_79
SLOW_80:
    s_nop 15
    v_max3_f32 v5, v128, v129, v130
    v_max3_f32 v5, v5, v131, v136
    v_max3_f32 v5, v5, v137, v138
    v_max_f32 v5, v5, v139
    v_mov_b32 v7, v5
    s_nop 1
    v_permlane32_swap_b32 v5, v7
    s_nop 1
    v_max_f32 v5, v5, v7
    v_mov_b32 v7, v5
    s_nop 1
    v_permlane16_swap_b32 v5, v7
    s_nop 1
    v_max_f32 v5, v5, v7
    v_add_f32 v5, 0x42800000, v5
    v_max_f32 v5, s77, v5
    v_max3_f32 v6, v132, v133, v134
    v_max3_f32 v6, v6, v135, v140
    v_max3_f32 v6, v6, v141, v142
    v_max_f32 v6, v6, v143
    v_mov_b32 v7, v6
    s_nop 1
    v_permlane32_swap_b32 v6, v7
    s_nop 1
    v_max_f32 v6, v6, v7
    v_mov_b32 v7, v6
    s_nop 1
    v_permlane16_swap_b32 v6, v7
    s_nop 1
    v_max_f32 v6, v6, v7
    v_add_f32 v6, 0x42800000, v6
    v_max_f32 v6, s77, v6
    v_sub_f32 v160, v160, v5
    v_sub_f32 v128, v128, v5
    v_sub_f32 v112, v112, v5
    v_sub_f32 v161, v161, v5
    v_sub_f32 v129, v129, v5
    v_sub_f32 v113, v113, v5
    v_sub_f32 v162, v162, v5
    v_sub_f32 v130, v130, v5
    v_sub_f32 v114, v114, v5
    v_sub_f32 v163, v163, v5
    v_sub_f32 v131, v131, v5
    v_sub_f32 v115, v115, v5
    v_sub_f32 v164, v164, v6
    v_sub_f32 v132, v132, v6
    v_sub_f32 v116, v116, v6
    v_sub_f32 v165, v165, v6
    v_sub_f32 v133, v133, v6
    v_sub_f32 v117, v117, v6
    v_sub_f32 v166, v166, v6
    v_sub_f32 v134, v134, v6
    v_sub_f32 v118, v118, v6
    v_sub_f32 v167, v167, v6
    v_sub_f32 v135, v135, v6
    v_sub_f32 v119, v119, v6
    v_sub_f32 v168, v168, v5
    v_sub_f32 v136, v136, v5
    v_sub_f32 v120, v120, v5
    v_sub_f32 v169, v169, v5
    v_sub_f32 v137, v137, v5
    v_sub_f32 v121, v121, v5
    v_sub_f32 v170, v170, v5
    v_sub_f32 v138, v138, v5
    v_sub_f32 v122, v122, v5
    v_sub_f32 v171, v171, v5
    v_sub_f32 v139, v139, v5
    v_sub_f32 v123, v123, v5
    v_sub_f32 v172, v172, v6
    v_sub_f32 v140, v140, v6
    v_sub_f32 v124, v124, v6
    v_sub_f32 v173, v173, v6
    v_sub_f32 v141, v141, v6
    v_sub_f32 v125, v125, v6
    v_sub_f32 v174, v174, v6
    v_sub_f32 v142, v142, v6
    v_sub_f32 v126, v126, v6
    v_sub_f32 v175, v175, v6
    v_sub_f32 v143, v143, v6
    v_sub_f32 v127, v127, v6
    s_cmp_lg_u32 s77, 0
    s_cbranch_scc1 SLOWF_143
    v_exp_f32 v5, -v5
    v_exp_f32 v6, -v6
    s_nop 0
    v_mul_f32 v48, v48, v5
    v_mul_f32 v49, v49, v5
    v_mul_f32 v50, v50, v5
    v_mul_f32 v51, v51, v5
    v_mul_f32 v52, v52, v6
    v_mul_f32 v53, v53, v6
    v_mul_f32 v54, v54, v6
    v_mul_f32 v55, v55, v6
    v_mul_f32 v56, v56, v5
    v_mul_f32 v57, v57, v5
    v_mul_f32 v58, v58, v5
    v_mul_f32 v59, v59, v5
    v_mul_f32 v60, v60, v6
    v_mul_f32 v61, v61, v6
    v_mul_f32 v62, v62, v6
    v_mul_f32 v63, v63, v6
    v_mul_f32 v64, v64, v5
    v_mul_f32 v65, v65, v5
    v_mul_f32 v66, v66, v5
    v_mul_f32 v67, v67, v5
    v_mul_f32 v68, v68, v6
    v_mul_f32 v69, v69, v6
    v_mul_f32 v70, v70, v6
    v_mul_f32 v71, v71, v6
    v_mul_f32 v72, v72, v5
    v_mul_f32 v73, v73, v5
    v_mul_f32 v74, v74, v5
    v_mul_f32 v75, v75, v5
    v_mul_f32 v76, v76, v6
    v_mul_f32 v77, v77, v6
    v_mul_f32 v78, v78, v6
    v_mul_f32 v79, v79, v6
    v_mul_f32 v80, v80, v5
    v_mul_f32 v81, v81, v5
    v_mul_f32 v82, v82, v5
    v_mul_f32 v83, v83, v5
    v_mul_f32 v84, v84, v6
    v_mul_f32 v85, v85, v6
    v_mul_f32 v86, v86, v6
    v_mul_f32 v87, v87, v6
    v_mul_f32 v88, v88, v5
    v_mul_f32 v89, v89, v5
    v_mul_f32 v90, v90, v5
    v_mul_f32 v91, v91, v5
    v_mul_f32 v92, v92, v6
    v_mul_f32 v93, v93, v6
    v_mul_f32 v94, v94, v6
    v_mul_f32 v95, v95, v6
    v_mul_f32 v96, v96, v5
    v_mul_f32 v97, v97, v5
    v_mul_f32 v98, v98, v5
    v_mul_f32 v99, v99, v5
    v_mul_f32 v100, v100, v6
    v_mul_f32 v101, v101, v6
    v_mul_f32 v102, v102, v6
    v_mul_f32 v103, v103, v6
    v_mul_f32 v104, v104, v5
    v_mul_f32 v105, v105, v5
    v_mul_f32 v106, v106, v5
    v_mul_f32 v107, v107, v5
    v_mul_f32 v108, v108, v6
    v_mul_f32 v109, v109, v6
    v_mul_f32 v110, v110, v6
    v_mul_f32 v111, v111, v6
    v_mul_f32 v176, v176, v5
    v_mul_f32 v177, v177, v5
    v_mul_f32 v178, v178, v5
    v_mul_f32 v179, v179, v5
    v_mul_f32 v180, v180, v6
    v_mul_f32 v181, v181, v6
    v_mul_f32 v182, v182, v6
    v_mul_f32 v183, v183, v6
SLOWF_143:
    s_mov_b32 s77, 0
    s_mov_b32 s79, 0
    v_exp_f32 v11, v128
    v_exp_f32 v12, v129
    s_nop 0
    v_cvt_pk_bf16_f32 v152, v11, v12
    v_exp_f32 v13, v130
    v_exp_f32 v14, v131
    s_nop 0
    v_cvt_pk_bf16_f32 v153, v13, v14
    v_exp_f32 v11, v132
    v_exp_f32 v12, v133
    s_nop 0
    v_cvt_pk_bf16_f32 v156, v11, v12
    v_exp_f32 v13, v134
    v_exp_f32 v14, v135
    s_nop 0
    v_cvt_pk_bf16_f32 v157, v13, v14
    v_exp_f32 v11, v136
    v_exp_f32 v12, v137
    s_nop 0
    v_cvt_pk_bf16_f32 v154, v11, v12
    v_exp_f32 v13, v138
    v_exp_f32 v14, v139
    s_nop 0
    v_cvt_pk_bf16_f32 v155, v13, v14
    v_exp_f32 v11, v140
    v_exp_f32 v12, v141
    s_nop 0
    v_cvt_pk_bf16_f32 v158, v11, v12
    v_exp_f32 v13, v142
    v_exp_f32 v14, v143
    s_nop 0
    v_cvt_pk_bf16_f32 v159, v13, v14
    s_nop 1
    s_branch BACK_81
SLOW_82:
    s_nop 15
    v_max3_f32 v5, v112, v113, v114
    v_max3_f32 v5, v5, v115, v120
    v_max3_f32 v5, v5, v121, v122
    v_max_f32 v5, v5, v123
    v_mov_b32 v7, v5
    s_nop 1
    v_permlane32_swap_b32 v5, v7
    s_nop 1
    v_max_f32 v5, v5, v7
    v_mov_b32 v7, v5
    s_nop 1
    v_permlane16_swap_b32 v5, v7
    s_nop 1
    v_max_f32 v5, v5, v7
    v_add_f32 v5, 0x42800000, v5
    v_max_f32 v5, s77, v5
    v_max3_f32 v6, v116, v117, v118
    v_max3_f32 v6, v6, v119, v124
    v_max3_f32 v6, v6, v125, v126
    v_max_f32 v6, v6, v127
    v_mov_b32 v7, v6
    s_nop 1
    v_permlane32_swap_b32 v6, v7
    s_nop 1
    v_max_f32 v6, v6, v7
    v_mov_b32 v7, v6
    s_nop 1
    v_permlane16_swap_b32 v6, v7
    s_nop 1
    v_max_f32 v6, v6, v7
    v_add_f32 v6, 0x42800000, v6
    v_max_f32 v6, s77, v6
    v_sub_f32 v160, v160, v5
    v_sub_f32 v112, v112, v5
    v_sub_f32 v128, v128, v5
    v_sub_f32 v161, v161, v5
    v_sub_f32 v113, v113, v5
    v_sub_f32 v129, v129, v5
    v_sub_f32 v162, v162, v5
    v_sub_f32 v114, v114, v5
    v_sub_f32 v130, v130, v5
    v_sub_f32 v163, v163, v5
    v_sub_f32 v115, v115, v5
    v_sub_f32 v131, v131, v5
    v_sub_f32 v164, v164, v6
    v_sub_f32 v116, v116, v6
    v_sub_f32 v132, v132, v6
    v_sub_f32 v165, v165, v6
    v_sub_f32 v117, v117, v6
    v_sub_f32 v133, v133, v6
    v_sub_f32 v166, v166, v6
    v_sub_f32 v118, v118, v6
    v_sub_f32 v134, v134, v6
    v_sub_f32 v167, v167, v6
    v_sub_f32 v119, v119, v6
    v_sub_f32 v135, v135, v6
    v_sub_f32 v168, v168, v5
    v_sub_f32 v120, v120, v5
    v_sub_f32 v136, v136, v5
    v_sub_f32 v169, v169, v5
    v_sub_f32 v121, v121, v5
    v_sub_f32 v137, v137, v5
    v_sub_f32 v170, v170, v5
    v_sub_f32 v122, v122, v5
    v_sub_f32 v138, v138, v5
    v_sub_f32 v171, v171, v5
    v_sub_f32 v123, v123, v5
    v_sub_f32 v139, v139, v5
    v_sub_f32 v172, v172, v6
    v_sub_f32 v124, v124, v6
    v_sub_f32 v140, v140, v6
    v_sub_f32 v173, v173, v6
    v_sub_f32 v125, v125, v6
    v_sub_f32 v141, v141, v6
    v_sub_f32 v174, v174, v6
    v_sub_f32 v126, v126, v6
    v_sub_f32 v142, v142, v6
    v_sub_f32 v175, v175, v6
    v_sub_f32 v127, v127, v6
    v_sub_f32 v143, v143, v6
    s_cmp_lg_u32 s77, 0
    s_cbranch_scc1 SLOWF_144
    v_exp_f32 v5, -v5
    v_exp_f32 v6, -v6
    s_nop 0
    v_mul_f32 v48, v48, v5
    v_mul_f32 v49, v49, v5
    v_mul_f32 v50, v50, v5
    v_mul_f32 v51, v51, v5
    v_mul_f32 v52, v52, v6
    v_mul_f32 v53, v53, v6
    v_mul_f32 v54, v54, v6
    v_mul_f32 v55, v55, v6
    v_mul_f32 v56, v56, v5
    v_mul_f32 v57, v57, v5
    v_mul_f32 v58, v58, v5
    v_mul_f32 v59, v59, v5
    v_mul_f32 v60, v60, v6
    v_mul_f32 v61, v61, v6
    v_mul_f32 v62, v62, v6
    v_mul_f32 v63, v63, v6
    v_mul_f32 v64, v64, v5
    v_mul_f32 v65, v65, v5
    v_mul_f32 v66, v66, v5
    v_mul_f32 v67, v67, v5
    v_mul_f32 v68, v68, v6
    v_mul_f32 v69, v69, v6
    v_mul_f32 v70, v70, v6
    v_mul_f32 v71, v71, v6
    v_mul_f32 v72, v72, v5
    v_mul_f32 v73, v73, v5
    v_mul_f32 v74, v74, v5
    v_mul_f32 v75, v75, v5
    v_mul_f32 v76, v76, v6
    v_mul_f32 v77, v77, v6
    v_mul_f32 v78, v78, v6
    v_mul_f32 v79, v79, v6
    v_mul_f32 v80, v80, v5
    v_mul_f32 v81, v81, v5
    v_mul_f32 v82, v82, v5
    v_mul_f32 v83, v83, v5
    v_mul_f32 v84, v84, v6
    v_mul_f32 v85, v85, v6
    v_mul_f32 v86, v86, v6
    v_mul_f32 v87, v87, v6
    v_mul_f32 v88, v88, v5
    v_mul_f32 v89, v89, v5
    v_mul_f32 v90, v90, v5
    v_mul_f32 v91, v91, v5
    v_mul_f32 v92, v92, v6
    v_mul_f32 v93, v93, v6
    v_mul_f32 v94, v94, v6
    v_mul_f32 v95, v95, v6
    v_mul_f32 v96, v96, v5
    v_mul_f32 v97, v97, v5
    v_mul_f32 v98, v98, v5
    v_mul_f32 v99, v99, v5
    v_mul_f32 v100, v100, v6
    v_mul_f32 v101, v101, v6
    v_mul_f32 v102, v102, v6
    v_mul_f32 v103, v103, v6
    v_mul_f32 v104, v104, v5
    v_mul_f32 v105, v105, v5
    v_mul_f32 v106, v106, v5
    v_mul_f32 v107, v107, v5
    v_mul_f32 v108, v108, v6
    v_mul_f32 v109, v109, v6
    v_mul_f32 v110, v110, v6
    v_mul_f32 v111, v111, v6
    v_mul_f32 v176, v176, v5
    v_mul_f32 v177, v177, v5
    v_mul_f32 v178, v178, v5
    v_mul_f32 v179, v179, v5
    v_mul_f32 v180, v180, v6
    v_mul_f32 v181, v181, v6
    v_mul_f32 v182, v182, v6
    v_mul_f32 v183, v183, v6
SLOWF_144:
    s_mov_b32 s77, 0
    s_mov_b32 s79, 0
    v_exp_f32 v11, v112
    v_exp_f32 v12, v113
    s_nop 0
    v_cvt_pk_bf16_f32 v144, v11, v12
    v_exp_f32 v13, v114
    v_exp_f32 v14, v115
    s_nop 0
    v_cvt_pk_bf16_f32 v145, v13, v14
    v_exp_f32 v11, v116
    v_exp_f32 v12, v117
    s_nop 0
    v_cvt_pk_bf16_f32 v148, v11, v12
    v_exp_f32 v13, v118
    v_exp_f32 v14, v119
    s_nop 0
    v_cvt_pk_bf16_f32 v149, v13, v14
    v_exp_f32 v11, v120
    v_exp_f32 v12, v121
    s_nop 0
    v_cvt_pk_bf16_f32 v146, v11, v12
    v_exp_f32 v13, v122
    v_exp_f32 v14, v123
    s_nop 0
    v_cvt_pk_bf16_f32 v147, v13, v14
    v_exp_f32 v11, v124
    v_exp_f32 v12, v125
    s_nop 0
    v_cvt_pk_bf16_f32 v150, v11, v12
    v_exp_f32 v13, v126
    v_exp_f32 v14, v127
    s_nop 0
    v_cvt_pk_bf16_f32 v151, v13, v14
    s_nop 1
    s_branch BACK_83
SLOW_90:
    s_nop 15
    v_max3_f32 v5, v128, v129, v130
    v_max3_f32 v5, v5, v131, v136
    v_max3_f32 v5, v5, v137, v138
    v_max_f32 v5, v5, v139
    v_mov_b32 v7, v5
    s_nop 1
    v_permlane32_swap_b32 v5, v7
    s_nop 1
    v_max_f32 v5, v5, v7
    v_mov_b32 v7, v5
    s_nop 1
    v_permlane16_swap_b32 v5, v7
    s_nop 1
    v_max_f32 v5, v5, v7
    v_add_f32 v5, 0x42800000, v5
    v_max_f32 v5, s77, v5
    v_max3_f32 v6, v132, v133, v134
    v_max3_f32 v6, v6, v135, v140
    v_max3_f32 v6, v6, v141, v142
    v_max_f32 v6, v6, v143
    v_mov_b32 v7, v6
    s_nop 1
    v_permlane32_swap_b32 v6, v7
    s_nop 1
    v_max_f32 v6, v6, v7
    v_mov_b32 v7, v6
    s_nop 1
    v_permlane16_swap_b32 v6, v7
    s_nop 1
    v_max_f32 v6, v6, v7
    v_add_f32 v6, 0x42800000, v6
    v_max_f32 v6, s77, v6
    v_sub_f32 v160, v160, v5
    v_sub_f32 v128, v128, v5
    v_sub_f32 v112, v112, v5
    v_sub_f32 v161, v161, v5
    v_sub_f32 v129, v129, v5
    v_sub_f32 v113, v113, v5
    v_sub_f32 v162, v162, v5
    v_sub_f32 v130, v130, v5
    v_sub_f32 v114, v114, v5
    v_sub_f32 v163, v163, v5
    v_sub_f32 v131, v131, v5
    v_sub_f32 v115, v115, v5
    v_sub_f32 v164, v164, v6
    v_sub_f32 v132, v132, v6
    v_sub_f32 v116, v116, v6
    v_sub_f32 v165, v165, v6
    v_sub_f32 v133, v133, v6
    v_sub_f32 v117, v117, v6
    v_sub_f32 v166, v166, v6
    v_sub_f32 v134, v134, v6
    v_sub_f32 v118, v118, v6
    v_sub_f32 v167, v167, v6
    v_sub_f32 v135, v135, v6
    v_sub_f32 v119, v119, v6
    v_sub_f32 v168, v168, v5
    v_sub_f32 v136, v136, v5
    v_sub_f32 v120, v120, v5
    v_sub_f32 v169, v169, v5
    v_sub_f32 v137, v137, v5
    v_sub_f32 v121, v121, v5
    v_sub_f32 v170, v170, v5
    v_sub_f32 v138, v138, v5
    v_sub_f32 v122, v122, v5
    v_sub_f32 v171, v171, v5
    v_sub_f32 v139, v139, v5
    v_sub_f32 v123, v123, v5
    v_sub_f32 v172, v172, v6
    v_sub_f32 v140, v140, v6
    v_sub_f32 v124, v124, v6
    v_sub_f32 v173, v173, v6
    v_sub_f32 v141, v141, v6
    v_sub_f32 v125, v125, v6
    v_sub_f32 v174, v174, v6
    v_sub_f32 v142, v142, v6
    v_sub_f32 v126, v126, v6
    v_sub_f32 v175, v175, v6
    v_sub_f32 v143, v143, v6
    v_sub_f32 v127, v127, v6
    s_cmp_lg_u32 s77, 0
    s_cbranch_scc1 SLOWF_145
    v_exp_f32 v5, -v5
    v_exp_f32 v6, -v6
    s_nop 0
    v_mul_f32 v48, v48, v5
    v_mul_f32 v49, v49, v5
    v_mul_f32 v50, v50, v5
    v_mul_f32 v51, v51, v5
    v_mul_f32 v52, v52, v6
    v_mul_f32 v53, v53, v6
    v_mul_f32 v54, v54, v6
    v_mul_f32 v55, v55, v6
    v_mul_f32 v56, v56, v5
    v_mul_f32 v57, v57, v5
    v_mul_f32 v58, v58, v5
    v_mul_f32 v59, v59, v5
    v_mul_f32 v60, v60, v6
    v_mul_f32 v61, v61, v6
    v_mul_f32 v62, v62, v6
    v_mul_f32 v63, v63, v6
    v_mul_f32 v64, v64, v5
    v_mul_f32 v65, v65, v5
    v_mul_f32 v66, v66, v5
    v_mul_f32 v67, v67, v5
    v_mul_f32 v68, v68, v6
    v_mul_f32 v69, v69, v6
    v_mul_f32 v70, v70, v6
    v_mul_f32 v71, v71, v6
    v_mul_f32 v72, v72, v5
    v_mul_f32 v73, v73, v5
    v_mul_f32 v74, v74, v5
    v_mul_f32 v75, v75, v5
    v_mul_f32 v76, v76, v6
    v_mul_f32 v77, v77, v6
    v_mul_f32 v78, v78, v6
    v_mul_f32 v79, v79, v6
    v_mul_f32 v80, v80, v5
    v_mul_f32 v81, v81, v5
    v_mul_f32 v82, v82, v5
    v_mul_f32 v83, v83, v5
    v_mul_f32 v84, v84, v6
    v_mul_f32 v85, v85, v6
    v_mul_f32 v86, v86, v6
    v_mul_f32 v87, v87, v6
    v_mul_f32 v88, v88, v5
    v_mul_f32 v89, v89, v5
    v_mul_f32 v90, v90, v5
    v_mul_f32 v91, v91, v5
    v_mul_f32 v92, v92, v6
    v_mul_f32 v93, v93, v6
    v_mul_f32 v94, v94, v6
    v_mul_f32 v95, v95, v6
    v_mul_f32 v96, v96, v5
    v_mul_f32 v97, v97, v5
    v_mul_f32 v98, v98, v5
    v_mul_f32 v99, v99, v5
    v_mul_f32 v100, v100, v6
    v_mul_f32 v101, v101, v6
    v_mul_f32 v102, v102, v6
    v_mul_f32 v103, v103, v6
    v_mul_f32 v104, v104, v5
    v_mul_f32 v105, v105, v5
    v_mul_f32 v106, v106, v5
    v_mul_f32 v107, v107, v5
    v_mul_f32 v108, v108, v6
    v_mul_f32 v109, v109, v6
    v_mul_f32 v110, v110, v6
    v_mul_f32 v111, v111, v6
    v_mul_f32 v176, v176, v5
    v_mul_f32 v177, v177, v5
    v_mul_f32 v178, v178, v5
    v_mul_f32 v179, v179, v5
    v_mul_f32 v180, v180, v6
    v_mul_f32 v181, v181, v6
    v_mul_f32 v182, v182, v6
    v_mul_f32 v183, v183, v6
SLOWF_145:
    s_mov_b32 s77, 0
    s_mov_b32 s79, 0
    v_exp_f32 v11, v128
    v_exp_f32 v12, v129
    s_nop 0
    v_cvt_pk_bf16_f32 v152, v11, v12
    v_exp_f32 v13, v130
    v_exp_f32 v14, v131
    s_nop 0
    v_cvt_pk_bf16_f32 v153, v13, v14
    v_exp_f32 v11, v132
    v_exp_f32 v12, v133
    s_nop 0
    v_cvt_pk_bf16_f32 v156, v11, v12
    v_exp_f32 v13, v134
    v_exp_f32 v14, v135
    s_nop 0
    v_cvt_pk_bf16_f32 v157, v13, v14
    v_exp_f32 v11, v136
    v_exp_f32 v12, v137
    s_nop 0
    v_cvt_pk_bf16_f32 v154, v11, v12
    v_exp_f32 v13, v138
    v_exp_f32 v14, v139
    s_nop 0
    v_cvt_pk_bf16_f32 v155, v13, v14
    v_exp_f32 v11, v140
    v_exp_f32 v12, v141
    s_nop 0
    v_cvt_pk_bf16_f32 v158, v11, v12
    v_exp_f32 v13, v142
    v_exp_f32 v14, v143
    s_nop 0
    v_cvt_pk_bf16_f32 v159, v13, v14
    s_nop 1
    s_branch BACK_91
SLOW_94:
    s_nop 15
    v_max3_f32 v5, v128, v129, v130
    v_max3_f32 v5, v5, v131, v136
    v_max3_f32 v5, v5, v137, v138
    v_max_f32 v5, v5, v139
    v_mov_b32 v7, v5
    s_nop 1
    v_permlane32_swap_b32 v5, v7
    s_nop 1
    v_max_f32 v5, v5, v7
    v_mov_b32 v7, v5
    s_nop 1
    v_permlane16_swap_b32 v5, v7
    s_nop 1
    v_max_f32 v5, v5, v7
    v_add_f32 v5, 0x42800000, v5
    v_max_f32 v5, s77, v5
    v_max3_f32 v6, v132, v133, v134
    v_max3_f32 v6, v6, v135, v140
    v_max3_f32 v6, v6, v141, v142
    v_max_f32 v6, v6, v143
    v_mov_b32 v7, v6
    s_nop 1
    v_permlane32_swap_b32 v6, v7
    s_nop 1
    v_max_f32 v6, v6, v7
    v_mov_b32 v7, v6
    s_nop 1
    v_permlane16_swap_b32 v6, v7
    s_nop 1
    v_max_f32 v6, v6, v7
    v_add_f32 v6, 0x42800000, v6
    v_max_f32 v6, s77, v6
    v_sub_f32 v160, v160, v5
    v_sub_f32 v128, v128, v5
    v_sub_f32 v112, v112, v5
    v_sub_f32 v161, v161, v5
    v_sub_f32 v129, v129, v5
    v_sub_f32 v113, v113, v5
    v_sub_f32 v162, v162, v5
    v_sub_f32 v130, v130, v5
    v_sub_f32 v114, v114, v5
    v_sub_f32 v163, v163, v5
    v_sub_f32 v131, v131, v5
    v_sub_f32 v115, v115, v5
    v_sub_f32 v164, v164, v6
    v_sub_f32 v132, v132, v6
    v_sub_f32 v116, v116, v6
    v_sub_f32 v165, v165, v6
    v_sub_f32 v133, v133, v6
    v_sub_f32 v117, v117, v6
    v_sub_f32 v166, v166, v6
    v_sub_f32 v134, v134, v6
    v_sub_f32 v118, v118, v6
    v_sub_f32 v167, v167, v6
    v_sub_f32 v135, v135, v6
    v_sub_f32 v119, v119, v6
    v_sub_f32 v168, v168, v5
    v_sub_f32 v136, v136, v5
    v_sub_f32 v120, v120, v5
    v_sub_f32 v169, v169, v5
    v_sub_f32 v137, v137, v5
    v_sub_f32 v121, v121, v5
    v_sub_f32 v170, v170, v5
    v_sub_f32 v138, v138, v5
    v_sub_f32 v122, v122, v5
    v_sub_f32 v171, v171, v5
    v_sub_f32 v139, v139, v5
    v_sub_f32 v123, v123, v5
    v_sub_f32 v172, v172, v6
    v_sub_f32 v140, v140, v6
    v_sub_f32 v124, v124, v6
    v_sub_f32 v173, v173, v6
    v_sub_f32 v141, v141, v6
    v_sub_f32 v125, v125, v6
    v_sub_f32 v174, v174, v6
    v_sub_f32 v142, v142, v6
    v_sub_f32 v126, v126, v6
    v_sub_f32 v175, v175, v6
    v_sub_f32 v143, v143, v6
    v_sub_f32 v127, v127, v6
    s_cmp_lg_u32 s77, 0
    s_cbranch_scc1 SLOWF_146
    v_exp_f32 v5, -v5
    v_exp_f32 v6, -v6
    s_nop 0
    v_mul_f32 v48, v48, v5
    v_mul_f32 v49, v49, v5
    v_mul_f32 v50, v50, v5
    v_mul_f32 v51, v51, v5
    v_mul_f32 v52, v52, v6
    v_mul_f32 v53, v53, v6
    v_mul_f32 v54, v54, v6
    v_mul_f32 v55, v55, v6
    v_mul_f32 v56, v56, v5
    v_mul_f32 v57, v57, v5
    v_mul_f32 v58, v58, v5
    v_mul_f32 v59, v59, v5
    v_mul_f32 v60, v60, v6
    v_mul_f32 v61, v61, v6
    v_mul_f32 v62, v62, v6
    v_mul_f32 v63, v63, v6
    v_mul_f32 v64, v64, v5
    v_mul_f32 v65, v65, v5
    v_mul_f32 v66, v66, v5
    v_mul_f32 v67, v67, v5
    v_mul_f32 v68, v68, v6
    v_mul_f32 v69, v69, v6
    v_mul_f32 v70, v70, v6
    v_mul_f32 v71, v71, v6
    v_mul_f32 v72, v72, v5
    v_mul_f32 v73, v73, v5
    v_mul_f32 v74, v74, v5
    v_mul_f32 v75, v75, v5
    v_mul_f32 v76, v76, v6
    v_mul_f32 v77, v77, v6
    v_mul_f32 v78, v78, v6
    v_mul_f32 v79, v79, v6
    v_mul_f32 v80, v80, v5
    v_mul_f32 v81, v81, v5
    v_mul_f32 v82, v82, v5
    v_mul_f32 v83, v83, v5
    v_mul_f32 v84, v84, v6
    v_mul_f32 v85, v85, v6
    v_mul_f32 v86, v86, v6
    v_mul_f32 v87, v87, v6
    v_mul_f32 v88, v88, v5
    v_mul_f32 v89, v89, v5
    v_mul_f32 v90, v90, v5
    v_mul_f32 v91, v91, v5
    v_mul_f32 v92, v92, v6
    v_mul_f32 v93, v93, v6
    v_mul_f32 v94, v94, v6
    v_mul_f32 v95, v95, v6
    v_mul_f32 v96, v96, v5
    v_mul_f32 v97, v97, v5
    v_mul_f32 v98, v98, v5
    v_mul_f32 v99, v99, v5
    v_mul_f32 v100, v100, v6
    v_mul_f32 v101, v101, v6
    v_mul_f32 v102, v102, v6
    v_mul_f32 v103, v103, v6
    v_mul_f32 v104, v104, v5
    v_mul_f32 v105, v105, v5
    v_mul_f32 v106, v106, v5
    v_mul_f32 v107, v107, v5
    v_mul_f32 v108, v108, v6
    v_mul_f32 v109, v109, v6
    v_mul_f32 v110, v110, v6
    v_mul_f32 v111, v111, v6
    v_mul_f32 v176, v176, v5
    v_mul_f32 v177, v177, v5
    v_mul_f32 v178, v178, v5
    v_mul_f32 v179, v179, v5
    v_mul_f32 v180, v180, v6
    v_mul_f32 v181, v181, v6
    v_mul_f32 v182, v182, v6
    v_mul_f32 v183, v183, v6
SLOWF_146:
    s_mov_b32 s77, 0
    s_mov_b32 s79, 0
    v_exp_f32 v11, v128
    v_exp_f32 v12, v129
    s_nop 0
    v_cvt_pk_bf16_f32 v152, v11, v12
    v_exp_f32 v13, v130
    v_exp_f32 v14, v131
    s_nop 0
    v_cvt_pk_bf16_f32 v153, v13, v14
    v_exp_f32 v11, v132
    v_exp_f32 v12, v133
    s_nop 0
    v_cvt_pk_bf16_f32 v156, v11, v12
    v_exp_f32 v13, v134
    v_exp_f32 v14, v135
    s_nop 0
    v_cvt_pk_bf16_f32 v157, v13, v14
    v_exp_f32 v11, v136
    v_exp_f32 v12, v137
    s_nop 0
    v_cvt_pk_bf16_f32 v154, v11, v12
    v_exp_f32 v13, v138
    v_exp_f32 v14, v139
    s_nop 0
    v_cvt_pk_bf16_f32 v155, v13, v14
    v_exp_f32 v11, v140
    v_exp_f32 v12, v141
    s_nop 0
    v_cvt_pk_bf16_f32 v158, v11, v12
    v_exp_f32 v13, v142
    v_exp_f32 v14, v143
    s_nop 0
    v_cvt_pk_bf16_f32 v159, v13, v14
    s_nop 1
    s_branch BACK_95
SLOW_106:
    s_nop 15
    v_max3_f32 v5, v112, v113, v114
    v_max3_f32 v5, v5, v115, v120
    v_max3_f32 v5, v5, v121, v122
    v_max_f32 v5, v5, v123
    v_mov_b32 v7, v5
    s_nop 1
    v_permlane32_swap_b32 v5, v7
    s_nop 1
    v_max_f32 v5, v5, v7
    v_mov_b32 v7, v5
    s_nop 1
    v_permlane16_swap_b32 v5, v7
    s_nop 1
    v_max_f32 v5, v5, v7
    v_add_f32 v5, 0x42800000, v5
    v_max_f32 v5, s77, v5
    v_max3_f32 v6, v116, v117, v118
    v_max3_f32 v6, v6, v119, v124
    v_max3_f32 v6, v6, v125, v126
    v_max_f32 v6, v6, v127
    v_mov_b32 v7, v6
    s_nop 1
    v_permlane32_swap_b32 v6, v7
    s_nop 1
    v_max_f32 v6, v6, v7
    v_mov_b32 v7, v6
    s_nop 1
    v_permlane16_swap_b32 v6, v7
    s_nop 1
    v_max_f32 v6, v6, v7
    v_add_f32 v6, 0x42800000, v6
    v_max_f32 v6, s77, v6
    v_sub_f32 v160, v160, v5
    v_sub_f32 v112, v112, v5
    v_sub_f32 v128, v128, v5
    v_sub_f32 v161, v161, v5
    v_sub_f32 v113, v113, v5
    v_sub_f32 v129, v129, v5
    v_sub_f32 v162, v162, v5
    v_sub_f32 v114, v114, v5
    v_sub_f32 v130, v130, v5
    v_sub_f32 v163, v163, v5
    v_sub_f32 v115, v115, v5
    v_sub_f32 v131, v131, v5
    v_sub_f32 v164, v164, v6
    v_sub_f32 v116, v116, v6
    v_sub_f32 v132, v132, v6
    v_sub_f32 v165, v165, v6
    v_sub_f32 v117, v117, v6
    v_sub_f32 v133, v133, v6
    v_sub_f32 v166, v166, v6
    v_sub_f32 v118, v118, v6
    v_sub_f32 v134, v134, v6
    v_sub_f32 v167, v167, v6
    v_sub_f32 v119, v119, v6
    v_sub_f32 v135, v135, v6
    v_sub_f32 v168, v168, v5
    v_sub_f32 v120, v120, v5
    v_sub_f32 v136, v136, v5
    v_sub_f32 v169, v169, v5
    v_sub_f32 v121, v121, v5
    v_sub_f32 v137, v137, v5
    v_sub_f32 v170, v170, v5
    v_sub_f32 v122, v122, v5
    v_sub_f32 v138, v138, v5
    v_sub_f32 v171, v171, v5
    v_sub_f32 v123, v123, v5
    v_sub_f32 v139, v139, v5
    v_sub_f32 v172, v172, v6
    v_sub_f32 v124, v124, v6
    v_sub_f32 v140, v140, v6
    v_sub_f32 v173, v173, v6
    v_sub_f32 v125, v125, v6
    v_sub_f32 v141, v141, v6
    v_sub_f32 v174, v174, v6
    v_sub_f32 v126, v126, v6
    v_sub_f32 v142, v142, v6
    v_sub_f32 v175, v175, v6
    v_sub_f32 v127, v127, v6
    v_sub_f32 v143, v143, v6
    s_cmp_lg_u32 s77, 0
    s_cbranch_scc1 SLOWF_147
    v_exp_f32 v5, -v5
    v_exp_f32 v6, -v6
    s_nop 0
    v_mul_f32 v48, v48, v5
    v_mul_f32 v49, v49, v5
    v_mul_f32 v50, v50, v5
    v_mul_f32 v51, v51, v5
    v_mul_f32 v52, v52, v6
    v_mul_f32 v53, v53, v6
    v_mul_f32 v54, v54, v6
    v_mul_f32 v55, v55, v6
    v_mul_f32 v56, v56, v5
    v_mul_f32 v57, v57, v5
    v_mul_f32 v58, v58, v5
    v_mul_f32 v59, v59, v5
    v_mul_f32 v60, v60, v6
    v_mul_f32 v61, v61, v6
    v_mul_f32 v62, v62, v6
    v_mul_f32 v63, v63, v6
    v_mul_f32 v64, v64, v5
    v_mul_f32 v65, v65, v5
    v_mul_f32 v66, v66, v5
    v_mul_f32 v67, v67, v5
    v_mul_f32 v68, v68, v6
    v_mul_f32 v69, v69, v6
    v_mul_f32 v70, v70, v6
    v_mul_f32 v71, v71, v6
    v_mul_f32 v72, v72, v5
    v_mul_f32 v73, v73, v5
    v_mul_f32 v74, v74, v5
    v_mul_f32 v75, v75, v5
    v_mul_f32 v76, v76, v6
    v_mul_f32 v77, v77, v6
    v_mul_f32 v78, v78, v6
    v_mul_f32 v79, v79, v6
    v_mul_f32 v80, v80, v5
    v_mul_f32 v81, v81, v5
    v_mul_f32 v82, v82, v5
    v_mul_f32 v83, v83, v5
    v_mul_f32 v84, v84, v6
    v_mul_f32 v85, v85, v6
    v_mul_f32 v86, v86, v6
    v_mul_f32 v87, v87, v6
    v_mul_f32 v88, v88, v5
    v_mul_f32 v89, v89, v5
    v_mul_f32 v90, v90, v5
    v_mul_f32 v91, v91, v5
    v_mul_f32 v92, v92, v6
    v_mul_f32 v93, v93, v6
    v_mul_f32 v94, v94, v6
    v_mul_f32 v95, v95, v6
    v_mul_f32 v96, v96, v5
    v_mul_f32 v97, v97, v5
    v_mul_f32 v98, v98, v5
    v_mul_f32 v99, v99, v5
    v_mul_f32 v100, v100, v6
    v_mul_f32 v101, v101, v6
    v_mul_f32 v102, v102, v6
    v_mul_f32 v103, v103, v6
    v_mul_f32 v104, v104, v5
    v_mul_f32 v105, v105, v5
    v_mul_f32 v106, v106, v5
    v_mul_f32 v107, v107, v5
    v_mul_f32 v108, v108, v6
    v_mul_f32 v109, v109, v6
    v_mul_f32 v110, v110, v6
    v_mul_f32 v111, v111, v6
    v_mul_f32 v176, v176, v5
    v_mul_f32 v177, v177, v5
    v_mul_f32 v178, v178, v5
    v_mul_f32 v179, v179, v5
    v_mul_f32 v180, v180, v6
    v_mul_f32 v181, v181, v6
    v_mul_f32 v182, v182, v6
    v_mul_f32 v183, v183, v6
SLOWF_147:
    s_mov_b32 s77, 0
    s_mov_b32 s79, 0
    v_exp_f32 v11, v112
    v_exp_f32 v12, v113
    s_nop 0
    v_cvt_pk_bf16_f32 v144, v11, v12
    v_exp_f32 v13, v114
    v_exp_f32 v14, v115
    s_nop 0
    v_cvt_pk_bf16_f32 v145, v13, v14
    v_exp_f32 v11, v116
    v_exp_f32 v12, v117
    s_nop 0
    v_cvt_pk_bf16_f32 v148, v11, v12
    v_exp_f32 v13, v118
    v_exp_f32 v14, v119
    s_nop 0
    v_cvt_pk_bf16_f32 v149, v13, v14
    v_exp_f32 v11, v120
    v_exp_f32 v12, v121
    s_nop 0
    v_cvt_pk_bf16_f32 v146, v11, v12
    v_exp_f32 v13, v122
    v_exp_f32 v14, v123
    s_nop 0
    v_cvt_pk_bf16_f32 v147, v13, v14
    v_exp_f32 v11, v124
    v_exp_f32 v12, v125
    s_nop 0
    v_cvt_pk_bf16_f32 v150, v11, v12
    v_exp_f32 v13, v126
    v_exp_f32 v14, v127
    s_nop 0
    v_cvt_pk_bf16_f32 v151, v13, v14
    s_nop 1
    s_branch BACK_107
SLOW_113:
    s_nop 15
    v_max3_f32 v5, v112, v113, v114
    v_max3_f32 v5, v5, v115, v120
    v_max3_f32 v5, v5, v121, v122
    v_max_f32 v5, v5, v123
    v_mov_b32 v7, v5
    s_nop 1
    v_permlane32_swap_b32 v5, v7
    s_nop 1
    v_max_f32 v5, v5, v7
    v_mov_b32 v7, v5
    s_nop 1
    v_permlane16_swap_b32 v5, v7
    s_nop 1
    v_max_f32 v5, v5, v7
    v_add_f32 v5, 0x42800000, v5
    v_max_f32 v5, s77, v5
    v_max3_f32 v6, v116, v117, v118
    v_max3_f32 v6, v6, v119, v124
    v_max3_f32 v6, v6, v125, v126
    v_max_f32 v6, v6, v127
    v_mov_b32 v7, v6
    s_nop 1
    v_permlane32_swap_b32 v6, v7
    s_nop 1
    v_max_f32 v6, v6, v7
    v_mov_b32 v7, v6
    s_nop 1
    v_permlane16_swap_b32 v6, v7
    s_nop 1
    v_max_f32 v6, v6, v7
    v_add_f32 v6, 0x42800000, v6
    v_max_f32 v6, s77, v6
    v_sub_f32 v160, v160, v5
    v_sub_f32 v112, v112, v5
    v_sub_f32 v128, v128, v5
    v_sub_f32 v161, v161, v5
    v_sub_f32 v113, v113, v5
    v_sub_f32 v129, v129, v5
    v_sub_f32 v162, v162, v5
    v_sub_f32 v114, v114, v5
    v_sub_f32 v130, v130, v5
    v_sub_f32 v163, v163, v5
    v_sub_f32 v115, v115, v5
    v_sub_f32 v131, v131, v5
    v_sub_f32 v164, v164, v6
    v_sub_f32 v116, v116, v6
    v_sub_f32 v132, v132, v6
    v_sub_f32 v165, v165, v6
    v_sub_f32 v117, v117, v6
    v_sub_f32 v133, v133, v6
    v_sub_f32 v166, v166, v6
    v_sub_f32 v118, v118, v6
    v_sub_f32 v134, v134, v6
    v_sub_f32 v167, v167, v6
    v_sub_f32 v119, v119, v6
    v_sub_f32 v135, v135, v6
    v_sub_f32 v168, v168, v5
    v_sub_f32 v120, v120, v5
    v_sub_f32 v136, v136, v5
    v_sub_f32 v169, v169, v5
    v_sub_f32 v121, v121, v5
    v_sub_f32 v137, v137, v5
    v_sub_f32 v170, v170, v5
    v_sub_f32 v122, v122, v5
    v_sub_f32 v138, v138, v5
    v_sub_f32 v171, v171, v5
    v_sub_f32 v123, v123, v5
    v_sub_f32 v139, v139, v5
    v_sub_f32 v172, v172, v6
    v_sub_f32 v124, v124, v6
    v_sub_f32 v140, v140, v6
    v_sub_f32 v173, v173, v6
    v_sub_f32 v125, v125, v6
    v_sub_f32 v141, v141, v6
    v_sub_f32 v174, v174, v6
    v_sub_f32 v126, v126, v6
    v_sub_f32 v142, v142, v6
    v_sub_f32 v175, v175, v6
    v_sub_f32 v127, v127, v6
    v_sub_f32 v143, v143, v6
    s_cmp_lg_u32 s77, 0
    s_cbranch_scc1 SLOWF_148
    v_exp_f32 v5, -v5
    v_exp_f32 v6, -v6
    s_nop 0
    v_mul_f32 v48, v48, v5
    v_mul_f32 v49, v49, v5
    v_mul_f32 v50, v50, v5
    v_mul_f32 v51, v51, v5
    v_mul_f32 v52, v52, v6
    v_mul_f32 v53, v53, v6
    v_mul_f32 v54, v54, v6
    v_mul_f32 v55, v55, v6
    v_mul_f32 v56, v56, v5
    v_mul_f32 v57, v57, v5
    v_mul_f32 v58, v58, v5
    v_mul_f32 v59, v59, v5
    v_mul_f32 v60, v60, v6
    v_mul_f32 v61, v61, v6
    v_mul_f32 v62, v62, v6
    v_mul_f32 v63, v63, v6
    v_mul_f32 v64, v64, v5
    v_mul_f32 v65, v65, v5
    v_mul_f32 v66, v66, v5
    v_mul_f32 v67, v67, v5
    v_mul_f32 v68, v68, v6
    v_mul_f32 v69, v69, v6
    v_mul_f32 v70, v70, v6
    v_mul_f32 v71, v71, v6
    v_mul_f32 v72, v72, v5
    v_mul_f32 v73, v73, v5
    v_mul_f32 v74, v74, v5
    v_mul_f32 v75, v75, v5
    v_mul_f32 v76, v76, v6
    v_mul_f32 v77, v77, v6
    v_mul_f32 v78, v78, v6
    v_mul_f32 v79, v79, v6
    v_mul_f32 v80, v80, v5
    v_mul_f32 v81, v81, v5
    v_mul_f32 v82, v82, v5
    v_mul_f32 v83, v83, v5
    v_mul_f32 v84, v84, v6
    v_mul_f32 v85, v85, v6
    v_mul_f32 v86, v86, v6
    v_mul_f32 v87, v87, v6
    v_mul_f32 v88, v88, v5
    v_mul_f32 v89, v89, v5
    v_mul_f32 v90, v90, v5
    v_mul_f32 v91, v91, v5
    v_mul_f32 v92, v92, v6
    v_mul_f32 v93, v93, v6
    v_mul_f32 v94, v94, v6
    v_mul_f32 v95, v95, v6
    v_mul_f32 v96, v96, v5
    v_mul_f32 v97, v97, v5
    v_mul_f32 v98, v98, v5
    v_mul_f32 v99, v99, v5
    v_mul_f32 v100, v100, v6
    v_mul_f32 v101, v101, v6
    v_mul_f32 v102, v102, v6
    v_mul_f32 v103, v103, v6
    v_mul_f32 v104, v104, v5
    v_mul_f32 v105, v105, v5
    v_mul_f32 v106, v106, v5
    v_mul_f32 v107, v107, v5
    v_mul_f32 v108, v108, v6
    v_mul_f32 v109, v109, v6
    v_mul_f32 v110, v110, v6
    v_mul_f32 v111, v111, v6
    v_mul_f32 v176, v176, v5
    v_mul_f32 v177, v177, v5
    v_mul_f32 v178, v178, v5
    v_mul_f32 v179, v179, v5
    v_mul_f32 v180, v180, v6
    v_mul_f32 v181, v181, v6
    v_mul_f32 v182, v182, v6
    v_mul_f32 v183, v183, v6
SLOWF_148:
    s_mov_b32 s77, 0
    s_mov_b32 s79, 0
    v_exp_f32 v11, v112
    v_exp_f32 v12, v113
    s_nop 0
    v_cvt_pk_bf16_f32 v144, v11, v12
    v_exp_f32 v13, v114
    v_exp_f32 v14, v115
    s_nop 0
    v_cvt_pk_bf16_f32 v145, v13, v14
    v_exp_f32 v11, v116
    v_exp_f32 v12, v117
    s_nop 0
    v_cvt_pk_bf16_f32 v148, v11, v12
    v_exp_f32 v13, v118
    v_exp_f32 v14, v119
    s_nop 0
    v_cvt_pk_bf16_f32 v149, v13, v14
    v_exp_f32 v11, v120
    v_exp_f32 v12, v121
    s_nop 0
    v_cvt_pk_bf16_f32 v146, v11, v12
    v_exp_f32 v13, v122
    v_exp_f32 v14, v123
    s_nop 0
    v_cvt_pk_bf16_f32 v147, v13, v14
    v_exp_f32 v11, v124
    v_exp_f32 v12, v125
    s_nop 0
    v_cvt_pk_bf16_f32 v150, v11, v12
    v_exp_f32 v13, v126
    v_exp_f32 v14, v127
    s_nop 0
    v_cvt_pk_bf16_f32 v151, v13, v14
    s_nop 1
    s_branch BACK_114
SLOW_120:
    s_nop 15
    v_max3_f32 v5, v112, v113, v114
    v_max3_f32 v5, v5, v115, v120
    v_max3_f32 v5, v5, v121, v122
    v_max_f32 v5, v5, v123
    v_mov_b32 v7, v5
    s_nop 1
    v_permlane32_swap_b32 v5, v7
    s_nop 1
    v_max_f32 v5, v5, v7
    v_mov_b32 v7, v5
    s_nop 1
    v_permlane16_swap_b32 v5, v7
    s_nop 1
    v_max_f32 v5, v5, v7
    v_add_f32 v5, 0x42800000, v5
    v_max_f32 v5, s77, v5
    v_max3_f32 v6, v116, v117, v118
    v_max3_f32 v6, v6, v119, v124
    v_max3_f32 v6, v6, v125, v126
    v_max_f32 v6, v6, v127
    v_mov_b32 v7, v6
    s_nop 1
    v_permlane32_swap_b32 v6, v7
    s_nop 1
    v_max_f32 v6, v6, v7
    v_mov_b32 v7, v6
    s_nop 1
    v_permlane16_swap_b32 v6, v7
    s_nop 1
    v_max_f32 v6, v6, v7
    v_add_f32 v6, 0x42800000, v6
    v_max_f32 v6, s77, v6
    v_sub_f32 v160, v160, v5
    v_sub_f32 v112, v112, v5
    v_sub_f32 v128, v128, v5
    v_sub_f32 v161, v161, v5
    v_sub_f32 v113, v113, v5
    v_sub_f32 v129, v129, v5
    v_sub_f32 v162, v162, v5
    v_sub_f32 v114, v114, v5
    v_sub_f32 v130, v130, v5
    v_sub_f32 v163, v163, v5
    v_sub_f32 v115, v115, v5
    v_sub_f32 v131, v131, v5
    v_sub_f32 v164, v164, v6
    v_sub_f32 v116, v116, v6
    v_sub_f32 v132, v132, v6
    v_sub_f32 v165, v165, v6
    v_sub_f32 v117, v117, v6
    v_sub_f32 v133, v133, v6
    v_sub_f32 v166, v166, v6
    v_sub_f32 v118, v118, v6
    v_sub_f32 v134, v134, v6
    v_sub_f32 v167, v167, v6
    v_sub_f32 v119, v119, v6
    v_sub_f32 v135, v135, v6
    v_sub_f32 v168, v168, v5
    v_sub_f32 v120, v120, v5
    v_sub_f32 v136, v136, v5
    v_sub_f32 v169, v169, v5
    v_sub_f32 v121, v121, v5
    v_sub_f32 v137, v137, v5
    v_sub_f32 v170, v170, v5
    v_sub_f32 v122, v122, v5
    v_sub_f32 v138, v138, v5
    v_sub_f32 v171, v171, v5
    v_sub_f32 v123, v123, v5
    v_sub_f32 v139, v139, v5
    v_sub_f32 v172, v172, v6
    v_sub_f32 v124, v124, v6
    v_sub_f32 v140, v140, v6
    v_sub_f32 v173, v173, v6
    v_sub_f32 v125, v125, v6
    v_sub_f32 v141, v141, v6
    v_sub_f32 v174, v174, v6
    v_sub_f32 v126, v126, v6
    v_sub_f32 v142, v142, v6
    v_sub_f32 v175, v175, v6
    v_sub_f32 v127, v127, v6
    v_sub_f32 v143, v143, v6
    s_cmp_lg_u32 s77, 0
    s_cbranch_scc1 SLOWF_149
    v_exp_f32 v5, -v5
    v_exp_f32 v6, -v6
    s_nop 0
    v_mul_f32 v48, v48, v5
    v_mul_f32 v49, v49, v5
    v_mul_f32 v50, v50, v5
    v_mul_f32 v51, v51, v5
    v_mul_f32 v52, v52, v6
    v_mul_f32 v53, v53, v6
    v_mul_f32 v54, v54, v6
    v_mul_f32 v55, v55, v6
    v_mul_f32 v56, v56, v5
    v_mul_f32 v57, v57, v5
    v_mul_f32 v58, v58, v5
    v_mul_f32 v59, v59, v5
    v_mul_f32 v60, v60, v6
    v_mul_f32 v61, v61, v6
    v_mul_f32 v62, v62, v6
    v_mul_f32 v63, v63, v6
    v_mul_f32 v64, v64, v5
    v_mul_f32 v65, v65, v5
    v_mul_f32 v66, v66, v5
    v_mul_f32 v67, v67, v5
    v_mul_f32 v68, v68, v6
    v_mul_f32 v69, v69, v6
    v_mul_f32 v70, v70, v6
    v_mul_f32 v71, v71, v6
    v_mul_f32 v72, v72, v5
    v_mul_f32 v73, v73, v5
    v_mul_f32 v74, v74, v5
    v_mul_f32 v75, v75, v5
    v_mul_f32 v76, v76, v6
    v_mul_f32 v77, v77, v6
    v_mul_f32 v78, v78, v6
    v_mul_f32 v79, v79, v6
    v_mul_f32 v80, v80, v5
    v_mul_f32 v81, v81, v5
    v_mul_f32 v82, v82, v5
    v_mul_f32 v83, v83, v5
    v_mul_f32 v84, v84, v6
    v_mul_f32 v85, v85, v6
    v_mul_f32 v86, v86, v6
    v_mul_f32 v87, v87, v6
    v_mul_f32 v88, v88, v5
    v_mul_f32 v89, v89, v5
    v_mul_f32 v90, v90, v5
    v_mul_f32 v91, v91, v5
    v_mul_f32 v92, v92, v6
    v_mul_f32 v93, v93, v6
    v_mul_f32 v94, v94, v6
    v_mul_f32 v95, v95, v6
    v_mul_f32 v96, v96, v5
    v_mul_f32 v97, v97, v5
    v_mul_f32 v98, v98, v5
    v_mul_f32 v99, v99, v5
    v_mul_f32 v100, v100, v6
    v_mul_f32 v101, v101, v6
    v_mul_f32 v102, v102, v6
    v_mul_f32 v103, v103, v6
    v_mul_f32 v104, v104, v5
    v_mul_f32 v105, v105, v5
    v_mul_f32 v106, v106, v5
    v_mul_f32 v107, v107, v5
    v_mul_f32 v108, v108, v6
    v_mul_f32 v109, v109, v6
    v_mul_f32 v110, v110, v6
    v_mul_f32 v111, v111, v6
    v_mul_f32 v176, v176, v5
    v_mul_f32 v177, v177, v5
    v_mul_f32 v178, v178, v5
    v_mul_f32 v179, v179, v5
    v_mul_f32 v180, v180, v6
    v_mul_f32 v181, v181, v6
    v_mul_f32 v182, v182, v6
    v_mul_f32 v183, v183, v6
SLOWF_149:
    s_mov_b32 s77, 0
    s_mov_b32 s79, 0
    v_exp_f32 v11, v112
    v_exp_f32 v12, v113
    s_nop 0
    v_cvt_pk_bf16_f32 v144, v11, v12
    v_exp_f32 v13, v114
    v_exp_f32 v14, v115
    s_nop 0
    v_cvt_pk_bf16_f32 v145, v13, v14
    v_exp_f32 v11, v116
    v_exp_f32 v12, v117
    s_nop 0
    v_cvt_pk_bf16_f32 v148, v11, v12
    v_exp_f32 v13, v118
    v_exp_f32 v14, v119
    s_nop 0
    v_cvt_pk_bf16_f32 v149, v13, v14
    v_exp_f32 v11, v120
    v_exp_f32 v12, v121
    s_nop 0
    v_cvt_pk_bf16_f32 v146, v11, v12
    v_exp_f32 v13, v122
    v_exp_f32 v14, v123
    s_nop 0
    v_cvt_pk_bf16_f32 v147, v13, v14
    v_exp_f32 v11, v124
    v_exp_f32 v12, v125
    s_nop 0
    v_cvt_pk_bf16_f32 v150, v11, v12
    v_exp_f32 v13, v126
    v_exp_f32 v14, v127
    s_nop 0
    v_cvt_pk_bf16_f32 v151, v13, v14
    s_nop 1
    s_branch BACK_121
ATT_EXIT_72:
    s_waitcnt lgkmcnt(0)
L_P4:
    s_cmp_ge_u32 s64, 4
    s_cbranch_scc1 P4G_150
    s_waitcnt vmcnt(0)
    s_and_b32 s66, s2, 3
    s_lshl_b32 s66, s66, 2
    s_add_u32 s66, s66, s64
    s_add_u32 s66, s66, 16
    s_lshr_b32 s67, s2, 2
    v_lshlrev_b32 v2, 4, v1
    v_and_b32 v6, 31, v1
    s_lshl_b32 s68, s67, 5
    v_add_u32 v6, s68, v6
    v_mul_u32_u24 v6, 1152, v6
    v_lshrrev_b32 v7, 5, v1
    v_lshl_add_u32 v8, v7, 3, v6
    s_mul_i32 s68, s66, 36
    s_add_u32 s68, s68, 50331648
    buffer_load_dwordx2 v[16:17], v8, s[56:59], s68 offen
    buffer_load_dwordx2 v[18:19], v8, s[56:59], s68 offen offset:16
    buffer_load_dword v20, v6, s[56:59], s68 offen offset:32
    v_lshlrev_b32 v7, 2, v1
    s_mov_b32 s68, 62922752
    buffer_load_dword v11, v7, s[56:59], s68 offen
    s_mul_i32 s69, s64, 2368
    s_add_u32 m0, s69, 131072
    s_add_u32 s68, s69, 54525952
    buffer_load_dwordx4 v2, s[56:59], s68 offen lds
    buffer_load_dwordx4 v2, s[56:59], s68 offen offset:1024 lds
    s_mov_b64 exec, 0xfffff
    buffer_load_dwordx4 v2, s[56:59], s68 offen offset:2048 lds
    s_mov_b64 exec, -1
    s_mul_i32 s69, s64, 2368
    s_add_u32 m0, s69, 147456
    s_add_u32 s68, s69, 54535424
    buffer_load_dwordx4 v2, s[56:59], s68 offen lds
    buffer_load_dwordx4 v2, s[56:59], s68 offen offset:1024 lds
    s_mov_b64 exec, 0xfffff
    buffer_load_dwordx4 v2, s[56:59], s68 offen offset:2048 lds
    s_mov_b64 exec, -1
    s_barrier
    s_lshl_b32 s10, s2, 3
    s_add_u32 s10, s10, 32768
    s_cmp_lg_u32 s64, 0
    s_cbranch_scc1 SY_152
    s_memrealtime s[12:13]
    v_mov_b32 v122, s10
    s_mov_b32 s8, 62914560
    s_waitcnt lgkmcnt(0)
    v_mov_b32 v120, s12
    v_mov_b32 v121, s13
    s_mov_b64 exec, 1
    buffer_store_dwordx2 v[120:121], v122, s[56:59], s8 offen sc1
    s_mov_b64 exec, -1
SY_152:
    s_mov_b32 s71, 0x40004000
    v_mov_b32 v32, 0
    v_mov_b32 v33, 0
    v_mov_b32 v34, 0
    v_mov_b32 v35, 0
    v_mov_b32 v36, 0
    v_mov_b32 v37, 0
    v_mov_b32 v38, 0
    v_mov_b32 v39, 0
    v_mov_b32 v40, 0
    v_mov_b32 v41, 0
    v_mov_b32 v42, 0
    v_mov_b32 v43, 0
    v_mov_b32 v44, 0
    v_mov_b32 v45, 0
    v_mov_b32 v46, 0
    v_mov_b32 v47, 0
    v_mov_b32 v88, 0
    v_mov_b32 v89, 0
    v_mov_b32 v90, 0
    v_mov_b32 v91, 0
    v_mov_b32 v92, 0
    v_mov_b32 v93, 0
    v_mov_b32 v94, 0
    v_mov_b32 v95, 0
    v_mov_b32 v21, 0
    v_mov_b32 v22, 0
    v_mov_b32 v23, 0
    v_mov_b32 v170, v2
    v_and_b32 v171, 31, v1
    v_min_u32 v172, 18, v171
    v_lshlrev_b32 v171, 2, v171
    v_lshrrev_b32 v7, 5, v1
    v_mul_u32_u24 v7, 304, v7
    v_lshl_add_u32 v172, v172, 4, v7
    v_add_u32 v160, 131072, v170
    v_add_u32 v161, 131072, v170
    v_add_u32 v162, 147456, v170
    v_add_u32 v163, 131072, v171
    v_add_u32 v164, 131072, v171
    v_add_u32 v165, 147456, v171
    v_add_u32 v166, 131072, v172
    v_add_u32 v167, 131072, v172
    v_add_u32 v168, 147456, v172
    v_mov_b32 v117, 0
    v_mov_b32 v118, 0
    v_mov_b32 v119, 0
    v_mov_b32 v133, 0
    v_mov_b32 v134, 0
    v_mov_b32 v135, 0
    s_mul_i32 s76, s64, 2368
    s_add_u32 s70, s76, 54544896
    s_add_u32 s77, s76, 54668032
    s_mov_b32 s75, 114688
    s_mov_b32 s74, 0
    v_cmp_gt_u32 vcc, 32, v1
    s_waitcnt vmcnt(3)
    s_nop 0
    v_cndmask_b32 v20, 0, v20, vcc
    s_barrier
    ds_swizzle_b32 v7, v11 offset:0x41f
    s_waitcnt lgkmcnt(0)
    v_max_u32 v11, v11, v7
    ds_swizzle_b32 v7, v11 offset:0x81f
    s_waitcnt lgkmcnt(0)
    v_max_u32 v11, v11, v7
    ds_swizzle_b32 v7, v11 offset:0x101f
    s_waitcnt lgkmcnt(0)
    v_max_u32 v11, v11, v7
    ds_swizzle_b32 v7, v11 offset:0x201f
    s_waitcnt lgkmcnt(0)
    v_max_u32 v11, v11, v7
    ds_swizzle_b32 v7, v11 offset:0x401f
    s_waitcnt lgkmcnt(0)
    v_max_u32 v11, v11, v7
    v_mov_b32 v7, v11
    s_nop 1
    v_permlane32_swap_b32 v11, v7
    s_nop 1
    v_max_u32 v11, v11, v7
    ds_read_b128 v[112:115], v161
    ds_read_b32 v116, v164 offset:1024
    v_mov_b32 v7, 0
    v_lshlrev_b32 v12, 16, v16
    v_and_b32 v13, 0xffff0000, v16
    v_fmac_f32 v7, v12, v12
    v_fmac_f32 v7, v13, v13
    v_lshlrev_b32 v12, 16, v17
    v_and_b32 v13, 0xffff0000, v17
    v_fmac_f32 v7, v12, v12
    v_fmac_f32 v7, v13, v13
    v_lshlrev_b32 v12, 16, v18
    v_and_b32 v13, 0xffff0000, v18
    v_fmac_f32 v7, v12, v12
    v_fmac_f32 v7, v13, v13
    v_lshlrev_b32 v12, 16, v19
    v_and_b32 v13, 0xffff0000, v19
    v_fmac_f32 v7, v12, v12
    v_fmac_f32 v7, v13, v13
    v_lshlrev_b32 v12, 16, v20
    v_and_b32 v13, 0xffff0000, v20
    v_fmac_f32 v7, v12, v12
    v_fmac_f32 v7, v13, v13
    v_mov_b32 v8, v7
    s_nop 1
    v_permlane32_swap_b32 v7, v8
    s_nop 1
    v_add_f32 v7, v7, v8
    v_mul_f32 v7, v7, v11
    v_sqrt_f32 v7, v7
    s_nop 0
    v_mul_f32 v7, 0x3f828f5c, v7
    v_add_f32 v7, 0x3c23d70a, v7
    v_cmp_nge_f32 vcc, 0x42200000, v7
    s_cbranch_vccnz AA_CHK_153
    v_sub_f32 v96, 0, v7
    v_sub_f32 v97, 0, v7
    v_sub_f32 v98, 0, v7
    v_sub_f32 v99, 0, v7
    v_sub_f32 v100, 0, v7
    v_sub_f32 v101, 0, v7
    v_sub_f32 v102, 0, v7
    v_sub_f32 v103, 0, v7
    v_sub_f32 v104, 0, v7
    v_sub_f32 v105, 0, v7
    v_sub_f32 v106, 0, v7
    v_sub_f32 v107, 0, v7
    v_sub_f32 v108, 0, v7
    v_sub_f32 v109, 0, v7
    v_sub_f32 v110, 0, v7
    v_sub_f32 v111, 0, v7
    v_mov_b32 v11, 0
    s_waitcnt lgkmcnt(0)
    s_nop 0
    v_mfma_f32_32x32x16_bf16 v[48:63], v[112:115], v[16:19], v[96:111]
    v_mfma_f32_32x32x16_bf16 v[48:63], v[116:119], v[20:23], v[48:63]
    ds_read_b128 v[112:115], v161 offset:2368
    ds_read_b32 v116, v164 offset:3392
    ds_read_b128 v[120:123], v166 offset:8256
    ds_read_b128 v[124:127], v166 offset:8864
    s_nop 15
AA_LOOP_155:
    s_waitcnt lgkmcnt(2)
    v_mfma_f32_32x32x16_bf16 v[64:79], v[112:115], v[16:19], v[96:111]
    ds_read_b128 v[128:131], v161 offset:4736
    v_exp_f32 v180, v48
    v_exp_f32 v181, v49
    v_exp_f32 v182, v50
    v_exp_f32 v183, v51
    v_mfma_f32_32x32x16_bf16 v[64:79], v[116:119], v[20:23], v[64:79]
    ds_read_b32 v132, v164 offset:5760
    v_exp_f32 v184, v52
    v_exp_f32 v185, v53
    v_cvt_pk_bf16_f32 v80, v180, v181
    v_exp_f32 v186, v54
    v_cvt_pk_bf16_f32 v81, v182, v183
    v_exp_f32 v187, v55
    s_waitcnt lgkmcnt(2)
    v_mfma_f32_32x32x16_bf16 v[32:47], v[120:123], v[88:91], v[32:47]
    ds_read_b128 v[136:139], v167 offset:1152
    v_exp_f32 v180, v56
    v_exp_f32 v181, v57
    v_cvt_pk_bf16_f32 v82, v184, v185
    v_exp_f32 v182, v58
    v_cvt_pk_bf16_f32 v83, v186, v187
    v_exp_f32 v183, v59
    v_mfma_f32_32x32x16_bf16 v[32:47], v[124:127], v[92:95], v[32:47]
    ds_read_b128 v[140:143], v167 offset:1760
    v_exp_f32 v184, v60
    v_exp_f32 v185, v61
    v_cvt_pk_bf16_f32 v84, v180, v181
    v_exp_f32 v186, v62
    v_cvt_pk_bf16_f32 v85, v182, v183
    v_exp_f32 v187, v63
    v_cvt_pk_bf16_f32 v86, v184, v185
    s_nop 0
    v_cvt_pk_bf16_f32 v87, v186, v187
    s_waitcnt lgkmcnt(2)
    v_mfma_f32_32x32x16_bf16 v[48:63], v[128:131], v[16:19], v[96:111]
    ds_read_b128 v[112:115], v161 offset:7104
    v_exp_f32 v180, v64
    v_exp_f32 v181, v65
    v_exp_f32 v182, v66
    v_exp_f32 v183, v67
    v_mfma_f32_32x32x16_bf16 v[48:63], v[132:135], v[20:23], v[48:63]
    ds_read_b32 v116, v164 offset:8128
    v_exp_f32 v184, v68
    v_exp_f32 v185, v69
    v_cvt_pk_bf16_f32 v88, v180, v181
    v_exp_f32 v186, v70
    v_cvt_pk_bf16_f32 v89, v182, v183
    v_exp_f32 v187, v71
    s_waitcnt lgkmcnt(2)
    v_mfma_f32_32x32x16_bf16 v[32:47], v[136:139], v[80:83], v[32:47]
    s_waitcnt vmcnt(0)
    s_barrier
    s_add_u32 m0, s75, s76
    s_nop 0
    buffer_load_dwordx4 v2, s[56:59], s70 offen lds
    buffer_load_dwordx4 v2, s[56:59], s70 offen offset:1024 lds
    s_mov_b64 exec, 0xfffff
    buffer_load_dwordx4 v2, s[56:59], s70 offen offset:2048 lds
    s_mov_b64 exec, -1
    s_add_u32 s70, s70, 9472
    s_min_u32 s70, s70, s77
    ds_read_b128 v[120:123], v167 offset:3520
    v_exp_f32 v180, v72
    v_exp_f32 v181, v73
    v_cvt_pk_bf16_f32 v90, v184, v185
    v_exp_f32 v182, v74
    v_cvt_pk_bf16_f32 v91, v186, v187
    v_exp_f32 v183, v75
    v_mfma_f32_32x32x16_bf16 v[32:47], v[140:143], v[84:87], v[32:47]
    ds_read_b128 v[124:127], v167 offset:4128
    v_exp_f32 v184, v76
    v_exp_f32 v185, v77
    v_cvt_pk_bf16_f32 v92, v180, v181
    v_exp_f32 v186, v78
    v_cvt_pk_bf16_f32 v93, v182, v183
    v_exp_f32 v187, v79
    v_cvt_pk_bf16_f32 v94, v184, v185
    s_nop 0
    v_cvt_pk_bf16_f32 v95, v186, v187
    s_waitcnt lgkmcnt(2)
    v_mfma_f32_32x32x16_bf16 v[64:79], v[112:115], v[16:19], v[96:111]
    ds_read_b128 v[128:131], v162 offset:0
    v_exp_f32 v180, v48
    v_exp_f32 v181, v49
    v_exp_f32 v182, v50
    v_exp_f32 v183, v51
    v_mfma_f32_32x32x16_bf16 v[64:79], v[116:119], v[20:23], v[64:79]
    ds_read_b32 v132, v165 offset:1024
    v_exp_f32 v184, v52
    v_exp_f32 v185, v53
    v_cvt_pk_bf16_f32 v80, v180, v181
    v_exp_f32 v186, v54
    v_cvt_pk_bf16_f32 v81, v182, v183
    v_exp_f32 v187, v55
    s_waitcnt lgkmcnt(2)
    v_mfma_f32_32x32x16_bf16 v[32:47], v[120:123], v[88:91], v[32:47]
    ds_read_b128 v[136:139], v167 offset:5888
    v_exp_f32 v180, v56
    v_exp_f32 v181, v57
    v_cvt_pk_bf16_f32 v82, v184, v185
    v_exp_f32 v182, v58
    v_cvt_pk_bf16_f32 v83, v186, v187
    v_exp_f32 v183, v59
    v_mfma_f32_32x32x16_bf16 v[32:47], v[124:127], v[92:95], v[32:47]
    ds_read_b128 v[140:143], v167 offset:6496
    v_exp_f32 v184, v60
    v_exp_f32 v185, v61
    v_cvt_pk_bf16_f32 v84, v180, v181
    v_exp_f32 v186, v62
    v_cvt_pk_bf16_f32 v85, v182, v183
    v_exp_f32 v187, v63
    v_cvt_pk_bf16_f32 v86, v184, v185
    s_nop 0
    v_cvt_pk_bf16_f32 v87, v186, v187
    s_waitcnt lgkmcnt(2)
    v_mfma_f32_32x32x16_bf16 v[48:63], v[128:131], v[16:19], v[96:111]
    ds_read_b128 v[112:115], v162 offset:2368
    v_exp_f32 v180, v64
    v_exp_f32 v181, v65
    v_exp_f32 v182, v66
    v_exp_f32 v183, v67
    v_mfma_f32_32x32x16_bf16 v[48:63], v[132:135], v[20:23], v[48:63]
    ds_read_b32 v116, v165 offset:3392
    v_exp_f32 v184, v68
    s_add_u32 s74, s74, 1
    s_mov_b32 s68, s75
    v_exp_f32 v185, v69
    v_cvt_pk_bf16_f32 v88, v180, v181
    s_add_u32 s75, s75, 16384
    v_exp_f32 v186, v70
    v_cvt_pk_bf16_f32 v89, v182, v183
    s_cmp_ge_u32 s75, 163840
    v_exp_f32 v187, v71
    s_cselect_b32 s75, 114688, s75
    s_waitcnt lgkmcnt(2)
    v_mfma_f32_32x32x16_bf16 v[32:47], v[136:139], v[80:83], v[32:47]
    s_barrier
    ds_read_b128 v[120:123], v167 offset:8256
    v_exp_f32 v180, v72
    v_exp_f32 v181, v73
    v_cvt_pk_bf16_f32 v90, v184, v185
    v_exp_f32 v182, v74
    v_cvt_pk_bf16_f32 v91, v186, v187
    v_exp_f32 v183, v75
    v_mfma_f32_32x32x16_bf16 v[32:47], v[140:143], v[84:87], v[32:47]
    ds_read_b128 v[124:127], v167 offset:8864
    v_exp_f32 v184, v76
    v_exp_f32 v185, v77
    v_cvt_pk_bf16_f32 v92, v180, v181
    v_exp_f32 v186, v78
    v_cvt_pk_bf16_f32 v93, v182, v183
    v_exp_f32 v187, v79
    v_cvt_pk_bf16_f32 v94, v184, v185
    v_mov_b32 v166, v167
    v_cvt_pk_bf16_f32 v95, v186, v187
    v_mov_b32 v161, v162
    v_add_u32 v162, s68, v170
    v_mov_b32 v164, v165
    v_add_u32 v165, s68, v171
    v_mov_b32 v167, v168
    v_add_u32 v168, s68, v172
    s_cmp_lt_u32 s74, 16
    s_cbranch_scc1 AA_LOOP_155
    s_branch AA_J_154
AA_CHK_153:
    v_mov_b32 v11, 1
    s_waitcnt lgkmcnt(0)
    v_mfma_f32_32x32x16_bf16 v[48:63], v[112:115], v[16:19], 0
    v_mfma_f32_32x32x16_bf16 v[48:63], v[116:119], v[20:23], v[48:63]
    s_nop 15
    v_max3_f32 v7, v48, v49, v50
    v_max3_f32 v7, v7, v51, v52
    v_max3_f32 v7, v7, v53, v54
    v_max3_f32 v7, v7, v55, v56
    v_max3_f32 v7, v7, v57, v58
    v_max3_f32 v7, v7, v59, v60
    v_max3_f32 v7, v7, v61, v62
    v_max_f32 v7, v7, v63
    v_mov_b32 v8, v7
    s_nop 1
    v_permlane32_swap_b32 v7, v8
    s_nop 1
    v_max_f32 v7, v7, v8
    v_add_f32 v7, 0x42800000, v7
    v_sub_f32 v96, 0, v7
    v_sub_f32 v48, v48, v7
    v_sub_f32 v97, 0, v7
    v_sub_f32 v49, v49, v7
    v_sub_f32 v98, 0, v7
    v_sub_f32 v50, v50, v7
    v_sub_f32 v99, 0, v7
    v_sub_f32 v51, v51, v7
    v_sub_f32 v100, 0, v7
    v_sub_f32 v52, v52, v7
    v_sub_f32 v101, 0, v7
    v_sub_f32 v53, v53, v7
    v_sub_f32 v102, 0, v7
    v_sub_f32 v54, v54, v7
    v_sub_f32 v103, 0, v7
    v_sub_f32 v55, v55, v7
    v_sub_f32 v104, 0, v7
    v_sub_f32 v56, v56, v7
    v_sub_f32 v105, 0, v7
    v_sub_f32 v57, v57, v7
    v_sub_f32 v106, 0, v7
    v_sub_f32 v58, v58, v7
    v_sub_f32 v107, 0, v7
    v_sub_f32 v59, v59, v7
    v_sub_f32 v108, 0, v7
    v_sub_f32 v60, v60, v7
    v_sub_f32 v109, 0, v7
    v_sub_f32 v61, v61, v7
    v_sub_f32 v110, 0, v7
    v_sub_f32 v62, v62, v7
    v_sub_f32 v111, 0, v7
    v_sub_f32 v63, v63, v7
    ds_read_b128 v[112:115], v161 offset:2368
    ds_read_b32 v116, v164 offset:3392
    ds_read_b128 v[120:123], v166 offset:8256
    ds_read_b128 v[124:127], v166 offset:8864
AA_LOOP_156:
    s_waitcnt lgkmcnt(2)
    v_mfma_f32_32x32x16_bf16 v[64:79], v[112:115], v[16:19], v[96:111]
    ds_read_b128 v[128:131], v161 offset:4736
    v_exp_f32 v180, v48
    v_exp_f32 v181, v49
    v_exp_f32 v182, v50
    v_exp_f32 v183, v51
    v_mfma_f32_32x32x16_bf16 v[64:79], v[116:119], v[20:23], v[64:79]
    ds_read_b32 v132, v164 offset:5760
    v_exp_f32 v184, v52
    v_exp_f32 v185, v53
    v_cvt_pk_bf16_f32 v80, v180, v181
    v_exp_f32 v186, v54
    v_cvt_pk_bf16_f32 v81, v182, v183
    v_exp_f32 v187, v55
    s_waitcnt lgkmcnt(2)
    v_mfma_f32_32x32x16_bf16 v[32:47], v[120:123], v[88:91], v[32:47]
    ds_read_b128 v[136:139], v167 offset:1152
    v_exp_f32 v180, v56
    v_or_b32 v10, v80, v81
    v_exp_f32 v181, v57
    v_cvt_pk_bf16_f32 v82, v184, v185
    v_exp_f32 v182, v58
    v_cvt_pk_bf16_f32 v83, v186, v187
    v_exp_f32 v183, v59
    v_mfma_f32_32x32x16_bf16 v[32:47], v[124:127], v[92:95], v[32:47]
    ds_read_b128 v[140:143], v167 offset:1760
    v_exp_f32 v184, v60
    v_or3_b32 v10, v10, v82, v83
    v_exp_f32 v185, v61
    v_cvt_pk_bf16_f32 v84, v180, v181
    v_exp_f32 v186, v62
    v_cvt_pk_bf16_f32 v85, v182, v183
    v_exp_f32 v187, v63
    v_cvt_pk_bf16_f32 v86, v184, v185
    v_or3_b32 v10, v10, v84, v85
    v_cvt_pk_bf16_f32 v87, v186, v187
    s_nop 1
    v_or3_b32 v10, v10, v86, v87
    v_and_b32 v10, s71, v10
    v_cmp_ne_u32 vcc, 0, v10
    s_cbranch_vccnz AA_SLOW_157
AA_BACK_158:
    s_waitcnt lgkmcnt(2)
    v_mfma_f32_32x32x16_bf16 v[48:63], v[128:131], v[16:19], v[96:111]
    ds_read_b128 v[112:115], v161 offset:7104
    v_exp_f32 v180, v64
    v_exp_f32 v181, v65
    v_exp_f32 v182, v66
    v_exp_f32 v183, v67
    v_mfma_f32_32x32x16_bf16 v[48:63], v[132:135], v[20:23], v[48:63]
    ds_read_b32 v116, v164 offset:8128
    v_exp_f32 v184, v68
    v_exp_f32 v185, v69
    v_cvt_pk_bf16_f32 v88, v180, v181
    v_exp_f32 v186, v70
    v_cvt_pk_bf16_f32 v89, v182, v183
    v_exp_f32 v187, v71
    s_waitcnt lgkmcnt(2)
    v_mfma_f32_32x32x16_bf16 v[32:47], v[136:139], v[80:83], v[32:47]
    s_waitcnt vmcnt(0)
    s_barrier
    s_add_u32 m0, s75, s76
    s_nop 0
    buffer_load_dwordx4 v2, s[56:59], s70 offen lds
    buffer_load_dwordx4 v2, s[56:59], s70 offen offset:1024 lds
    s_mov_b64 exec, 0xfffff
    buffer_load_dwordx4 v2, s[56:59], s70 offen offset:2048 lds
    s_mov_b64 exec, -1
    s_add_u32 s70, s70, 9472
    s_min_u32 s70, s70, s77
    ds_read_b128 v[120:123], v167 offset:3520
    v_exp_f32 v180, v72
    v_or_b32 v10, v88, v89
    v_exp_f32 v181, v73
    v_cvt_pk_bf16_f32 v90, v184, v185
    v_exp_f32 v182, v74
    v_cvt_pk_bf16_f32 v91, v186, v187
    v_exp_f32 v183, v75
    v_mfma_f32_32x32x16_bf16 v[32:47], v[140:143], v[84:87], v[32:47]
    ds_read_b128 v[124:127], v167 offset:4128
    v_exp_f32 v184, v76
    v_or3_b32 v10, v10, v90, v91
    v_exp_f32 v185, v77
    v_cvt_pk_bf16_f32 v92, v180, v181
    v_exp_f32 v186, v78
    v_cvt_pk_bf16_f32 v93, v182, v183
    v_exp_f32 v187, v79
    v_cvt_pk_bf16_f32 v94, v184, v185
    v_or3_b32 v10, v10, v92, v93
    v_cvt_pk_bf16_f32 v95, v186, v187
    s_nop 1
    v_or3_b32 v10, v10, v94, v95
    v_and_b32 v10, s71, v10
    v_cmp_ne_u32 vcc, 0, v10
    s_cbranch_vccnz AA_SLOW_159
AA_BACK_160:
    s_waitcnt lgkmcnt(2)
    v_mfma_f32_32x32x16_bf16 v[64:79], v[112:115], v[16:19], v[96:111]
    ds_read_b128 v[128:131], v162 offset:0
    v_exp_f32 v180, v48
    v_exp_f32 v181, v49
    v_exp_f32 v182, v50
    v_exp_f32 v183, v51
    v_mfma_f32_32x32x16_bf16 v[64:79], v[116:119], v[20:23], v[64:79]
    ds_read_b32 v132, v165 offset:1024
    v_exp_f32 v184, v52
    v_exp_f32 v185, v53
    v_cvt_pk_bf16_f32 v80, v180, v181
    v_exp_f32 v186, v54
    v_cvt_pk_bf16_f32 v81, v182, v183
    v_exp_f32 v187, v55
    s_waitcnt lgkmcnt(2)
    v_mfma_f32_32x32x16_bf16 v[32:47], v[120:123], v[88:91], v[32:47]
    ds_read_b128 v[136:139], v167 offset:5888
    v_exp_f32 v180, v56
    v_or_b32 v10, v80, v81
    v_exp_f32 v181, v57
    v_cvt_pk_bf16_f32 v82, v184, v185
    v_exp_f32 v182, v58
    v_cvt_pk_bf16_f32 v83, v186, v187
    v_exp_f32 v183, v59
    v_mfma_f32_32x32x16_bf16 v[32:47], v[124:127], v[92:95], v[32:47]
    ds_read_b128 v[140:143], v167 offset:6496
    v_exp_f32 v184, v60
    v_or3_b32 v10, v10, v82, v83
    v_exp_f32 v185, v61
    v_cvt_pk_bf16_f32 v84, v180, v181
    v_exp_f32 v186, v62
    v_cvt_pk_bf16_f32 v85, v182, v183
    v_exp_f32 v187, v63
    v_cvt_pk_bf16_f32 v86, v184, v185
    v_or3_b32 v10, v10, v84, v85
    v_cvt_pk_bf16_f32 v87, v186, v187
    s_nop 1
    v_or3_b32 v10, v10, v86, v87
    v_and_b32 v10, s71, v10
    v_cmp_ne_u32 vcc, 0, v10
    s_cbranch_vccnz AA_SLOW_161
AA_BACK_162:
    s_waitcnt lgkmcnt(2)
    v_mfma_f32_32x32x16_bf16 v[48:63], v[128:131], v[16:19], v[96:111]
    ds_read_b128 v[112:115], v162 offset:2368
    v_exp_f32 v180, v64
    v_exp_f32 v181, v65
    v_exp_f32 v182, v66
    v_exp_f32 v183, v67
    v_mfma_f32_32x32x16_bf16 v[48:63], v[132:135], v[20:23], v[48:63]
    ds_read_b32 v116, v165 offset:3392
    v_exp_f32 v184, v68
    s_add_u32 s74, s74, 1
    s_mov_b32 s68, s75
    v_exp_f32 v185, v69
    v_cvt_pk_bf16_f32 v88, v180, v181
    s_add_u32 s75, s75, 16384
    v_exp_f32 v186, v70
    v_cvt_pk_bf16_f32 v89, v182, v183
    s_cmp_ge_u32 s75, 163840
    v_exp_f32 v187, v71
    s_cselect_b32 s75, 114688, s75
    s_waitcnt lgkmcnt(2)
    v_mfma_f32_32x32x16_bf16 v[32:47], v[136:139], v[80:83], v[32:47]
    s_barrier
    ds_read_b128 v[120:123], v167 offset:8256
    v_exp_f32 v180, v72
    v_or_b32 v10, v88, v89
    v_exp_f32 v181, v73
    v_cvt_pk_bf16_f32 v90, v184, v185
    v_exp_f32 v182, v74
    v_cvt_pk_bf16_f32 v91, v186, v187
    v_exp_f32 v183, v75
    v_mfma_f32_32x32x16_bf16 v[32:47], v[140:143], v[84:87], v[32:47]
    ds_read_b128 v[124:127], v167 offset:8864
    v_exp_f32 v184, v76
    v_or3_b32 v10, v10, v90, v91
    v_exp_f32 v185, v77
    v_cvt_pk_bf16_f32 v92, v180, v181
    v_exp_f32 v186, v78
    v_cvt_pk_bf16_f32 v93, v182, v183
    v_exp_f32 v187, v79
    v_cvt_pk_bf16_f32 v94, v184, v185
    v_or3_b32 v10, v10, v92, v93
    v_cvt_pk_bf16_f32 v95, v186, v187
    v_mov_b32 v166, v167
    s_nop 1
    v_or3_b32 v10, v10, v94, v95
    v_and_b32 v10, s71, v10
    v_cmp_ne_u32 vcc, 0, v10
    v_mov_b32 v161, v162
    v_add_u32 v162, s68, v170
    v_mov_b32 v164, v165
    v_add_u32 v165, s68, v171
    v_mov_b32 v167, v168
    v_add_u32 v168, s68, v172
    s_cbranch_vccnz AA_SLOW_163
AA_BACK_164:
    s_cmp_lt_u32 s74, 16
    s_cbranch_scc1 AA_LOOP_156
AA_J_154:
    s_waitcnt lgkmcnt(0)
    v_mfma_f32_32x32x16_bf16 v[32:47], v[120:123], v[88:91], v[32:47]
    v_mfma_f32_32x32x16_bf16 v[32:47], v[124:127], v[92:95], v[32:47]
    s_nop 15
    v_rcp_f32 v7, v42
    s_nop 0
    v_mul_f32 v32, v32, v7
    v_mul_f32 v33, v33, v7
    v_mul_f32 v34, v34, v7
    v_mul_f32 v35, v35, v7
    v_mul_f32 v36, v36, v7
    v_mul_f32 v37, v37, v7
    v_mul_f32 v38, v38, v7
    v_mul_f32 v39, v39, v7
    v_mul_f32 v40, v40, v7
    v_mul_f32 v41, v41, v7
    v_cvt_pk_bf16_f32 v80, v32, v33
    v_cvt_pk_bf16_f32 v81, v34, v35
    v_cvt_pk_bf16_f32 v82, v36, v37
    v_cvt_pk_bf16_f32 v83, v38, v39
    v_cvt_pk_bf16_f32 v84, v40, v41
    v_lshrrev_b32 v6, 1, v6
    v_lshrrev_b32 v7, 5, v1
    v_lshl_add_u32 v8, v7, 3, v6
    s_and_b32 s68, s66, 15
    s_mul_i32 s68, s68, 36
    s_add_u32 s68, s68, 57802752
    buffer_store_dwordx2 v[80:81], v8, s[56:59], s68 offen sc1
    buffer_store_dwordx2 v[82:83], v8, s[56:59], s68 offen offset:16 sc1
    v_cmp_gt_u32 vcc, 32, v1
    s_and_saveexec_b64 s[72:73], vcc
    buffer_store_dword v84, v6, s[56:59], s68 offen offset:32 sc1
    s_mov_b64 exec, s[72:73]
    s_branch AA_END_165
AA_SLOW_157:
    s_nop 15
    v_max3_f32 v7, v48, v49, v50
    v_max3_f32 v7, v7, v51, v52
    v_max3_f32 v7, v7, v53, v54
    v_max3_f32 v7, v7, v55, v56
    v_max3_f32 v7, v7, v57, v58
    v_max3_f32 v7, v7, v59, v60
    v_max3_f32 v7, v7, v61, v62
    v_max_f32 v7, v7, v63
    v_mov_b32 v8, v7
    s_nop 1
    v_permlane32_swap_b32 v7, v8
    s_nop 1
    v_max_f32 v7, v7, v8
    v_add_f32 v7, 0x42800000, v7
    v_max_f32 v7, 0, v7
    v_sub_f32 v96, v96, v7
    v_sub_f32 v48, v48, v7
    v_sub_f32 v64, v64, v7
    v_sub_f32 v97, v97, v7
    v_sub_f32 v49, v49, v7
    v_sub_f32 v65, v65, v7
    v_sub_f32 v98, v98, v7
    v_sub_f32 v50, v50, v7
    v_sub_f32 v66, v66, v7
    v_sub_f32 v99, v99, v7
    v_sub_f32 v51, v51, v7
    v_sub_f32 v67, v67, v7
    v_sub_f32 v100, v100, v7
    v_sub_f32 v52, v52, v7
    v_sub_f32 v68, v68, v7
    v_sub_f32 v101, v101, v7
    v_sub_f32 v53, v53, v7
    v_sub_f32 v69, v69, v7
    v_sub_f32 v102, v102, v7
    v_sub_f32 v54, v54, v7
    v_sub_f32 v70, v70, v7
    v_sub_f32 v103, v103, v7
    v_sub_f32 v55, v55, v7
    v_sub_f32 v71, v71, v7
    v_sub_f32 v104, v104, v7
    v_sub_f32 v56, v56, v7
    v_sub_f32 v72, v72, v7
    v_sub_f32 v105, v105, v7
    v_sub_f32 v57, v57, v7
    v_sub_f32 v73, v73, v7
    v_sub_f32 v106, v106, v7
    v_sub_f32 v58, v58, v7
    v_sub_f32 v74, v74, v7
    v_sub_f32 v107, v107, v7
    v_sub_f32 v59, v59, v7
    v_sub_f32 v75, v75, v7
    v_sub_f32 v108, v108, v7
    v_sub_f32 v60, v60, v7
    v_sub_f32 v76, v76, v7
    v_sub_f32 v109, v109, v7
    v_sub_f32 v61, v61, v7
    v_sub_f32 v77, v77, v7
    v_sub_f32 v110, v110, v7
    v_sub_f32 v62, v62, v7
    v_sub_f32 v78, v78, v7
    v_sub_f32 v111, v111, v7
    v_sub_f32 v63, v63, v7
    v_sub_f32 v79, v79, v7
    v_exp_f32 v8, -v7
    s_nop 0
    v_mul_f32 v32, v32, v8
    v_mul_f32 v33, v33, v8
    v_mul_f32 v34, v34, v8
    v_mul_f32 v35, v35, v8
    v_mul_f32 v36, v36, v8
    v_mul_f32 v37, v37, v8
    v_mul_f32 v38, v38, v8
    v_mul_f32 v39, v39, v8
    v_mul_f32 v40, v40, v8
    v_mul_f32 v41, v41, v8
    v_mul_f32 v42, v42, v8
    v_mul_f32 v43, v43, v8
    v_mul_f32 v44, v44, v8
    v_mul_f32 v45, v45, v8
    v_mul_f32 v46, v46, v8
    v_mul_f32 v47, v47, v8
    v_exp_f32 v12, v48
    v_exp_f32 v13, v49
    s_nop 0
    v_cvt_pk_bf16_f32 v80, v12, v13
    v_exp_f32 v14, v50
    v_exp_f32 v15, v51
    s_nop 0
    v_cvt_pk_bf16_f32 v81, v14, v15
    v_exp_f32 v12, v52
    v_exp_f32 v13, v53
    s_nop 0
    v_cvt_pk_bf16_f32 v82, v12, v13
    v_exp_f32 v14, v54
    v_exp_f32 v15, v55
    s_nop 0
    v_cvt_pk_bf16_f32 v83, v14, v15
    v_exp_f32 v12, v56
    v_exp_f32 v13, v57
    s_nop 0
    v_cvt_pk_bf16_f32 v84, v12, v13
    v_exp_f32 v14, v58
    v_exp_f32 v15, v59
    s_nop 0
    v_cvt_pk_bf16_f32 v85, v14, v15
    v_exp_f32 v12, v60
    v_exp_f32 v13, v61
    s_nop 0
    v_cvt_pk_bf16_f32 v86, v12, v13
    v_exp_f32 v14, v62
    v_exp_f32 v15, v63
    s_nop 0
    v_cvt_pk_bf16_f32 v87, v14, v15
    s_nop 1
    s_branch AA_BACK_158
AA_SLOW_159:
    s_nop 15
    v_max3_f32 v7, v64, v65, v66
    v_max3_f32 v7, v7, v67, v68
    v_max3_f32 v7, v7, v69, v70
    v_max3_f32 v7, v7, v71, v72
    v_max3_f32 v7, v7, v73, v74
    v_max3_f32 v7, v7, v75, v76
    v_max3_f32 v7, v7, v77, v78
    v_max_f32 v7, v7, v79
    v_mov_b32 v8, v7
    s_nop 1
    v_permlane32_swap_b32 v7, v8
    s_nop 1
    v_max_f32 v7, v7, v8
    v_add_f32 v7, 0x42800000, v7
    v_max_f32 v7, 0, v7
    v_sub_f32 v96, v96, v7
    v_sub_f32 v64, v64, v7
    v_sub_f32 v48, v48, v7
    v_sub_f32 v97, v97, v7
    v_sub_f32 v65, v65, v7
    v_sub_f32 v49, v49, v7
    v_sub_f32 v98, v98, v7
    v_sub_f32 v66, v66, v7
    v_sub_f32 v50, v50, v7
    v_sub_f32 v99, v99, v7
    v_sub_f32 v67, v67, v7
    v_sub_f32 v51, v51, v7
    v_sub_f32 v100, v100, v7
    v_sub_f32 v68, v68, v7
    v_sub_f32 v52, v52, v7
    v_sub_f32 v101, v101, v7
    v_sub_f32 v69, v69, v7
    v_sub_f32 v53, v53, v7
    v_sub_f32 v102, v102, v7
    v_sub_f32 v70, v70, v7
    v_sub_f32 v54, v54, v7
    v_sub_f32 v103, v103, v7
    v_sub_f32 v71, v71, v7
    v_sub_f32 v55, v55, v7
    v_sub_f32 v104, v104, v7
    v_sub_f32 v72, v72, v7
    v_sub_f32 v56, v56, v7
    v_sub_f32 v105, v105, v7
    v_sub_f32 v73, v73, v7
    v_sub_f32 v57, v57, v7
    v_sub_f32 v106, v106, v7
    v_sub_f32 v74, v74, v7
    v_sub_f32 v58, v58, v7
    v_sub_f32 v107, v107, v7
    v_sub_f32 v75, v75, v7
    v_sub_f32 v59, v59, v7
    v_sub_f32 v108, v108, v7
    v_sub_f32 v76, v76, v7
    v_sub_f32 v60, v60, v7
    v_sub_f32 v109, v109, v7
    v_sub_f32 v77, v77, v7
    v_sub_f32 v61, v61, v7
    v_sub_f32 v110, v110, v7
    v_sub_f32 v78, v78, v7
    v_sub_f32 v62, v62, v7
    v_sub_f32 v111, v111, v7
    v_sub_f32 v79, v79, v7
    v_sub_f32 v63, v63, v7
    v_exp_f32 v8, -v7
    s_nop 0
    v_mul_f32 v32, v32, v8
    v_mul_f32 v33, v33, v8
    v_mul_f32 v34, v34, v8
    v_mul_f32 v35, v35, v8
    v_mul_f32 v36, v36, v8
    v_mul_f32 v37, v37, v8
    v_mul_f32 v38, v38, v8
    v_mul_f32 v39, v39, v8
    v_mul_f32 v40, v40, v8
    v_mul_f32 v41, v41, v8
    v_mul_f32 v42, v42, v8
    v_mul_f32 v43, v43, v8
    v_mul_f32 v44, v44, v8
    v_mul_f32 v45, v45, v8
    v_mul_f32 v46, v46, v8
    v_mul_f32 v47, v47, v8
    v_exp_f32 v12, v64
    v_exp_f32 v13, v65
    s_nop 0
    v_cvt_pk_bf16_f32 v88, v12, v13
    v_exp_f32 v14, v66
    v_exp_f32 v15, v67
    s_nop 0
    v_cvt_pk_bf16_f32 v89, v14, v15
    v_exp_f32 v12, v68
    v_exp_f32 v13, v69
    s_nop 0
    v_cvt_pk_bf16_f32 v90, v12, v13
    v_exp_f32 v14, v70
    v_exp_f32 v15, v71
    s_nop 0
    v_cvt_pk_bf16_f32 v91, v14, v15
    v_exp_f32 v12, v72
    v_exp_f32 v13, v73
    s_nop 0
    v_cvt_pk_bf16_f32 v92, v12, v13
    v_exp_f32 v14, v74
    v_exp_f32 v15, v75
    s_nop 0
    v_cvt_pk_bf16_f32 v93, v14, v15
    v_exp_f32 v12, v76
    v_exp_f32 v13, v77
    s_nop 0
    v_cvt_pk_bf16_f32 v94, v12, v13
    v_exp_f32 v14, v78
    v_exp_f32 v15, v79
    s_nop 0
    v_cvt_pk_bf16_f32 v95, v14, v15
    s_nop 1
    s_branch AA_BACK_160
AA_SLOW_161:
    s_nop 15
    v_max3_f32 v7, v48, v49, v50
    v_max3_f32 v7, v7, v51, v52
    v_max3_f32 v7, v7, v53, v54
    v_max3_f32 v7, v7, v55, v56
    v_max3_f32 v7, v7, v57, v58
    v_max3_f32 v7, v7, v59, v60
    v_max3_f32 v7, v7, v61, v62
    v_max_f32 v7, v7, v63
    v_mov_b32 v8, v7
    s_nop 1
    v_permlane32_swap_b32 v7, v8
    s_nop 1
    v_max_f32 v7, v7, v8
    v_add_f32 v7, 0x42800000, v7
    v_max_f32 v7, 0, v7
    v_sub_f32 v96, v96, v7
    v_sub_f32 v48, v48, v7
    v_sub_f32 v64, v64, v7
    v_sub_f32 v97, v97, v7
    v_sub_f32 v49, v49, v7
    v_sub_f32 v65, v65, v7
    v_sub_f32 v98, v98, v7
    v_sub_f32 v50, v50, v7
    v_sub_f32 v66, v66, v7
    v_sub_f32 v99, v99, v7
    v_sub_f32 v51, v51, v7
    v_sub_f32 v67, v67, v7
    v_sub_f32 v100, v100, v7
    v_sub_f32 v52, v52, v7
    v_sub_f32 v68, v68, v7
    v_sub_f32 v101, v101, v7
    v_sub_f32 v53, v53, v7
    v_sub_f32 v69, v69, v7
    v_sub_f32 v102, v102, v7
    v_sub_f32 v54, v54, v7
    v_sub_f32 v70, v70, v7
    v_sub_f32 v103, v103, v7
    v_sub_f32 v55, v55, v7
    v_sub_f32 v71, v71, v7
    v_sub_f32 v104, v104, v7
    v_sub_f32 v56, v56, v7
    v_sub_f32 v72, v72, v7
    v_sub_f32 v105, v105, v7
    v_sub_f32 v57, v57, v7
    v_sub_f32 v73, v73, v7
    v_sub_f32 v106, v106, v7
    v_sub_f32 v58, v58, v7
    v_sub_f32 v74, v74, v7
    v_sub_f32 v107, v107, v7
    v_sub_f32 v59, v59, v7
    v_sub_f32 v75, v75, v7
    v_sub_f32 v108, v108, v7
    v_sub_f32 v60, v60, v7
    v_sub_f32 v76, v76, v7
    v_sub_f32 v109, v109, v7
    v_sub_f32 v61, v61, v7
    v_sub_f32 v77, v77, v7
    v_sub_f32 v110, v110, v7
    v_sub_f32 v62, v62, v7
    v_sub_f32 v78, v78, v7
    v_sub_f32 v111, v111, v7
    v_sub_f32 v63, v63, v7
    v_sub_f32 v79, v79, v7
    v_exp_f32 v8, -v7
    s_nop 0
    v_mul_f32 v32, v32, v8
    v_mul_f32 v33, v33, v8
    v_mul_f32 v34, v34, v8
    v_mul_f32 v35, v35, v8
    v_mul_f32 v36, v36, v8
    v_mul_f32 v37, v37, v8
    v_mul_f32 v38, v38, v8
    v_mul_f32 v39, v39, v8
    v_mul_f32 v40, v40, v8
    v_mul_f32 v41, v41, v8
    v_mul_f32 v42, v42, v8
    v_mul_f32 v43, v43, v8
    v_mul_f32 v44, v44, v8
    v_mul_f32 v45, v45, v8
    v_mul_f32 v46, v46, v8
    v_mul_f32 v47, v47, v8
    v_exp_f32 v12, v48
    v_exp_f32 v13, v49
    s_nop 0
    v_cvt_pk_bf16_f32 v80, v12, v13
    v_exp_f32 v14, v50
    v_exp_f32 v15, v51
    s_nop 0
    v_cvt_pk_bf16_f32 v81, v14, v15
    v_exp_f32 v12, v52
    v_exp_f32 v13, v53
    s_nop 0
    v_cvt_pk_bf16_f32 v82, v12, v13
    v_exp_f32 v14, v54
    v_exp_f32 v15, v55
    s_nop 0
    v_cvt_pk_bf16_f32 v83, v14, v15
    v_exp_f32 v12, v56
    v_exp_f32 v13, v57
    s_nop 0
    v_cvt_pk_bf16_f32 v84, v12, v13
    v_exp_f32 v14, v58
    v_exp_f32 v15, v59
    s_nop 0
    v_cvt_pk_bf16_f32 v85, v14, v15
    v_exp_f32 v12, v60
    v_exp_f32 v13, v61
    s_nop 0
    v_cvt_pk_bf16_f32 v86, v12, v13
    v_exp_f32 v14, v62
    v_exp_f32 v15, v63
    s_nop 0
    v_cvt_pk_bf16_f32 v87, v14, v15
    s_nop 1
    s_branch AA_BACK_162
AA_SLOW_163:
    s_nop 15
    v_max3_f32 v7, v64, v65, v66
    v_max3_f32 v7, v7, v67, v68
    v_max3_f32 v7, v7, v69, v70
    v_max3_f32 v7, v7, v71, v72
    v_max3_f32 v7, v7, v73, v74
    v_max3_f32 v7, v7, v75, v76
    v_max3_f32 v7, v7, v77, v78
    v_max_f32 v7, v7, v79
    v_mov_b32 v8, v7
    s_nop 1
    v_permlane32_swap_b32 v7, v8
    s_nop 1
    v_max_f32 v7, v7, v8
    v_add_f32 v7, 0x42800000, v7
    v_max_f32 v7, 0, v7
    v_sub_f32 v96, v96, v7
    v_sub_f32 v64, v64, v7
    v_sub_f32 v48, v48, v7
    v_sub_f32 v97, v97, v7
    v_sub_f32 v65, v65, v7
    v_sub_f32 v49, v49, v7
    v_sub_f32 v98, v98, v7
    v_sub_f32 v66, v66, v7
    v_sub_f32 v50, v50, v7
    v_sub_f32 v99, v99, v7
    v_sub_f32 v67, v67, v7
    v_sub_f32 v51, v51, v7
    v_sub_f32 v100, v100, v7
    v_sub_f32 v68, v68, v7
    v_sub_f32 v52, v52, v7
    v_sub_f32 v101, v101, v7
    v_sub_f32 v69, v69, v7
    v_sub_f32 v53, v53, v7
    v_sub_f32 v102, v102, v7
    v_sub_f32 v70, v70, v7
    v_sub_f32 v54, v54, v7
    v_sub_f32 v103, v103, v7
    v_sub_f32 v71, v71, v7
    v_sub_f32 v55, v55, v7
    v_sub_f32 v104, v104, v7
    v_sub_f32 v72, v72, v7
    v_sub_f32 v56, v56, v7
    v_sub_f32 v105, v105, v7
    v_sub_f32 v73, v73, v7
    v_sub_f32 v57, v57, v7
    v_sub_f32 v106, v106, v7
    v_sub_f32 v74, v74, v7
    v_sub_f32 v58, v58, v7
    v_sub_f32 v107, v107, v7
    v_sub_f32 v75, v75, v7
    v_sub_f32 v59, v59, v7
    v_sub_f32 v108, v108, v7
    v_sub_f32 v76, v76, v7
    v_sub_f32 v60, v60, v7
    v_sub_f32 v109, v109, v7
    v_sub_f32 v77, v77, v7
    v_sub_f32 v61, v61, v7
    v_sub_f32 v110, v110, v7
    v_sub_f32 v78, v78, v7
    v_sub_f32 v62, v62, v7
    v_sub_f32 v111, v111, v7
    v_sub_f32 v79, v79, v7
    v_sub_f32 v63, v63, v7
    v_exp_f32 v8, -v7
    s_nop 0
    v_mul_f32 v32, v32, v8
    v_mul_f32 v33, v33, v8
    v_mul_f32 v34, v34, v8
    v_mul_f32 v35, v35, v8
    v_mul_f32 v36, v36, v8
    v_mul_f32 v37, v37, v8
    v_mul_f32 v38, v38, v8
    v_mul_f32 v39, v39, v8
    v_mul_f32 v40, v40, v8
    v_mul_f32 v41, v41, v8
    v_mul_f32 v42, v42, v8
    v_mul_f32 v43, v43, v8
    v_mul_f32 v44, v44, v8
    v_mul_f32 v45, v45, v8
    v_mul_f32 v46, v46, v8
    v_mul_f32 v47, v47, v8
    v_exp_f32 v12, v64
    v_exp_f32 v13, v65
    s_nop 0
    v_cvt_pk_bf16_f32 v88, v12, v13
    v_exp_f32 v14, v66
    v_exp_f32 v15, v67
    s_nop 0
    v_cvt_pk_bf16_f32 v89, v14, v15
    v_exp_f32 v12, v68
    v_exp_f32 v13, v69
    s_nop 0
    v_cvt_pk_bf16_f32 v90, v12, v13
    v_exp_f32 v14, v70
    v_exp_f32 v15, v71
    s_nop 0
    v_cvt_pk_bf16_f32 v91, v14, v15
    v_exp_f32 v12, v72
    v_exp_f32 v13, v73
    s_nop 0
    v_cvt_pk_bf16_f32 v92, v12, v13
    v_exp_f32 v14, v74
    v_exp_f32 v15, v75
    s_nop 0
    v_cvt_pk_bf16_f32 v93, v14, v15
    v_exp_f32 v12, v76
    v_exp_f32 v13, v77
    s_nop 0
    v_cvt_pk_bf16_f32 v94, v12, v13
    v_exp_f32 v14, v78
    v_exp_f32 v15, v79
    s_nop 0
    v_cvt_pk_bf16_f32 v95, v14, v15
    s_nop 1
    s_branch AA_BACK_164
AA_END_165:
    s_waitcnt vmcnt(0)
    s_barrier
    s_lshl_b32 s10, s2, 3
    s_add_u32 s10, s10, 34816
    s_cmp_lg_u32 s64, 0
    s_cbranch_scc1 SY_166
    s_memrealtime s[12:13]
    v_mov_b32 v122, s10
    s_mov_b32 s8, 62914560
    s_waitcnt lgkmcnt(0)
    v_mov_b32 v120, s12
    v_mov_b32 v121, s13
    s_mov_b64 exec, 1
    buffer_store_dwordx2 v[120:121], v122, s[56:59], s8 offen sc1
    s_mov_b64 exec, -1
SY_166:
    s_branch P4E_151
P4G_150:
    s_barrier
    s_and_b32 s66, s2, 7
    s_lshr_b32 s67, s2, 3
    s_sub_u32 s77, s64, 4
    v_lshlrev_b32 v7, 4, v1
    s_mov_b32 s52, s38
    s_and_b32 s53, s39, 0xffff
    s_mov_b32 s54, 4718592
    s_mov_b32 s55, 0x00020000
    s_mov_b32 s78, 0
    s_barrier
    s_add_u32 s78, s78, 1
    s_mov_b32 s60, s36
    s_and_b32 s61, s37, 0xffff
    s_mov_b32 s62, 4718592
    s_mov_b32 s63, 0x00020000
    s_lshr_b32 s68, s66, 1
    s_mul_i32 s68, s68, 9216
    s_mul_i32 s69, s67, 288
    s_add_u32 s68, s68, s69
    s_mul_i32 s69, s77, 72
    s_add_u32 s68, s68, s69
    v_add_u32 v250, s68, v1
    v_lshlrev_b32 v250, 7, v250
    buffer_load_dword v251, v250, s[60:63], 0 offen
    v_cmp_gt_u32 vcc, 8, v1
    v_add_u32 v250, 8192, v250
    s_nop 0
    v_cndmask_b32 v250, -1, v250, vcc
    buffer_load_dword v252, v250, s[60:63], 0 offen
    s_mov_b32 s60, s24
    s_and_b32 s61, s25, 0xffff
    s_mov_b32 s62, 663552
    s_mov_b32 s63, 0x00020000
    s_mul_i32 s68, s67, 162
    s_mul_i32 s69, s77, 41
    s_add_u32 s68, s68, s69
    v_add_u32 v250, s68, v1
    v_lshlrev_b32 v250, 7, v250
    v_cmp_gt_u32 vcc, 41, v1
    s_nop 1
    v_cndmask_b32 v250, -1, v250, vcc
    buffer_load_dword v253, v250, s[60:63], 0 offen
    s_cmp_ge_u32 s67, 24
    s_cbranch_scc1 P4A_167
    s_mov_b32 s48, s36
    s_and_b32 s49, s37, 0xffff
    s_mov_b32 s50, 4718592
    s_mov_b32 s51, 0x00020000
    s_lshr_b32 s72, s66, 1
    s_mul_i32 s68, s67, 21846
    s_lshr_b32 s68, s68, 16
    s_mul_i32 s69, s68, 3
    s_sub_u32 s71, s67, s69
    s_and_b32 s70, s66, 1
    s_lshl_b32 s70, s70, 3
    s_add_u32 s70, s70, s68
    s_mul_i32 s80, s70, 3
    s_add_u32 s80, s80, s71
    s_mul_i32 s68, s77, 192
    s_movk_i32 s69, 2731
    v_add_u32 v160, s68, v1
    v_mul_lo_u32 v161, v160, s69
    v_lshrrev_b32 v161, 16, v161
    v_mul_u32_u24 v162, 24, v161
    v_sub_u32 v162, v160, v162
    v_bfe_u32 v163, v161, 1, 1
    v_lshlrev_b32 v163, 2, v163
    v_xor_b32 v162, v162, v163
    v_mul_u32_u24 v161, 1152, v161
    v_lshl_add_u32 v3, v162, 4, v161
    v_add_u32 v160, s68, v1
    v_add_u32 v160, 64, v160
    v_mul_lo_u32 v161, v160, s69
    v_lshrrev_b32 v161, 16, v161
    v_mul_u32_u24 v162, 24, v161
    v_sub_u32 v162, v160, v162
    v_bfe_u32 v163, v161, 1, 1
    v_lshlrev_b32 v163, 2, v163
    v_xor_b32 v162, v162, v163
    v_mul_u32_u24 v161, 1152, v161
    v_lshl_add_u32 v4, v162, 4, v161
    v_add_u32 v160, s68, v1
    v_add_u32 v160, 128, v160
    v_mul_lo_u32 v161, v160, s69
    v_lshrrev_b32 v161, 16, v161
    v_mul_u32_u24 v162, 24, v161
    v_sub_u32 v162, v160, v162
    v_bfe_u32 v163, v161, 1, 1
    v_lshlrev_b32 v163, 2, v163
    v_xor_b32 v162, v162, v163
    v_mul_u32_u24 v161, 1152, v161
    v_lshl_add_u32 v5, v162, 4, v161
    s_mul_i32 s68, s71, 384
    v_add_u32 v3, s68, v3
    v_add_u32 v4, s68, v4
    v_add_u32 v5, s68, v5
    s_mul_i32 s76, s77, 3072
    s_add_u32 s76, s76, 8192
    s_lshl_b32 s75, s77, 11
    v_bfe_u32 v160, v1, 2, 2
    v_lshrrev_b32 v161, 5, v1
    v_lshl_add_u32 v161, v161, 2, v160
    v_mul_u32_u24 v161, 384, v161
    v_add_u32 v161, 8192, v161
    v_and_b32 v162, 1, v1
    v_lshl_add_u32 v161, v162, 3, v161
    v_bfe_u32 v162, v1, 4, 1
    v_bfe_u32 v163, v1, 1, 1
    v_lshl_add_u32 v162, v162, 1, v163
    v_bfe_u32 v163, v1, 3, 1
    v_lshlrev_b32 v163, 2, v163
    s_lshr_b32 s68, s77, 1
    s_mul_i32 s68, s68, 12
    s_add_u32 s69, s68, 0
    v_add_u32 v164, s69, v162
    v_xor_b32 v164, v164, v163
    v_lshl_add_u32 v12, v164, 4, v161
    s_add_u32 s69, s68, 4
    v_add_u32 v164, s69, v162
    v_xor_b32 v164, v164, v163
    v_lshl_add_u32 v13, v164, 4, v161
    s_add_u32 s69, s68, 8
    v_add_u32 v164, s69, v162
    v_xor_b32 v164, v164, v163
    v_lshl_add_u32 v14, v164, 4, v161
    s_mul_i32 s74, s72, 1179648
    s_lshl_b32 s68, s70, 2
    s_add_u32 s68, s68, s77
    s_lshl_b32 s68, s68, 8
    s_lshl_b32 s69, s72, 6
    s_add_u32 s68, s68, s69
    s_lshl_b32 s68, s68, 10
    s_add_u32 s73, s68, 33554432
    s_and_b32 s68, s77, 1
    s_lshl_b32 s68, s68, 12
    v_add_u32 v8, s68, v7
    v_add_u32 v9, 1024, v8
    v_add_u32 v10, 40960, v8
    v_add_u32 v11, 40960, v9
    v_mov_b32 v64, 0
    v_mov_b32 v65, 0
    v_mov_b32 v66, 0
    v_mov_b32 v67, 0
    v_mov_b32 v68, 0
    v_mov_b32 v69, 0
    v_mov_b32 v70, 0
    v_mov_b32 v71, 0
    v_mov_b32 v72, 0
    v_mov_b32 v73, 0
    v_mov_b32 v74, 0
    v_mov_b32 v75, 0
    v_mov_b32 v76, 0
    v_mov_b32 v77, 0
    v_mov_b32 v78, 0
    v_mov_b32 v79, 0
    v_mov_b32 v80, 0
    v_mov_b32 v81, 0
    v_mov_b32 v82, 0
    v_mov_b32 v83, 0
    v_mov_b32 v84, 0
    v_mov_b32 v85, 0
    v_mov_b32 v86, 0
    v_mov_b32 v87, 0
    v_mov_b32 v88, 0
    v_mov_b32 v89, 0
    v_mov_b32 v90, 0
    v_mov_b32 v91, 0
    v_mov_b32 v92, 0
    v_mov_b32 v93, 0
    v_mov_b32 v94, 0
    v_mov_b32 v95, 0
    v_mov_b32 v96, 0
    v_mov_b32 v97, 0
    v_mov_b32 v98, 0
    v_mov_b32 v99, 0
    v_mov_b32 v100, 0
    v_mov_b32 v101, 0
    v_mov_b32 v102, 0
    v_mov_b32 v103, 0
    v_mov_b32 v104, 0
    v_mov_b32 v105, 0
    v_mov_b32 v106, 0
    v_mov_b32 v107, 0
    v_mov_b32 v108, 0
    v_mov_b32 v109, 0
    v_mov_b32 v110, 0
    v_mov_b32 v111, 0
    v_mov_b32 v112, 0
    v_mov_b32 v113, 0
    v_mov_b32 v114, 0
    v_mov_b32 v115, 0
    v_mov_b32 v116, 0
    v_mov_b32 v117, 0
    v_mov_b32 v118, 0
    v_mov_b32 v119, 0
    v_mov_b32 v120, 0
    v_mov_b32 v121, 0
    v_mov_b32 v122, 0
    v_mov_b32 v123, 0
    v_mov_b32 v124, 0
    v_mov_b32 v125, 0
    v_mov_b32 v126, 0
    v_mov_b32 v127, 0
    v_mov_b32 v128, 0
    v_mov_b32 v129, 0
    v_mov_b32 v130, 0
    v_mov_b32 v131, 0
    v_mov_b32 v132, 0
    v_mov_b32 v133, 0
    v_mov_b32 v134, 0
    v_mov_b32 v135, 0
    v_mov_b32 v136, 0
    v_mov_b32 v137, 0
    v_mov_b32 v138, 0
    v_mov_b32 v139, 0
    v_mov_b32 v140, 0
    v_mov_b32 v141, 0
    v_mov_b32 v142, 0
    v_mov_b32 v143, 0
    v_mov_b32 v144, 0
    v_mov_b32 v145, 0
    v_mov_b32 v146, 0
    v_mov_b32 v147, 0
    v_mov_b32 v148, 0
    v_mov_b32 v149, 0
    v_mov_b32 v150, 0
    v_mov_b32 v151, 0
    v_mov_b32 v152, 0
    v_mov_b32 v153, 0
    v_mov_b32 v154, 0
    v_mov_b32 v155, 0
    v_mov_b32 v156, 0
    v_mov_b32 v157, 0
    v_mov_b32 v158, 0
    v_mov_b32 v159, 0
    s_barrier
    s_add_u32 s78, s78, 1
    s_waitcnt vmcnt(3)
    s_lshr_b32 s10, s2, 5
    s_lshl_b32 s10, s10, 2
    s_add_u32 s10, s10, s77
    s_sub_u32 s10, 63, s10
    s_lshl_b32 s10, s10, 5
    s_and_b32 s9, s2, 31
    s_add_u32 s10, s10, s9
    s_lshl_b32 s10, s10, 3
    s_add_u32 s10, s10, 12288
    s_memrealtime s[12:13]
    v_mov_b32 v54, s10
    s_mov_b32 s8, 62914560
    s_waitcnt lgkmcnt(0)
    v_mov_b32 v52, s12
    v_mov_b32 v53, s13
    s_mov_b64 exec, 1
    buffer_store_dwordx2 v[52:53], v54, s[56:59], s8 offen sc1
    s_mov_b64 exec, -1
SY_169:
    v_lshrrev_b32 v58, 3, v1
    s_lshl_b32 s9, s70, 2
    v_add_u32 v58, s9, v58
    v_lshlrev_b32 v58, 5, v58
    v_and_b32 v59, 7, v1
    v_add_u32 v58, v58, v59
    s_lshl_b32 s9, s72, 3
    v_add_u32 v58, s9, v58
    v_lshlrev_b32 v58, 3, v58
    v_add_u32 v58, 12288, v58
    s_cmp_lg_u32 s64, 4
    s_cbranch_scc1 SY_170
    v_mov_b32 v56, 0
    v_mov_b32 v57, 98304
    ds_write_b32 v57, v56
    s_waitcnt lgkmcnt(0)
SY_170:
    s_mov_b32 s11, 0
PL_171:
    s_cmp_lg_u32 s64, 4
    s_cbranch_scc1 SY_172
    s_mov_b32 s8, 62914560
    buffer_load_dwordx2 v[56:57], v58, s[56:59], s8 offen sc1
SY_172:
    s_barrier
    s_add_u32 s78, s78, 1
    s_barrier
    s_add_u32 s78, s78, 1
    s_cmp_lg_u32 s64, 4
    s_cbranch_scc1 SY_173
    s_memrealtime s[12:13]
    s_waitcnt vmcnt(0) lgkmcnt(0)
    s_add_u32 s12, s12, 200
    s_addc_u32 s13, s13, 0
    s_add_u32 s11, s11, 1
    s_cmp_ge_u32 s11, 0x80000
    s_cbranch_scc1 FE_175
    s_mov_b64 exec, 0xffffffff
    v_cmp_gt_u64 vcc, s[14:15], v[56:57]
    s_cbranch_vccnz FE_174
    v_cmp_lt_u64 vcc, s[12:13], v[56:57]
    s_cbranch_vccnz FE_174
FE_175:
    s_mov_b64 exec, -1
    v_mov_b32 v56, 1
    v_mov_b32 v57, 98304
    ds_write_b32 v57, v56
    s_waitcnt vmcnt(0) lgkmcnt(0)
    s_branch SY_173
FE_174:
    s_mov_b64 exec, -1
    s_and_b32 s12, s11, 31
    s_cmp_lg_u32 s12, 31
    s_cbranch_scc1 EP_176
    v_mov_b32 v56, 248
    buffer_load_dwordx2 v[56:57], v56, s[4:7], 0 offen sc1
    s_waitcnt vmcnt(0)
    v_readfirstlane_b32 s12, v56
    v_readfirstlane_b32 s13, v57
    s_nop 3
    s_not_b64 s[14:15], s[12:13]
EP_176:
SY_173:
    s_barrier
    s_add_u32 s78, s78, 1
    v_mov_b32 v56, 98304
    ds_read_b32 v57, v56
    s_waitcnt lgkmcnt(0)
    v_readfirstlane_b32 s10, v57
    s_nop 3
    s_cmp_eq_u32 s10, 0
    s_cbranch_scc1 PL_171
    s_cmp_lg_u32 s64, 5
    s_cbranch_scc1 CW_177
    s_getpc_b64 s[12:13]
CWH_178:
    s_add_u32 s12, s12, L_PUB-CWH_178
    s_addc_u32 s13, s13, 0
    v_lshlrev_b32 v250, 7, v1
    s_mov_b64 exec, 0xffffff
    global_load_dword v251, v250, s[12:13]
    s_mov_b64 exec, -1
CW_177:
    s_add_u32 m0, s75, 0
    s_nop 0
    buffer_load_dwordx4 v7, s[56:59], s73 offen lds
    buffer_load_dwordx4 v7, s[56:59], s73 offen offset:1024 lds
    s_add_u32 s73, s73, 2048
    s_add_u32 m0, s76, 0
    s_nop 0
    buffer_load_dwordx4 v3, s[48:51], s74 offen lds
    s_add_u32 m0, s76, 1024
    s_nop 0
    buffer_load_dwordx4 v4, s[48:51], s74 offen lds
    s_add_u32 m0, s76, 2048
    s_nop 0
    buffer_load_dwordx4 v5, s[48:51], s74 offen lds
    s_add_u32 s74, s74, 36864
    s_add_u32 m0, s75, 20480
    s_nop 0
    buffer_load_dwordx4 v7, s[56:59], s73 offen lds
    buffer_load_dwordx4 v7, s[56:59], s73 offen offset:1024 lds
    s_add_u32 s73, s73, 2048
    s_add_u32 m0, s76, 20480
    s_nop 0
    buffer_load_dwordx4 v3, s[48:51], s74 offen lds
    s_add_u32 m0, s76, 21504
    s_nop 0
    buffer_load_dwordx4 v4, s[48:51], s74 offen lds
    s_add_u32 m0, s76, 22528
    s_nop 0
    buffer_load_dwordx4 v5, s[48:51], s74 offen lds
    s_add_u32 s74, s74, 36864
    s_add_u32 m0, s75, 40960
    s_nop 0
    buffer_load_dwordx4 v7, s[56:59], s73 offen lds
    buffer_load_dwordx4 v7, s[56:59], s73 offen offset:1024 lds
    s_add_u32 s73, s73, 2048
    s_add_u32 m0, s76, 40960
    s_nop 0
    buffer_load_dwordx4 v3, s[48:51], s74 offen lds
    s_add_u32 m0, s76, 41984
    s_nop 0
    buffer_load_dwordx4 v4, s[48:51], s74 offen lds
    s_add_u32 m0, s76, 43008
    s_nop 0
    buffer_load_dwordx4 v5, s[48:51], s74 offen lds
    s_add_u32 s74, s74, 36864
    s_add_u32 m0, s75, 61440
    s_nop 0
    buffer_load_dwordx4 v7, s[56:59], s73 offen lds
    buffer_load_dwordx4 v7, s[56:59], s73 offen offset:1024 lds
    s_add_u32 s73, s73, 2048
    s_add_u32 m0, s76, 61440
    s_nop 0
    buffer_load_dwordx4 v3, s[48:51], s74 offen lds
    s_add_u32 m0, s76, 62464
    s_nop 0
    buffer_load_dwordx4 v4, s[48:51], s74 offen lds
    s_add_u32 m0, s76, 63488
    s_nop 0
    buffer_load_dwordx4 v5, s[48:51], s74 offen lds
    s_add_u32 s74, s74, 36864
    s_waitcnt vmcnt(15)
    s_barrier
    s_add_u32 s78, s78, 1
    ds_read_b128 v[16:19], v8 offset:0
    ds_read_b128 v[20:23], v8 offset:2048
    ds_read_b64_tr_b16 v[24:25], v12 offset:0
    ds_read_b64_tr_b16 v[26:27], v12 offset:6144
    ds_read_b64_tr_b16 v[28:29], v13 offset:0
    ds_read_b64_tr_b16 v[30:31], v13 offset:6144
    ds_read_b64_tr_b16 v[32:33], v14 offset:0
    ds_read_b64_tr_b16 v[34:35], v14 offset:6144
    s_mov_b32 s79, 0
OB_LOOP_179:
    s_waitcnt lgkmcnt(0)
    v_mfma_f32_32x32x16_bf16 v[64:79], v[24:27], v[16:19], v[64:79]
    ds_read_b128 v[36:39], v9 offset:0
    ds_read_b128 v[40:43], v9 offset:2048
    ds_read_b64_tr_b16 v[44:45], v12 offset:3072
    v_mfma_f32_32x32x16_bf16 v[80:95], v[28:31], v[16:19], v[80:95]
    ds_read_b64_tr_b16 v[46:47], v12 offset:9216
    ds_read_b64_tr_b16 v[48:49], v13 offset:3072
    ds_read_b64_tr_b16 v[50:51], v13 offset:9216
    v_mfma_f32_32x32x16_bf16 v[96:111], v[32:35], v[16:19], v[96:111]
    ds_read_b64_tr_b16 v[52:53], v14 offset:3072
    ds_read_b64_tr_b16 v[54:55], v14 offset:9216
    v_mfma_f32_32x32x16_bf16 v[112:127], v[24:27], v[20:23], v[112:127]
    v_mfma_f32_32x32x16_bf16 v[128:143], v[28:31], v[20:23], v[128:143]
    v_mfma_f32_32x32x16_bf16 v[144:159], v[32:35], v[20:23], v[144:159]
    s_waitcnt vmcnt(10) lgkmcnt(0)
    s_barrier
    s_add_u32 s78, s78, 1
    v_mfma_f32_32x32x16_bf16 v[64:79], v[44:47], v[36:39], v[64:79]
    ds_read_b128 v[16:19], v8 offset:20480
    ds_read_b128 v[20:23], v8 offset:22528
    ds_read_b64_tr_b16 v[24:25], v12 offset:20480
    v_mfma_f32_32x32x16_bf16 v[80:95], v[48:51], v[36:39], v[80:95]
    ds_read_b64_tr_b16 v[26:27], v12 offset:26624
    ds_read_b64_tr_b16 v[28:29], v13 offset:20480
    ds_read_b64_tr_b16 v[30:31], v13 offset:26624
    s_add_u32 m0, s75, 0
    s_nop 0
    buffer_load_dwordx4 v7, s[56:59], s73 offen lds
    v_mfma_f32_32x32x16_bf16 v[96:111], v[52:55], v[36:39], v[96:111]
    ds_read_b64_tr_b16 v[32:33], v14 offset:20480
    ds_read_b64_tr_b16 v[34:35], v14 offset:26624
    buffer_load_dwordx4 v7, s[56:59], s73 offen offset:1024 lds
    s_add_u32 s73, s73, 2048
    v_mfma_f32_32x32x16_bf16 v[112:127], v[44:47], v[40:43], v[112:127]
    s_add_u32 m0, s76, 0
    s_nop 0
    buffer_load_dwordx4 v3, s[48:51], s74 offen lds
    v_mfma_f32_32x32x16_bf16 v[128:143], v[48:51], v[40:43], v[128:143]
    s_add_u32 m0, s76, 1024
    s_nop 0
    buffer_load_dwordx4 v4, s[48:51], s74 offen lds
    v_mfma_f32_32x32x16_bf16 v[144:159], v[52:55], v[40:43], v[144:159]
    s_add_u32 m0, s76, 2048
    s_nop 0
    buffer_load_dwordx4 v5, s[48:51], s74 offen lds
    s_add_u32 s74, s74, 36864
    s_waitcnt lgkmcnt(0)
    v_mfma_f32_32x32x16_bf16 v[64:79], v[24:27], v[16:19], v[64:79]
    ds_read_b128 v[36:39], v9 offset:20480
    ds_read_b128 v[40:43], v9 offset:22528
    ds_read_b64_tr_b16 v[44:45], v12 offset:23552
    v_mfma_f32_32x32x16_bf16 v[80:95], v[28:31], v[16:19], v[80:95]
    ds_read_b64_tr_b16 v[46:47], v12 offset:29696
    ds_read_b64_tr_b16 v[48:49], v13 offset:23552
    ds_read_b64_tr_b16 v[50:51], v13 offset:29696
    v_mfma_f32_32x32x16_bf16 v[96:111], v[32:35], v[16:19], v[96:111]
    ds_read_b64_tr_b16 v[52:53], v14 offset:23552
    ds_read_b64_tr_b16 v[54:55], v14 offset:29696
    v_mfma_f32_32x32x16_bf16 v[112:127], v[24:27], v[20:23], v[112:127]
    v_mfma_f32_32x32x16_bf16 v[128:143], v[28:31], v[20:23], v[128:143]
    v_mfma_f32_32x32x16_bf16 v[144:159], v[32:35], v[20:23], v[144:159]
    s_waitcnt vmcnt(10) lgkmcnt(0)
    s_barrier
    s_add_u32 s78, s78, 1
    v_mfma_f32_32x32x16_bf16 v[64:79], v[44:47], v[36:39], v[64:79]
    v_add_u32 v12, 0xa000, v12
    v_add_u32 v13, 0xa000, v13
    v_add_u32 v14, 0xa000, v14
    v_mfma_f32_32x32x16_bf16 v[80:95], v[48:51], v[36:39], v[80:95]
    ds_read_b128 v[16:19], v10 offset:0
    ds_read_b128 v[20:23], v10 offset:2048
    ds_read_b64_tr_b16 v[24:25], v12 offset:0
    s_add_u32 m0, s75, 20480
    s_nop 0
    buffer_load_dwordx4 v7, s[56:59], s73 offen lds
    v_mfma_f32_32x32x16_bf16 v[96:111], v[52:55], v[36:39], v[96:111]
    ds_read_b64_tr_b16 v[26:27], v12 offset:6144
    ds_read_b64_tr_b16 v[28:29], v13 offset:0
    ds_read_b64_tr_b16 v[30:31], v13 offset:6144
    buffer_load_dwordx4 v7, s[56:59], s73 offen offset:1024 lds
    s_add_u32 s73, s73, 2048
    v_mfma_f32_32x32x16_bf16 v[112:127], v[44:47], v[40:43], v[112:127]
    ds_read_b64_tr_b16 v[32:33], v14 offset:0
    ds_read_b64_tr_b16 v[34:35], v14 offset:6144
    s_add_u32 m0, s76, 20480
    s_nop 0
    buffer_load_dwordx4 v3, s[48:51], s74 offen lds
    v_mfma_f32_32x32x16_bf16 v[128:143], v[48:51], v[40:43], v[128:143]
    s_add_u32 m0, s76, 21504
    s_nop 0
    buffer_load_dwordx4 v4, s[48:51], s74 offen lds
    v_mfma_f32_32x32x16_bf16 v[144:159], v[52:55], v[40:43], v[144:159]
    s_add_u32 m0, s76, 22528
    s_nop 0
    buffer_load_dwordx4 v5, s[48:51], s74 offen lds
    s_add_u32 s74, s74, 36864
    s_waitcnt lgkmcnt(0)
    v_mfma_f32_32x32x16_bf16 v[64:79], v[24:27], v[16:19], v[64:79]
    ds_read_b128 v[36:39], v11 offset:0
    ds_read_b128 v[40:43], v11 offset:2048
    ds_read_b64_tr_b16 v[44:45], v12 offset:3072
    v_mfma_f32_32x32x16_bf16 v[80:95], v[28:31], v[16:19], v[80:95]
    ds_read_b64_tr_b16 v[46:47], v12 offset:9216
    ds_read_b64_tr_b16 v[48:49], v13 offset:3072
    ds_read_b64_tr_b16 v[50:51], v13 offset:9216
    v_mfma_f32_32x32x16_bf16 v[96:111], v[32:35], v[16:19], v[96:111]
    ds_read_b64_tr_b16 v[52:53], v14 offset:3072
    ds_read_b64_tr_b16 v[54:55], v14 offset:9216
    v_mfma_f32_32x32x16_bf16 v[112:127], v[24:27], v[20:23], v[112:127]
    v_mfma_f32_32x32x16_bf16 v[128:143], v[28:31], v[20:23], v[128:143]
    v_mfma_f32_32x32x16_bf16 v[144:159], v[32:35], v[20:23], v[144:159]
    s_waitcnt vmcnt(10) lgkmcnt(0)
    s_barrier
    s_add_u32 s78, s78, 1
    v_mfma_f32_32x32x16_bf16 v[64:79], v[44:47], v[36:39], v[64:79]
    ds_read_b128 v[16:19], v10 offset:20480
    ds_read_b128 v[20:23], v10 offset:22528
    ds_read_b64_tr_b16 v[24:25], v12 offset:20480
    v_mfma_f32_32x32x16_bf16 v[80:95], v[48:51], v[36:39], v[80:95]
    ds_read_b64_tr_b16 v[26:27], v12 offset:26624
    ds_read_b64_tr_b16 v[28:29], v13 offset:20480
    ds_read_b64_tr_b16 v[30:31], v13 offset:26624
    s_add_u32 m0, s75, 40960
    s_nop 0
    buffer_load_dwordx4 v7, s[56:59], s73 offen lds
    v_mfma_f32_32x32x16_bf16 v[96:111], v[52:55], v[36:39], v[96:111]
    ds_read_b64_tr_b16 v[32:33], v14 offset:20480
    ds_read_b64_tr_b16 v[34:35], v14 offset:26624
    buffer_load_dwordx4 v7, s[56:59], s73 offen offset:1024 lds
    s_add_u32 s73, s73, 2048
    v_mfma_f32_32x32x16_bf16 v[112:127], v[44:47], v[40:43], v[112:127]
    s_add_u32 m0, s76, 40960
    s_nop 0
    buffer_load_dwordx4 v3, s[48:51], s74 offen lds
    v_mfma_f32_32x32x16_bf16 v[128:143], v[48:51], v[40:43], v[128:143]
    s_add_u32 m0, s76, 41984
    s_nop 0
    buffer_load_dwordx4 v4, s[48:51], s74 offen lds
    v_mfma_f32_32x32x16_bf16 v[144:159], v[52:55], v[40:43], v[144:159]
    s_add_u32 m0, s76, 43008
    s_nop 0
    buffer_load_dwordx4 v5, s[48:51], s74 offen lds
    s_add_u32 s74, s74, 36864
    s_waitcnt lgkmcnt(0)
    v_mfma_f32_32x32x16_bf16 v[64:79], v[24:27], v[16:19], v[64:79]
    ds_read_b128 v[36:39], v11 offset:20480
    ds_read_b128 v[40:43], v11 offset:22528
    ds_read_b64_tr_b16 v[44:45], v12 offset:23552
    v_mfma_f32_32x32x16_bf16 v[80:95], v[28:31], v[16:19], v[80:95]
    ds_read_b64_tr_b16 v[46:47], v12 offset:29696
    ds_read_b64_tr_b16 v[48:49], v13 offset:23552
    ds_read_b64_tr_b16 v[50:51], v13 offset:29696
    v_mfma_f32_32x32x16_bf16 v[96:111], v[32:35], v[16:19], v[96:111]
    ds_read_b64_tr_b16 v[52:53], v14 offset:23552
    ds_read_b64_tr_b16 v[54:55], v14 offset:29696
    v_mfma_f32_32x32x16_bf16 v[112:127], v[24:27], v[20:23], v[112:127]
    v_mfma_f32_32x32x16_bf16 v[128:143], v[28:31], v[20:23], v[128:143]
    v_mfma_f32_32x32x16_bf16 v[144:159], v[32:35], v[20:23], v[144:159]
    s_waitcnt vmcnt(10) lgkmcnt(0)
    s_barrier
    s_add_u32 s78, s78, 1
    v_mfma_f32_32x32x16_bf16 v[64:79], v[44:47], v[36:39], v[64:79]
    v_add_u32 v12, 0xffff6000, v12
    v_add_u32 v13, 0xffff6000, v13
    v_add_u32 v14, 0xffff6000, v14
    v_mfma_f32_32x32x16_bf16 v[80:95], v[48:51], v[36:39], v[80:95]
    ds_read_b128 v[16:19], v8 offset:0
    ds_read_b128 v[20:23], v8 offset:2048
    ds_read_b64_tr_b16 v[24:25], v12 offset:0
    s_add_u32 m0, s75, 61440
    s_nop 0
    buffer_load_dwordx4 v7, s[56:59], s73 offen lds
    v_mfma_f32_32x32x16_bf16 v[96:111], v[52:55], v[36:39], v[96:111]
    ds_read_b64_tr_b16 v[26:27], v12 offset:6144
    ds_read_b64_tr_b16 v[28:29], v13 offset:0
    ds_read_b64_tr_b16 v[30:31], v13 offset:6144
    buffer_load_dwordx4 v7, s[56:59], s73 offen offset:1024 lds
    s_add_u32 s73, s73, 2048
    v_mfma_f32_32x32x16_bf16 v[112:127], v[44:47], v[40:43], v[112:127]
    ds_read_b64_tr_b16 v[32:33], v14 offset:0
    ds_read_b64_tr_b16 v[34:35], v14 offset:6144
    s_add_u32 m0, s76, 61440
    s_nop 0
    buffer_load_dwordx4 v3, s[48:51], s74 offen lds
    v_mfma_f32_32x32x16_bf16 v[128:143], v[48:51], v[40:43], v[128:143]
    s_add_u32 m0, s76, 62464
    s_nop 0
    buffer_load_dwordx4 v4, s[48:51], s74 offen lds
    v_mfma_f32_32x32x16_bf16 v[144:159], v[52:55], v[40:43], v[144:159]
    s_add_u32 m0, s76, 63488
    s_nop 0
    buffer_load_dwordx4 v5, s[48:51], s74 offen lds
    s_add_u32 s74, s74, 36864
    s_add_u32 s79, s79, 1
    s_cmp_lt_u32 s79, 7
    s_cbranch_scc1 OB_LOOP_179
    s_waitcnt lgkmcnt(0)
    v_mfma_f32_32x32x16_bf16 v[64:79], v[24:27], v[16:19], v[64:79]
    ds_read_b128 v[36:39], v9 offset:0
    ds_read_b128 v[40:43], v9 offset:2048
    ds_read_b64_tr_b16 v[44:45], v12 offset:3072
    v_mfma_f32_32x32x16_bf16 v[80:95], v[28:31], v[16:19], v[80:95]
    ds_read_b64_tr_b16 v[46:47], v12 offset:9216
    ds_read_b64_tr_b16 v[48:49], v13 offset:3072
    ds_read_b64_tr_b16 v[50:51], v13 offset:9216
    v_mfma_f32_32x32x16_bf16 v[96:111], v[32:35], v[16:19], v[96:111]
    ds_read_b64_tr_b16 v[52:53], v14 offset:3072
    ds_read_b64_tr_b16 v[54:55], v14 offset:9216
    v_mfma_f32_32x32x16_bf16 v[112:127], v[24:27], v[20:23], v[112:127]
    v_mfma_f32_32x32x16_bf16 v[128:143], v[28:31], v[20:23], v[128:143]
    v_mfma_f32_32x32x16_bf16 v[144:159], v[32:35], v[20:23], v[144:159]
    s_waitcnt vmcnt(10) lgkmcnt(0)
    s_barrier
    s_add_u32 s78, s78, 1
    v_mfma_f32_32x32x16_bf16 v[64:79], v[44:47], v[36:39], v[64:79]
    ds_read_b128 v[16:19], v8 offset:20480
    ds_read_b128 v[20:23], v8 offset:22528
    ds_read_b64_tr_b16 v[24:25], v12 offset:20480
    v_mfma_f32_32x32x16_bf16 v[80:95], v[48:51], v[36:39], v[80:95]
    ds_read_b64_tr_b16 v[26:27], v12 offset:26624
    ds_read_b64_tr_b16 v[28:29], v13 offset:20480
    ds_read_b64_tr_b16 v[30:31], v13 offset:26624
    v_mfma_f32_32x32x16_bf16 v[96:111], v[52:55], v[36:39], v[96:111]
    ds_read_b64_tr_b16 v[32:33], v14 offset:20480
    ds_read_b64_tr_b16 v[34:35], v14 offset:26624
    v_mfma_f32_32x32x16_bf16 v[112:127], v[44:47], v[40:43], v[112:127]
    v_mfma_f32_32x32x16_bf16 v[128:143], v[48:51], v[40:43], v[128:143]
    v_mfma_f32_32x32x16_bf16 v[144:159], v[52:55], v[40:43], v[144:159]
    s_waitcnt lgkmcnt(0)
    v_mfma_f32_32x32x16_bf16 v[64:79], v[24:27], v[16:19], v[64:79]
    ds_read_b128 v[36:39], v9 offset:20480
    ds_read_b128 v[40:43], v9 offset:22528
    ds_read_b64_tr_b16 v[44:45], v12 offset:23552
    v_mfma_f32_32x32x16_bf16 v[80:95], v[28:31], v[16:19], v[80:95]
    ds_read_b64_tr_b16 v[46:47], v12 offset:29696
    ds_read_b64_tr_b16 v[48:49], v13 offset:23552
    ds_read_b64_tr_b16 v[50:51], v13 offset:29696
    v_mfma_f32_32x32x16_bf16 v[96:111], v[32:35], v[16:19], v[96:111]
    ds_read_b64_tr_b16 v[52:53], v14 offset:23552
    ds_read_b64_tr_b16 v[54:55], v14 offset:29696
    v_mfma_f32_32x32x16_bf16 v[112:127], v[24:27], v[20:23], v[112:127]
    v_mfma_f32_32x32x16_bf16 v[128:143], v[28:31], v[20:23], v[128:143]
    v_mfma_f32_32x32x16_bf16 v[144:159], v[32:35], v[20:23], v[144:159]
    s_waitcnt vmcnt(5) lgkmcnt(0)
    s_barrier
    s_add_u32 s78, s78, 1
    v_mfma_f32_32x32x16_bf16 v[64:79], v[44:47], v[36:39], v[64:79]
    v_add_u32 v12, 0xa000, v12
    v_add_u32 v13, 0xa000, v13
    v_add_u32 v14, 0xa000, v14
    v_mfma_f32_32x32x16_bf16 v[80:95], v[48:51], v[36:39], v[80:95]
    ds_read_b128 v[16:19], v10 offset:0
    ds_read_b128 v[20:23], v10 offset:2048
    ds_read_b64_tr_b16 v[24:25], v12 offset:0
    v_mfma_f32_32x32x16_bf16 v[96:111], v[52:55], v[36:39], v[96:111]
    ds_read_b64_tr_b16 v[26:27], v12 offset:6144
    ds_read_b64_tr_b16 v[28:29], v13 offset:0
    ds_read_b64_tr_b16 v[30:31], v13 offset:6144
    v_mfma_f32_32x32x16_bf16 v[112:127], v[44:47], v[40:43], v[112:127]
    ds_read_b64_tr_b16 v[32:33], v14 offset:0
    ds_read_b64_tr_b16 v[34:35], v14 offset:6144
    v_mfma_f32_32x32x16_bf16 v[128:143], v[48:51], v[40:43], v[128:143]
    v_mfma_f32_32x32x16_bf16 v[144:159], v[52:55], v[40:43], v[144:159]
    s_waitcnt lgkmcnt(0)
    v_mfma_f32_32x32x16_bf16 v[64:79], v[24:27], v[16:19], v[64:79]
    ds_read_b128 v[36:39], v11 offset:0
    ds_read_b128 v[40:43], v11 offset:2048
    ds_read_b64_tr_b16 v[44:45], v12 offset:3072
    v_mfma_f32_32x32x16_bf16 v[80:95], v[28:31], v[16:19], v[80:95]
    ds_read_b64_tr_b16 v[46:47], v12 offset:9216
    ds_read_b64_tr_b16 v[48:49], v13 offset:3072
    ds_read_b64_tr_b16 v[50:51], v13 offset:9216
    v_mfma_f32_32x32x16_bf16 v[96:111], v[32:35], v[16:19], v[96:111]
    ds_read_b64_tr_b16 v[52:53], v14 offset:3072
    ds_read_b64_tr_b16 v[54:55], v14 offset:9216
    v_mfma_f32_32x32x16_bf16 v[112:127], v[24:27], v[20:23], v[112:127]
    v_mfma_f32_32x32x16_bf16 v[128:143], v[28:31], v[20:23], v[128:143]
    v_mfma_f32_32x32x16_bf16 v[144:159], v[32:35], v[20:23], v[144:159]
    s_waitcnt vmcnt(0) lgkmcnt(0)
    s_barrier
    s_add_u32 s78, s78, 1
    v_mfma_f32_32x32x16_bf16 v[64:79], v[44:47], v[36:39], v[64:79]
    ds_read_b128 v[16:19], v10 offset:20480
    ds_read_b128 v[20:23], v10 offset:22528
    ds_read_b64_tr_b16 v[24:25], v12 offset:20480
    v_mfma_f32_32x32x16_bf16 v[80:95], v[48:51], v[36:39], v[80:95]
    ds_read_b64_tr_b16 v[26:27], v12 offset:26624
    ds_read_b64_tr_b16 v[28:29], v13 offset:20480
    ds_read_b64_tr_b16 v[30:31], v13 offset:26624
    v_mfma_f32_32x32x16_bf16 v[96:111], v[52:55], v[36:39], v[96:111]
    ds_read_b64_tr_b16 v[32:33], v14 offset:20480
    ds_read_b64_tr_b16 v[34:35], v14 offset:26624
    v_mfma_f32_32x32x16_bf16 v[112:127], v[44:47], v[40:43], v[112:127]
    v_mfma_f32_32x32x16_bf16 v[128:143], v[48:51], v[40:43], v[128:143]
    v_mfma_f32_32x32x16_bf16 v[144:159], v[52:55], v[40:43], v[144:159]
    s_waitcnt lgkmcnt(0)
    v_mfma_f32_32x32x16_bf16 v[64:79], v[24:27], v[16:19], v[64:79]
    ds_read_b128 v[36:39], v11 offset:20480
    ds_read_b128 v[40:43], v11 offset:22528
    ds_read_b64_tr_b16 v[44:45], v12 offset:23552
    v_mfma_f32_32x32x16_bf16 v[80:95], v[28:31], v[16:19], v[80:95]
    ds_read_b64_tr_b16 v[46:47], v12 offset:29696
    ds_read_b64_tr_b16 v[48:49], v13 offset:23552
    ds_read_b64_tr_b16 v[50:51], v13 offset:29696
    v_mfma_f32_32x32x16_bf16 v[96:111], v[32:35], v[16:19], v[96:111]
    ds_read_b64_tr_b16 v[52:53], v14 offset:23552
    ds_read_b64_tr_b16 v[54:55], v14 offset:29696
    v_mfma_f32_32x32x16_bf16 v[112:127], v[24:27], v[20:23], v[112:127]
    v_mfma_f32_32x32x16_bf16 v[128:143], v[28:31], v[20:23], v[128:143]
    v_mfma_f32_32x32x16_bf16 v[144:159], v[32:35], v[20:23], v[144:159]
    s_waitcnt lgkmcnt(0)
    s_barrier
    s_add_u32 s78, s78, 1
    v_mfma_f32_32x32x16_bf16 v[64:79], v[44:47], v[36:39], v[64:79]
    v_mfma_f32_32x32x16_bf16 v[80:95], v[48:51], v[36:39], v[80:95]
    v_mfma_f32_32x32x16_bf16 v[96:111], v[52:55], v[36:39], v[96:111]
    v_mfma_f32_32x32x16_bf16 v[112:127], v[44:47], v[40:43], v[112:127]
    v_mfma_f32_32x32x16_bf16 v[128:143], v[48:51], v[40:43], v[128:143]
    v_mfma_f32_32x32x16_bf16 v[144:159], v[52:55], v[40:43], v[144:159]
L_PUB:
    s_lshl_b32 s68, s80, 2
    s_add_u32 s68, s68, s72
    s_lshl_b32 s68, s68, 2
    s_and_b32 s79, s77, 1
    s_lshl_b32 s79, s79, 1
    s_add_u32 s68, s68, s79
    s_mul_i32 s68, s68, 6
    s_lshr_b32 s69, s77, 1
    s_mul_i32 s69, s69, 3
    s_add_u32 s68, s68, s69
    s_lshl_b32 s68, s68, 12
    s_add_u32 s68, s68, 67108864
    s_nop 7
    s_add_u32 s69, s79, 0
    s_cmp_eq_u32 s69, s72
    s_cbranch_scc1 PB_180
    s_add_u32 s69, s68, 0
    buffer_store_dwordx4 v[64:67], v7, s[56:59], s69 offen offset:0 sc1
    buffer_store_dwordx4 v[68:71], v7, s[56:59], s69 offen offset:1024 sc1
    buffer_store_dwordx4 v[72:75], v7, s[56:59], s69 offen offset:2048 sc1
    buffer_store_dwordx4 v[76:79], v7, s[56:59], s69 offen offset:3072 sc1
    s_add_u32 s69, s68, 4096
    buffer_store_dwordx4 v[80:83], v7, s[56:59], s69 offen offset:0 sc1
    buffer_store_dwordx4 v[84:87], v7, s[56:59], s69 offen offset:1024 sc1
    buffer_store_dwordx4 v[88:91], v7, s[56:59], s69 offen offset:2048 sc1
    buffer_store_dwordx4 v[92:95], v7, s[56:59], s69 offen offset:3072 sc1
    s_add_u32 s69, s68, 8192
    buffer_store_dwordx4 v[96:99], v7, s[56:59], s69 offen offset:0 sc1
    buffer_store_dwordx4 v[100:103], v7, s[56:59], s69 offen offset:1024 sc1
    buffer_store_dwordx4 v[104:107], v7, s[56:59], s69 offen offset:2048 sc1
    buffer_store_dwordx4 v[108:111], v7, s[56:59], s69 offen offset:3072 sc1
PB_180:
    s_add_u32 s69, s79, 1
    s_cmp_eq_u32 s69, s72
    s_cbranch_scc1 PB_181
    s_add_u32 s69, s68, 24576
    buffer_store_dwordx4 v[112:115], v7, s[56:59], s69 offen offset:0 sc1
    buffer_store_dwordx4 v[116:119], v7, s[56:59], s69 offen offset:1024 sc1
    buffer_store_dwordx4 v[120:123], v7, s[56:59], s69 offen offset:2048 sc1
    buffer_store_dwordx4 v[124:127], v7, s[56:59], s69 offen offset:3072 sc1
    s_add_u32 s69, s68, 28672
    buffer_store_dwordx4 v[128:131], v7, s[56:59], s69 offen offset:0 sc1
    buffer_store_dwordx4 v[132:135], v7, s[56:59], s69 offen offset:1024 sc1
    buffer_store_dwordx4 v[136:139], v7, s[56:59], s69 offen offset:2048 sc1
    buffer_store_dwordx4 v[140:143], v7, s[56:59], s69 offen offset:3072 sc1
    s_add_u32 s69, s68, 32768
    buffer_store_dwordx4 v[144:147], v7, s[56:59], s69 offen offset:0 sc1
    buffer_store_dwordx4 v[148:151], v7, s[56:59], s69 offen offset:1024 sc1
    buffer_store_dwordx4 v[152:155], v7, s[56:59], s69 offen offset:2048 sc1
    buffer_store_dwordx4 v[156:159], v7, s[56:59], s69 offen offset:3072 sc1
PB_181:
    s_waitcnt vmcnt(0)
    s_lshl_b32 s9, s80, 7
    s_add_u32 s9, s9, 49152
    s_lshl_b32 s10, s72, 2
    s_add_u32 s10, s10, s77
    s_lshl_b32 s10, s10, 3
    s_add_u32 s10, s10, s9
    s_memrealtime s[12:13]
    v_mov_b32 v58, s10
    s_mov_b32 s8, 62914560
    s_waitcnt lgkmcnt(0)
    v_mov_b32 v56, s12
    v_mov_b32 v57, s13
    s_mov_b64 exec, 1
    buffer_store_dwordx2 v[56:57], v58, s[56:59], s8 offen sc1
    s_mov_b64 exec, -1
SY_182:
    v_lshlrev_b32 v58, 3, v1
    v_add_u32 v58, s9, v58
    s_mov_b32 s8, 62914560
    s_mov_b32 s10, 0
FW_184:
    buffer_load_dwordx2 v[56:57], v58, s[56:59], s8 offen offset:0 sc1
    s_waitcnt vmcnt(0)
FW_186:
    s_memrealtime s[12:13]
    s_waitcnt lgkmcnt(0)
    s_add_u32 s12, s12, 200
    s_addc_u32 s13, s13, 0
    s_mov_b64 exec, 0xffff
    v_cmp_gt_u64 vcc, s[14:15], v[56:57]
    s_cbranch_vccnz FW_187
    v_cmp_lt_u64 vcc, s[12:13], v[56:57]
    s_cbranch_vccnz FW_187
    s_branch FW_185
FW_187:
    s_mov_b64 exec, -1
    s_sleep 2
    s_and_b32 s12, s10, 31
    s_cmp_lg_u32 s12, 31
    s_cbranch_scc1 EP_188
    v_mov_b32 v56, 248
    buffer_load_dwordx2 v[56:57], v56, s[4:7], 0 offen sc1
    s_waitcnt vmcnt(0)
    v_readfirstlane_b32 s12, v56
    v_readfirstlane_b32 s13, v57
    s_nop 3
    s_not_b64 s[14:15], s[12:13]
EP_188:
    s_add_u32 s10, s10, 1
    s_cmp_lt_u32 s10, 0x80000
    s_cbranch_scc1 FW_184
FW_185:
    s_mov_b64 exec, -1
SY_183:
    s_and_b32 s68, s77, 1
    s_lshr_b32 s69, s72, 1
    s_cmp_lg_u32 s68, s69
    s_cbranch_scc1 GA_189
    s_and_b32 s68, s72, 1
    s_cmp_eq_u32 s68, 0
    s_cbranch_scc1 GA_190
    v_mov_b32 v64, v112
    v_mov_b32 v65, v113
    v_mov_b32 v66, v114
    v_mov_b32 v67, v115
    v_mov_b32 v68, v116
    v_mov_b32 v69, v117
    v_mov_b32 v70, v118
    v_mov_b32 v71, v119
    v_mov_b32 v72, v120
    v_mov_b32 v73, v121
    v_mov_b32 v74, v122
    v_mov_b32 v75, v123
    v_mov_b32 v76, v124
    v_mov_b32 v77, v125
    v_mov_b32 v78, v126
    v_mov_b32 v79, v127
    v_mov_b32 v80, v128
    v_mov_b32 v81, v129
    v_mov_b32 v82, v130
    v_mov_b32 v83, v131
    v_mov_b32 v84, v132
    v_mov_b32 v85, v133
    v_mov_b32 v86, v134
    v_mov_b32 v87, v135
    v_mov_b32 v88, v136
    v_mov_b32 v89, v137
    v_mov_b32 v90, v138
    v_mov_b32 v91, v139
    v_mov_b32 v92, v140
    v_mov_b32 v93, v141
    v_mov_b32 v94, v142
    v_mov_b32 v95, v143
    v_mov_b32 v96, v144
    v_mov_b32 v97, v145
    v_mov_b32 v98, v146
    v_mov_b32 v99, v147
    v_mov_b32 v100, v148
    v_mov_b32 v101, v149
    v_mov_b32 v102, v150
    v_mov_b32 v103, v151
    v_mov_b32 v104, v152
    v_mov_b32 v105, v153
    v_mov_b32 v106, v154
    v_mov_b32 v107, v155
    v_mov_b32 v108, v156
    v_mov_b32 v109, v157
    v_mov_b32 v110, v158
    v_mov_b32 v111, v159
GA_190:
    s_add_u32 s69, s72, 1
    s_and_b32 s69, s69, 3
    s_lshl_b32 s68, s80, 2
    s_add_u32 s68, s68, s69
    s_lshl_b32 s68, s68, 2
    s_add_u32 s68, s68, s72
    s_mul_i32 s68, s68, 6
    s_lshr_b32 s69, s77, 1
    s_mul_i32 s69, s69, 3
    s_add_u32 s68, s68, s69
    s_lshl_b32 s68, s68, 12
    s_add_u32 s68, s68, 67108864
    buffer_load_dwordx4 v[112:115], v7, s[56:59], s68 offen offset:0
    buffer_load_dwordx4 v[116:119], v7, s[56:59], s68 offen offset:1024
    buffer_load_dwordx4 v[120:123], v7, s[56:59], s68 offen offset:2048
    buffer_load_dwordx4 v[124:127], v7, s[56:59], s68 offen offset:3072
    s_add_u32 s68, s68, 4096
    buffer_load_dwordx4 v[128:131], v7, s[56:59], s68 offen offset:0
    buffer_load_dwordx4 v[132:135], v7, s[56:59], s68 offen offset:1024
    buffer_load_dwordx4 v[136:139], v7, s[56:59], s68 offen offset:2048
    buffer_load_dwordx4 v[140:143], v7, s[56:59], s68 offen offset:3072
    s_add_u32 s68, s68, 4096
    buffer_load_dwordx4 v[144:147], v7, s[56:59], s68 offen offset:0
    buffer_load_dwordx4 v[148:151], v7, s[56:59], s68 offen offset:1024
    buffer_load_dwordx4 v[152:155], v7, s[56:59], s68 offen offset:2048
    buffer_load_dwordx4 v[156:159], v7, s[56:59], s68 offen offset:3072
    s_add_u32 s69, s72, 2
    s_and_b32 s69, s69, 3
    s_lshl_b32 s68, s80, 2
    s_add_u32 s68, s68, s69
    s_lshl_b32 s68, s68, 2
    s_add_u32 s68, s68, s72
    s_mul_i32 s68, s68, 6
    s_lshr_b32 s69, s77, 1
    s_mul_i32 s69, s69, 3
    s_add_u32 s68, s68, s69
    s_lshl_b32 s68, s68, 12
    s_add_u32 s68, s68, 67108864
    buffer_load_dwordx4 v[160:163], v7, s[56:59], s68 offen offset:0
    buffer_load_dwordx4 v[164:167], v7, s[56:59], s68 offen offset:1024
    buffer_load_dwordx4 v[168:171], v7, s[56:59], s68 offen offset:2048
    buffer_load_dwordx4 v[172:175], v7, s[56:59], s68 offen offset:3072
    s_add_u32 s68, s68, 4096
    buffer_load_dwordx4 v[176:179], v7, s[56:59], s68 offen offset:0
    buffer_load_dwordx4 v[180:183], v7, s[56:59], s68 offen offset:1024
    buffer_load_dwordx4 v[184:187], v7, s[56:59], s68 offen offset:2048
    buffer_load_dwordx4 v[188:191], v7, s[56:59], s68 offen offset:3072
    s_add_u32 s68, s68, 4096
    buffer_load_dwordx4 v[192:195], v7, s[56:59], s68 offen offset:0
    buffer_load_dwordx4 v[196:199], v7, s[56:59], s68 offen offset:1024
    buffer_load_dwordx4 v[200:203], v7, s[56:59], s68 offen offset:2048
    buffer_load_dwordx4 v[204:207], v7, s[56:59], s68 offen offset:3072
    s_add_u32 s69, s72, 3
    s_and_b32 s69, s69, 3
    s_lshl_b32 s68, s80, 2
    s_add_u32 s68, s68, s69
    s_lshl_b32 s68, s68, 2
    s_add_u32 s68, s68, s72
    s_mul_i32 s68, s68, 6
    s_lshr_b32 s69, s77, 1
    s_mul_i32 s69, s69, 3
    s_add_u32 s68, s68, s69
    s_lshl_b32 s68, s68, 12
    s_add_u32 s68, s68, 67108864
    buffer_load_dwordx4 v[208:211], v7, s[56:59], s68 offen offset:0
    buffer_load_dwordx4 v[212:215], v7, s[56:59], s68 offen offset:1024
    buffer_load_dwordx4 v[216:219], v7, s[56:59], s68 offen offset:2048
    buffer_load_dwordx4 v[220:223], v7, s[56:59], s68 offen offset:3072
    s_add_u32 s68, s68, 4096
    buffer_load_dwordx4 v[224:227], v7, s[56:59], s68 offen offset:0
    buffer_load_dwordx4 v[228:231], v7, s[56:59], s68 offen offset:1024
    buffer_load_dwordx4 v[232:235], v7, s[56:59], s68 offen offset:2048
    buffer_load_dwordx4 v[236:239], v7, s[56:59], s68 offen offset:3072
    s_add_u32 s68, s68, 4096
    buffer_load_dwordx4 v[240:243], v7, s[56:59], s68 offen offset:0
    buffer_load_dwordx4 v[244:247], v7, s[56:59], s68 offen offset:1024
    buffer_load_dwordx4 v[248:251], v7, s[56:59], s68 offen offset:2048
    buffer_load_dwordx4 v[252:255], v7, s[56:59], s68 offen offset:3072
    s_waitcnt vmcnt(24)
    v_add_f32 v64, v64, v112
    v_add_f32 v65, v65, v113
    v_add_f32 v66, v66, v114
    v_add_f32 v67, v67, v115
    v_add_f32 v68, v68, v116
    v_add_f32 v69, v69, v117
    v_add_f32 v70, v70, v118
    v_add_f32 v71, v71, v119
    v_add_f32 v72, v72, v120
    v_add_f32 v73, v73, v121
    v_add_f32 v74, v74, v122
    v_add_f32 v75, v75, v123
    v_add_f32 v76, v76, v124
    v_add_f32 v77, v77, v125
    v_add_f32 v78, v78, v126
    v_add_f32 v79, v79, v127
    v_add_f32 v80, v80, v128
    v_add_f32 v81, v81, v129
    v_add_f32 v82, v82, v130
    v_add_f32 v83, v83, v131
    v_add_f32 v84, v84, v132
    v_add_f32 v85, v85, v133
    v_add_f32 v86, v86, v134
    v_add_f32 v87, v87, v135
    v_add_f32 v88, v88, v136
    v_add_f32 v89, v89, v137
    v_add_f32 v90, v90, v138
    v_add_f32 v91, v91, v139
    v_add_f32 v92, v92, v140
    v_add_f32 v93, v93, v141
    v_add_f32 v94, v94, v142
    v_add_f32 v95, v95, v143
    v_add_f32 v96, v96, v144
    v_add_f32 v97, v97, v145
    v_add_f32 v98, v98, v146
    v_add_f32 v99, v99, v147
    v_add_f32 v100, v100, v148
    v_add_f32 v101, v101, v149
    v_add_f32 v102, v102, v150
    v_add_f32 v103, v103, v151
    v_add_f32 v104, v104, v152
    v_add_f32 v105, v105, v153
    v_add_f32 v106, v106, v154
    v_add_f32 v107, v107, v155
    v_add_f32 v108, v108, v156
    v_add_f32 v109, v109, v157
    v_add_f32 v110, v110, v158
    v_add_f32 v111, v111, v159
    s_waitcnt vmcnt(12)
    v_add_f32 v64, v64, v160
    v_add_f32 v65, v65, v161
    v_add_f32 v66, v66, v162
    v_add_f32 v67, v67, v163
    v_add_f32 v68, v68, v164
    v_add_f32 v69, v69, v165
    v_add_f32 v70, v70, v166
    v_add_f32 v71, v71, v167
    v_add_f32 v72, v72, v168
    v_add_f32 v73, v73, v169
    v_add_f32 v74, v74, v170
    v_add_f32 v75, v75, v171
    v_add_f32 v76, v76, v172
    v_add_f32 v77, v77, v173
    v_add_f32 v78, v78, v174
    v_add_f32 v79, v79, v175
    v_add_f32 v80, v80, v176
    v_add_f32 v81, v81, v177
    v_add_f32 v82, v82, v178
    v_add_f32 v83, v83, v179
    v_add_f32 v84, v84, v180
    v_add_f32 v85, v85, v181
    v_add_f32 v86, v86, v182
    v_add_f32 v87, v87, v183
    v_add_f32 v88, v88, v184
    v_add_f32 v89, v89, v185
    v_add_f32 v90, v90, v186
    v_add_f32 v91, v91, v187
    v_add_f32 v92, v92, v188
    v_add_f32 v93, v93, v189
    v_add_f32 v94, v94, v190
    v_add_f32 v95, v95, v191
    v_add_f32 v96, v96, v192
    v_add_f32 v97, v97, v193
    v_add_f32 v98, v98, v194
    v_add_f32 v99, v99, v195
    v_add_f32 v100, v100, v196
    v_add_f32 v101, v101, v197
    v_add_f32 v102, v102, v198
    v_add_f32 v103, v103, v199
    v_add_f32 v104, v104, v200
    v_add_f32 v105, v105, v201
    v_add_f32 v106, v106, v202
    v_add_f32 v107, v107, v203
    v_add_f32 v108, v108, v204
    v_add_f32 v109, v109, v205
    v_add_f32 v110, v110, v206
    v_add_f32 v111, v111, v207
    s_waitcnt vmcnt(0)
    v_add_f32 v64, v64, v208
    v_add_f32 v65, v65, v209
    v_add_f32 v66, v66, v210
    v_add_f32 v67, v67, v211
    v_add_f32 v68, v68, v212
    v_add_f32 v69, v69, v213
    v_add_f32 v70, v70, v214
    v_add_f32 v71, v71, v215
    v_add_f32 v72, v72, v216
    v_add_f32 v73, v73, v217
    v_add_f32 v74, v74, v218
    v_add_f32 v75, v75, v219
    v_add_f32 v76, v76, v220
    v_add_f32 v77, v77, v221
    v_add_f32 v78, v78, v222
    v_add_f32 v79, v79, v223
    v_add_f32 v80, v80, v224
    v_add_f32 v81, v81, v225
    v_add_f32 v82, v82, v226
    v_add_f32 v83, v83, v227
    v_add_f32 v84, v84, v228
    v_add_f32 v85, v85, v229
    v_add_f32 v86, v86, v230
    v_add_f32 v87, v87, v231
    v_add_f32 v88, v88, v232
    v_add_f32 v89, v89, v233
    v_add_f32 v90, v90, v234
    v_add_f32 v91, v91, v235
    v_add_f32 v92, v92, v236
    v_add_f32 v93, v93, v237
    v_add_f32 v94, v94, v238
    v_add_f32 v95, v95, v239
    v_add_f32 v96, v96, v240
    v_add_f32 v97, v97, v241
    v_add_f32 v98, v98, v242
    v_add_f32 v99, v99, v243
    v_add_f32 v100, v100, v244
    v_add_f32 v101, v101, v245
    v_add_f32 v102, v102, v246
    v_add_f32 v103, v103, v247
    v_add_f32 v104, v104, v248
    v_add_f32 v105, v105, v249
    v_add_f32 v106, v106, v250
    v_add_f32 v107, v107, v251
    v_add_f32 v108, v108, v252
    v_add_f32 v109, v109, v253
    v_add_f32 v110, v110, v254
    v_add_f32 v111, v111, v255
    v_and_b32 v16, 31, v1
    s_lshl_b32 s68, s70, 7
    s_and_b32 s69, s77, 1
    s_lshl_b32 s69, s69, 6
    s_add_u32 s68, s68, s69
    v_add_u32 v16, s68, v16
    v_mul_u32_u24 v16, 2304, v16
    v_lshrrev_b32 v17, 5, v1
    v_lshl_add_u32 v16, v17, 4, v16
    s_mul_i32 s68, s71, 192
    s_lshr_b32 s69, s77, 1
    s_mul_i32 s69, s69, 96
    s_add_u32 s68, s68, s69
    s_lshl_b32 s68, s68, 1
    s_add_u32 s68, s68, 1152
    s_and_b32 s69, s72, 1
    s_mul_i32 s69, s69, 73728
    s_add_u32 s68, s68, s69
    v_cvt_pk_bf16_f32 v64, v64, v65
    v_cvt_pk_bf16_f32 v65, v66, v67
    v_cvt_pk_bf16_f32 v66, v68, v69
    v_cvt_pk_bf16_f32 v67, v70, v71
    v_cvt_pk_bf16_f32 v68, v72, v73
    v_cvt_pk_bf16_f32 v69, v74, v75
    v_cvt_pk_bf16_f32 v70, v76, v77
    v_cvt_pk_bf16_f32 v71, v78, v79
    s_nop 1
    v_permlane32_swap_b32 v64, v66
    v_permlane32_swap_b32 v65, v67
    v_permlane32_swap_b32 v68, v70
    v_permlane32_swap_b32 v69, v71
    s_nop 1
    buffer_store_dwordx4 v[64:67], v16, s[52:55], s68 offen offset:0
    buffer_store_dwordx4 v[68:71], v16, s[52:55], s68 offen offset:32
    v_cvt_pk_bf16_f32 v80, v80, v81
    v_cvt_pk_bf16_f32 v81, v82, v83
    v_cvt_pk_bf16_f32 v82, v84, v85
    v_cvt_pk_bf16_f32 v83, v86, v87
    v_cvt_pk_bf16_f32 v84, v88, v89
    v_cvt_pk_bf16_f32 v85, v90, v91
    v_cvt_pk_bf16_f32 v86, v92, v93
    v_cvt_pk_bf16_f32 v87, v94, v95
    s_nop 1
    v_permlane32_swap_b32 v80, v82
    v_permlane32_swap_b32 v81, v83
    v_permlane32_swap_b32 v84, v86
    v_permlane32_swap_b32 v85, v87
    s_nop 1
    buffer_store_dwordx4 v[80:83], v16, s[52:55], s68 offen offset:64
    buffer_store_dwordx4 v[84:87], v16, s[52:55], s68 offen offset:96
    v_cvt_pk_bf16_f32 v96, v96, v97
    v_cvt_pk_bf16_f32 v97, v98, v99
    v_cvt_pk_bf16_f32 v98, v100, v101
    v_cvt_pk_bf16_f32 v99, v102, v103
    v_cvt_pk_bf16_f32 v100, v104, v105
    v_cvt_pk_bf16_f32 v101, v106, v107
    v_cvt_pk_bf16_f32 v102, v108, v109
    v_cvt_pk_bf16_f32 v103, v110, v111
    s_nop 1
    v_permlane32_swap_b32 v96, v98
    v_permlane32_swap_b32 v97, v99
    v_permlane32_swap_b32 v100, v102
    v_permlane32_swap_b32 v101, v103
    s_nop 1
    buffer_store_dwordx4 v[96:99], v16, s[52:55], s68 offen offset:128
    buffer_store_dwordx4 v[100:103], v16, s[52:55], s68 offen offset:160
GA_189:
    s_branch P4E_151
P4A_167:
    s_barrier
    s_add_u32 s78, s78, 1
    s_waitcnt vmcnt(3)
    s_lshr_b32 s10, s2, 5
    s_lshl_b32 s10, s10, 2
    s_add_u32 s10, s10, s77
    s_sub_u32 s10, 63, s10
    s_lshl_b32 s10, s10, 5
    s_and_b32 s9, s2, 31
    s_add_u32 s10, s10, s9
    s_lshl_b32 s10, s10, 3
    s_add_u32 s10, s10, 12288
    s_memrealtime s[12:13]
    v_mov_b32 v54, s10
    s_mov_b32 s8, 62914560
    s_waitcnt lgkmcnt(0)
    v_mov_b32 v52, s12
    v_mov_b32 v53, s13
    s_mov_b64 exec, 1
    buffer_store_dwordx2 v[52:53], v54, s[56:59], s8 offen sc1
    s_mov_b64 exec, -1
SY_191:
    s_cmp_ge_u32 s67, 30
    s_cbranch_scc1 P4E_151
    s_mov_b32 s48, s24
    s_and_b32 s49, s25, 0xffff
    s_mov_b32 s50, 663552
    s_mov_b32 s51, 0x00020000
    s_mul_i32 s68, s66, 6
    s_add_u32 s68, s68, s67
    s_sub_u32 s68, s68, 24
    s_mul_i32 s70, s68, 21846
    s_lshr_b32 s70, s70, 16
    s_mul_i32 s69, s70, 3
    s_sub_u32 s71, s68, s69
    s_mul_i32 s68, s77, 192
    s_movk_i32 s69, 2731
    v_add_u32 v160, s68, v1
    v_mul_lo_u32 v161, v160, s69
    v_lshrrev_b32 v161, 16, v161
    v_mul_u32_u24 v162, 24, v161
    v_sub_u32 v162, v160, v162
    v_bfe_u32 v163, v161, 1, 1
    v_lshlrev_b32 v163, 2, v163
    v_xor_b32 v162, v162, v163
    v_mul_u32_u24 v161, 1152, v161
    v_lshl_add_u32 v3, v162, 4, v161
    v_add_u32 v160, s68, v1
    v_add_u32 v160, 64, v160
    v_mul_lo_u32 v161, v160, s69
    v_lshrrev_b32 v161, 16, v161
    v_mul_u32_u24 v162, 24, v161
    v_sub_u32 v162, v160, v162
    v_bfe_u32 v163, v161, 1, 1
    v_lshlrev_b32 v163, 2, v163
    v_xor_b32 v162, v162, v163
    v_mul_u32_u24 v161, 1152, v161
    v_lshl_add_u32 v4, v162, 4, v161
    v_add_u32 v160, s68, v1
    v_add_u32 v160, 128, v160
    v_mul_lo_u32 v161, v160, s69
    v_lshrrev_b32 v161, 16, v161
    v_mul_u32_u24 v162, 24, v161
    v_sub_u32 v162, v160, v162
    v_bfe_u32 v163, v161, 1, 1
    v_lshlrev_b32 v163, 2, v163
    v_xor_b32 v162, v162, v163
    v_mul_u32_u24 v161, 1152, v161
    v_lshl_add_u32 v5, v162, 4, v161
    s_mul_i32 s68, s71, 384
    v_add_u32 v3, s68, v3
    v_add_u32 v4, s68, v4
    v_add_u32 v5, s68, v5
    s_mul_i32 s76, s77, 3072
    s_add_u32 s76, s76, 8192
    s_lshl_b32 s75, s77, 11
    v_bfe_u32 v160, v1, 2, 2
    v_lshrrev_b32 v161, 5, v1
    v_lshl_add_u32 v161, v161, 3, v160
    v_mul_u32_u24 v161, 384, v161
    v_add_u32 v161, 8192, v161
    v_and_b32 v162, 1, v1
    v_lshl_add_u32 v161, v162, 3, v161
    v_bfe_u32 v162, v1, 4, 1
    v_bfe_u32 v163, v1, 1, 1
    v_lshl_add_u32 v162, v162, 1, v163
    v_bfe_u32 v163, v1, 3, 1
    v_lshlrev_b32 v163, 2, v163
    s_lshr_b32 s68, s77, 1
    s_mul_i32 s68, s68, 12
    s_add_u32 s69, s68, 0
    v_add_u32 v164, s69, v162
    v_xor_b32 v164, v164, v163
    v_lshl_add_u32 v12, v164, 4, v161
    s_add_u32 s69, s68, 4
    v_add_u32 v164, s69, v162
    v_xor_b32 v164, v164, v163
    v_lshl_add_u32 v13, v164, 4, v161
    s_add_u32 s69, s68, 8
    v_add_u32 v164, s69, v162
    v_xor_b32 v164, v164, v163
    v_lshl_add_u32 v14, v164, 4, v161
    s_mov_b32 s74, 0
    s_mov_b32 s73, 56623104
    v_lshrrev_b32 v161, 4, v1
    v_and_b32 v162, 3, v1
    v_xor_b32 v163, v162, v161
    v_lshrrev_b32 v160, 2, v1
    s_lshl_b32 s68, s70, 7
    s_lshl_b32 s69, s77, 5
    s_add_u32 s68, s68, s69
    v_add_u32 v160, s68, v160
    v_mul_u32_u24 v160, 576, v160
    v_lshl_add_u32 v2, v163, 4, v160
    v_and_b32 v160, 31, v1
    s_and_b32 s68, s77, 1
    s_lshl_b32 s68, s68, 6
    v_add_u32 v161, s68, v160
    v_lshlrev_b32 v161, 6, v161
    v_bfe_u32 v162, v1, 2, 2
    v_lshrrev_b32 v163, 5, v1
    v_add_u32 v164, 0, v163
    v_xor_b32 v164, v164, v162
    v_lshl_add_u32 v8, v164, 4, v161
    v_add_u32 v10, 40960, v8
    v_add_u32 v164, 2, v163
    v_xor_b32 v164, v164, v162
    v_lshl_add_u32 v9, v164, 4, v161
    v_add_u32 v11, 40960, v9
    v_mov_b32 v64, 0
    v_mov_b32 v65, 0
    v_mov_b32 v66, 0
    v_mov_b32 v67, 0
    v_mov_b32 v68, 0
    v_mov_b32 v69, 0
    v_mov_b32 v70, 0
    v_mov_b32 v71, 0
    v_mov_b32 v72, 0
    v_mov_b32 v73, 0
    v_mov_b32 v74, 0
    v_mov_b32 v75, 0
    v_mov_b32 v76, 0
    v_mov_b32 v77, 0
    v_mov_b32 v78, 0
    v_mov_b32 v79, 0
    v_mov_b32 v80, 0
    v_mov_b32 v81, 0
    v_mov_b32 v82, 0
    v_mov_b32 v83, 0
    v_mov_b32 v84, 0
    v_mov_b32 v85, 0
    v_mov_b32 v86, 0
    v_mov_b32 v87, 0
    v_mov_b32 v88, 0
    v_mov_b32 v89, 0
    v_mov_b32 v90, 0
    v_mov_b32 v91, 0
    v_mov_b32 v92, 0
    v_mov_b32 v93, 0
    v_mov_b32 v94, 0
    v_mov_b32 v95, 0
    v_mov_b32 v96, 0
    v_mov_b32 v97, 0
    v_mov_b32 v98, 0
    v_mov_b32 v99, 0
    v_mov_b32 v100, 0
    v_mov_b32 v101, 0
    v_mov_b32 v102, 0
    v_mov_b32 v103, 0
    v_mov_b32 v104, 0
    v_mov_b32 v105, 0
    v_mov_b32 v106, 0
    v_mov_b32 v107, 0
    v_mov_b32 v108, 0
    v_mov_b32 v109, 0
    v_mov_b32 v110, 0
    v_mov_b32 v111, 0
    v_mov_b32 v112, 0
    v_mov_b32 v113, 0
    v_mov_b32 v114, 0
    v_mov_b32 v115, 0
    v_mov_b32 v116, 0
    v_mov_b32 v117, 0
    v_mov_b32 v118, 0
    v_mov_b32 v119, 0
    v_mov_b32 v120, 0
    v_mov_b32 v121, 0
    v_mov_b32 v122, 0
    v_mov_b32 v123, 0
    v_mov_b32 v124, 0
    v_mov_b32 v125, 0
    v_mov_b32 v126, 0
    v_mov_b32 v127, 0
    v_mov_b32 v128, 0
    v_mov_b32 v129, 0
    v_mov_b32 v130, 0
    v_mov_b32 v131, 0
    v_mov_b32 v132, 0
    v_mov_b32 v133, 0
    v_mov_b32 v134, 0
    v_mov_b32 v135, 0
    v_mov_b32 v136, 0
    v_mov_b32 v137, 0
    v_mov_b32 v138, 0
    v_mov_b32 v139, 0
    v_mov_b32 v140, 0
    v_mov_b32 v141, 0
    v_mov_b32 v142, 0
    v_mov_b32 v143, 0
    v_mov_b32 v144, 0
    v_mov_b32 v145, 0
    v_mov_b32 v146, 0
    v_mov_b32 v147, 0
    v_mov_b32 v148, 0
    v_mov_b32 v149, 0
    v_mov_b32 v150, 0
    v_mov_b32 v151, 0
    v_mov_b32 v152, 0
    v_mov_b32 v153, 0
    v_mov_b32 v154, 0
    v_mov_b32 v155, 0
    v_mov_b32 v156, 0
    v_mov_b32 v157, 0
    v_mov_b32 v158, 0
    v_mov_b32 v159, 0
    s_barrier
    s_add_u32 s78, s78, 1
    s_barrier
    s_add_u32 s78, s78, 1
    s_barrier
    s_add_u32 s78, s78, 1
    s_lshl_b32 s9, s70, 7
    s_add_u32 s9, s9, 32768
    s_add_u32 m0, s76, 0
    s_nop 0
    buffer_load_dwordx4 v3, s[48:51], s74 offen lds
    s_add_u32 m0, s76, 1024
    s_nop 0
    buffer_load_dwordx4 v4, s[48:51], s74 offen lds
    s_add_u32 m0, s76, 2048
    s_nop 0
    buffer_load_dwordx4 v5, s[48:51], s74 offen lds
    s_add_u32 s74, s74, 36864
    s_add_u32 m0, s76, 20480
    s_nop 0
    buffer_load_dwordx4 v3, s[48:51], s74 offen lds
    s_add_u32 m0, s76, 21504
    s_nop 0
    buffer_load_dwordx4 v4, s[48:51], s74 offen lds
    s_add_u32 m0, s76, 22528
    s_nop 0
    buffer_load_dwordx4 v5, s[48:51], s74 offen lds
    s_add_u32 s74, s74, 36864
    s_add_u32 m0, s76, 40960
    s_nop 0
    buffer_load_dwordx4 v3, s[48:51], s74 offen lds
    s_add_u32 m0, s76, 41984
    s_nop 0
    buffer_load_dwordx4 v4, s[48:51], s74 offen lds
    s_add_u32 m0, s76, 43008
    s_nop 0
    buffer_load_dwordx4 v5, s[48:51], s74 offen lds
    s_add_u32 s74, s74, 36864
    s_add_u32 m0, s76, 61440
    s_nop 0
    buffer_load_dwordx4 v3, s[48:51], s74 offen lds
    s_add_u32 m0, s76, 62464
    s_nop 0
    buffer_load_dwordx4 v4, s[48:51], s74 offen lds
    s_add_u32 m0, s76, 63488
    s_nop 0
    buffer_load_dwordx4 v5, s[48:51], s74 offen lds
    s_add_u32 s74, s74, 36864
    v_lshlrev_b32 v58, 3, v1
    v_add_u32 v58, s9, v58
    s_mov_b32 s8, 62914560
    s_mov_b32 s10, 0
FW_193:
    buffer_load_dwordx2 v[56:57], v58, s[56:59], s8 offen offset:0 sc1
    s_waitcnt vmcnt(0)
FW_195:
    s_memrealtime s[12:13]
    s_waitcnt lgkmcnt(0)
    s_add_u32 s12, s12, 200
    s_addc_u32 s13, s13, 0
    s_mov_b64 exec, 0xffff
    v_cmp_gt_u64 vcc, s[14:15], v[56:57]
    s_cbranch_vccnz FW_196
    v_cmp_lt_u64 vcc, s[12:13], v[56:57]
    s_cbranch_vccnz FW_196
    s_branch FW_194
FW_196:
    s_mov_b64 exec, -1
    s_sleep 2
    s_and_b32 s12, s10, 31
    s_cmp_lg_u32 s12, 31
    s_cbranch_scc1 EP_197
    v_mov_b32 v56, 248
    buffer_load_dwordx2 v[56:57], v56, s[4:7], 0 offen sc1
    s_waitcnt vmcnt(0)
    v_readfirstlane_b32 s12, v56
    v_readfirstlane_b32 s13, v57
    s_nop 3
    s_not_b64 s[14:15], s[12:13]
EP_197:
    s_add_u32 s10, s10, 1
    s_cmp_lt_u32 s10, 0x80000
    s_cbranch_scc1 FW_193
FW_194:
    s_mov_b64 exec, -1
SY_192:
    s_add_u32 m0, s75, 0
    s_add_u32 s68, s73, 9216
    buffer_load_dwordx4 v2, s[56:59], s73 offen sc1 lds
    s_add_u32 m0, s75, 1024
    s_add_u32 s73, s73, 64
    buffer_load_dwordx4 v2, s[56:59], s68 offen sc1 lds
    s_add_u32 m0, s75, 20480
    s_add_u32 s68, s73, 9216
    buffer_load_dwordx4 v2, s[56:59], s73 offen sc1 lds
    s_add_u32 m0, s75, 21504
    s_add_u32 s73, s73, 64
    buffer_load_dwordx4 v2, s[56:59], s68 offen sc1 lds
    s_add_u32 m0, s75, 40960
    s_add_u32 s68, s73, 9216
    buffer_load_dwordx4 v2, s[56:59], s73 offen sc1 lds
    s_add_u32 m0, s75, 41984
    s_add_u32 s73, s73, 64
    buffer_load_dwordx4 v2, s[56:59], s68 offen sc1 lds
    s_add_u32 m0, s75, 61440
    s_add_u32 s68, s73, 9216
    buffer_load_dwordx4 v2, s[56:59], s73 offen sc1 lds
    s_add_u32 m0, s75, 62464
    s_add_u32 s73, s73, 64
    buffer_load_dwordx4 v2, s[56:59], s68 offen sc1 lds
    s_waitcnt vmcnt(6)
    s_barrier
    s_add_u32 s78, s78, 1
    ds_read_b128 v[16:19], v8 offset:0
    ds_read_b128 v[20:23], v8 offset:2048
    ds_read_b64_tr_b16 v[24:25], v12 offset:0
    ds_read_b64_tr_b16 v[26:27], v12 offset:1536
    ds_read_b64_tr_b16 v[28:29], v13 offset:0
    ds_read_b64_tr_b16 v[30:31], v13 offset:1536
    ds_read_b64_tr_b16 v[32:33], v14 offset:0
    ds_read_b64_tr_b16 v[34:35], v14 offset:1536
    s_waitcnt lgkmcnt(0)
    v_mfma_f32_32x32x16_bf16 v[64:79], v[24:27], v[16:19], v[64:79]
    ds_read_b128 v[36:39], v9 offset:0
    ds_read_b128 v[40:43], v9 offset:2048
    ds_read_b64_tr_b16 v[44:45], v12 offset:6144
    v_mfma_f32_32x32x16_bf16 v[80:95], v[28:31], v[16:19], v[80:95]
    ds_read_b64_tr_b16 v[46:47], v12 offset:7680
    ds_read_b64_tr_b16 v[48:49], v13 offset:6144
    ds_read_b64_tr_b16 v[50:51], v13 offset:7680
    v_mfma_f32_32x32x16_bf16 v[96:111], v[32:35], v[16:19], v[96:111]
    ds_read_b64_tr_b16 v[52:53], v14 offset:6144
    ds_read_b64_tr_b16 v[54:55], v14 offset:7680
    v_mfma_f32_32x32x16_bf16 v[112:127], v[24:27], v[20:23], v[112:127]
    v_mfma_f32_32x32x16_bf16 v[128:143], v[28:31], v[20:23], v[128:143]
    v_mfma_f32_32x32x16_bf16 v[144:159], v[32:35], v[20:23], v[144:159]
    s_waitcnt vmcnt(4) lgkmcnt(0)
    s_barrier
    s_add_u32 s78, s78, 1
    v_mfma_f32_32x32x16_bf16 v[64:79], v[44:47], v[36:39], v[64:79]
    ds_read_b128 v[16:19], v8 offset:20480
    ds_read_b128 v[20:23], v8 offset:22528
    ds_read_b64_tr_b16 v[24:25], v12 offset:20480
    v_mfma_f32_32x32x16_bf16 v[80:95], v[48:51], v[36:39], v[80:95]
    ds_read_b64_tr_b16 v[26:27], v12 offset:22016
    ds_read_b64_tr_b16 v[28:29], v13 offset:20480
    ds_read_b64_tr_b16 v[30:31], v13 offset:22016
    s_add_u32 m0, s75, 0
    s_add_u32 s68, s73, 9216
    buffer_load_dwordx4 v2, s[56:59], s73 offen sc1 lds
    v_mfma_f32_32x32x16_bf16 v[96:111], v[52:55], v[36:39], v[96:111]
    ds_read_b64_tr_b16 v[32:33], v14 offset:20480
    ds_read_b64_tr_b16 v[34:35], v14 offset:22016
    s_add_u32 m0, s75, 1024
    s_add_u32 s73, s73, 64
    buffer_load_dwordx4 v2, s[56:59], s68 offen sc1 lds
    v_mfma_f32_32x32x16_bf16 v[112:127], v[44:47], v[40:43], v[112:127]
    s_add_u32 m0, s76, 0
    s_nop 0
    buffer_load_dwordx4 v3, s[48:51], s74 offen lds
    v_mfma_f32_32x32x16_bf16 v[128:143], v[48:51], v[40:43], v[128:143]
    s_add_u32 m0, s76, 1024
    s_nop 0
    buffer_load_dwordx4 v4, s[48:51], s74 offen lds
    v_mfma_f32_32x32x16_bf16 v[144:159], v[52:55], v[40:43], v[144:159]
    s_add_u32 m0, s76, 2048
    s_nop 0
    buffer_load_dwordx4 v5, s[48:51], s74 offen lds
    s_add_u32 s74, s74, 36864
    s_waitcnt lgkmcnt(0)
    v_mfma_f32_32x32x16_bf16 v[64:79], v[24:27], v[16:19], v[64:79]
    ds_read_b128 v[36:39], v9 offset:20480
    ds_read_b128 v[40:43], v9 offset:22528
    ds_read_b64_tr_b16 v[44:45], v12 offset:26624
    v_mfma_f32_32x32x16_bf16 v[80:95], v[28:31], v[16:19], v[80:95]
    ds_read_b64_tr_b16 v[46:47], v12 offset:28160
    ds_read_b64_tr_b16 v[48:49], v13 offset:26624
    ds_read_b64_tr_b16 v[50:51], v13 offset:28160
    v_mfma_f32_32x32x16_bf16 v[96:111], v[32:35], v[16:19], v[96:111]
    ds_read_b64_tr_b16 v[52:53], v14 offset:26624
    ds_read_b64_tr_b16 v[54:55], v14 offset:28160
    v_mfma_f32_32x32x16_bf16 v[112:127], v[24:27], v[20:23], v[112:127]
    v_mfma_f32_32x32x16_bf16 v[128:143], v[28:31], v[20:23], v[128:143]
    v_mfma_f32_32x32x16_bf16 v[144:159], v[32:35], v[20:23], v[144:159]
    s_waitcnt vmcnt(7) lgkmcnt(0)
    s_barrier
    s_add_u32 s78, s78, 1
    v_mfma_f32_32x32x16_bf16 v[64:79], v[44:47], v[36:39], v[64:79]
    v_add_u32 v12, 0xa000, v12
    v_add_u32 v13, 0xa000, v13
    v_add_u32 v14, 0xa000, v14
    v_mfma_f32_32x32x16_bf16 v[80:95], v[48:51], v[36:39], v[80:95]
    ds_read_b128 v[16:19], v10 offset:0
    ds_read_b128 v[20:23], v10 offset:2048
    ds_read_b64_tr_b16 v[24:25], v12 offset:0
    s_add_u32 m0, s75, 20480
    s_add_u32 s68, s73, 9216
    buffer_load_dwordx4 v2, s[56:59], s73 offen sc1 lds
    v_mfma_f32_32x32x16_bf16 v[96:111], v[52:55], v[36:39], v[96:111]
    ds_read_b64_tr_b16 v[26:27], v12 offset:1536
    ds_read_b64_tr_b16 v[28:29], v13 offset:0
    ds_read_b64_tr_b16 v[30:31], v13 offset:1536
    s_add_u32 m0, s75, 21504
    s_add_u32 s73, s73, 64
    buffer_load_dwordx4 v2, s[56:59], s68 offen sc1 lds
    v_mfma_f32_32x32x16_bf16 v[112:127], v[44:47], v[40:43], v[112:127]
    ds_read_b64_tr_b16 v[32:33], v14 offset:0
    ds_read_b64_tr_b16 v[34:35], v14 offset:1536
    s_add_u32 m0, s76, 20480
    s_nop 0
    buffer_load_dwordx4 v3, s[48:51], s74 offen lds
    v_mfma_f32_32x32x16_bf16 v[128:143], v[48:51], v[40:43], v[128:143]
    s_add_u32 m0, s76, 21504
    s_nop 0
    buffer_load_dwordx4 v4, s[48:51], s74 offen lds
    v_mfma_f32_32x32x16_bf16 v[144:159], v[52:55], v[40:43], v[144:159]
    s_add_u32 m0, s76, 22528
    s_nop 0
    buffer_load_dwordx4 v5, s[48:51], s74 offen lds
    s_add_u32 s74, s74, 36864
    s_waitcnt lgkmcnt(0)
    v_mfma_f32_32x32x16_bf16 v[64:79], v[24:27], v[16:19], v[64:79]
    ds_read_b128 v[36:39], v11 offset:0
    ds_read_b128 v[40:43], v11 offset:2048
    ds_read_b64_tr_b16 v[44:45], v12 offset:6144
    v_mfma_f32_32x32x16_bf16 v[80:95], v[28:31], v[16:19], v[80:95]
    ds_read_b64_tr_b16 v[46:47], v12 offset:7680
    ds_read_b64_tr_b16 v[48:49], v13 offset:6144
    ds_read_b64_tr_b16 v[50:51], v13 offset:7680
    v_mfma_f32_32x32x16_bf16 v[96:111], v[32:35], v[16:19], v[96:111]
    ds_read_b64_tr_b16 v[52:53], v14 offset:6144
    ds_read_b64_tr_b16 v[54:55], v14 offset:7680
    v_mfma_f32_32x32x16_bf16 v[112:127], v[24:27], v[20:23], v[112:127]
    v_mfma_f32_32x32x16_bf16 v[128:143], v[28:31], v[20:23], v[128:143]
    v_mfma_f32_32x32x16_bf16 v[144:159], v[32:35], v[20:23], v[144:159]
    s_waitcnt vmcnt(10) lgkmcnt(0)
    s_barrier
    s_add_u32 s78, s78, 1
    v_mfma_f32_32x32x16_bf16 v[64:79], v[44:47], v[36:39], v[64:79]
    ds_read_b128 v[16:19], v10 offset:20480
    ds_read_b128 v[20:23], v10 offset:22528
    ds_read_b64_tr_b16 v[24:25], v12 offset:20480
    v_mfma_f32_32x32x16_bf16 v[80:95], v[48:51], v[36:39], v[80:95]
    ds_read_b64_tr_b16 v[26:27], v12 offset:22016
    ds_read_b64_tr_b16 v[28:29], v13 offset:20480
    ds_read_b64_tr_b16 v[30:31], v13 offset:22016
    s_add_u32 m0, s75, 40960
    s_add_u32 s68, s73, 9216
    buffer_load_dwordx4 v2, s[56:59], s73 offen sc1 lds
    v_mfma_f32_32x32x16_bf16 v[96:111], v[52:55], v[36:39], v[96:111]
    ds_read_b64_tr_b16 v[32:33], v14 offset:20480
    ds_read_b64_tr_b16 v[34:35], v14 offset:22016
    s_add_u32 m0, s75, 41984
    s_add_u32 s73, s73, 64
    buffer_load_dwordx4 v2, s[56:59], s68 offen sc1 lds
    v_mfma_f32_32x32x16_bf16 v[112:127], v[44:47], v[40:43], v[112:127]
    s_add_u32 m0, s76, 40960
    s_nop 0
    buffer_load_dwordx4 v3, s[48:51], s74 offen lds
    v_mfma_f32_32x32x16_bf16 v[128:143], v[48:51], v[40:43], v[128:143]
    s_add_u32 m0, s76, 41984
    s_nop 0
    buffer_load_dwordx4 v4, s[48:51], s74 offen lds
    v_mfma_f32_32x32x16_bf16 v[144:159], v[52:55], v[40:43], v[144:159]
    s_add_u32 m0, s76, 43008
    s_nop 0
    buffer_load_dwordx4 v5, s[48:51], s74 offen lds
    s_add_u32 s74, s74, 36864
    s_waitcnt lgkmcnt(0)
    v_mfma_f32_32x32x16_bf16 v[64:79], v[24:27], v[16:19], v[64:79]
    ds_read_b128 v[36:39], v11 offset:20480
    ds_read_b128 v[40:43], v11 offset:22528
    ds_read_b64_tr_b16 v[44:45], v12 offset:26624
    v_mfma_f32_32x32x16_bf16 v[80:95], v[28:31], v[16:19], v[80:95]
    ds_read_b64_tr_b16 v[46:47], v12 offset:28160
    ds_read_b64_tr_b16 v[48:49], v13 offset:26624
    ds_read_b64_tr_b16 v[50:51], v13 offset:28160
    v_mfma_f32_32x32x16_bf16 v[96:111], v[32:35], v[16:19], v[96:111]
    ds_read_b64_tr_b16 v[52:53], v14 offset:26624
    ds_read_b64_tr_b16 v[54:55], v14 offset:28160
    v_mfma_f32_32x32x16_bf16 v[112:127], v[24:27], v[20:23], v[112:127]
    v_mfma_f32_32x32x16_bf16 v[128:143], v[28:31], v[20:23], v[128:143]
    v_mfma_f32_32x32x16_bf16 v[144:159], v[32:35], v[20:23], v[144:159]
    s_waitcnt vmcnt(10) lgkmcnt(0)
    s_barrier
    s_add_u32 s78, s78, 1
    v_mfma_f32_32x32x16_bf16 v[64:79], v[44:47], v[36:39], v[64:79]
    v_add_u32 v12, 0xffff6000, v12
    v_add_u32 v13, 0xffff6000, v13
    v_add_u32 v14, 0xffff6000, v14
    v_mfma_f32_32x32x16_bf16 v[80:95], v[48:51], v[36:39], v[80:95]
    ds_read_b128 v[16:19], v8 offset:0
    ds_read_b128 v[20:23], v8 offset:2048
    ds_read_b64_tr_b16 v[24:25], v12 offset:0
    s_add_u32 m0, s75, 61440
    s_add_u32 s68, s73, 9216
    buffer_load_dwordx4 v2, s[56:59], s73 offen sc1 lds
    v_mfma_f32_32x32x16_bf16 v[96:111], v[52:55], v[36:39], v[96:111]
    ds_read_b64_tr_b16 v[26:27], v12 offset:1536
    ds_read_b64_tr_b16 v[28:29], v13 offset:0
    ds_read_b64_tr_b16 v[30:31], v13 offset:1536
    s_add_u32 m0, s75, 62464
    s_add_u32 s73, s73, 64
    buffer_load_dwordx4 v2, s[56:59], s68 offen sc1 lds
    v_mfma_f32_32x32x16_bf16 v[112:127], v[44:47], v[40:43], v[112:127]
    ds_read_b64_tr_b16 v[32:33], v14 offset:0
    ds_read_b64_tr_b16 v[34:35], v14 offset:1536
    s_add_u32 m0, s76, 61440
    s_nop 0
    buffer_load_dwordx4 v3, s[48:51], s74 offen lds
    v_mfma_f32_32x32x16_bf16 v[128:143], v[48:51], v[40:43], v[128:143]
    s_add_u32 m0, s76, 62464
    s_nop 0
    buffer_load_dwordx4 v4, s[48:51], s74 offen lds
    v_mfma_f32_32x32x16_bf16 v[144:159], v[52:55], v[40:43], v[144:159]
    s_add_u32 m0, s76, 63488
    s_nop 0
    buffer_load_dwordx4 v5, s[48:51], s74 offen lds
    s_add_u32 s74, s74, 36864
    s_waitcnt lgkmcnt(0)
    v_mfma_f32_32x32x16_bf16 v[64:79], v[24:27], v[16:19], v[64:79]
    ds_read_b128 v[36:39], v9 offset:0
    ds_read_b128 v[40:43], v9 offset:2048
    ds_read_b64_tr_b16 v[44:45], v12 offset:6144
    v_mfma_f32_32x32x16_bf16 v[80:95], v[28:31], v[16:19], v[80:95]
    ds_read_b64_tr_b16 v[46:47], v12 offset:7680
    ds_read_b64_tr_b16 v[48:49], v13 offset:6144
    ds_read_b64_tr_b16 v[50:51], v13 offset:7680
    v_mfma_f32_32x32x16_bf16 v[96:111], v[32:35], v[16:19], v[96:111]
    ds_read_b64_tr_b16 v[52:53], v14 offset:6144
    ds_read_b64_tr_b16 v[54:55], v14 offset:7680
    v_mfma_f32_32x32x16_bf16 v[112:127], v[24:27], v[20:23], v[112:127]
    v_mfma_f32_32x32x16_bf16 v[128:143], v[28:31], v[20:23], v[128:143]
    v_mfma_f32_32x32x16_bf16 v[144:159], v[32:35], v[20:23], v[144:159]
    s_waitcnt vmcnt(10) lgkmcnt(0)
    s_barrier
    s_add_u32 s78, s78, 1
    v_mfma_f32_32x32x16_bf16 v[64:79], v[44:47], v[36:39], v[64:79]
    ds_read_b128 v[16:19], v8 offset:20480
    ds_read_b128 v[20:23], v8 offset:22528
    ds_read_b64_tr_b16 v[24:25], v12 offset:20480
    v_mfma_f32_32x32x16_bf16 v[80:95], v[48:51], v[36:39], v[80:95]
    ds_read_b64_tr_b16 v[26:27], v12 offset:22016
    ds_read_b64_tr_b16 v[28:29], v13 offset:20480
    ds_read_b64_tr_b16 v[30:31], v13 offset:22016
    s_add_u32 m0, s75, 0
    s_add_u32 s68, s73, 9216
    buffer_load_dwordx4 v2, s[56:59], s73 offen sc1 lds
    v_mfma_f32_32x32x16_bf16 v[96:111], v[52:55], v[36:39], v[96:111]
    ds_read_b64_tr_b16 v[32:33], v14 offset:20480
    ds_read_b64_tr_b16 v[34:35], v14 offset:22016
    s_add_u32 m0, s75, 1024
    s_add_u32 s73, s73, 64
    buffer_load_dwordx4 v2, s[56:59], s68 offen sc1 lds
    v_mfma_f32_32x32x16_bf16 v[112:127], v[44:47], v[40:43], v[112:127]
    s_add_u32 m0, s76, 0
    s_nop 0
    buffer_load_dwordx4 v3, s[48:51], s74 offen lds
    v_mfma_f32_32x32x16_bf16 v[128:143], v[48:51], v[40:43], v[128:143]
    s_add_u32 m0, s76, 1024
    s_nop 0
    buffer_load_dwordx4 v4, s[48:51], s74 offen lds
    v_mfma_f32_32x32x16_bf16 v[144:159], v[52:55], v[40:43], v[144:159]
    s_add_u32 m0, s76, 2048
    s_nop 0
    buffer_load_dwordx4 v5, s[48:51], s74 offen lds
    s_add_u32 s74, s74, 36864
    s_waitcnt lgkmcnt(0)
    v_mfma_f32_32x32x16_bf16 v[64:79], v[24:27], v[16:19], v[64:79]
    ds_read_b128 v[36:39], v9 offset:20480
    ds_read_b128 v[40:43], v9 offset:22528
    ds_read_b64_tr_b16 v[44:45], v12 offset:26624
    v_mfma_f32_32x32x16_bf16 v[80:95], v[28:31], v[16:19], v[80:95]
    ds_read_b64_tr_b16 v[46:47], v12 offset:28160
    ds_read_b64_tr_b16 v[48:49], v13 offset:26624
    ds_read_b64_tr_b16 v[50:51], v13 offset:28160
    v_mfma_f32_32x32x16_bf16 v[96:111], v[32:35], v[16:19], v[96:111]
    ds_read_b64_tr_b16 v[52:53], v14 offset:26624
    ds_read_b64_tr_b16 v[54:55], v14 offset:28160
    v_mfma_f32_32x32x16_bf16 v[112:127], v[24:27], v[20:23], v[112:127]
    v_mfma_f32_32x32x16_bf16 v[128:143], v[28:31], v[20:23], v[128:143]
    v_mfma_f32_32x32x16_bf16 v[144:159], v[32:35], v[20:23], v[144:159]
    s_waitcnt vmcnt(10) lgkmcnt(0)
    s_barrier
    s_add_u32 s78, s78, 1
    v_mfma_f32_32x32x16_bf16 v[64:79], v[44:47], v[36:39], v[64:79]
    v_add_u32 v12, 0xa000, v12
    v_add_u32 v13, 0xa000, v13
    v_add_u32 v14, 0xa000, v14
    v_mfma_f32_32x32x16_bf16 v[80:95], v[48:51], v[36:39], v[80:95]
    ds_read_b128 v[16:19], v10 offset:0
    ds_read_b128 v[20:23], v10 offset:2048
    ds_read_b64_tr_b16 v[24:25], v12 offset:0
    v_mfma_f32_32x32x16_bf16 v[96:111], v[52:55], v[36:39], v[96:111]
    ds_read_b64_tr_b16 v[26:27], v12 offset:1536
    ds_read_b64_tr_b16 v[28:29], v13 offset:0
    ds_read_b64_tr_b16 v[30:31], v13 offset:1536
    v_mfma_f32_32x32x16_bf16 v[112:127], v[44:47], v[40:43], v[112:127]
    ds_read_b64_tr_b16 v[32:33], v14 offset:0
    ds_read_b64_tr_b16 v[34:35], v14 offset:1536
    v_mfma_f32_32x32x16_bf16 v[128:143], v[48:51], v[40:43], v[128:143]
    v_mfma_f32_32x32x16_bf16 v[144:159], v[52:55], v[40:43], v[144:159]
    s_waitcnt lgkmcnt(0)
    v_mfma_f32_32x32x16_bf16 v[64:79], v[24:27], v[16:19], v[64:79]
    ds_read_b128 v[36:39], v11 offset:0
    ds_read_b128 v[40:43], v11 offset:2048
    ds_read_b64_tr_b16 v[44:45], v12 offset:6144
    v_mfma_f32_32x32x16_bf16 v[80:95], v[28:31], v[16:19], v[80:95]
    ds_read_b64_tr_b16 v[46:47], v12 offset:7680
    ds_read_b64_tr_b16 v[48:49], v13 offset:6144
    ds_read_b64_tr_b16 v[50:51], v13 offset:7680
    v_mfma_f32_32x32x16_bf16 v[96:111], v[32:35], v[16:19], v[96:111]
    ds_read_b64_tr_b16 v[52:53], v14 offset:6144
    ds_read_b64_tr_b16 v[54:55], v14 offset:7680
    v_mfma_f32_32x32x16_bf16 v[112:127], v[24:27], v[20:23], v[112:127]
    v_mfma_f32_32x32x16_bf16 v[128:143], v[28:31], v[20:23], v[128:143]
    v_mfma_f32_32x32x16_bf16 v[144:159], v[32:35], v[20:23], v[144:159]
    s_waitcnt vmcnt(5) lgkmcnt(0)
    s_barrier
    s_add_u32 s78, s78, 1
    v_mfma_f32_32x32x16_bf16 v[64:79], v[44:47], v[36:39], v[64:79]
    ds_read_b128 v[16:19], v10 offset:20480
    ds_read_b128 v[20:23], v10 offset:22528
    ds_read_b64_tr_b16 v[24:25], v12 offset:20480
    v_mfma_f32_32x32x16_bf16 v[80:95], v[48:51], v[36:39], v[80:95]
    ds_read_b64_tr_b16 v[26:27], v12 offset:22016
    ds_read_b64_tr_b16 v[28:29], v13 offset:20480
    ds_read_b64_tr_b16 v[30:31], v13 offset:22016
    v_mfma_f32_32x32x16_bf16 v[96:111], v[52:55], v[36:39], v[96:111]
    ds_read_b64_tr_b16 v[32:33], v14 offset:20480
    ds_read_b64_tr_b16 v[34:35], v14 offset:22016
    v_mfma_f32_32x32x16_bf16 v[112:127], v[44:47], v[40:43], v[112:127]
    v_mfma_f32_32x32x16_bf16 v[128:143], v[48:51], v[40:43], v[128:143]
    v_mfma_f32_32x32x16_bf16 v[144:159], v[52:55], v[40:43], v[144:159]
    s_waitcnt lgkmcnt(0)
    v_mfma_f32_32x32x16_bf16 v[64:79], v[24:27], v[16:19], v[64:79]
    ds_read_b128 v[36:39], v11 offset:20480
    ds_read_b128 v[40:43], v11 offset:22528
    ds_read_b64_tr_b16 v[44:45], v12 offset:26624
    v_mfma_f32_32x32x16_bf16 v[80:95], v[28:31], v[16:19], v[80:95]
    ds_read_b64_tr_b16 v[46:47], v12 offset:28160
    ds_read_b64_tr_b16 v[48:49], v13 offset:26624
    ds_read_b64_tr_b16 v[50:51], v13 offset:28160
    v_mfma_f32_32x32x16_bf16 v[96:111], v[32:35], v[16:19], v[96:111]
    ds_read_b64_tr_b16 v[52:53], v14 offset:26624
    ds_read_b64_tr_b16 v[54:55], v14 offset:28160
    v_mfma_f32_32x32x16_bf16 v[112:127], v[24:27], v[20:23], v[112:127]
    v_mfma_f32_32x32x16_bf16 v[128:143], v[28:31], v[20:23], v[128:143]
    v_mfma_f32_32x32x16_bf16 v[144:159], v[32:35], v[20:23], v[144:159]
    s_waitcnt vmcnt(0) lgkmcnt(0)
    s_barrier
    s_add_u32 s78, s78, 1
    v_mfma_f32_32x32x16_bf16 v[64:79], v[44:47], v[36:39], v[64:79]
    v_add_u32 v12, 0xffff6000, v12
    v_add_u32 v13, 0xffff6000, v13
    v_add_u32 v14, 0xffff6000, v14
    v_mfma_f32_32x32x16_bf16 v[80:95], v[48:51], v[36:39], v[80:95]
    ds_read_b128 v[16:19], v8 offset:0
    ds_read_b128 v[20:23], v8 offset:2048
    ds_read_b64_tr_b16 v[24:25], v12 offset:0
    v_mfma_f32_32x32x16_bf16 v[96:111], v[52:55], v[36:39], v[96:111]
    ds_read_b64_tr_b16 v[26:27], v12 offset:1536
    ds_read_b64_tr_b16 v[28:29], v13 offset:0
    ds_read_b64_tr_b16 v[30:31], v13 offset:1536
    v_mfma_f32_32x32x16_bf16 v[112:127], v[44:47], v[40:43], v[112:127]
    ds_read_b64_tr_b16 v[32:33], v14 offset:0
    ds_read_b64_tr_b16 v[34:35], v14 offset:1536
    v_mfma_f32_32x32x16_bf16 v[128:143], v[48:51], v[40:43], v[128:143]
    v_mfma_f32_32x32x16_bf16 v[144:159], v[52:55], v[40:43], v[144:159]
    s_waitcnt lgkmcnt(0)
    v_mfma_f32_32x32x16_bf16 v[64:79], v[24:27], v[16:19], v[64:79]
    ds_read_b128 v[36:39], v9 offset:0
    ds_read_b128 v[40:43], v9 offset:2048
    ds_read_b64_tr_b16 v[44:45], v12 offset:6144
    v_mfma_f32_32x32x16_bf16 v[80:95], v[28:31], v[16:19], v[80:95]
    ds_read_b64_tr_b16 v[46:47], v12 offset:7680
    ds_read_b64_tr_b16 v[48:49], v13 offset:6144
    ds_read_b64_tr_b16 v[50:51], v13 offset:7680
    v_mfma_f32_32x32x16_bf16 v[96:111], v[32:35], v[16:19], v[96:111]
    ds_read_b64_tr_b16 v[52:53], v14 offset:6144
    ds_read_b64_tr_b16 v[54:55], v14 offset:7680
    v_mfma_f32_32x32x16_bf16 v[112:127], v[24:27], v[20:23], v[112:127]
    v_mfma_f32_32x32x16_bf16 v[128:143], v[28:31], v[20:23], v[128:143]
    v_mfma_f32_32x32x16_bf16 v[144:159], v[32:35], v[20:23], v[144:159]
    s_waitcnt lgkmcnt(0)
    s_barrier
    s_add_u32 s78, s78, 1
    v_mfma_f32_32x32x16_bf16 v[64:79], v[44:47], v[36:39], v[64:79]
    v_mfma_f32_32x32x16_bf16 v[80:95], v[48:51], v[36:39], v[80:95]
    v_mfma_f32_32x32x16_bf16 v[96:111], v[52:55], v[36:39], v[96:111]
    v_mfma_f32_32x32x16_bf16 v[112:127], v[44:47], v[40:43], v[112:127]
    v_mfma_f32_32x32x16_bf16 v[128:143], v[48:51], v[40:43], v[128:143]
    v_mfma_f32_32x32x16_bf16 v[144:159], v[52:55], v[40:43], v[144:159]
    s_cmp_lg_u32 s64, 5
    s_cbranch_scc1 CW_198
    s_getpc_b64 s[12:13]
CWH_199:
    s_add_u32 s12, s12, L_TAIL-CWH_199
    s_addc_u32 s13, s13, 0
    v_lshlrev_b32 v250, 7, v1
    s_mov_b64 exec, 0x7fffffff
    global_load_dword v251, v250, s[12:13]
    s_mov_b64 exec, -1
CW_198:
P4B_168:
    s_barrier
    s_add_u32 s78, s78, 1
    s_cmp_lt_u32 s78, 34
    s_cbranch_scc1 P4B_168
    s_lshl_b32 s9, s70, 7
    s_add_u32 s9, s9, 34816
L_TAIL:
    s_mov_b32 s73, 57802752
    s_add_u32 m0, s76, 0
    s_nop 0
    buffer_load_dwordx4 v3, s[48:51], s74 offen lds
    s_add_u32 m0, s76, 1024
    s_nop 0
    buffer_load_dwordx4 v4, s[48:51], s74 offen lds
    s_add_u32 m0, s76, 2048
    s_nop 0
    buffer_load_dwordx4 v5, s[48:51], s74 offen lds
    s_add_u32 s74, s74, 36864
    s_add_u32 m0, s76, 20480
    s_nop 0
    buffer_load_dwordx4 v3, s[48:51], s74 offen lds
    s_add_u32 m0, s76, 21504
    s_nop 0
    buffer_load_dwordx4 v4, s[48:51], s74 offen lds
    s_add_u32 m0, s76, 22528
    s_nop 0
    buffer_load_dwordx4 v5, s[48:51], s74 offen lds
    s_add_u32 s74, s74, 36864
    s_add_u32 m0, s76, 40960
    s_nop 0
    buffer_load_dwordx4 v3, s[48:51], s74 offen lds
    s_add_u32 m0, s76, 41984
    s_nop 0
    buffer_load_dwordx4 v4, s[48:51], s74 offen lds
    s_add_u32 m0, s76, 43008
    s_nop 0
    buffer_load_dwordx4 v5, s[48:51], s74 offen lds
    s_add_u32 s74, s74, 36864
    s_add_u32 m0, s76, 61440
    s_nop 0
    buffer_load_dwordx4 v3, s[48:51], s74 offen lds
    s_add_u32 m0, s76, 62464
    s_nop 0
    buffer_load_dwordx4 v4, s[48:51], s74 offen lds
    s_add_u32 m0, s76, 63488
    s_nop 0
    buffer_load_dwordx4 v5, s[48:51], s74 offen lds
    s_add_u32 s74, s74, 36864
    v_lshlrev_b32 v58, 3, v1
    v_add_u32 v58, s9, v58
    s_mov_b32 s8, 62914560
    s_mov_b32 s10, 0
FW_201:
    buffer_load_dwordx2 v[56:57], v58, s[56:59], s8 offen offset:0 sc1
    s_waitcnt vmcnt(0)
FW_203:
    s_memrealtime s[12:13]
    s_waitcnt lgkmcnt(0)
    s_add_u32 s12, s12, 200
    s_addc_u32 s13, s13, 0
    s_mov_b64 exec, 0xffff
    v_cmp_gt_u64 vcc, s[14:15], v[56:57]
    s_cbranch_vccnz FW_204
    v_cmp_lt_u64 vcc, s[12:13], v[56:57]
    s_cbranch_vccnz FW_204
    s_branch FW_202
FW_204:
    s_mov_b64 exec, -1
    s_sleep 2
    s_and_b32 s12, s10, 31
    s_cmp_lg_u32 s12, 31
    s_cbranch_scc1 EP_205
    v_mov_b32 v56, 248
    buffer_load_dwordx2 v[56:57], v56, s[4:7], 0 offen sc1
    s_waitcnt vmcnt(0)
    v_readfirstlane_b32 s12, v56
    v_readfirstlane_b32 s13, v57
    s_nop 3
    s_not_b64 s[14:15], s[12:13]
EP_205:
    s_add_u32 s10, s10, 1
    s_cmp_lt_u32 s10, 0x80000
    s_cbranch_scc1 FW_201
FW_202:
    s_mov_b64 exec, -1
SY_200:
    s_add_u32 m0, s75, 81920
    s_add_u32 s68, s73, 9216
    buffer_load_dwordx4 v2, s[56:59], s73 offen sc1 lds
    s_add_u32 m0, s75, 82944
    s_add_u32 s73, s73, 64
    buffer_load_dwordx4 v2, s[56:59], s68 offen sc1 lds
    s_add_u32 m0, s75, 90112
    s_add_u32 s68, s73, 9216
    buffer_load_dwordx4 v2, s[56:59], s73 offen sc1 lds
    s_add_u32 m0, s75, 91136
    s_add_u32 s73, s73, 64
    buffer_load_dwordx4 v2, s[56:59], s68 offen sc1 lds
    s_add_u32 m0, s75, 98304
    s_add_u32 s68, s73, 9216
    buffer_load_dwordx4 v2, s[56:59], s73 offen sc1 lds
    s_add_u32 m0, s75, 99328
    s_add_u32 s73, s73, 64
    buffer_load_dwordx4 v2, s[56:59], s68 offen sc1 lds
    s_add_u32 m0, s75, 106496
    s_add_u32 s68, s73, 9216
    buffer_load_dwordx4 v2, s[56:59], s73 offen sc1 lds
    s_add_u32 m0, s75, 107520
    s_add_u32 s73, s73, 64
    buffer_load_dwordx4 v2, s[56:59], s68 offen sc1 lds
    s_add_u32 m0, s75, 114688
    s_add_u32 s68, s73, 9216
    buffer_load_dwordx4 v2, s[56:59], s73 offen sc1 lds
    s_add_u32 m0, s75, 115712
    s_add_u32 s73, s73, 64
    buffer_load_dwordx4 v2, s[56:59], s68 offen sc1 lds
    s_add_u32 m0, s75, 122880
    s_add_u32 s68, s73, 9216
    buffer_load_dwordx4 v2, s[56:59], s73 offen sc1 lds
    s_add_u32 m0, s75, 123904
    s_add_u32 s73, s73, 64
    buffer_load_dwordx4 v2, s[56:59], s68 offen sc1 lds
    s_add_u32 m0, s75, 131072
    s_add_u32 s68, s73, 9216
    buffer_load_dwordx4 v2, s[56:59], s73 offen sc1 lds
    s_add_u32 m0, s75, 132096
    s_add_u32 s73, s73, 64
    buffer_load_dwordx4 v2, s[56:59], s68 offen sc1 lds
    s_add_u32 m0, s75, 139264
    s_add_u32 s68, s73, 9216
    buffer_load_dwordx4 v2, s[56:59], s73 offen sc1 lds
    s_add_u32 m0, s75, 140288
    s_add_u32 s73, s73, 64
    buffer_load_dwordx4 v2, s[56:59], s68 offen sc1 lds
    s_add_u32 m0, s75, 147456
    s_add_u32 s68, s73, 9216
    buffer_load_dwordx4 v2, s[56:59], s73 offen sc1 lds
    s_add_u32 m0, s75, 148480
    s_add_u32 s73, s73, 64
    buffer_load_dwordx4 v2, s[56:59], s68 offen sc1 lds
    v_add_u32 v10, 122880, v8
    v_add_u32 v8, 81920, v8
    v_add_u32 v11, 122880, v9
    v_add_u32 v9, 81920, v9
    s_waitcnt vmcnt(0)
    s_barrier
    s_add_u32 s78, s78, 1
    ds_read_b128 v[16:19], v8 offset:0
    ds_read_b128 v[20:23], v8 offset:2048
    ds_read_b64_tr_b16 v[24:25], v12 offset:0
    ds_read_b64_tr_b16 v[26:27], v12 offset:1536
    ds_read_b64_tr_b16 v[28:29], v13 offset:0
    ds_read_b64_tr_b16 v[30:31], v13 offset:1536
    ds_read_b64_tr_b16 v[32:33], v14 offset:0
    ds_read_b64_tr_b16 v[34:35], v14 offset:1536
    s_waitcnt lgkmcnt(0)
    v_mfma_f32_32x32x16_bf16 v[64:79], v[24:27], v[16:19], v[64:79]
    ds_read_b128 v[36:39], v9 offset:0
    ds_read_b128 v[40:43], v9 offset:2048
    ds_read_b64_tr_b16 v[44:45], v12 offset:6144
    v_mfma_f32_32x32x16_bf16 v[80:95], v[28:31], v[16:19], v[80:95]
    ds_read_b64_tr_b16 v[46:47], v12 offset:7680
    ds_read_b64_tr_b16 v[48:49], v13 offset:6144
    ds_read_b64_tr_b16 v[50:51], v13 offset:7680
    v_mfma_f32_32x32x16_bf16 v[96:111], v[32:35], v[16:19], v[96:111]
    ds_read_b64_tr_b16 v[52:53], v14 offset:6144
    ds_read_b64_tr_b16 v[54:55], v14 offset:7680
    v_mfma_f32_32x32x16_bf16 v[112:127], v[24:27], v[20:23], v[112:127]
    v_mfma_f32_32x32x16_bf16 v[128:143], v[28:31], v[20:23], v[128:143]
    v_mfma_f32_32x32x16_bf16 v[144:159], v[32:35], v[20:23], v[144:159]
    s_waitcnt lgkmcnt(0)
    s_barrier
    s_add_u32 s78, s78, 1
    v_mfma_f32_32x32x16_bf16 v[64:79], v[44:47], v[36:39], v[64:79]
    ds_read_b128 v[16:19], v8 offset:8192
    ds_read_b128 v[20:23], v8 offset:10240
    ds_read_b64_tr_b16 v[24:25], v12 offset:20480
    v_mfma_f32_32x32x16_bf16 v[80:95], v[48:51], v[36:39], v[80:95]
    ds_read_b64_tr_b16 v[26:27], v12 offset:22016
    ds_read_b64_tr_b16 v[28:29], v13 offset:20480
    ds_read_b64_tr_b16 v[30:31], v13 offset:22016
    s_add_u32 m0, s76, 0
    s_nop 0
    buffer_load_dwordx4 v3, s[48:51], s74 offen lds
    v_mfma_f32_32x32x16_bf16 v[96:111], v[52:55], v[36:39], v[96:111]
    ds_read_b64_tr_b16 v[32:33], v14 offset:20480
    ds_read_b64_tr_b16 v[34:35], v14 offset:22016
    s_add_u32 m0, s76, 1024
    s_nop 0
    buffer_load_dwordx4 v4, s[48:51], s74 offen lds
    v_mfma_f32_32x32x16_bf16 v[112:127], v[44:47], v[40:43], v[112:127]
    s_add_u32 m0, s76, 2048
    s_nop 0
    buffer_load_dwordx4 v5, s[48:51], s74 offen lds
    s_add_u32 s74, s74, 36864
    v_mfma_f32_32x32x16_bf16 v[128:143], v[48:51], v[40:43], v[128:143]
    v_mfma_f32_32x32x16_bf16 v[144:159], v[52:55], v[40:43], v[144:159]
    s_waitcnt lgkmcnt(0)
    v_mfma_f32_32x32x16_bf16 v[64:79], v[24:27], v[16:19], v[64:79]
    ds_read_b128 v[36:39], v9 offset:8192
    ds_read_b128 v[40:43], v9 offset:10240
    ds_read_b64_tr_b16 v[44:45], v12 offset:26624
    v_mfma_f32_32x32x16_bf16 v[80:95], v[28:31], v[16:19], v[80:95]
    ds_read_b64_tr_b16 v[46:47], v12 offset:28160
    ds_read_b64_tr_b16 v[48:49], v13 offset:26624
    ds_read_b64_tr_b16 v[50:51], v13 offset:28160
    v_mfma_f32_32x32x16_bf16 v[96:111], v[32:35], v[16:19], v[96:111]
    ds_read_b64_tr_b16 v[52:53], v14 offset:26624
    ds_read_b64_tr_b16 v[54:55], v14 offset:28160
    v_mfma_f32_32x32x16_bf16 v[112:127], v[24:27], v[20:23], v[112:127]
    v_mfma_f32_32x32x16_bf16 v[128:143], v[28:31], v[20:23], v[128:143]
    v_mfma_f32_32x32x16_bf16 v[144:159], v[32:35], v[20:23], v[144:159]
    s_waitcnt lgkmcnt(0)
    s_barrier
    s_add_u32 s78, s78, 1
    v_mfma_f32_32x32x16_bf16 v[64:79], v[44:47], v[36:39], v[64:79]
    ds_read_b128 v[16:19], v8 offset:16384
    ds_read_b128 v[20:23], v8 offset:18432
    v_add_u32 v12, 0xa000, v12
    v_mfma_f32_32x32x16_bf16 v[80:95], v[48:51], v[36:39], v[80:95]
    v_add_u32 v13, 0xa000, v13
    v_add_u32 v14, 0xa000, v14
    ds_read_b64_tr_b16 v[24:25], v12 offset:0
    s_add_u32 m0, s76, 20480
    s_nop 0
    buffer_load_dwordx4 v3, s[48:51], s74 offen lds
    v_mfma_f32_32x32x16_bf16 v[96:111], v[52:55], v[36:39], v[96:111]
    ds_read_b64_tr_b16 v[26:27], v12 offset:1536
    ds_read_b64_tr_b16 v[28:29], v13 offset:0
    ds_read_b64_tr_b16 v[30:31], v13 offset:1536
    s_add_u32 m0, s76, 21504
    s_nop 0
    buffer_load_dwordx4 v4, s[48:51], s74 offen lds
    v_mfma_f32_32x32x16_bf16 v[112:127], v[44:47], v[40:43], v[112:127]
    ds_read_b64_tr_b16 v[32:33], v14 offset:0
    ds_read_b64_tr_b16 v[34:35], v14 offset:1536
    s_add_u32 m0, s76, 22528
    s_nop 0
    buffer_load_dwordx4 v5, s[48:51], s74 offen lds
    s_add_u32 s74, s74, 36864
    v_mfma_f32_32x32x16_bf16 v[128:143], v[48:51], v[40:43], v[128:143]
    v_mfma_f32_32x32x16_bf16 v[144:159], v[52:55], v[40:43], v[144:159]
    s_waitcnt lgkmcnt(0)
    v_mfma_f32_32x32x16_bf16 v[64:79], v[24:27], v[16:19], v[64:79]
    ds_read_b128 v[36:39], v9 offset:16384
    ds_read_b128 v[40:43], v9 offset:18432
    ds_read_b64_tr_b16 v[44:45], v12 offset:6144
    v_mfma_f32_32x32x16_bf16 v[80:95], v[28:31], v[16:19], v[80:95]
    ds_read_b64_tr_b16 v[46:47], v12 offset:7680
    ds_read_b64_tr_b16 v[48:49], v13 offset:6144
    ds_read_b64_tr_b16 v[50:51], v13 offset:7680
    v_mfma_f32_32x32x16_bf16 v[96:111], v[32:35], v[16:19], v[96:111]
    ds_read_b64_tr_b16 v[52:53], v14 offset:6144
    ds_read_b64_tr_b16 v[54:55], v14 offset:7680
    v_mfma_f32_32x32x16_bf16 v[112:127], v[24:27], v[20:23], v[112:127]
    v_mfma_f32_32x32x16_bf16 v[128:143], v[28:31], v[20:23], v[128:143]
    v_mfma_f32_32x32x16_bf16 v[144:159], v[32:35], v[20:23], v[144:159]
    s_waitcnt lgkmcnt(0)
    s_barrier
    s_add_u32 s78, s78, 1
    v_mfma_f32_32x32x16_bf16 v[64:79], v[44:47], v[36:39], v[64:79]
    ds_read_b128 v[16:19], v8 offset:24576
    ds_read_b128 v[20:23], v8 offset:26624
    ds_read_b64_tr_b16 v[24:25], v12 offset:20480
    v_mfma_f32_32x32x16_bf16 v[80:95], v[48:51], v[36:39], v[80:95]
    ds_read_b64_tr_b16 v[26:27], v12 offset:22016
    ds_read_b64_tr_b16 v[28:29], v13 offset:20480
    ds_read_b64_tr_b16 v[30:31], v13 offset:22016
    s_add_u32 m0, s76, 40960
    s_nop 0
    buffer_load_dwordx4 v3, s[48:51], s74 offen lds
    v_mfma_f32_32x32x16_bf16 v[96:111], v[52:55], v[36:39], v[96:111]
    ds_read_b64_tr_b16 v[32:33], v14 offset:20480
    ds_read_b64_tr_b16 v[34:35], v14 offset:22016
    s_add_u32 m0, s76, 41984
    s_nop 0
    buffer_load_dwordx4 v4, s[48:51], s74 offen lds
    v_mfma_f32_32x32x16_bf16 v[112:127], v[44:47], v[40:43], v[112:127]
    s_add_u32 m0, s76, 43008
    s_nop 0
    buffer_load_dwordx4 v5, s[48:51], s74 offen lds
    s_add_u32 s74, s74, 36864
    v_mfma_f32_32x32x16_bf16 v[128:143], v[48:51], v[40:43], v[128:143]
    v_mfma_f32_32x32x16_bf16 v[144:159], v[52:55], v[40:43], v[144:159]
    s_waitcnt lgkmcnt(0)
    v_mfma_f32_32x32x16_bf16 v[64:79], v[24:27], v[16:19], v[64:79]
    ds_read_b128 v[36:39], v9 offset:24576
    ds_read_b128 v[40:43], v9 offset:26624
    ds_read_b64_tr_b16 v[44:45], v12 offset:26624
    v_mfma_f32_32x32x16_bf16 v[80:95], v[28:31], v[16:19], v[80:95]
    ds_read_b64_tr_b16 v[46:47], v12 offset:28160
    ds_read_b64_tr_b16 v[48:49], v13 offset:26624
    ds_read_b64_tr_b16 v[50:51], v13 offset:28160
    v_mfma_f32_32x32x16_bf16 v[96:111], v[32:35], v[16:19], v[96:111]
    ds_read_b64_tr_b16 v[52:53], v14 offset:26624
    ds_read_b64_tr_b16 v[54:55], v14 offset:28160
    v_mfma_f32_32x32x16_bf16 v[112:127], v[24:27], v[20:23], v[112:127]
    v_mfma_f32_32x32x16_bf16 v[128:143], v[28:31], v[20:23], v[128:143]
    v_mfma_f32_32x32x16_bf16 v[144:159], v[32:35], v[20:23], v[144:159]
    s_waitcnt vmcnt(6) lgkmcnt(0)
    s_barrier
    s_add_u32 s78, s78, 1
    v_mfma_f32_32x32x16_bf16 v[64:79], v[44:47], v[36:39], v[64:79]
    ds_read_b128 v[16:19], v8 offset:32768
    ds_read_b128 v[20:23], v8 offset:34816
    v_add_u32 v12, 0xffff6000, v12
    v_mfma_f32_32x32x16_bf16 v[80:95], v[48:51], v[36:39], v[80:95]
    v_add_u32 v13, 0xffff6000, v13
    v_add_u32 v14, 0xffff6000, v14
    ds_read_b64_tr_b16 v[24:25], v12 offset:0
    s_add_u32 m0, s76, 61440
    s_nop 0
    buffer_load_dwordx4 v3, s[48:51], s74 offen lds
    v_mfma_f32_32x32x16_bf16 v[96:111], v[52:55], v[36:39], v[96:111]
    ds_read_b64_tr_b16 v[26:27], v12 offset:1536
    ds_read_b64_tr_b16 v[28:29], v13 offset:0
    ds_read_b64_tr_b16 v[30:31], v13 offset:1536
    s_add_u32 m0, s76, 62464
    s_nop 0
    buffer_load_dwordx4 v4, s[48:51], s74 offen lds
    v_mfma_f32_32x32x16_bf16 v[112:127], v[44:47], v[40:43], v[112:127]
    ds_read_b64_tr_b16 v[32:33], v14 offset:0
    ds_read_b64_tr_b16 v[34:35], v14 offset:1536
    s_add_u32 m0, s76, 63488
    s_nop 0
    buffer_load_dwordx4 v5, s[48:51], s74 offen lds
    s_add_u32 s74, s74, 36864
    v_mfma_f32_32x32x16_bf16 v[128:143], v[48:51], v[40:43], v[128:143]
    v_mfma_f32_32x32x16_bf16 v[144:159], v[52:55], v[40:43], v[144:159]
    s_waitcnt lgkmcnt(0)
    v_mfma_f32_32x32x16_bf16 v[64:79], v[24:27], v[16:19], v[64:79]
    ds_read_b128 v[36:39], v9 offset:32768
    ds_read_b128 v[40:43], v9 offset:34816
    ds_read_b64_tr_b16 v[44:45], v12 offset:6144
    v_mfma_f32_32x32x16_bf16 v[80:95], v[28:31], v[16:19], v[80:95]
    ds_read_b64_tr_b16 v[46:47], v12 offset:7680
    ds_read_b64_tr_b16 v[48:49], v13 offset:6144
    ds_read_b64_tr_b16 v[50:51], v13 offset:7680
    v_mfma_f32_32x32x16_bf16 v[96:111], v[32:35], v[16:19], v[96:111]
    ds_read_b64_tr_b16 v[52:53], v14 offset:6144
    ds_read_b64_tr_b16 v[54:55], v14 offset:7680
    v_mfma_f32_32x32x16_bf16 v[112:127], v[24:27], v[20:23], v[112:127]
    v_mfma_f32_32x32x16_bf16 v[128:143], v[28:31], v[20:23], v[128:143]
    v_mfma_f32_32x32x16_bf16 v[144:159], v[32:35], v[20:23], v[144:159]
    s_waitcnt vmcnt(6) lgkmcnt(0)
    s_barrier
    s_add_u32 s78, s78, 1
    v_mfma_f32_32x32x16_bf16 v[64:79], v[44:47], v[36:39], v[64:79]
    ds_read_b128 v[16:19], v10 offset:0
    ds_read_b128 v[20:23], v10 offset:2048
    ds_read_b64_tr_b16 v[24:25], v12 offset:20480
    v_mfma_f32_32x32x16_bf16 v[80:95], v[48:51], v[36:39], v[80:95]
    ds_read_b64_tr_b16 v[26:27], v12 offset:22016
    ds_read_b64_tr_b16 v[28:29], v13 offset:20480
    ds_read_b64_tr_b16 v[30:31], v13 offset:22016
    s_add_u32 m0, s76, 0
    s_nop 0
    buffer_load_dwordx4 v3, s[48:51], s74 offen lds
    v_mfma_f32_32x32x16_bf16 v[96:111], v[52:55], v[36:39], v[96:111]
    ds_read_b64_tr_b16 v[32:33], v14 offset:20480
    ds_read_b64_tr_b16 v[34:35], v14 offset:22016
    s_add_u32 m0, s76, 1024
    s_nop 0
    buffer_load_dwordx4 v4, s[48:51], s74 offen lds
    v_mfma_f32_32x32x16_bf16 v[112:127], v[44:47], v[40:43], v[112:127]
    s_add_u32 m0, s76, 2048
    s_nop 0
    buffer_load_dwordx4 v5, s[48:51], s74 offen lds
    s_add_u32 s74, s74, 36864
    v_mfma_f32_32x32x16_bf16 v[128:143], v[48:51], v[40:43], v[128:143]
    v_mfma_f32_32x32x16_bf16 v[144:159], v[52:55], v[40:43], v[144:159]
    s_waitcnt lgkmcnt(0)
    v_mfma_f32_32x32x16_bf16 v[64:79], v[24:27], v[16:19], v[64:79]
    ds_read_b128 v[36:39], v11 offset:0
    ds_read_b128 v[40:43], v11 offset:2048
    ds_read_b64_tr_b16 v[44:45], v12 offset:26624
    v_mfma_f32_32x32x16_bf16 v[80:95], v[28:31], v[16:19], v[80:95]
    ds_read_b64_tr_b16 v[46:47], v12 offset:28160
    ds_read_b64_tr_b16 v[48:49], v13 offset:26624
    ds_read_b64_tr_b16 v[50:51], v13 offset:28160
    v_mfma_f32_32x32x16_bf16 v[96:111], v[32:35], v[16:19], v[96:111]
    ds_read_b64_tr_b16 v[52:53], v14 offset:26624
    ds_read_b64_tr_b16 v[54:55], v14 offset:28160
    v_mfma_f32_32x32x16_bf16 v[112:127], v[24:27], v[20:23], v[112:127]
    v_mfma_f32_32x32x16_bf16 v[128:143], v[28:31], v[20:23], v[128:143]
    v_mfma_f32_32x32x16_bf16 v[144:159], v[32:35], v[20:23], v[144:159]
    s_waitcnt vmcnt(6) lgkmcnt(0)
    s_barrier
    s_add_u32 s78, s78, 1
    v_mfma_f32_32x32x16_bf16 v[64:79], v[44:47], v[36:39], v[64:79]
    ds_read_b128 v[16:19], v10 offset:8192
    ds_read_b128 v[20:23], v10 offset:10240
    v_add_u32 v12, 0xa000, v12
    v_mfma_f32_32x32x16_bf16 v[80:95], v[48:51], v[36:39], v[80:95]
    v_add_u32 v13, 0xa000, v13
    v_add_u32 v14, 0xa000, v14
    ds_read_b64_tr_b16 v[24:25], v12 offset:0
    v_mfma_f32_32x32x16_bf16 v[96:111], v[52:55], v[36:39], v[96:111]
    ds_read_b64_tr_b16 v[26:27], v12 offset:1536
    ds_read_b64_tr_b16 v[28:29], v13 offset:0
    ds_read_b64_tr_b16 v[30:31], v13 offset:1536
    v_mfma_f32_32x32x16_bf16 v[112:127], v[44:47], v[40:43], v[112:127]
    ds_read_b64_tr_b16 v[32:33], v14 offset:0
    ds_read_b64_tr_b16 v[34:35], v14 offset:1536
    v_mfma_f32_32x32x16_bf16 v[128:143], v[48:51], v[40:43], v[128:143]
    v_mfma_f32_32x32x16_bf16 v[144:159], v[52:55], v[40:43], v[144:159]
    s_waitcnt lgkmcnt(0)
    v_mfma_f32_32x32x16_bf16 v[64:79], v[24:27], v[16:19], v[64:79]
    ds_read_b128 v[36:39], v11 offset:8192
    ds_read_b128 v[40:43], v11 offset:10240
    ds_read_b64_tr_b16 v[44:45], v12 offset:6144
    v_mfma_f32_32x32x16_bf16 v[80:95], v[28:31], v[16:19], v[80:95]
    ds_read_b64_tr_b16 v[46:47], v12 offset:7680
    ds_read_b64_tr_b16 v[48:49], v13 offset:6144
    ds_read_b64_tr_b16 v[50:51], v13 offset:7680
    v_mfma_f32_32x32x16_bf16 v[96:111], v[32:35], v[16:19], v[96:111]
    ds_read_b64_tr_b16 v[52:53], v14 offset:6144
    ds_read_b64_tr_b16 v[54:55], v14 offset:7680
    v_mfma_f32_32x32x16_bf16 v[112:127], v[24:27], v[20:23], v[112:127]
    v_mfma_f32_32x32x16_bf16 v[128:143], v[28:31], v[20:23], v[128:143]
    v_mfma_f32_32x32x16_bf16 v[144:159], v[32:35], v[20:23], v[144:159]
    s_waitcnt vmcnt(3) lgkmcnt(0)
    s_barrier
    s_add_u32 s78, s78, 1
    v_mfma_f32_32x32x16_bf16 v[64:79], v[44:47], v[36:39], v[64:79]
    ds_read_b128 v[16:19], v10 offset:16384
    ds_read_b128 v[20:23], v10 offset:18432
    ds_read_b64_tr_b16 v[24:25], v12 offset:20480
    v_mfma_f32_32x32x16_bf16 v[80:95], v[48:51], v[36:39], v[80:95]
    ds_read_b64_tr_b16 v[26:27], v12 offset:22016
    ds_read_b64_tr_b16 v[28:29], v13 offset:20480
    ds_read_b64_tr_b16 v[30:31], v13 offset:22016
    v_mfma_f32_32x32x16_bf16 v[96:111], v[52:55], v[36:39], v[96:111]
    ds_read_b64_tr_b16 v[32:33], v14 offset:20480
    ds_read_b64_tr_b16 v[34:35], v14 offset:22016
    v_mfma_f32_32x32x16_bf16 v[112:127], v[44:47], v[40:43], v[112:127]
    v_mfma_f32_32x32x16_bf16 v[128:143], v[48:51], v[40:43], v[128:143]
    v_mfma_f32_32x32x16_bf16 v[144:159], v[52:55], v[40:43], v[144:159]
    s_waitcnt lgkmcnt(0)
    v_mfma_f32_32x32x16_bf16 v[64:79], v[24:27], v[16:19], v[64:79]
    ds_read_b128 v[36:39], v11 offset:16384
    ds_read_b128 v[40:43], v11 offset:18432
    ds_read_b64_tr_b16 v[44:45], v12 offset:26624
    v_mfma_f32_32x32x16_bf16 v[80:95], v[28:31], v[16:19], v[80:95]
    ds_read_b64_tr_b16 v[46:47], v12 offset:28160
    ds_read_b64_tr_b16 v[48:49], v13 offset:26624
    ds_read_b64_tr_b16 v[50:51], v13 offset:28160
    v_mfma_f32_32x32x16_bf16 v[96:111], v[32:35], v[16:19], v[96:111]
    ds_read_b64_tr_b16 v[52:53], v14 offset:26624
    ds_read_b64_tr_b16 v[54:55], v14 offset:28160
    v_mfma_f32_32x32x16_bf16 v[112:127], v[24:27], v[20:23], v[112:127]
    v_mfma_f32_32x32x16_bf16 v[128:143], v[28:31], v[20:23], v[128:143]
    v_mfma_f32_32x32x16_bf16 v[144:159], v[32:35], v[20:23], v[144:159]
    s_waitcnt vmcnt(0) lgkmcnt(0)
    s_barrier
    s_add_u32 s78, s78, 1
    v_mfma_f32_32x32x16_bf16 v[64:79], v[44:47], v[36:39], v[64:79]
    ds_read_b128 v[16:19], v10 offset:24576
    ds_read_b128 v[20:23], v10 offset:26624
    v_add_u32 v12, 0xffff6000, v12
    v_mfma_f32_32x32x16_bf16 v[80:95], v[48:51], v[36:39], v[80:95]
    v_add_u32 v13, 0xffff6000, v13
    v_add_u32 v14, 0xffff6000, v14
    ds_read_b64_tr_b16 v[24:25], v12 offset:0
    v_mfma_f32_32x32x16_bf16 v[96:111], v[52:55], v[36:39], v[96:111]
    ds_read_b64_tr_b16 v[26:27], v12 offset:1536
    ds_read_b64_tr_b16 v[28:29], v13 offset:0
    ds_read_b64_tr_b16 v[30:31], v13 offset:1536
    v_mfma_f32_32x32x16_bf16 v[112:127], v[44:47], v[40:43], v[112:127]
    ds_read_b64_tr_b16 v[32:33], v14 offset:0
    ds_read_b64_tr_b16 v[34:35], v14 offset:1536
    v_mfma_f32_32x32x16_bf16 v[128:143], v[48:51], v[40:43], v[128:143]
    v_mfma_f32_32x32x16_bf16 v[144:159], v[52:55], v[40:43], v[144:159]
    s_waitcnt lgkmcnt(0)
    v_mfma_f32_32x32x16_bf16 v[64:79], v[24:27], v[16:19], v[64:79]
    ds_read_b128 v[36:39], v11 offset:24576
    ds_read_b128 v[40:43], v11 offset:26624
    ds_read_b64_tr_b16 v[44:45], v12 offset:6144
    v_mfma_f32_32x32x16_bf16 v[80:95], v[28:31], v[16:19], v[80:95]
    ds_read_b64_tr_b16 v[46:47], v12 offset:7680
    ds_read_b64_tr_b16 v[48:49], v13 offset:6144
    ds_read_b64_tr_b16 v[50:51], v13 offset:7680
    v_mfma_f32_32x32x16_bf16 v[96:111], v[32:35], v[16:19], v[96:111]
    ds_read_b64_tr_b16 v[52:53], v14 offset:6144
    ds_read_b64_tr_b16 v[54:55], v14 offset:7680
    v_mfma_f32_32x32x16_bf16 v[112:127], v[24:27], v[20:23], v[112:127]
    v_mfma_f32_32x32x16_bf16 v[128:143], v[28:31], v[20:23], v[128:143]
    v_mfma_f32_32x32x16_bf16 v[144:159], v[32:35], v[20:23], v[144:159]
    s_waitcnt lgkmcnt(0)
    v_mfma_f32_32x32x16_bf16 v[64:79], v[44:47], v[36:39], v[64:79]
    v_mfma_f32_32x32x16_bf16 v[80:95], v[48:51], v[36:39], v[80:95]
    v_mfma_f32_32x32x16_bf16 v[96:111], v[52:55], v[36:39], v[96:111]
    v_mfma_f32_32x32x16_bf16 v[112:127], v[44:47], v[40:43], v[112:127]
    v_mfma_f32_32x32x16_bf16 v[128:143], v[48:51], v[40:43], v[128:143]
    v_mfma_f32_32x32x16_bf16 v[144:159], v[52:55], v[40:43], v[144:159]
    s_nop 15
    v_and_b32 v160, 31, v1
    s_lshl_b32 s68, s70, 7
    s_and_b32 s69, s77, 1
    s_lshl_b32 s69, s69, 6
    s_add_u32 s68, s68, s69
    v_add_u32 v160, s68, v160
    v_mul_u32_u24 v160, 2304, v160
    v_lshrrev_b32 v161, 5, v1
    v_lshl_add_u32 v160, v161, 4, v160
    s_mul_i32 s68, s71, 192
    s_lshr_b32 s69, s77, 1
    s_mul_i32 s69, s69, 96
    s_add_u32 s68, s68, s69
    s_lshl_b32 s68, s68, 1
    s_add_u32 s69, s68, 73728
    v_cvt_pk_bf16_f32 v64, v64, v65
    v_cvt_pk_bf16_f32 v65, v66, v67
    v_cvt_pk_bf16_f32 v66, v68, v69
    v_cvt_pk_bf16_f32 v67, v70, v71
    v_cvt_pk_bf16_f32 v68, v72, v73
    v_cvt_pk_bf16_f32 v69, v74, v75
    v_cvt_pk_bf16_f32 v70, v76, v77
    v_cvt_pk_bf16_f32 v71, v78, v79
    s_nop 1
    v_permlane32_swap_b32 v64, v66
    v_permlane32_swap_b32 v65, v67
    v_permlane32_swap_b32 v68, v70
    v_permlane32_swap_b32 v69, v71
    s_nop 1
    buffer_store_dwordx4 v[64:67], v160, s[52:55], s68 offen offset:0
    buffer_store_dwordx4 v[68:71], v160, s[52:55], s68 offen offset:32
    v_cvt_pk_bf16_f32 v80, v80, v81
    v_cvt_pk_bf16_f32 v81, v82, v83
    v_cvt_pk_bf16_f32 v82, v84, v85
    v_cvt_pk_bf16_f32 v83, v86, v87
    v_cvt_pk_bf16_f32 v84, v88, v89
    v_cvt_pk_bf16_f32 v85, v90, v91
    v_cvt_pk_bf16_f32 v86, v92, v93
    v_cvt_pk_bf16_f32 v87, v94, v95
    s_nop 1
    v_permlane32_swap_b32 v80, v82
    v_permlane32_swap_b32 v81, v83
    v_permlane32_swap_b32 v84, v86
    v_permlane32_swap_b32 v85, v87
    s_nop 1
    buffer_store_dwordx4 v[80:83], v160, s[52:55], s68 offen offset:64
    buffer_store_dwordx4 v[84:87], v160, s[52:55], s68 offen offset:96
    v_cvt_pk_bf16_f32 v96, v96, v97
    v_cvt_pk_bf16_f32 v97, v98, v99
    v_cvt_pk_bf16_f32 v98, v100, v101
    v_cvt_pk_bf16_f32 v99, v102, v103
    v_cvt_pk_bf16_f32 v100, v104, v105
    v_cvt_pk_bf16_f32 v101, v106, v107
    v_cvt_pk_bf16_f32 v102, v108, v109
    v_cvt_pk_bf16_f32 v103, v110, v111
    s_nop 1
    v_permlane32_swap_b32 v96, v98
    v_permlane32_swap_b32 v97, v99
    v_permlane32_swap_b32 v100, v102
    v_permlane32_swap_b32 v101, v103
    s_nop 1
    buffer_store_dwordx4 v[96:99], v160, s[52:55], s68 offen offset:128
    buffer_store_dwordx4 v[100:103], v160, s[52:55], s68 offen offset:160
    v_cvt_pk_bf16_f32 v112, v112, v113
    v_cvt_pk_bf16_f32 v113, v114, v115
    v_cvt_pk_bf16_f32 v114, v116, v117
    v_cvt_pk_bf16_f32 v115, v118, v119
    v_cvt_pk_bf16_f32 v116, v120, v121
    v_cvt_pk_bf16_f32 v117, v122, v123
    v_cvt_pk_bf16_f32 v118, v124, v125
    v_cvt_pk_bf16_f32 v119, v126, v127
    s_nop 1
    v_permlane32_swap_b32 v112, v114
    v_permlane32_swap_b32 v113, v115
    v_permlane32_swap_b32 v116, v118
    v_permlane32_swap_b32 v117, v119
    s_nop 1
    buffer_store_dwordx4 v[112:115], v160, s[52:55], s69 offen offset:0
    buffer_store_dwordx4 v[116:119], v160, s[52:55], s69 offen offset:32
    v_cvt_pk_bf16_f32 v128, v128, v129
    v_cvt_pk_bf16_f32 v129, v130, v131
    v_cvt_pk_bf16_f32 v130, v132, v133
    v_cvt_pk_bf16_f32 v131, v134, v135
    v_cvt_pk_bf16_f32 v132, v136, v137
    v_cvt_pk_bf16_f32 v133, v138, v139
    v_cvt_pk_bf16_f32 v134, v140, v141
    v_cvt_pk_bf16_f32 v135, v142, v143
    s_nop 1
    v_permlane32_swap_b32 v128, v130
    v_permlane32_swap_b32 v129, v131
    v_permlane32_swap_b32 v132, v134
    v_permlane32_swap_b32 v133, v135
    s_nop 1
    buffer_store_dwordx4 v[128:131], v160, s[52:55], s69 offen offset:64
    buffer_store_dwordx4 v[132:135], v160, s[52:55], s69 offen offset:96
    v_cvt_pk_bf16_f32 v144, v144, v145
    v_cvt_pk_bf16_f32 v145, v146, v147
    v_cvt_pk_bf16_f32 v146, v148, v149
    v_cvt_pk_bf16_f32 v147, v150, v151
    v_cvt_pk_bf16_f32 v148, v152, v153
    v_cvt_pk_bf16_f32 v149, v154, v155
    v_cvt_pk_bf16_f32 v150, v156, v157
    v_cvt_pk_bf16_f32 v151, v158, v159
    s_nop 1
    v_permlane32_swap_b32 v144, v146
    v_permlane32_swap_b32 v145, v147
    v_permlane32_swap_b32 v148, v150
    v_permlane32_swap_b32 v149, v151
    s_nop 1
    buffer_store_dwordx4 v[144:147], v160, s[52:55], s69 offen offset:128
    buffer_store_dwordx4 v[148:151], v160, s[52:55], s69 offen offset:160
P4E_151:
L_FIN:
    s_waitcnt vmcnt(0)
DONE_1:
    s_endpgm
.section .rodata,"a"
.p2align 6
.amdhsa_kernel concat_heads__grouped_kv_mqa__compressed_kv_cla__prompt_kernel
  .amdhsa_next_free_vgpr 256
  .amdhsa_next_free_sgpr 102
  .amdhsa_accum_offset 256
  .amdhsa_group_segment_fixed_size 0
  .amdhsa_kernarg_size 112
  .amdhsa_user_sgpr_count 2
  .amdhsa_user_sgpr_kernarg_segment_ptr 1
  .amdhsa_system_sgpr_workgroup_id_x 1
.end_amdhsa_kernel
```
